```python
import torch

def _softmax(x, axis=-1):
    return torch.softmax(x, dim=axis)

def _gelu(x):
    return torch.nn.functional.gelu(x, approximate='tanh')

def _silu(x):
    return torch.nn.functional.silu(x)

def _sigmoid(x):
    return torch.sigmoid(x)

def _layernorm(x, axis=-1, eps=1e-05):
    m = x.mean(dim=axis, keepdim=True)
    v = x.var(dim=axis, keepdim=True, unbiased=False)
    return (x - m) / torch.sqrt(v + eps)

def _scatter_add(tgt, idx, src, axis=0):
    return tgt.clone().index_add_(axis, idx, src)

def _segment_sum(src, seg, n):
    out = torch.zeros((n,) + src.shape[1:], dtype=src.dtype)
    return out.index_add_(0, seg, src)

def _pad(x, pw):
    flat = tuple((v for pair in reversed(pw) for v in pair))
    return torch.nn.functional.pad(x, flat)
kernel_name = 'parallel_sum__memory_aug_recurrent_mem_tr__glu_gated_reglu__prompt'

def setup_inputs():

    _w = lambda a: (lambda t: t.to(torch.bfloat16) if t.is_floating_point() else t)(torch.as_tensor(a))

    def _A_setup():
        B, S, Dm = (1, 2048, 640)
        H, Dh = (32, 128)
        M, seg = (8, 32)
        seg = min(seg, S)
        S = S // seg * seg
        return {'x': _w((lambda *s: torch.randn(*s, dtype=torch.bfloat16) * 0.05)(B, S, Dm)), 'mem0': _w((lambda *s: torch.randn(*s, dtype=torch.bfloat16) * 0.2)(B, M, Dm)), 'Wq': _w((lambda *s: torch.randn(*s, dtype=torch.bfloat16) * 1.6)(Dm, H, Dh) * Dm ** (-0.5)), 'Wk': _w((lambda *s: torch.randn(*s, dtype=torch.bfloat16) * 1.6)(Dm, H, Dh) * Dm ** (-0.5)), 'Wv': _w((lambda *s: torch.randn(*s, dtype=torch.bfloat16) * 0.2)(Dm, H, Dh) * Dm ** (-0.5)), 'Wo': _w((lambda *s: torch.randn(*s, dtype=torch.bfloat16) * 0.2)(H, Dh, Dm) * (H * Dh) ** (-0.5)), 'seg_len': seg}
    _A_in = _A_setup()

    def _B_setup():
        B, S, D, F = (1, 2048, 640, 1728)
        return {'x': _w((lambda *s: torch.randn(*s, dtype=torch.bfloat16) * 0.05)(B, S, D)), 'W_gate': _w((lambda *s: torch.randn(*s, dtype=torch.bfloat16) * 0.2)(D, F) * (2.0 / D) ** 0.5), 'W_up': _w((lambda *s: torch.randn(*s, dtype=torch.bfloat16) * 0.2)(D, F) * (2.0 / D) ** 0.5), 'W_down': _w((lambda *s: torch.randn(*s, dtype=torch.bfloat16) * 0.2)(F, D) * (1.0 / F) ** 0.5)}
    _B_in = _B_setup()
    return {'A_x': _A_in['x'], 'A_mem0': _A_in['mem0'], 'A_Wq': _A_in['Wq'], 'A_Wk': _A_in['Wk'], 'A_Wv': _A_in['Wv'], 'A_Wo': _A_in['Wo'], 'A_seg_len': _A_in['seg_len'], 'B_x': _B_in['x'], 'B_W_gate': _B_in['W_gate'], 'B_W_up': _B_in['W_up'], 'B_W_down': _B_in['W_down']}

def reference(A_x, A_mem0, A_Wq, A_Wk, A_Wv, A_Wo, A_seg_len, B_x, B_W_gate, B_W_up, B_W_down):

    def _A_ref(x, mem0, Wq, Wk, Wv, Wo, seg_len):
        B, S, Dm = x.shape
        H, Dh = (Wq.shape[1], Wq.shape[2])
        M = mem0.shape[1]
        scale = Dh ** (-0.5)
        n_seg = S // seg_len
        L = M + seg_len
        idx = torch.arange(L)
        mask = (idx[:, None] < M) | (idx[:, None] >= idx[None, :])
        mem = mem0
        outs = []
        for s in range(n_seg):
            xs = x[:, s * seg_len:(s + 1) * seg_len, :].clone()
            h = torch.concatenate([mem, xs], axis=1)
            q = torch.einsum('btd,dhe->bhte', h, Wq)
            k = torch.einsum('btd,dhe->bhte', h, Wk)
            v = torch.einsum('btd,dhe->bhte', h, Wv)
            scores = torch.einsum('bhqe,bhke->bhqk', q, k) * scale
            scores = torch.where(mask[None, None], scores, -1000000000.0)
            p = _softmax(scores, axis=-1)
            o = torch.einsum('bhqk,bhke->bhqe', p, v)
            o = torch.einsum('bhte,hed->btd', o, Wo)
            mem = o[:, :M, :].clone()
            outs.append(o[:, M:, :])
        return torch.concatenate(outs, axis=1)

    def _B_ref(x, W_gate, W_up, W_down):
        gate = torch.einsum('bsd,df->bsf', x, W_gate)
        up = torch.einsum('bsd,df->bsf', x, W_up)
        gate = gate * (lambda x, dt: x.to(dt))(gate > 0, gate.dtype)
        h = gate * up
        return torch.einsum('bsf,fd->bsd', h, W_down)
    x = A_x
    xn = _layernorm(x, axis=-1)
    return x + _A_ref(xn, A_mem0, A_Wq, A_Wk, A_Wv, A_Wo, A_seg_len) + _B_ref(xn, B_W_gate, B_W_up, B_W_down)
```

```asm
; @launch kernel=main_kernel grid=(256,1,1) block=(256,1,1) lds=163840
.amdgcn_target "amdgcn-amd-amdhsa--gfx950"
.text
.globl main_kernel
.p2align 8
.type main_kernel,@function
main_kernel:
    s_cmp_ge_u32 s2, 256
    s_cbranch_scc1 K_END0
    s_load_dwordx2 s[4:5], s[0:1], 96
    s_load_dwordx2 s[8:9], s[0:1], 104
    s_load_dwordx2 s[12:13], s[0:1], 0
    s_load_dwordx2 s[80:81], s[0:1], 16
    s_load_dwordx2 s[84:85], s[0:1], 24
    s_load_dwordx2 s[88:89], s[0:1], 32
    s_load_dwordx2 s[92:93], s[0:1], 64
    s_load_dwordx2 s[96:97], s[0:1], 72
    s_mov_b32 s6, 256
    s_mov_b32 s7, 0x20000
    s_mov_b32 s10, 268435456
    s_mov_b32 s11, 0x20000
    s_mov_b32 s14, 2621440
    s_mov_b32 s15, 0x20000
    s_mov_b32 s82, 5242880
    s_mov_b32 s83, 0x20000
    s_mov_b32 s86, 5242880
    s_mov_b32 s87, 0x20000
    s_mov_b32 s90, 5242880
    s_mov_b32 s91, 0x20000
    s_mov_b32 s94, 2211840
    s_mov_b32 s95, 0x20000
    s_mov_b32 s98, 2211840
    s_mov_b32 s99, 0x20000
    s_waitcnt lgkmcnt(0)
    v_lshrrev_b32 v1, 6, v0
    s_nop 0
    v_readfirstlane_b32 s17, v1
K_NS:
    s_mov_b32 s79, 0
    s_mov_b32 s3, 0
    s_getreg_b32 s16, hwreg(HW_REG_XCC_ID)
    s_and_b32 s16, s16, 15
    s_mov_b32 s18, 32
    s_mov_b32 s19, 0
    s_cmp_eq_u32 s16, 1
    s_cbranch_scc1 K_TK
    s_mov_b32 s19, 1
    s_cmp_eq_u32 s16, 3
    s_cbranch_scc0 K_REG
K_TK:
    s_lshl_b32 s28, s19, 2
    s_barrier
    v_mov_b32 v14, s28
    v_mov_b32 v15, 1
    v_mov_b32 v13, 163832
    s_cmp_eq_u32 s17, 0
    s_cbranch_scc0 K_T1
    s_mov_b64 exec, 1
    global_atomic_add v12, v14, v15, s[4:5] offset:0 sc0
    s_waitcnt vmcnt(0)
    ds_write_b32 v13, v12
    s_waitcnt lgkmcnt(0)
    s_mov_b64 exec, -1
K_T1:
    s_barrier
    ds_read_b32 v12, v13
    s_waitcnt lgkmcnt(0)
    v_readfirstlane_b32 s18, v12
K_REG:
    s_nop 0
    s_cmp_ge_u32 s18, 32
    s_cbranch_scc1 K_WORK
    s_cmp_eq_u32 s18, 31
    s_cbranch_scc0 K_NF
    s_lshl_b32 s28, s19, 2
    v_mov_b32 v14, 0
    v_mov_b32 v15, 33
    buffer_store_dword v15, v14, s[4:7], s28 offen offset:144 sc1
K_NF:
    s_mov_b32 s71, 1
    s_branch K_TEAM
K_END0:
    s_endpgm
K_WORK:
    s_barrier
    v_mov_b32 v14, 0
    v_mov_b32 v15, 1
    v_mov_b32 v13, 163832
    s_cmp_eq_u32 s17, 0
    s_cbranch_scc0 K_T0
    s_mov_b64 exec, 1
    global_atomic_add v12, v14, v15, s[4:5] offset:132 sc0
    s_waitcnt vmcnt(0)
    ds_write_b32 v13, v12
    s_waitcnt lgkmcnt(0)
    s_mov_b64 exec, -1
K_T0:
    s_barrier
    ds_read_b32 v12, v13
    s_waitcnt lgkmcnt(0)
    v_readfirstlane_b32 s18, v12
    s_nop 0
    s_mov_b32 s71, s18
    s_cmp_lt_u32 s18, 2
    s_cbranch_scc1 K_MISC
    s_cmp_ge_u32 s18, 160
    s_cbranch_scc1 K_LN2
    s_cmp_ge_u32 s18, 146
    s_cbranch_scc1 K_INI
    s_cmp_ge_u32 s18, 18
    s_cbranch_scc1 K_PD
    s_sub_u32 s70, s71, 2
    s_branch K_LN
K_LN2:
    s_sub_u32 s70, 207, s71
K_LN:
    s_load_dwordx2 s[12:13], s[0:1], 0
    s_mov_b32 s14, 2621440
    s_mov_b32 s15, 0x20000
    s_waitcnt lgkmcnt(0)
    s_lshl_b32 s19, s70, 2
    s_add_u32 s19, s19, s17
    v_and_b32 v2, 63, v0
    v_lshrrev_b32 v3, 4, v2
    v_and_b32 v4, 15, v2
    s_lshl_b32 s28, s19, 2
    v_add_u32 v5, s28, v3
    v_mul_u32_u24 v6, 1280, v5
    v_lshl_add_u32 v6, v4, 4, v6
    buffer_load_dwordx4 v[16:19], v6, s[12:15], 0 offen offset:0
    buffer_load_dwordx4 v[20:23], v6, s[12:15], 0 offen offset:256
    buffer_load_dwordx4 v[24:27], v6, s[12:15], 0 offen offset:512
    buffer_load_dwordx4 v[28:31], v6, s[12:15], 0 offen offset:768
    buffer_load_dwordx4 v[32:35], v6, s[12:15], 0 offen offset:1024
    v_lshrrev_b32 v7, 5, v5
    v_mul_u32_u24 v7, 40960, v7
    v_lshrrev_b32 v8, 1, v4
    v_lshl_add_u32 v7, v8, 10, v7
    v_and_b32 v8, 1, v4
    v_lshl_add_u32 v7, v8, 9, v7
    v_and_b32 v8, 31, v5
    v_lshl_add_u32 v7, v8, 4, v7
    s_waitcnt vmcnt(4)
    v_lshlrev_b32 v40, 16, v16
    v_and_b32 v41, 0xffff0000, v16
    v_lshlrev_b32 v42, 16, v17
    v_and_b32 v43, 0xffff0000, v17
    v_lshlrev_b32 v44, 16, v18
    v_and_b32 v45, 0xffff0000, v18
    v_lshlrev_b32 v46, 16, v19
    v_and_b32 v47, 0xffff0000, v19
    s_waitcnt vmcnt(3)
    v_lshlrev_b32 v48, 16, v20
    v_and_b32 v49, 0xffff0000, v20
    v_lshlrev_b32 v50, 16, v21
    v_and_b32 v51, 0xffff0000, v21
    v_lshlrev_b32 v52, 16, v22
    v_and_b32 v53, 0xffff0000, v22
    v_lshlrev_b32 v54, 16, v23
    v_and_b32 v55, 0xffff0000, v23
    s_waitcnt vmcnt(2)
    v_lshlrev_b32 v56, 16, v24
    v_and_b32 v57, 0xffff0000, v24
    v_lshlrev_b32 v58, 16, v25
    v_and_b32 v59, 0xffff0000, v25
    v_lshlrev_b32 v60, 16, v26
    v_and_b32 v61, 0xffff0000, v26
    v_lshlrev_b32 v62, 16, v27
    v_and_b32 v63, 0xffff0000, v27
    s_waitcnt vmcnt(1)
    v_lshlrev_b32 v64, 16, v28
    v_and_b32 v65, 0xffff0000, v28
    v_lshlrev_b32 v66, 16, v29
    v_and_b32 v67, 0xffff0000, v29
    v_lshlrev_b32 v68, 16, v30
    v_and_b32 v69, 0xffff0000, v30
    v_lshlrev_b32 v70, 16, v31
    v_and_b32 v71, 0xffff0000, v31
    s_waitcnt vmcnt(0)
    v_lshlrev_b32 v72, 16, v32
    v_and_b32 v73, 0xffff0000, v32
    v_lshlrev_b32 v74, 16, v33
    v_and_b32 v75, 0xffff0000, v33
    v_lshlrev_b32 v76, 16, v34
    v_and_b32 v77, 0xffff0000, v34
    v_lshlrev_b32 v78, 16, v35
    v_and_b32 v79, 0xffff0000, v35
    v_add_f32 v10, v40, v44
    v_add_f32 v11, v41, v45
    v_add_f32 v12, v42, v46
    v_add_f32 v13, v43, v47
    v_add_f32 v10, v10, v48
    v_add_f32 v11, v11, v49
    v_add_f32 v12, v12, v50
    v_add_f32 v13, v13, v51
    v_add_f32 v10, v10, v52
    v_add_f32 v11, v11, v53
    v_add_f32 v12, v12, v54
    v_add_f32 v13, v13, v55
    v_add_f32 v10, v10, v56
    v_add_f32 v11, v11, v57
    v_add_f32 v12, v12, v58
    v_add_f32 v13, v13, v59
    v_add_f32 v10, v10, v60
    v_add_f32 v11, v11, v61
    v_add_f32 v12, v12, v62
    v_add_f32 v13, v13, v63
    v_add_f32 v10, v10, v64
    v_add_f32 v11, v11, v65
    v_add_f32 v12, v12, v66
    v_add_f32 v13, v13, v67
    v_add_f32 v10, v10, v68
    v_add_f32 v11, v11, v69
    v_add_f32 v12, v12, v70
    v_add_f32 v13, v13, v71
    v_add_f32 v10, v10, v72
    v_add_f32 v11, v11, v73
    v_add_f32 v12, v12, v74
    v_add_f32 v13, v13, v75
    v_add_f32 v10, v10, v76
    v_add_f32 v11, v11, v77
    v_add_f32 v12, v12, v78
    v_add_f32 v13, v13, v79
    v_add_f32 v10, v10, v11
    v_add_f32 v12, v12, v13
    v_add_f32 v10, v10, v12
    s_nop 1
    v_add_f32_dpp v10, v10, v10 quad_perm:[1,0,3,2] row_mask:0xf bank_mask:0xf
    s_nop 1
    v_add_f32_dpp v10, v10, v10 quad_perm:[2,3,0,1] row_mask:0xf bank_mask:0xf
    s_nop 1
    v_add_f32_dpp v10, v10, v10 row_half_mirror row_mask:0xf bank_mask:0xf
    s_nop 1
    v_add_f32_dpp v10, v10, v10 row_mirror row_mask:0xf bank_mask:0xf
    v_mul_f32 v9, 0x3acccccd, v10
    v_mov_b32 v10, 0
    v_mov_b32 v11, 0
    v_mov_b32 v12, 0
    v_mov_b32 v13, 0
    v_sub_f32 v80, v40, v9
    v_fmac_f32 v10, v80, v80
    v_sub_f32 v81, v41, v9
    v_fmac_f32 v11, v81, v81
    v_sub_f32 v82, v42, v9
    v_fmac_f32 v12, v82, v82
    v_sub_f32 v83, v43, v9
    v_fmac_f32 v13, v83, v83
    v_sub_f32 v84, v44, v9
    v_fmac_f32 v10, v84, v84
    v_sub_f32 v85, v45, v9
    v_fmac_f32 v11, v85, v85
    v_sub_f32 v86, v46, v9
    v_fmac_f32 v12, v86, v86
    v_sub_f32 v87, v47, v9
    v_fmac_f32 v13, v87, v87
    v_sub_f32 v80, v48, v9
    v_fmac_f32 v10, v80, v80
    v_sub_f32 v81, v49, v9
    v_fmac_f32 v11, v81, v81
    v_sub_f32 v82, v50, v9
    v_fmac_f32 v12, v82, v82
    v_sub_f32 v83, v51, v9
    v_fmac_f32 v13, v83, v83
    v_sub_f32 v84, v52, v9
    v_fmac_f32 v10, v84, v84
    v_sub_f32 v85, v53, v9
    v_fmac_f32 v11, v85, v85
    v_sub_f32 v86, v54, v9
    v_fmac_f32 v12, v86, v86
    v_sub_f32 v87, v55, v9
    v_fmac_f32 v13, v87, v87
    v_sub_f32 v80, v56, v9
    v_fmac_f32 v10, v80, v80
    v_sub_f32 v81, v57, v9
    v_fmac_f32 v11, v81, v81
    v_sub_f32 v82, v58, v9
    v_fmac_f32 v12, v82, v82
    v_sub_f32 v83, v59, v9
    v_fmac_f32 v13, v83, v83
    v_sub_f32 v84, v60, v9
    v_fmac_f32 v10, v84, v84
    v_sub_f32 v85, v61, v9
    v_fmac_f32 v11, v85, v85
    v_sub_f32 v86, v62, v9
    v_fmac_f32 v12, v86, v86
    v_sub_f32 v87, v63, v9
    v_fmac_f32 v13, v87, v87
    v_sub_f32 v80, v64, v9
    v_fmac_f32 v10, v80, v80
    v_sub_f32 v81, v65, v9
    v_fmac_f32 v11, v81, v81
    v_sub_f32 v82, v66, v9
    v_fmac_f32 v12, v82, v82
    v_sub_f32 v83, v67, v9
    v_fmac_f32 v13, v83, v83
    v_sub_f32 v84, v68, v9
    v_fmac_f32 v10, v84, v84
    v_sub_f32 v85, v69, v9
    v_fmac_f32 v11, v85, v85
    v_sub_f32 v86, v70, v9
    v_fmac_f32 v12, v86, v86
    v_sub_f32 v87, v71, v9
    v_fmac_f32 v13, v87, v87
    v_sub_f32 v80, v72, v9
    v_fmac_f32 v10, v80, v80
    v_sub_f32 v81, v73, v9
    v_fmac_f32 v11, v81, v81
    v_sub_f32 v82, v74, v9
    v_fmac_f32 v12, v82, v82
    v_sub_f32 v83, v75, v9
    v_fmac_f32 v13, v83, v83
    v_sub_f32 v84, v76, v9
    v_fmac_f32 v10, v84, v84
    v_sub_f32 v85, v77, v9
    v_fmac_f32 v11, v85, v85
    v_sub_f32 v86, v78, v9
    v_fmac_f32 v12, v86, v86
    v_sub_f32 v87, v79, v9
    v_fmac_f32 v13, v87, v87
    v_add_f32 v10, v10, v11
    v_add_f32 v12, v12, v13
    v_add_f32 v10, v10, v12
    s_nop 1
    v_add_f32_dpp v10, v10, v10 quad_perm:[1,0,3,2] row_mask:0xf bank_mask:0xf
    s_nop 1
    v_add_f32_dpp v10, v10, v10 quad_perm:[2,3,0,1] row_mask:0xf bank_mask:0xf
    s_nop 1
    v_add_f32_dpp v10, v10, v10 row_half_mirror row_mask:0xf bank_mask:0xf
    s_nop 1
    v_add_f32_dpp v10, v10, v10 row_mirror row_mask:0xf bank_mask:0xf
    v_mul_f32 v10, 0x3acccccd, v10
    v_cvt_pk_bf16_f32 v10, v10, v10
    v_and_b32 v10, 0xffff0000, v10
    v_add_f32 v10, 0x3727c5ac, v10
    v_cvt_pk_bf16_f32 v10, v10, v10
    v_and_b32 v10, 0xffff0000, v10
    v_sqrt_f32 v10, v10
    s_nop 0
    v_cvt_pk_bf16_f32 v10, v10, v10
    v_and_b32 v10, 0xffff0000, v10
    v_rcp_f32 v11, v10
    v_cvt_pk_bf16_f32 v9, v9, v9
    v_and_b32 v9, 0xffff0000, v9
    v_fma_f32 v12, -v10, v11, 1.0
    v_fma_f32 v11, v12, v11, v11
    v_sub_f32 v40, v40, v9
    v_sub_f32 v41, v41, v9
    v_cvt_pk_bf16_f32 v16, v40, v41
    v_sub_f32 v42, v42, v9
    v_sub_f32 v43, v43, v9
    v_cvt_pk_bf16_f32 v17, v42, v43
    v_sub_f32 v44, v44, v9
    v_sub_f32 v45, v45, v9
    v_cvt_pk_bf16_f32 v18, v44, v45
    v_sub_f32 v46, v46, v9
    v_sub_f32 v47, v47, v9
    v_cvt_pk_bf16_f32 v19, v46, v47
    v_sub_f32 v48, v48, v9
    v_sub_f32 v49, v49, v9
    v_cvt_pk_bf16_f32 v20, v48, v49
    v_sub_f32 v50, v50, v9
    v_sub_f32 v51, v51, v9
    v_cvt_pk_bf16_f32 v21, v50, v51
    v_sub_f32 v52, v52, v9
    v_sub_f32 v53, v53, v9
    v_cvt_pk_bf16_f32 v22, v52, v53
    v_sub_f32 v54, v54, v9
    v_sub_f32 v55, v55, v9
    v_cvt_pk_bf16_f32 v23, v54, v55
    v_sub_f32 v56, v56, v9
    v_sub_f32 v57, v57, v9
    v_cvt_pk_bf16_f32 v24, v56, v57
    v_sub_f32 v58, v58, v9
    v_sub_f32 v59, v59, v9
    v_cvt_pk_bf16_f32 v25, v58, v59
    v_sub_f32 v60, v60, v9
    v_sub_f32 v61, v61, v9
    v_cvt_pk_bf16_f32 v26, v60, v61
    v_sub_f32 v62, v62, v9
    v_sub_f32 v63, v63, v9
    v_cvt_pk_bf16_f32 v27, v62, v63
    v_sub_f32 v64, v64, v9
    v_sub_f32 v65, v65, v9
    v_cvt_pk_bf16_f32 v28, v64, v65
    v_sub_f32 v66, v66, v9
    v_sub_f32 v67, v67, v9
    v_cvt_pk_bf16_f32 v29, v66, v67
    v_sub_f32 v68, v68, v9
    v_sub_f32 v69, v69, v9
    v_cvt_pk_bf16_f32 v30, v68, v69
    v_sub_f32 v70, v70, v9
    v_sub_f32 v71, v71, v9
    v_cvt_pk_bf16_f32 v31, v70, v71
    v_sub_f32 v72, v72, v9
    v_sub_f32 v73, v73, v9
    v_cvt_pk_bf16_f32 v32, v72, v73
    v_sub_f32 v74, v74, v9
    v_sub_f32 v75, v75, v9
    v_cvt_pk_bf16_f32 v33, v74, v75
    v_sub_f32 v76, v76, v9
    v_sub_f32 v77, v77, v9
    v_cvt_pk_bf16_f32 v34, v76, v77
    v_sub_f32 v78, v78, v9
    v_sub_f32 v79, v79, v9
    v_cvt_pk_bf16_f32 v35, v78, v79
    v_lshlrev_b32 v40, 16, v16
    v_and_b32 v41, 0xffff0000, v16
    v_lshlrev_b32 v42, 16, v17
    v_and_b32 v43, 0xffff0000, v17
    v_lshlrev_b32 v44, 16, v18
    v_and_b32 v45, 0xffff0000, v18
    v_lshlrev_b32 v46, 16, v19
    v_and_b32 v47, 0xffff0000, v19
    v_lshlrev_b32 v48, 16, v20
    v_and_b32 v49, 0xffff0000, v20
    v_lshlrev_b32 v50, 16, v21
    v_and_b32 v51, 0xffff0000, v21
    v_lshlrev_b32 v52, 16, v22
    v_and_b32 v53, 0xffff0000, v22
    v_lshlrev_b32 v54, 16, v23
    v_and_b32 v55, 0xffff0000, v23
    v_lshlrev_b32 v56, 16, v24
    v_and_b32 v57, 0xffff0000, v24
    v_lshlrev_b32 v58, 16, v25
    v_and_b32 v59, 0xffff0000, v25
    v_lshlrev_b32 v60, 16, v26
    v_and_b32 v61, 0xffff0000, v26
    v_lshlrev_b32 v62, 16, v27
    v_and_b32 v63, 0xffff0000, v27
    v_lshlrev_b32 v64, 16, v28
    v_and_b32 v65, 0xffff0000, v28
    v_lshlrev_b32 v66, 16, v29
    v_and_b32 v67, 0xffff0000, v29
    v_lshlrev_b32 v68, 16, v30
    v_and_b32 v69, 0xffff0000, v30
    v_lshlrev_b32 v70, 16, v31
    v_and_b32 v71, 0xffff0000, v31
    v_lshlrev_b32 v72, 16, v32
    v_and_b32 v73, 0xffff0000, v32
    v_lshlrev_b32 v74, 16, v33
    v_and_b32 v75, 0xffff0000, v33
    v_lshlrev_b32 v76, 16, v34
    v_and_b32 v77, 0xffff0000, v34
    v_lshlrev_b32 v78, 16, v35
    v_and_b32 v79, 0xffff0000, v35
    v_mul_f32 v40, v40, v11
    v_mul_f32 v41, v41, v11
    v_mul_f32 v42, v42, v11
    v_mul_f32 v43, v43, v11
    v_mul_f32 v44, v44, v11
    v_mul_f32 v45, v45, v11
    v_mul_f32 v46, v46, v11
    v_mul_f32 v47, v47, v11
    v_mul_f32 v48, v48, v11
    v_mul_f32 v49, v49, v11
    v_mul_f32 v50, v50, v11
    v_mul_f32 v51, v51, v11
    v_mul_f32 v52, v52, v11
    v_mul_f32 v53, v53, v11
    v_mul_f32 v54, v54, v11
    v_mul_f32 v55, v55, v11
    v_mul_f32 v56, v56, v11
    v_mul_f32 v57, v57, v11
    v_mul_f32 v58, v58, v11
    v_mul_f32 v59, v59, v11
    v_mul_f32 v60, v60, v11
    v_mul_f32 v61, v61, v11
    v_mul_f32 v62, v62, v11
    v_mul_f32 v63, v63, v11
    v_mul_f32 v64, v64, v11
    v_mul_f32 v65, v65, v11
    v_mul_f32 v66, v66, v11
    v_mul_f32 v67, v67, v11
    v_mul_f32 v68, v68, v11
    v_mul_f32 v69, v69, v11
    v_mul_f32 v70, v70, v11
    v_mul_f32 v71, v71, v11
    v_mul_f32 v72, v72, v11
    v_mul_f32 v73, v73, v11
    v_mul_f32 v74, v74, v11
    v_mul_f32 v75, v75, v11
    v_mul_f32 v76, v76, v11
    v_mul_f32 v77, v77, v11
    v_mul_f32 v78, v78, v11
    v_mul_f32 v79, v79, v11
    v_cvt_pk_bf16_f32 v16, v40, v41
    v_cvt_pk_bf16_f32 v17, v42, v43
    v_cvt_pk_bf16_f32 v18, v44, v45
    v_cvt_pk_bf16_f32 v19, v46, v47
    v_cvt_pk_bf16_f32 v20, v48, v49
    v_cvt_pk_bf16_f32 v21, v50, v51
    v_cvt_pk_bf16_f32 v22, v52, v53
    v_cvt_pk_bf16_f32 v23, v54, v55
    v_cvt_pk_bf16_f32 v24, v56, v57
    v_cvt_pk_bf16_f32 v25, v58, v59
    v_cvt_pk_bf16_f32 v26, v60, v61
    v_cvt_pk_bf16_f32 v27, v62, v63
    v_cvt_pk_bf16_f32 v28, v64, v65
    v_cvt_pk_bf16_f32 v29, v66, v67
    v_cvt_pk_bf16_f32 v30, v68, v69
    v_cvt_pk_bf16_f32 v31, v70, v71
    v_cvt_pk_bf16_f32 v32, v72, v73
    v_cvt_pk_bf16_f32 v33, v74, v75
    v_cvt_pk_bf16_f32 v34, v76, v77
    v_cvt_pk_bf16_f32 v35, v78, v79
    s_mov_b32 s28, 88080384
    buffer_store_dwordx4 v[16:19], v7, s[8:11], s28 offen sc1
    s_add_u32 s28, s28, 8192
    buffer_store_dwordx4 v[20:23], v7, s[8:11], s28 offen sc1
    s_add_u32 s28, s28, 8192
    buffer_store_dwordx4 v[24:27], v7, s[8:11], s28 offen sc1
    s_add_u32 s28, s28, 8192
    buffer_store_dwordx4 v[28:31], v7, s[8:11], s28 offen sc1
    s_add_u32 s28, s28, 8192
    buffer_store_dwordx4 v[32:35], v7, s[8:11], s28 offen sc1
    s_lshr_b32 s28, s70, 4
    s_lshl_b32 s28, s28, 2
    s_add_u32 s28, s28, 48
    s_cmp_lt_u32 s70, 16
    s_cselect_b32 s76, 17, 16
    s_waitcnt vmcnt(0)
    s_barrier
    s_cmp_eq_u32 s17, 0
    s_cbranch_scc0 K_LA
    v_mov_b32 v14, 0
    v_mov_b32 v15, 1
    s_mov_b64 exec, 1
    buffer_atomic_add v15, v14, s[4:7], s28 offen sc0
    s_waitcnt vmcnt(0)
    v_add_u32 v15, 1, v15
    s_nop 0
    v_readfirstlane_b32 s29, v15
    s_nop 0
    s_cmp_eq_u32 s29, s76
    s_cbranch_scc0 K_LA_N
    buffer_store_dword v15, v14, s[4:7], s28 offen offset:128 sc1
K_LA_N:
    s_mov_b64 exec, -1
K_LA:
    s_branch K_G0
K_PD:
    s_sub_u32 s18, s18, 18
    v_and_b32 v20, 63, v0
    v_lshlrev_b32 v2, 4, v20
    v_and_b32 v21, 0x33, v20
    v_bfe_u32 v22, v20, 2, 1
    v_lshl_or_b32 v21, v22, 3, v21
    v_bfe_u32 v22, v20, 3, 1
    v_lshl_or_b32 v21, v22, 2, v21
    s_lshr_b32 s28, s17, 1
    s_lshl_b32 s28, s28, 14
    v_lshlrev_b32 v22, 4, v21
    v_add_u32 v3, s28, v22
    v_lshrrev_b32 v22, 5, v20
    v_bfe_u32 v23, v20, 2, 2
    v_lshl_add_u32 v24, v22, 3, v23
    v_lshlrev_b32 v24, 7, v24
    v_bfe_u32 v25, v20, 4, 1
    v_lshl_add_u32 v24, v25, 5, v24
    v_and_b32 v25, 1, v20
    v_lshl_add_u32 v24, v25, 4, v24
    v_bfe_u32 v25, v20, 1, 1
    v_lshl_add_u32 v24, v25, 3, v24
    v_lshrrev_b32 v25, 1, v23
    v_lshl_add_u32 v24, v25, 6, v24
    s_and_b32 s28, s17, 1
    s_lshl_b32 s28, s28, 14
    s_add_u32 s28, s28, 32768
    v_add_u32 v4, s28, v24
    v_xor_b32 v5, 64, v4
    v_lshrrev_b32 v24, 3, v20
    v_and_b32 v25, 7, v20
    v_bfe_u32 v26, v20, 4, 1
    v_lshlrev_b32 v26, 2, v26
    v_xor_b32 v25, v25, v26
    v_lshlrev_b32 v25, 4, v25
    v_lshl_add_u32 v6, v24, 13, v25
    v_mul_u32_u24 v24, 3456, v24
    v_add_u32 v7, v24, v25
    v_and_b32 v23, 31, v21
    v_bfe_u32 v24, v23, 2, 1
    v_lshlrev_b32 v24, 12, v24
    v_lshrrev_b32 v25, 3, v23
    v_lshlrev_b32 v25, 2, v25
    v_and_b32 v26, 3, v23
    v_add_u32 v25, v25, v26
    v_lshl_add_u32 v25, v22, 4, v25
    v_lshl_add_u32 v8, v25, 4, v24
    v_and_b32 v24, 1, v23
    v_lshlrev_b32 v24, 10, v24
    v_lshrrev_b32 v25, 1, v23
    v_lshl_add_u32 v25, v22, 4, v25
    v_lshl_add_u32 v9, v25, 4, v24
    v_lshlrev_b32 v10, 4, v21
    s_mov_b32 s75, 0x20000
    s_mov_b32 s74, 5242880
    s_cmp_lt_u32 s18, 64
    s_cselect_b64 s[72:73], s[84:85], s[88:89]
    s_and_b32 s24, s18, 63
    s_lshl_b32 s24, s24, 7
    s_mul_i32 s28, s17, 1310720
    s_add_u32 s24, s24, s28
    s_mul_i32 s27, s17, 20480
    s_add_u32 m0, s27, 0
    s_add_u32 s28, s24, 0
    buffer_load_dwordx4 v6, s[72:75], s28 offen offset:0 lds
    s_add_u32 s28, s24, 64512
    buffer_load_dwordx4 v6, s[72:75], s28 offen offset:1024 lds
    s_add_u32 s28, s24, 129024
    buffer_load_dwordx4 v6, s[72:75], s28 offen offset:2048 lds
    s_add_u32 s28, s24, 193536
    buffer_load_dwordx4 v6, s[72:75], s28 offen offset:3072 lds
    s_add_u32 m0, s27, 4096
    s_add_u32 s28, s24, 262144
    buffer_load_dwordx4 v6, s[72:75], s28 offen offset:0 lds
    s_add_u32 s28, s24, 326656
    buffer_load_dwordx4 v6, s[72:75], s28 offen offset:1024 lds
    s_add_u32 s28, s24, 391168
    buffer_load_dwordx4 v6, s[72:75], s28 offen offset:2048 lds
    s_add_u32 s28, s24, 455680
    buffer_load_dwordx4 v6, s[72:75], s28 offen offset:3072 lds
    s_add_u32 m0, s27, 8192
    s_add_u32 s28, s24, 524288
    buffer_load_dwordx4 v6, s[72:75], s28 offen offset:0 lds
    s_add_u32 s28, s24, 588800
    buffer_load_dwordx4 v6, s[72:75], s28 offen offset:1024 lds
    s_add_u32 s28, s24, 653312
    buffer_load_dwordx4 v6, s[72:75], s28 offen offset:2048 lds
    s_add_u32 s28, s24, 717824
    buffer_load_dwordx4 v6, s[72:75], s28 offen offset:3072 lds
    s_add_u32 m0, s27, 12288
    s_add_u32 s28, s24, 786432
    buffer_load_dwordx4 v6, s[72:75], s28 offen offset:0 lds
    s_add_u32 s28, s24, 850944
    buffer_load_dwordx4 v6, s[72:75], s28 offen offset:1024 lds
    s_add_u32 s28, s24, 915456
    buffer_load_dwordx4 v6, s[72:75], s28 offen offset:2048 lds
    s_add_u32 s28, s24, 979968
    buffer_load_dwordx4 v6, s[72:75], s28 offen offset:3072 lds
    s_add_u32 m0, s27, 16384
    s_add_u32 s28, s24, 1048576
    buffer_load_dwordx4 v6, s[72:75], s28 offen offset:0 lds
    s_add_u32 s28, s24, 1113088
    buffer_load_dwordx4 v6, s[72:75], s28 offen offset:1024 lds
    s_add_u32 s28, s24, 1177600
    buffer_load_dwordx4 v6, s[72:75], s28 offen offset:2048 lds
    s_add_u32 s28, s24, 1242112
    buffer_load_dwordx4 v6, s[72:75], s28 offen offset:3072 lds
K_PN:
    s_mov_b32 s28, 176
    s_waitcnt vmcnt(0)
    s_cmp_eq_u32 s17, 0
    s_cbranch_scc0 K_WP_OK
    v_mov_b32 v14, 0
K_WP:
    buffer_load_dword v15, v14, s[4:7], s28 offen sc1
    s_add_u32 s3, s3, 1
    s_cmp_gt_u32 s3, 2000000
    s_cbranch_scc1 K_END
    s_waitcnt vmcnt(0)
    v_readfirstlane_b32 s29, v15
    s_nop 0
    s_cmp_ge_u32 s29, 1
    s_cbranch_scc1 K_WP_OK
    s_sleep 2
    s_branch K_WP
K_WP_OK:
    s_barrier
    s_mov_b32 s19, 0
K_PJ:
    v_and_b32 v12, 0x7ff, v4
    v_xor_b32 v49, 64, v12
    v_add_u32 v50, 40960, v12
    v_add_u32 v48, 40960, v49
    v_and_b32 v13, 0x3ff, v3
    s_add_u32 s22, s19, s17
    s_mul_i32 s23, s22, 40960
    s_add_u32 s23, s23, 88080384
    s_add_u32 s28, s23, 0
    buffer_load_dwordx4 v[96:99], v13, s[8:11], s28 offen offset:0 sc1
    buffer_load_dwordx4 v[100:103], v13, s[8:11], s28 offen offset:1024 sc1
    buffer_load_dwordx4 v[104:107], v13, s[8:11], s28 offen offset:2048 sc1
    buffer_load_dwordx4 v[108:111], v13, s[8:11], s28 offen offset:3072 sc1
    s_add_u32 s28, s23, 4096
    buffer_load_dwordx4 v[112:115], v13, s[8:11], s28 offen offset:0 sc1
    buffer_load_dwordx4 v[116:119], v13, s[8:11], s28 offen offset:1024 sc1
    buffer_load_dwordx4 v[120:123], v13, s[8:11], s28 offen offset:2048 sc1
    buffer_load_dwordx4 v[124:127], v13, s[8:11], s28 offen offset:3072 sc1
    s_add_u32 s28, s23, 8192
    buffer_load_dwordx4 v[128:131], v13, s[8:11], s28 offen offset:0 sc1
    buffer_load_dwordx4 v[132:135], v13, s[8:11], s28 offen offset:1024 sc1
    buffer_load_dwordx4 v[136:139], v13, s[8:11], s28 offen offset:2048 sc1
    buffer_load_dwordx4 v[140:143], v13, s[8:11], s28 offen offset:3072 sc1
    s_add_u32 s28, s23, 12288
    buffer_load_dwordx4 v[144:147], v13, s[8:11], s28 offen offset:0 sc1
    buffer_load_dwordx4 v[148:151], v13, s[8:11], s28 offen offset:1024 sc1
    buffer_load_dwordx4 v[152:155], v13, s[8:11], s28 offen offset:2048 sc1
    buffer_load_dwordx4 v[156:159], v13, s[8:11], s28 offen offset:3072 sc1
    s_add_u32 s28, s23, 16384
    buffer_load_dwordx4 v[160:163], v13, s[8:11], s28 offen offset:0 sc1
    buffer_load_dwordx4 v[164:167], v13, s[8:11], s28 offen offset:1024 sc1
    buffer_load_dwordx4 v[168:171], v13, s[8:11], s28 offen offset:2048 sc1
    buffer_load_dwordx4 v[172:175], v13, s[8:11], s28 offen offset:3072 sc1
    s_add_u32 s28, s23, 20480
    buffer_load_dwordx4 v[176:179], v13, s[8:11], s28 offen offset:0 sc1
    buffer_load_dwordx4 v[180:183], v13, s[8:11], s28 offen offset:1024 sc1
    buffer_load_dwordx4 v[184:187], v13, s[8:11], s28 offen offset:2048 sc1
    buffer_load_dwordx4 v[188:191], v13, s[8:11], s28 offen offset:3072 sc1
    s_add_u32 s28, s23, 24576
    buffer_load_dwordx4 v[192:195], v13, s[8:11], s28 offen offset:0 sc1
    buffer_load_dwordx4 v[196:199], v13, s[8:11], s28 offen offset:1024 sc1
    buffer_load_dwordx4 v[200:203], v13, s[8:11], s28 offen offset:2048 sc1
    buffer_load_dwordx4 v[204:207], v13, s[8:11], s28 offen offset:3072 sc1
    s_add_u32 s28, s23, 28672
    buffer_load_dwordx4 v[208:211], v13, s[8:11], s28 offen offset:0 sc1
    buffer_load_dwordx4 v[212:215], v13, s[8:11], s28 offen offset:1024 sc1
    buffer_load_dwordx4 v[216:219], v13, s[8:11], s28 offen offset:2048 sc1
    buffer_load_dwordx4 v[220:223], v13, s[8:11], s28 offen offset:3072 sc1
    s_add_u32 s28, s23, 32768
    buffer_load_dwordx4 v[224:227], v13, s[8:11], s28 offen offset:0 sc1
    buffer_load_dwordx4 v[228:231], v13, s[8:11], s28 offen offset:1024 sc1
    buffer_load_dwordx4 v[232:235], v13, s[8:11], s28 offen offset:2048 sc1
    buffer_load_dwordx4 v[236:239], v13, s[8:11], s28 offen offset:3072 sc1
    s_add_u32 s28, s23, 36864
    buffer_load_dwordx4 v[240:243], v13, s[8:11], s28 offen offset:0 sc1
    buffer_load_dwordx4 v[244:247], v13, s[8:11], s28 offen offset:1024 sc1
    buffer_load_dwordx4 v[248:251], v13, s[8:11], s28 offen offset:2048 sc1
    buffer_load_dwordx4 v[252:255], v13, s[8:11], s28 offen offset:3072 sc1
    ds_read_b64_tr_b16 v[16:17], v12 offset:0
    ds_read_b64_tr_b16 v[18:19], v12 offset:512
    ds_read_b64_tr_b16 v[20:21], v49 offset:0
    ds_read_b64_tr_b16 v[22:23], v49 offset:512
    ds_read_b64_tr_b16 v[24:25], v12 offset:2048
    ds_read_b64_tr_b16 v[26:27], v12 offset:2560
    ds_read_b64_tr_b16 v[28:29], v49 offset:2048
    ds_read_b64_tr_b16 v[30:31], v49 offset:2560
    ds_read_b64_tr_b16 v[32:33], v12 offset:4096
    ds_read_b64_tr_b16 v[34:35], v12 offset:4608
    ds_read_b64_tr_b16 v[36:37], v49 offset:4096
    ds_read_b64_tr_b16 v[38:39], v49 offset:4608
    s_cmp_ge_u32 s18, 64
    s_cbranch_scc1 P_V
    s_waitcnt vmcnt(39) lgkmcnt(10)
    v_mfma_f32_32x32x16_bf16 v[64:79], v[16:19], v[96:99], 0
    ds_read_b64_tr_b16 v[40:41], v12 offset:6144
    ds_read_b64_tr_b16 v[42:43], v12 offset:6656
    s_waitcnt lgkmcnt(10)
    v_mfma_f32_32x32x16_bf16 v[80:95], v[20:23], v[96:99], 0
    ds_read_b64_tr_b16 v[44:45], v49 offset:6144
    ds_read_b64_tr_b16 v[46:47], v49 offset:6656
    s_waitcnt vmcnt(38) lgkmcnt(10)
    v_mfma_f32_32x32x16_bf16 v[64:79], v[24:27], v[100:103], v[64:79]
    ds_read_b64_tr_b16 v[16:17], v12 offset:8192
    ds_read_b64_tr_b16 v[18:19], v12 offset:8704
    s_waitcnt lgkmcnt(10)
    v_mfma_f32_32x32x16_bf16 v[80:95], v[28:31], v[100:103], v[80:95]
    ds_read_b64_tr_b16 v[20:21], v49 offset:8192
    ds_read_b64_tr_b16 v[22:23], v49 offset:8704
    s_waitcnt vmcnt(37) lgkmcnt(10)
    v_mfma_f32_32x32x16_bf16 v[64:79], v[32:35], v[104:107], v[64:79]
    ds_read_b64_tr_b16 v[24:25], v12 offset:10240
    ds_read_b64_tr_b16 v[26:27], v12 offset:10752
    s_waitcnt lgkmcnt(10)
    v_mfma_f32_32x32x16_bf16 v[80:95], v[36:39], v[104:107], v[80:95]
    ds_read_b64_tr_b16 v[28:29], v49 offset:10240
    ds_read_b64_tr_b16 v[30:31], v49 offset:10752
    s_waitcnt vmcnt(36) lgkmcnt(10)
    v_mfma_f32_32x32x16_bf16 v[64:79], v[40:43], v[108:111], v[64:79]
    ds_read_b64_tr_b16 v[32:33], v12 offset:12288
    ds_read_b64_tr_b16 v[34:35], v12 offset:12800
    s_waitcnt lgkmcnt(10)
    v_mfma_f32_32x32x16_bf16 v[80:95], v[44:47], v[108:111], v[80:95]
    ds_read_b64_tr_b16 v[36:37], v49 offset:12288
    ds_read_b64_tr_b16 v[38:39], v49 offset:12800
    s_waitcnt vmcnt(35) lgkmcnt(10)
    v_mfma_f32_32x32x16_bf16 v[64:79], v[16:19], v[112:115], v[64:79]
    ds_read_b64_tr_b16 v[40:41], v12 offset:14336
    ds_read_b64_tr_b16 v[42:43], v12 offset:14848
    s_waitcnt lgkmcnt(10)
    v_mfma_f32_32x32x16_bf16 v[80:95], v[20:23], v[112:115], v[80:95]
    ds_read_b64_tr_b16 v[44:45], v49 offset:14336
    ds_read_b64_tr_b16 v[46:47], v49 offset:14848
    s_waitcnt vmcnt(34) lgkmcnt(10)
    v_mfma_f32_32x32x16_bf16 v[64:79], v[24:27], v[116:119], v[64:79]
    ds_read_b64_tr_b16 v[16:17], v12 offset:16384
    ds_read_b64_tr_b16 v[18:19], v12 offset:16896
    s_waitcnt lgkmcnt(10)
    v_mfma_f32_32x32x16_bf16 v[80:95], v[28:31], v[116:119], v[80:95]
    ds_read_b64_tr_b16 v[20:21], v49 offset:16384
    ds_read_b64_tr_b16 v[22:23], v49 offset:16896
    s_waitcnt vmcnt(33) lgkmcnt(10)
    v_mfma_f32_32x32x16_bf16 v[64:79], v[32:35], v[120:123], v[64:79]
    ds_read_b64_tr_b16 v[24:25], v12 offset:18432
    ds_read_b64_tr_b16 v[26:27], v12 offset:18944
    s_waitcnt lgkmcnt(10)
    v_mfma_f32_32x32x16_bf16 v[80:95], v[36:39], v[120:123], v[80:95]
    ds_read_b64_tr_b16 v[28:29], v49 offset:18432
    ds_read_b64_tr_b16 v[30:31], v49 offset:18944
    s_waitcnt vmcnt(32) lgkmcnt(10)
    v_mfma_f32_32x32x16_bf16 v[64:79], v[40:43], v[124:127], v[64:79]
    ds_read_b64_tr_b16 v[32:33], v12 offset:20480
    ds_read_b64_tr_b16 v[34:35], v12 offset:20992
    s_waitcnt lgkmcnt(10)
    v_mfma_f32_32x32x16_bf16 v[80:95], v[44:47], v[124:127], v[80:95]
    ds_read_b64_tr_b16 v[36:37], v49 offset:20480
    ds_read_b64_tr_b16 v[38:39], v49 offset:20992
    s_waitcnt vmcnt(31) lgkmcnt(10)
    v_mfma_f32_32x32x16_bf16 v[64:79], v[16:19], v[128:131], v[64:79]
    ds_read_b64_tr_b16 v[40:41], v12 offset:22528
    ds_read_b64_tr_b16 v[42:43], v12 offset:23040
    s_waitcnt lgkmcnt(10)
    v_mfma_f32_32x32x16_bf16 v[80:95], v[20:23], v[128:131], v[80:95]
    ds_read_b64_tr_b16 v[44:45], v49 offset:22528
    ds_read_b64_tr_b16 v[46:47], v49 offset:23040
    s_waitcnt vmcnt(30) lgkmcnt(10)
    v_mfma_f32_32x32x16_bf16 v[64:79], v[24:27], v[132:135], v[64:79]
    ds_read_b64_tr_b16 v[16:17], v12 offset:24576
    ds_read_b64_tr_b16 v[18:19], v12 offset:25088
    s_waitcnt lgkmcnt(10)
    v_mfma_f32_32x32x16_bf16 v[80:95], v[28:31], v[132:135], v[80:95]
    ds_read_b64_tr_b16 v[20:21], v49 offset:24576
    ds_read_b64_tr_b16 v[22:23], v49 offset:25088
    s_waitcnt vmcnt(29) lgkmcnt(10)
    v_mfma_f32_32x32x16_bf16 v[64:79], v[32:35], v[136:139], v[64:79]
    ds_read_b64_tr_b16 v[24:25], v12 offset:26624
    ds_read_b64_tr_b16 v[26:27], v12 offset:27136
    s_waitcnt lgkmcnt(10)
    v_mfma_f32_32x32x16_bf16 v[80:95], v[36:39], v[136:139], v[80:95]
    ds_read_b64_tr_b16 v[28:29], v49 offset:26624
    ds_read_b64_tr_b16 v[30:31], v49 offset:27136
    s_waitcnt vmcnt(28) lgkmcnt(10)
    v_mfma_f32_32x32x16_bf16 v[64:79], v[40:43], v[140:143], v[64:79]
    ds_read_b64_tr_b16 v[32:33], v12 offset:28672
    ds_read_b64_tr_b16 v[34:35], v12 offset:29184
    s_waitcnt lgkmcnt(10)
    v_mfma_f32_32x32x16_bf16 v[80:95], v[44:47], v[140:143], v[80:95]
    ds_read_b64_tr_b16 v[36:37], v49 offset:28672
    ds_read_b64_tr_b16 v[38:39], v49 offset:29184
    s_waitcnt vmcnt(27) lgkmcnt(10)
    v_mfma_f32_32x32x16_bf16 v[64:79], v[16:19], v[144:147], v[64:79]
    ds_read_b64_tr_b16 v[40:41], v12 offset:30720
    ds_read_b64_tr_b16 v[42:43], v12 offset:31232
    s_waitcnt lgkmcnt(10)
    v_mfma_f32_32x32x16_bf16 v[80:95], v[20:23], v[144:147], v[80:95]
    ds_read_b64_tr_b16 v[44:45], v49 offset:30720
    ds_read_b64_tr_b16 v[46:47], v49 offset:31232
    s_waitcnt vmcnt(26) lgkmcnt(10)
    v_mfma_f32_32x32x16_bf16 v[64:79], v[24:27], v[148:151], v[64:79]
    ds_read_b64_tr_b16 v[16:17], v12 offset:32768
    ds_read_b64_tr_b16 v[18:19], v12 offset:33280
    s_waitcnt lgkmcnt(10)
    v_mfma_f32_32x32x16_bf16 v[80:95], v[28:31], v[148:151], v[80:95]
    ds_read_b64_tr_b16 v[20:21], v49 offset:32768
    ds_read_b64_tr_b16 v[22:23], v49 offset:33280
    s_waitcnt vmcnt(25) lgkmcnt(10)
    v_mfma_f32_32x32x16_bf16 v[64:79], v[32:35], v[152:155], v[64:79]
    ds_read_b64_tr_b16 v[24:25], v12 offset:34816
    ds_read_b64_tr_b16 v[26:27], v12 offset:35328
    s_waitcnt lgkmcnt(10)
    v_mfma_f32_32x32x16_bf16 v[80:95], v[36:39], v[152:155], v[80:95]
    ds_read_b64_tr_b16 v[28:29], v49 offset:34816
    ds_read_b64_tr_b16 v[30:31], v49 offset:35328
    s_waitcnt vmcnt(24) lgkmcnt(10)
    v_mfma_f32_32x32x16_bf16 v[64:79], v[40:43], v[156:159], v[64:79]
    ds_read_b64_tr_b16 v[32:33], v12 offset:36864
    ds_read_b64_tr_b16 v[34:35], v12 offset:37376
    s_waitcnt lgkmcnt(10)
    v_mfma_f32_32x32x16_bf16 v[80:95], v[44:47], v[156:159], v[80:95]
    ds_read_b64_tr_b16 v[36:37], v49 offset:36864
    ds_read_b64_tr_b16 v[38:39], v49 offset:37376
    s_waitcnt vmcnt(23) lgkmcnt(10)
    v_mfma_f32_32x32x16_bf16 v[64:79], v[16:19], v[160:163], v[64:79]
    ds_read_b64_tr_b16 v[40:41], v12 offset:38912
    ds_read_b64_tr_b16 v[42:43], v12 offset:39424
    s_waitcnt lgkmcnt(10)
    v_mfma_f32_32x32x16_bf16 v[80:95], v[20:23], v[160:163], v[80:95]
    ds_read_b64_tr_b16 v[44:45], v49 offset:38912
    ds_read_b64_tr_b16 v[46:47], v49 offset:39424
    s_waitcnt vmcnt(22) lgkmcnt(10)
    v_mfma_f32_32x32x16_bf16 v[64:79], v[24:27], v[164:167], v[64:79]
    ds_read_b64_tr_b16 v[16:17], v50 offset:0
    ds_read_b64_tr_b16 v[18:19], v50 offset:512
    s_waitcnt lgkmcnt(10)
    v_mfma_f32_32x32x16_bf16 v[80:95], v[28:31], v[164:167], v[80:95]
    ds_read_b64_tr_b16 v[20:21], v48 offset:0
    ds_read_b64_tr_b16 v[22:23], v48 offset:512
    s_waitcnt vmcnt(21) lgkmcnt(10)
    v_mfma_f32_32x32x16_bf16 v[64:79], v[32:35], v[168:171], v[64:79]
    ds_read_b64_tr_b16 v[24:25], v50 offset:2048
    ds_read_b64_tr_b16 v[26:27], v50 offset:2560
    s_waitcnt lgkmcnt(10)
    v_mfma_f32_32x32x16_bf16 v[80:95], v[36:39], v[168:171], v[80:95]
    ds_read_b64_tr_b16 v[28:29], v48 offset:2048
    ds_read_b64_tr_b16 v[30:31], v48 offset:2560
    s_waitcnt vmcnt(20) lgkmcnt(10)
    v_mfma_f32_32x32x16_bf16 v[64:79], v[40:43], v[172:175], v[64:79]
    ds_read_b64_tr_b16 v[32:33], v50 offset:4096
    ds_read_b64_tr_b16 v[34:35], v50 offset:4608
    s_waitcnt lgkmcnt(10)
    v_mfma_f32_32x32x16_bf16 v[80:95], v[44:47], v[172:175], v[80:95]
    ds_read_b64_tr_b16 v[36:37], v48 offset:4096
    ds_read_b64_tr_b16 v[38:39], v48 offset:4608
    s_waitcnt vmcnt(19) lgkmcnt(10)
    v_mfma_f32_32x32x16_bf16 v[64:79], v[16:19], v[176:179], v[64:79]
    ds_read_b64_tr_b16 v[40:41], v50 offset:6144
    ds_read_b64_tr_b16 v[42:43], v50 offset:6656
    s_waitcnt lgkmcnt(10)
    v_mfma_f32_32x32x16_bf16 v[80:95], v[20:23], v[176:179], v[80:95]
    ds_read_b64_tr_b16 v[44:45], v48 offset:6144
    ds_read_b64_tr_b16 v[46:47], v48 offset:6656
    s_waitcnt vmcnt(18) lgkmcnt(10)
    v_mfma_f32_32x32x16_bf16 v[64:79], v[24:27], v[180:183], v[64:79]
    ds_read_b64_tr_b16 v[16:17], v50 offset:8192
    ds_read_b64_tr_b16 v[18:19], v50 offset:8704
    s_waitcnt lgkmcnt(10)
    v_mfma_f32_32x32x16_bf16 v[80:95], v[28:31], v[180:183], v[80:95]
    ds_read_b64_tr_b16 v[20:21], v48 offset:8192
    ds_read_b64_tr_b16 v[22:23], v48 offset:8704
    s_waitcnt vmcnt(17) lgkmcnt(10)
    v_mfma_f32_32x32x16_bf16 v[64:79], v[32:35], v[184:187], v[64:79]
    ds_read_b64_tr_b16 v[24:25], v50 offset:10240
    ds_read_b64_tr_b16 v[26:27], v50 offset:10752
    s_waitcnt lgkmcnt(10)
    v_mfma_f32_32x32x16_bf16 v[80:95], v[36:39], v[184:187], v[80:95]
    ds_read_b64_tr_b16 v[28:29], v48 offset:10240
    ds_read_b64_tr_b16 v[30:31], v48 offset:10752
    s_waitcnt vmcnt(16) lgkmcnt(10)
    v_mfma_f32_32x32x16_bf16 v[64:79], v[40:43], v[188:191], v[64:79]
    ds_read_b64_tr_b16 v[32:33], v50 offset:12288
    ds_read_b64_tr_b16 v[34:35], v50 offset:12800
    s_waitcnt lgkmcnt(10)
    v_mfma_f32_32x32x16_bf16 v[80:95], v[44:47], v[188:191], v[80:95]
    ds_read_b64_tr_b16 v[36:37], v48 offset:12288
    ds_read_b64_tr_b16 v[38:39], v48 offset:12800
    s_waitcnt vmcnt(15) lgkmcnt(10)
    v_mfma_f32_32x32x16_bf16 v[64:79], v[16:19], v[192:195], v[64:79]
    ds_read_b64_tr_b16 v[40:41], v50 offset:14336
    ds_read_b64_tr_b16 v[42:43], v50 offset:14848
    s_waitcnt lgkmcnt(10)
    v_mfma_f32_32x32x16_bf16 v[80:95], v[20:23], v[192:195], v[80:95]
    ds_read_b64_tr_b16 v[44:45], v48 offset:14336
    ds_read_b64_tr_b16 v[46:47], v48 offset:14848
    s_waitcnt vmcnt(14) lgkmcnt(10)
    v_mfma_f32_32x32x16_bf16 v[64:79], v[24:27], v[196:199], v[64:79]
    ds_read_b64_tr_b16 v[16:17], v50 offset:16384
    ds_read_b64_tr_b16 v[18:19], v50 offset:16896
    s_waitcnt lgkmcnt(10)
    v_mfma_f32_32x32x16_bf16 v[80:95], v[28:31], v[196:199], v[80:95]
    ds_read_b64_tr_b16 v[20:21], v48 offset:16384
    ds_read_b64_tr_b16 v[22:23], v48 offset:16896
    s_waitcnt vmcnt(13) lgkmcnt(10)
    v_mfma_f32_32x32x16_bf16 v[64:79], v[32:35], v[200:203], v[64:79]
    ds_read_b64_tr_b16 v[24:25], v50 offset:18432
    ds_read_b64_tr_b16 v[26:27], v50 offset:18944
    s_waitcnt lgkmcnt(10)
    v_mfma_f32_32x32x16_bf16 v[80:95], v[36:39], v[200:203], v[80:95]
    ds_read_b64_tr_b16 v[28:29], v48 offset:18432
    ds_read_b64_tr_b16 v[30:31], v48 offset:18944
    s_waitcnt vmcnt(12) lgkmcnt(10)
    v_mfma_f32_32x32x16_bf16 v[64:79], v[40:43], v[204:207], v[64:79]
    ds_read_b64_tr_b16 v[32:33], v50 offset:20480
    ds_read_b64_tr_b16 v[34:35], v50 offset:20992
    s_waitcnt lgkmcnt(10)
    v_mfma_f32_32x32x16_bf16 v[80:95], v[44:47], v[204:207], v[80:95]
    ds_read_b64_tr_b16 v[36:37], v48 offset:20480
    ds_read_b64_tr_b16 v[38:39], v48 offset:20992
    s_waitcnt vmcnt(11) lgkmcnt(10)
    v_mfma_f32_32x32x16_bf16 v[64:79], v[16:19], v[208:211], v[64:79]
    ds_read_b64_tr_b16 v[40:41], v50 offset:22528
    ds_read_b64_tr_b16 v[42:43], v50 offset:23040
    s_waitcnt lgkmcnt(10)
    v_mfma_f32_32x32x16_bf16 v[80:95], v[20:23], v[208:211], v[80:95]
    ds_read_b64_tr_b16 v[44:45], v48 offset:22528
    ds_read_b64_tr_b16 v[46:47], v48 offset:23040
    s_waitcnt vmcnt(10) lgkmcnt(10)
    v_mfma_f32_32x32x16_bf16 v[64:79], v[24:27], v[212:215], v[64:79]
    ds_read_b64_tr_b16 v[16:17], v50 offset:24576
    ds_read_b64_tr_b16 v[18:19], v50 offset:25088
    s_waitcnt lgkmcnt(10)
    v_mfma_f32_32x32x16_bf16 v[80:95], v[28:31], v[212:215], v[80:95]
    ds_read_b64_tr_b16 v[20:21], v48 offset:24576
    ds_read_b64_tr_b16 v[22:23], v48 offset:25088
    s_waitcnt vmcnt(9) lgkmcnt(10)
    v_mfma_f32_32x32x16_bf16 v[64:79], v[32:35], v[216:219], v[64:79]
    ds_read_b64_tr_b16 v[24:25], v50 offset:26624
    ds_read_b64_tr_b16 v[26:27], v50 offset:27136
    s_waitcnt lgkmcnt(10)
    v_mfma_f32_32x32x16_bf16 v[80:95], v[36:39], v[216:219], v[80:95]
    ds_read_b64_tr_b16 v[28:29], v48 offset:26624
    ds_read_b64_tr_b16 v[30:31], v48 offset:27136
    s_waitcnt vmcnt(8) lgkmcnt(10)
    v_mfma_f32_32x32x16_bf16 v[64:79], v[40:43], v[220:223], v[64:79]
    ds_read_b64_tr_b16 v[32:33], v50 offset:28672
    ds_read_b64_tr_b16 v[34:35], v50 offset:29184
    s_waitcnt lgkmcnt(10)
    v_mfma_f32_32x32x16_bf16 v[80:95], v[44:47], v[220:223], v[80:95]
    ds_read_b64_tr_b16 v[36:37], v48 offset:28672
    ds_read_b64_tr_b16 v[38:39], v48 offset:29184
    s_waitcnt vmcnt(7) lgkmcnt(10)
    v_mfma_f32_32x32x16_bf16 v[64:79], v[16:19], v[224:227], v[64:79]
    ds_read_b64_tr_b16 v[40:41], v50 offset:30720
    ds_read_b64_tr_b16 v[42:43], v50 offset:31232
    s_waitcnt lgkmcnt(10)
    v_mfma_f32_32x32x16_bf16 v[80:95], v[20:23], v[224:227], v[80:95]
    ds_read_b64_tr_b16 v[44:45], v48 offset:30720
    ds_read_b64_tr_b16 v[46:47], v48 offset:31232
    s_waitcnt vmcnt(6) lgkmcnt(10)
    v_mfma_f32_32x32x16_bf16 v[64:79], v[24:27], v[228:231], v[64:79]
    ds_read_b64_tr_b16 v[16:17], v50 offset:32768
    ds_read_b64_tr_b16 v[18:19], v50 offset:33280
    s_waitcnt lgkmcnt(10)
    v_mfma_f32_32x32x16_bf16 v[80:95], v[28:31], v[228:231], v[80:95]
    ds_read_b64_tr_b16 v[20:21], v48 offset:32768
    ds_read_b64_tr_b16 v[22:23], v48 offset:33280
    s_waitcnt vmcnt(5) lgkmcnt(10)
    v_mfma_f32_32x32x16_bf16 v[64:79], v[32:35], v[232:235], v[64:79]
    ds_read_b64_tr_b16 v[24:25], v50 offset:34816
    ds_read_b64_tr_b16 v[26:27], v50 offset:35328
    s_waitcnt lgkmcnt(10)
    v_mfma_f32_32x32x16_bf16 v[80:95], v[36:39], v[232:235], v[80:95]
    ds_read_b64_tr_b16 v[28:29], v48 offset:34816
    ds_read_b64_tr_b16 v[30:31], v48 offset:35328
    s_waitcnt vmcnt(4) lgkmcnt(10)
    v_mfma_f32_32x32x16_bf16 v[64:79], v[40:43], v[236:239], v[64:79]
    ds_read_b64_tr_b16 v[32:33], v50 offset:36864
    ds_read_b64_tr_b16 v[34:35], v50 offset:37376
    s_waitcnt lgkmcnt(10)
    v_mfma_f32_32x32x16_bf16 v[80:95], v[44:47], v[236:239], v[80:95]
    ds_read_b64_tr_b16 v[36:37], v48 offset:36864
    ds_read_b64_tr_b16 v[38:39], v48 offset:37376
    s_waitcnt vmcnt(3) lgkmcnt(10)
    v_mfma_f32_32x32x16_bf16 v[64:79], v[16:19], v[240:243], v[64:79]
    ds_read_b64_tr_b16 v[40:41], v50 offset:38912
    ds_read_b64_tr_b16 v[42:43], v50 offset:39424
    s_waitcnt lgkmcnt(10)
    v_mfma_f32_32x32x16_bf16 v[80:95], v[20:23], v[240:243], v[80:95]
    ds_read_b64_tr_b16 v[44:45], v48 offset:38912
    ds_read_b64_tr_b16 v[46:47], v48 offset:39424
    s_waitcnt vmcnt(2) lgkmcnt(10)
    v_mfma_f32_32x32x16_bf16 v[64:79], v[24:27], v[244:247], v[64:79]
    s_waitcnt lgkmcnt(8)
    v_mfma_f32_32x32x16_bf16 v[80:95], v[28:31], v[244:247], v[80:95]
    s_waitcnt vmcnt(1) lgkmcnt(6)
    v_mfma_f32_32x32x16_bf16 v[64:79], v[32:35], v[248:251], v[64:79]
    s_waitcnt lgkmcnt(4)
    v_mfma_f32_32x32x16_bf16 v[80:95], v[36:39], v[248:251], v[80:95]
    s_waitcnt vmcnt(0) lgkmcnt(2)
    v_mfma_f32_32x32x16_bf16 v[64:79], v[40:43], v[252:255], v[64:79]
    s_waitcnt lgkmcnt(0)
    v_mfma_f32_32x32x16_bf16 v[80:95], v[44:47], v[252:255], v[80:95]
    s_lshl_b32 s28, s22, 5
    s_bfe_u32 s29, s18, 0x50001
    s_add_u32 s28, s28, s29
    s_lshl_b32 s28, s28, 14
    s_and_b32 s29, s18, 1
    s_lshl_b32 s29, s29, 11
    s_add_u32 s28, s28, s29
    s_add_u32 s28, s28, 33554432
    v_cvt_pk_bf16_f32 v64, v64, v65
    v_cvt_pk_bf16_f32 v65, v66, v67
    v_cvt_pk_bf16_f32 v66, v68, v69
    v_cvt_pk_bf16_f32 v67, v70, v71
    buffer_store_dwordx4 v[64:67], v8, s[8:11], s28 offen offset:0 sc1
    v_cvt_pk_bf16_f32 v72, v72, v73
    v_cvt_pk_bf16_f32 v73, v74, v75
    v_cvt_pk_bf16_f32 v74, v76, v77
    v_cvt_pk_bf16_f32 v75, v78, v79
    buffer_store_dwordx4 v[72:75], v8, s[8:11], s28 offen offset:512 sc1
    v_cvt_pk_bf16_f32 v80, v80, v81
    v_cvt_pk_bf16_f32 v81, v82, v83
    v_cvt_pk_bf16_f32 v82, v84, v85
    v_cvt_pk_bf16_f32 v83, v86, v87
    buffer_store_dwordx4 v[80:83], v8, s[8:11], s28 offen offset:1024 sc1
    v_cvt_pk_bf16_f32 v88, v88, v89
    v_cvt_pk_bf16_f32 v89, v90, v91
    v_cvt_pk_bf16_f32 v90, v92, v93
    v_cvt_pk_bf16_f32 v91, v94, v95
    buffer_store_dwordx4 v[88:91], v8, s[8:11], s28 offen offset:1536 sc1
    s_branch P_END
P_V:
    s_waitcnt vmcnt(39) lgkmcnt(10)
    v_mfma_f32_32x32x16_bf16 v[64:79], v[96:99], v[16:19], 0
    ds_read_b64_tr_b16 v[40:41], v12 offset:6144
    ds_read_b64_tr_b16 v[42:43], v12 offset:6656
    s_waitcnt lgkmcnt(10)
    v_mfma_f32_32x32x16_bf16 v[80:95], v[96:99], v[20:23], 0
    ds_read_b64_tr_b16 v[44:45], v49 offset:6144
    ds_read_b64_tr_b16 v[46:47], v49 offset:6656
    s_waitcnt vmcnt(38) lgkmcnt(10)
    v_mfma_f32_32x32x16_bf16 v[64:79], v[100:103], v[24:27], v[64:79]
    ds_read_b64_tr_b16 v[16:17], v12 offset:8192
    ds_read_b64_tr_b16 v[18:19], v12 offset:8704
    s_waitcnt lgkmcnt(10)
    v_mfma_f32_32x32x16_bf16 v[80:95], v[100:103], v[28:31], v[80:95]
    ds_read_b64_tr_b16 v[20:21], v49 offset:8192
    ds_read_b64_tr_b16 v[22:23], v49 offset:8704
    s_waitcnt vmcnt(37) lgkmcnt(10)
    v_mfma_f32_32x32x16_bf16 v[64:79], v[104:107], v[32:35], v[64:79]
    ds_read_b64_tr_b16 v[24:25], v12 offset:10240
    ds_read_b64_tr_b16 v[26:27], v12 offset:10752
    s_waitcnt lgkmcnt(10)
    v_mfma_f32_32x32x16_bf16 v[80:95], v[104:107], v[36:39], v[80:95]
    ds_read_b64_tr_b16 v[28:29], v49 offset:10240
    ds_read_b64_tr_b16 v[30:31], v49 offset:10752
    s_waitcnt vmcnt(36) lgkmcnt(10)
    v_mfma_f32_32x32x16_bf16 v[64:79], v[108:111], v[40:43], v[64:79]
    ds_read_b64_tr_b16 v[32:33], v12 offset:12288
    ds_read_b64_tr_b16 v[34:35], v12 offset:12800
    s_waitcnt lgkmcnt(10)
    v_mfma_f32_32x32x16_bf16 v[80:95], v[108:111], v[44:47], v[80:95]
    ds_read_b64_tr_b16 v[36:37], v49 offset:12288
    ds_read_b64_tr_b16 v[38:39], v49 offset:12800
    s_waitcnt vmcnt(35) lgkmcnt(10)
    v_mfma_f32_32x32x16_bf16 v[64:79], v[112:115], v[16:19], v[64:79]
    ds_read_b64_tr_b16 v[40:41], v12 offset:14336
    ds_read_b64_tr_b16 v[42:43], v12 offset:14848
    s_waitcnt lgkmcnt(10)
    v_mfma_f32_32x32x16_bf16 v[80:95], v[112:115], v[20:23], v[80:95]
    ds_read_b64_tr_b16 v[44:45], v49 offset:14336
    ds_read_b64_tr_b16 v[46:47], v49 offset:14848
    s_waitcnt vmcnt(34) lgkmcnt(10)
    v_mfma_f32_32x32x16_bf16 v[64:79], v[116:119], v[24:27], v[64:79]
    ds_read_b64_tr_b16 v[16:17], v12 offset:16384
    ds_read_b64_tr_b16 v[18:19], v12 offset:16896
    s_waitcnt lgkmcnt(10)
    v_mfma_f32_32x32x16_bf16 v[80:95], v[116:119], v[28:31], v[80:95]
    ds_read_b64_tr_b16 v[20:21], v49 offset:16384
    ds_read_b64_tr_b16 v[22:23], v49 offset:16896
    s_waitcnt vmcnt(33) lgkmcnt(10)
    v_mfma_f32_32x32x16_bf16 v[64:79], v[120:123], v[32:35], v[64:79]
    ds_read_b64_tr_b16 v[24:25], v12 offset:18432
    ds_read_b64_tr_b16 v[26:27], v12 offset:18944
    s_waitcnt lgkmcnt(10)
    v_mfma_f32_32x32x16_bf16 v[80:95], v[120:123], v[36:39], v[80:95]
    ds_read_b64_tr_b16 v[28:29], v49 offset:18432
    ds_read_b64_tr_b16 v[30:31], v49 offset:18944
    s_waitcnt vmcnt(32) lgkmcnt(10)
    v_mfma_f32_32x32x16_bf16 v[64:79], v[124:127], v[40:43], v[64:79]
    ds_read_b64_tr_b16 v[32:33], v12 offset:20480
    ds_read_b64_tr_b16 v[34:35], v12 offset:20992
    s_waitcnt lgkmcnt(10)
    v_mfma_f32_32x32x16_bf16 v[80:95], v[124:127], v[44:47], v[80:95]
    ds_read_b64_tr_b16 v[36:37], v49 offset:20480
    ds_read_b64_tr_b16 v[38:39], v49 offset:20992
    s_waitcnt vmcnt(31) lgkmcnt(10)
    v_mfma_f32_32x32x16_bf16 v[64:79], v[128:131], v[16:19], v[64:79]
    ds_read_b64_tr_b16 v[40:41], v12 offset:22528
    ds_read_b64_tr_b16 v[42:43], v12 offset:23040
    s_waitcnt lgkmcnt(10)
    v_mfma_f32_32x32x16_bf16 v[80:95], v[128:131], v[20:23], v[80:95]
    ds_read_b64_tr_b16 v[44:45], v49 offset:22528
    ds_read_b64_tr_b16 v[46:47], v49 offset:23040
    s_waitcnt vmcnt(30) lgkmcnt(10)
    v_mfma_f32_32x32x16_bf16 v[64:79], v[132:135], v[24:27], v[64:79]
    ds_read_b64_tr_b16 v[16:17], v12 offset:24576
    ds_read_b64_tr_b16 v[18:19], v12 offset:25088
    s_waitcnt lgkmcnt(10)
    v_mfma_f32_32x32x16_bf16 v[80:95], v[132:135], v[28:31], v[80:95]
    ds_read_b64_tr_b16 v[20:21], v49 offset:24576
    ds_read_b64_tr_b16 v[22:23], v49 offset:25088
    s_waitcnt vmcnt(29) lgkmcnt(10)
    v_mfma_f32_32x32x16_bf16 v[64:79], v[136:139], v[32:35], v[64:79]
    ds_read_b64_tr_b16 v[24:25], v12 offset:26624
    ds_read_b64_tr_b16 v[26:27], v12 offset:27136
    s_waitcnt lgkmcnt(10)
    v_mfma_f32_32x32x16_bf16 v[80:95], v[136:139], v[36:39], v[80:95]
    ds_read_b64_tr_b16 v[28:29], v49 offset:26624
    ds_read_b64_tr_b16 v[30:31], v49 offset:27136
    s_waitcnt vmcnt(28) lgkmcnt(10)
    v_mfma_f32_32x32x16_bf16 v[64:79], v[140:143], v[40:43], v[64:79]
    ds_read_b64_tr_b16 v[32:33], v12 offset:28672
    ds_read_b64_tr_b16 v[34:35], v12 offset:29184
    s_waitcnt lgkmcnt(10)
    v_mfma_f32_32x32x16_bf16 v[80:95], v[140:143], v[44:47], v[80:95]
    ds_read_b64_tr_b16 v[36:37], v49 offset:28672
    ds_read_b64_tr_b16 v[38:39], v49 offset:29184
    s_waitcnt vmcnt(27) lgkmcnt(10)
    v_mfma_f32_32x32x16_bf16 v[64:79], v[144:147], v[16:19], v[64:79]
    ds_read_b64_tr_b16 v[40:41], v12 offset:30720
    ds_read_b64_tr_b16 v[42:43], v12 offset:31232
    s_waitcnt lgkmcnt(10)
    v_mfma_f32_32x32x16_bf16 v[80:95], v[144:147], v[20:23], v[80:95]
    ds_read_b64_tr_b16 v[44:45], v49 offset:30720
    ds_read_b64_tr_b16 v[46:47], v49 offset:31232
    s_waitcnt vmcnt(26) lgkmcnt(10)
    v_mfma_f32_32x32x16_bf16 v[64:79], v[148:151], v[24:27], v[64:79]
    ds_read_b64_tr_b16 v[16:17], v12 offset:32768
    ds_read_b64_tr_b16 v[18:19], v12 offset:33280
    s_waitcnt lgkmcnt(10)
    v_mfma_f32_32x32x16_bf16 v[80:95], v[148:151], v[28:31], v[80:95]
    ds_read_b64_tr_b16 v[20:21], v49 offset:32768
    ds_read_b64_tr_b16 v[22:23], v49 offset:33280
    s_waitcnt vmcnt(25) lgkmcnt(10)
    v_mfma_f32_32x32x16_bf16 v[64:79], v[152:155], v[32:35], v[64:79]
    ds_read_b64_tr_b16 v[24:25], v12 offset:34816
    ds_read_b64_tr_b16 v[26:27], v12 offset:35328
    s_waitcnt lgkmcnt(10)
    v_mfma_f32_32x32x16_bf16 v[80:95], v[152:155], v[36:39], v[80:95]
    ds_read_b64_tr_b16 v[28:29], v49 offset:34816
    ds_read_b64_tr_b16 v[30:31], v49 offset:35328
    s_waitcnt vmcnt(24) lgkmcnt(10)
    v_mfma_f32_32x32x16_bf16 v[64:79], v[156:159], v[40:43], v[64:79]
    ds_read_b64_tr_b16 v[32:33], v12 offset:36864
    ds_read_b64_tr_b16 v[34:35], v12 offset:37376
    s_waitcnt lgkmcnt(10)
    v_mfma_f32_32x32x16_bf16 v[80:95], v[156:159], v[44:47], v[80:95]
    ds_read_b64_tr_b16 v[36:37], v49 offset:36864
    ds_read_b64_tr_b16 v[38:39], v49 offset:37376
    s_waitcnt vmcnt(23) lgkmcnt(10)
    v_mfma_f32_32x32x16_bf16 v[64:79], v[160:163], v[16:19], v[64:79]
    ds_read_b64_tr_b16 v[40:41], v12 offset:38912
    ds_read_b64_tr_b16 v[42:43], v12 offset:39424
    s_waitcnt lgkmcnt(10)
    v_mfma_f32_32x32x16_bf16 v[80:95], v[160:163], v[20:23], v[80:95]
    ds_read_b64_tr_b16 v[44:45], v49 offset:38912
    ds_read_b64_tr_b16 v[46:47], v49 offset:39424
    s_waitcnt vmcnt(22) lgkmcnt(10)
    v_mfma_f32_32x32x16_bf16 v[64:79], v[164:167], v[24:27], v[64:79]
    ds_read_b64_tr_b16 v[16:17], v50 offset:0
    ds_read_b64_tr_b16 v[18:19], v50 offset:512
    s_waitcnt lgkmcnt(10)
    v_mfma_f32_32x32x16_bf16 v[80:95], v[164:167], v[28:31], v[80:95]
    ds_read_b64_tr_b16 v[20:21], v48 offset:0
    ds_read_b64_tr_b16 v[22:23], v48 offset:512
    s_waitcnt vmcnt(21) lgkmcnt(10)
    v_mfma_f32_32x32x16_bf16 v[64:79], v[168:171], v[32:35], v[64:79]
    ds_read_b64_tr_b16 v[24:25], v50 offset:2048
    ds_read_b64_tr_b16 v[26:27], v50 offset:2560
    s_waitcnt lgkmcnt(10)
    v_mfma_f32_32x32x16_bf16 v[80:95], v[168:171], v[36:39], v[80:95]
    ds_read_b64_tr_b16 v[28:29], v48 offset:2048
    ds_read_b64_tr_b16 v[30:31], v48 offset:2560
    s_waitcnt vmcnt(20) lgkmcnt(10)
    v_mfma_f32_32x32x16_bf16 v[64:79], v[172:175], v[40:43], v[64:79]
    ds_read_b64_tr_b16 v[32:33], v50 offset:4096
    ds_read_b64_tr_b16 v[34:35], v50 offset:4608
    s_waitcnt lgkmcnt(10)
    v_mfma_f32_32x32x16_bf16 v[80:95], v[172:175], v[44:47], v[80:95]
    ds_read_b64_tr_b16 v[36:37], v48 offset:4096
    ds_read_b64_tr_b16 v[38:39], v48 offset:4608
    s_waitcnt vmcnt(19) lgkmcnt(10)
    v_mfma_f32_32x32x16_bf16 v[64:79], v[176:179], v[16:19], v[64:79]
    ds_read_b64_tr_b16 v[40:41], v50 offset:6144
    ds_read_b64_tr_b16 v[42:43], v50 offset:6656
    s_waitcnt lgkmcnt(10)
    v_mfma_f32_32x32x16_bf16 v[80:95], v[176:179], v[20:23], v[80:95]
    ds_read_b64_tr_b16 v[44:45], v48 offset:6144
    ds_read_b64_tr_b16 v[46:47], v48 offset:6656
    s_waitcnt vmcnt(18) lgkmcnt(10)
    v_mfma_f32_32x32x16_bf16 v[64:79], v[180:183], v[24:27], v[64:79]
    ds_read_b64_tr_b16 v[16:17], v50 offset:8192
    ds_read_b64_tr_b16 v[18:19], v50 offset:8704
    s_waitcnt lgkmcnt(10)
    v_mfma_f32_32x32x16_bf16 v[80:95], v[180:183], v[28:31], v[80:95]
    ds_read_b64_tr_b16 v[20:21], v48 offset:8192
    ds_read_b64_tr_b16 v[22:23], v48 offset:8704
    s_waitcnt vmcnt(17) lgkmcnt(10)
    v_mfma_f32_32x32x16_bf16 v[64:79], v[184:187], v[32:35], v[64:79]
    ds_read_b64_tr_b16 v[24:25], v50 offset:10240
    ds_read_b64_tr_b16 v[26:27], v50 offset:10752
    s_waitcnt lgkmcnt(10)
    v_mfma_f32_32x32x16_bf16 v[80:95], v[184:187], v[36:39], v[80:95]
    ds_read_b64_tr_b16 v[28:29], v48 offset:10240
    ds_read_b64_tr_b16 v[30:31], v48 offset:10752
    s_waitcnt vmcnt(16) lgkmcnt(10)
    v_mfma_f32_32x32x16_bf16 v[64:79], v[188:191], v[40:43], v[64:79]
    ds_read_b64_tr_b16 v[32:33], v50 offset:12288
    ds_read_b64_tr_b16 v[34:35], v50 offset:12800
    s_waitcnt lgkmcnt(10)
    v_mfma_f32_32x32x16_bf16 v[80:95], v[188:191], v[44:47], v[80:95]
    ds_read_b64_tr_b16 v[36:37], v48 offset:12288
    ds_read_b64_tr_b16 v[38:39], v48 offset:12800
    s_waitcnt vmcnt(15) lgkmcnt(10)
    v_mfma_f32_32x32x16_bf16 v[64:79], v[192:195], v[16:19], v[64:79]
    ds_read_b64_tr_b16 v[40:41], v50 offset:14336
    ds_read_b64_tr_b16 v[42:43], v50 offset:14848
    s_waitcnt lgkmcnt(10)
    v_mfma_f32_32x32x16_bf16 v[80:95], v[192:195], v[20:23], v[80:95]
    ds_read_b64_tr_b16 v[44:45], v48 offset:14336
    ds_read_b64_tr_b16 v[46:47], v48 offset:14848
    s_waitcnt vmcnt(14) lgkmcnt(10)
    v_mfma_f32_32x32x16_bf16 v[64:79], v[196:199], v[24:27], v[64:79]
    ds_read_b64_tr_b16 v[16:17], v50 offset:16384
    ds_read_b64_tr_b16 v[18:19], v50 offset:16896
    s_waitcnt lgkmcnt(10)
    v_mfma_f32_32x32x16_bf16 v[80:95], v[196:199], v[28:31], v[80:95]
    ds_read_b64_tr_b16 v[20:21], v48 offset:16384
    ds_read_b64_tr_b16 v[22:23], v48 offset:16896
    s_waitcnt vmcnt(13) lgkmcnt(10)
    v_mfma_f32_32x32x16_bf16 v[64:79], v[200:203], v[32:35], v[64:79]
    ds_read_b64_tr_b16 v[24:25], v50 offset:18432
    ds_read_b64_tr_b16 v[26:27], v50 offset:18944
    s_waitcnt lgkmcnt(10)
    v_mfma_f32_32x32x16_bf16 v[80:95], v[200:203], v[36:39], v[80:95]
    ds_read_b64_tr_b16 v[28:29], v48 offset:18432
    ds_read_b64_tr_b16 v[30:31], v48 offset:18944
    s_waitcnt vmcnt(12) lgkmcnt(10)
    v_mfma_f32_32x32x16_bf16 v[64:79], v[204:207], v[40:43], v[64:79]
    ds_read_b64_tr_b16 v[32:33], v50 offset:20480
    ds_read_b64_tr_b16 v[34:35], v50 offset:20992
    s_waitcnt lgkmcnt(10)
    v_mfma_f32_32x32x16_bf16 v[80:95], v[204:207], v[44:47], v[80:95]
    ds_read_b64_tr_b16 v[36:37], v48 offset:20480
    ds_read_b64_tr_b16 v[38:39], v48 offset:20992
    s_waitcnt vmcnt(11) lgkmcnt(10)
    v_mfma_f32_32x32x16_bf16 v[64:79], v[208:211], v[16:19], v[64:79]
    ds_read_b64_tr_b16 v[40:41], v50 offset:22528
    ds_read_b64_tr_b16 v[42:43], v50 offset:23040
    s_waitcnt lgkmcnt(10)
    v_mfma_f32_32x32x16_bf16 v[80:95], v[208:211], v[20:23], v[80:95]
    ds_read_b64_tr_b16 v[44:45], v48 offset:22528
    ds_read_b64_tr_b16 v[46:47], v48 offset:23040
    s_waitcnt vmcnt(10) lgkmcnt(10)
    v_mfma_f32_32x32x16_bf16 v[64:79], v[212:215], v[24:27], v[64:79]
    ds_read_b64_tr_b16 v[16:17], v50 offset:24576
    ds_read_b64_tr_b16 v[18:19], v50 offset:25088
    s_waitcnt lgkmcnt(10)
    v_mfma_f32_32x32x16_bf16 v[80:95], v[212:215], v[28:31], v[80:95]
    ds_read_b64_tr_b16 v[20:21], v48 offset:24576
    ds_read_b64_tr_b16 v[22:23], v48 offset:25088
    s_waitcnt vmcnt(9) lgkmcnt(10)
    v_mfma_f32_32x32x16_bf16 v[64:79], v[216:219], v[32:35], v[64:79]
    ds_read_b64_tr_b16 v[24:25], v50 offset:26624
    ds_read_b64_tr_b16 v[26:27], v50 offset:27136
    s_waitcnt lgkmcnt(10)
    v_mfma_f32_32x32x16_bf16 v[80:95], v[216:219], v[36:39], v[80:95]
    ds_read_b64_tr_b16 v[28:29], v48 offset:26624
    ds_read_b64_tr_b16 v[30:31], v48 offset:27136
    s_waitcnt vmcnt(8) lgkmcnt(10)
    v_mfma_f32_32x32x16_bf16 v[64:79], v[220:223], v[40:43], v[64:79]
    ds_read_b64_tr_b16 v[32:33], v50 offset:28672
    ds_read_b64_tr_b16 v[34:35], v50 offset:29184
    s_waitcnt lgkmcnt(10)
    v_mfma_f32_32x32x16_bf16 v[80:95], v[220:223], v[44:47], v[80:95]
    ds_read_b64_tr_b16 v[36:37], v48 offset:28672
    ds_read_b64_tr_b16 v[38:39], v48 offset:29184
    s_waitcnt vmcnt(7) lgkmcnt(10)
    v_mfma_f32_32x32x16_bf16 v[64:79], v[224:227], v[16:19], v[64:79]
    ds_read_b64_tr_b16 v[40:41], v50 offset:30720
    ds_read_b64_tr_b16 v[42:43], v50 offset:31232
    s_waitcnt lgkmcnt(10)
    v_mfma_f32_32x32x16_bf16 v[80:95], v[224:227], v[20:23], v[80:95]
    ds_read_b64_tr_b16 v[44:45], v48 offset:30720
    ds_read_b64_tr_b16 v[46:47], v48 offset:31232
    s_waitcnt vmcnt(6) lgkmcnt(10)
    v_mfma_f32_32x32x16_bf16 v[64:79], v[228:231], v[24:27], v[64:79]
    ds_read_b64_tr_b16 v[16:17], v50 offset:32768
    ds_read_b64_tr_b16 v[18:19], v50 offset:33280
    s_waitcnt lgkmcnt(10)
    v_mfma_f32_32x32x16_bf16 v[80:95], v[228:231], v[28:31], v[80:95]
    ds_read_b64_tr_b16 v[20:21], v48 offset:32768
    ds_read_b64_tr_b16 v[22:23], v48 offset:33280
    s_waitcnt vmcnt(5) lgkmcnt(10)
    v_mfma_f32_32x32x16_bf16 v[64:79], v[232:235], v[32:35], v[64:79]
    ds_read_b64_tr_b16 v[24:25], v50 offset:34816
    ds_read_b64_tr_b16 v[26:27], v50 offset:35328
    s_waitcnt lgkmcnt(10)
    v_mfma_f32_32x32x16_bf16 v[80:95], v[232:235], v[36:39], v[80:95]
    ds_read_b64_tr_b16 v[28:29], v48 offset:34816
    ds_read_b64_tr_b16 v[30:31], v48 offset:35328
    s_waitcnt vmcnt(4) lgkmcnt(10)
    v_mfma_f32_32x32x16_bf16 v[64:79], v[236:239], v[40:43], v[64:79]
    ds_read_b64_tr_b16 v[32:33], v50 offset:36864
    ds_read_b64_tr_b16 v[34:35], v50 offset:37376
    s_waitcnt lgkmcnt(10)
    v_mfma_f32_32x32x16_bf16 v[80:95], v[236:239], v[44:47], v[80:95]
    ds_read_b64_tr_b16 v[36:37], v48 offset:36864
    ds_read_b64_tr_b16 v[38:39], v48 offset:37376
    s_waitcnt vmcnt(3) lgkmcnt(10)
    v_mfma_f32_32x32x16_bf16 v[64:79], v[240:243], v[16:19], v[64:79]
    ds_read_b64_tr_b16 v[40:41], v50 offset:38912
    ds_read_b64_tr_b16 v[42:43], v50 offset:39424
    s_waitcnt lgkmcnt(10)
    v_mfma_f32_32x32x16_bf16 v[80:95], v[240:243], v[20:23], v[80:95]
    ds_read_b64_tr_b16 v[44:45], v48 offset:38912
    ds_read_b64_tr_b16 v[46:47], v48 offset:39424
    s_waitcnt vmcnt(2) lgkmcnt(10)
    v_mfma_f32_32x32x16_bf16 v[64:79], v[244:247], v[24:27], v[64:79]
    s_waitcnt lgkmcnt(8)
    v_mfma_f32_32x32x16_bf16 v[80:95], v[244:247], v[28:31], v[80:95]
    s_waitcnt vmcnt(1) lgkmcnt(6)
    v_mfma_f32_32x32x16_bf16 v[64:79], v[248:251], v[32:35], v[64:79]
    s_waitcnt lgkmcnt(4)
    v_mfma_f32_32x32x16_bf16 v[80:95], v[248:251], v[36:39], v[80:95]
    s_waitcnt vmcnt(0) lgkmcnt(2)
    v_mfma_f32_32x32x16_bf16 v[64:79], v[252:255], v[40:43], v[64:79]
    s_waitcnt lgkmcnt(0)
    v_mfma_f32_32x32x16_bf16 v[80:95], v[252:255], v[44:47], v[80:95]
    s_lshl_b32 s28, s22, 5
    s_bfe_u32 s29, s18, 0x50001
    s_add_u32 s28, s28, s29
    s_lshl_b32 s28, s28, 14
    s_and_b32 s29, s18, 1
    s_lshl_b32 s29, s29, 12
    s_add_u32 s28, s28, s29
    s_add_u32 s28, s28, 33562624
    v_cvt_pk_bf16_f32 v64, v64, v65
    v_cvt_pk_bf16_f32 v65, v66, v67
    v_cvt_pk_bf16_f32 v66, v68, v69
    v_cvt_pk_bf16_f32 v67, v70, v71
    buffer_store_dwordx4 v[64:67], v9, s[8:11], s28 offen offset:0 sc1
    v_cvt_pk_bf16_f32 v72, v72, v73
    v_cvt_pk_bf16_f32 v73, v74, v75
    v_cvt_pk_bf16_f32 v74, v76, v77
    v_cvt_pk_bf16_f32 v75, v78, v79
    buffer_store_dwordx4 v[72:75], v9, s[8:11], s28 offen offset:512 sc1
    v_cvt_pk_bf16_f32 v80, v80, v81
    v_cvt_pk_bf16_f32 v81, v82, v83
    v_cvt_pk_bf16_f32 v82, v84, v85
    v_cvt_pk_bf16_f32 v83, v86, v87
    buffer_store_dwordx4 v[80:83], v9, s[8:11], s28 offen offset:2048 sc1
    v_cvt_pk_bf16_f32 v88, v88, v89
    v_cvt_pk_bf16_f32 v89, v90, v91
    v_cvt_pk_bf16_f32 v90, v92, v93
    v_cvt_pk_bf16_f32 v91, v94, v95
    buffer_store_dwordx4 v[88:91], v9, s[8:11], s28 offen offset:2560 sc1
P_END:
    s_cmp_eq_u32 s19, 0
    s_cbranch_scc0 K_PJ2
    s_waitcnt vmcnt(0)
    s_barrier
    s_cmp_eq_u32 s17, 0
    s_cbranch_scc0 K_LC
    s_lshr_b32 s28, s18, 1
    s_lshl_b32 s28, s28, 6
    s_and_b32 s29, s18, 1
    s_lshl_b32 s29, s29, 2
    s_add_u32 s28, s28, s29
    s_add_u32 s28, s28, 1073152
    v_mov_b32 v14, 0
    v_mov_b32 v15, 1
    s_mov_b64 exec, 1
    buffer_store_dword v15, v14, s[8:11], s28 offen sc1
    s_mov_b64 exec, -1
K_LC:
    s_mov_b32 s19, 4
    s_branch K_PJ
K_PJ2:
    s_mov_b32 s28, 80
    s_mov_b32 s76, 128
K_LA0:
    s_waitcnt vmcnt(0)
    s_barrier
    s_cmp_eq_u32 s17, 0
    s_cbranch_scc0 K_LB
    v_mov_b32 v14, 0
    v_mov_b32 v15, 1
    s_mov_b64 exec, 1
    buffer_atomic_add v15, v14, s[4:7], s28 offen sc0
    s_waitcnt vmcnt(0)
    v_add_u32 v15, 1, v15
    s_nop 0
    v_readfirstlane_b32 s29, v15
    s_nop 0
    s_cmp_eq_u32 s29, s76
    s_cbranch_scc0 K_LB_N
    buffer_store_dword v15, v14, s[4:7], s28 offen offset:128 sc1
K_LB_N:
    s_mov_b64 exec, -1
K_LB:
    s_add_u32 s70, s71, 44
    s_cmp_lt_u32 s70, 62
    s_cbranch_scc1 K_G0
    s_cmp_lt_u32 s70, 128
    s_cbranch_scc1 K_LN
    s_branch K_G0
K_INI:
    s_load_dwordx2 s[12:13], s[0:1], 8
    s_mov_b32 s14, 10240
    s_mov_b32 s15, 0x20000
    s_waitcnt lgkmcnt(0)
    s_sub_u32 s18, s18, 146
    v_lshlrev_b32 v2, 4, v0
    v_mov_b32 v4, -1
    v_mov_b32 v5, -1
    v_mov_b32 v6, -1
    v_mov_b32 v7, -1
    s_cmp_eq_u32 s18, 1
    s_cbranch_scc1 IJ_1
    s_cmp_eq_u32 s18, 2
    s_cbranch_scc1 IJ_2
    s_cmp_eq_u32 s18, 3
    s_cbranch_scc1 IJ_3
    s_cmp_eq_u32 s18, 4
    s_cbranch_scc1 IJ_4
    s_cmp_eq_u32 s18, 5
    s_cbranch_scc1 IJ_5
    s_cmp_eq_u32 s18, 6
    s_cbranch_scc1 IJ_6
    s_cmp_eq_u32 s18, 7
    s_cbranch_scc1 IJ_7
    s_cmp_eq_u32 s18, 8
    s_cbranch_scc1 IJ_8
    s_cmp_eq_u32 s18, 9
    s_cbranch_scc1 IJ_9
    s_cmp_eq_u32 s18, 10
    s_cbranch_scc1 IJ_10
    s_cmp_eq_u32 s18, 11
    s_cbranch_scc1 IJ_11
    s_cmp_ge_u32 s18, 12
    s_cbranch_scc1 IJ_12
IJ_0:
    s_mov_b32 s20, 20971520
    buffer_store_dwordx4 v[4:7], v2, s[8:11], s20 offen sc1
    s_mov_b32 s20, 21020672
    buffer_store_dwordx4 v[4:7], v2, s[8:11], s20 offen sc1
    s_mov_b32 s20, 21069824
    buffer_store_dwordx4 v[4:7], v2, s[8:11], s20 offen sc1
    s_mov_b32 s20, 21118976
    buffer_store_dwordx4 v[4:7], v2, s[8:11], s20 offen sc1
    s_mov_b32 s20, 21200896
    buffer_store_dwordx4 v[4:7], v2, s[8:11], s20 offen sc1
    s_mov_b32 s20, 21250048
    buffer_store_dwordx4 v[4:7], v2, s[8:11], s20 offen sc1
    s_mov_b32 s20, 21299200
    buffer_store_dwordx4 v[4:7], v2, s[8:11], s20 offen sc1
    s_mov_b32 s20, 21512192
    buffer_store_dwordx4 v[4:7], v2, s[8:11], s20 offen sc1
    s_mov_b32 s20, 21561344
    buffer_store_dwordx4 v[4:7], v2, s[8:11], s20 offen sc1
    s_mov_b32 s20, 21610496
    buffer_store_dwordx4 v[4:7], v2, s[8:11], s20 offen sc1
    s_mov_b32 s20, 21692416
    buffer_store_dwordx4 v[4:7], v2, s[8:11], s20 offen sc1
    s_mov_b32 s20, 21741568
    buffer_store_dwordx4 v[4:7], v2, s[8:11], s20 offen sc1
    s_mov_b32 s20, 21790720
    buffer_store_dwordx4 v[4:7], v2, s[8:11], s20 offen sc1
    s_mov_b32 s20, 21839872
    buffer_store_dwordx4 v[4:7], v2, s[8:11], s20 offen sc1
    s_mov_b32 s20, 22052864
    buffer_store_dwordx4 v[4:7], v2, s[8:11], s20 offen sc1
    s_mov_b32 s20, 22102016
    buffer_store_dwordx4 v[4:7], v2, s[8:11], s20 offen sc1
    s_mov_b32 s20, 22151168
    buffer_store_dwordx4 v[4:7], v2, s[8:11], s20 offen sc1
    s_mov_b32 s20, 22233088
    buffer_store_dwordx4 v[4:7], v2, s[8:11], s20 offen sc1
    s_mov_b32 s20, 22282240
    buffer_store_dwordx4 v[4:7], v2, s[8:11], s20 offen sc1
    s_mov_b32 s20, 22331392
    buffer_store_dwordx4 v[4:7], v2, s[8:11], s20 offen sc1
    s_mov_b32 s20, 22544384
    buffer_store_dwordx4 v[4:7], v2, s[8:11], s20 offen sc1
    s_mov_b32 s20, 22593536
    buffer_store_dwordx4 v[4:7], v2, s[8:11], s20 offen sc1
    s_mov_b32 s20, 22642688
    buffer_store_dwordx4 v[4:7], v2, s[8:11], s20 offen sc1
    s_mov_b32 s20, 22691840
    buffer_store_dwordx4 v[4:7], v2, s[8:11], s20 offen sc1
    s_mov_b32 s20, 22773760
    buffer_store_dwordx4 v[4:7], v2, s[8:11], s20 offen sc1
    s_mov_b32 s20, 22822912
    buffer_store_dwordx4 v[4:7], v2, s[8:11], s20 offen sc1
    s_mov_b32 s20, 22872064
    buffer_store_dwordx4 v[4:7], v2, s[8:11], s20 offen sc1
    s_mov_b32 s20, 574464
    buffer_store_dwordx4 v[4:7], v2, s[8:11], s20 offen sc1
    s_mov_b32 s20, 640000
    buffer_store_dwordx4 v[4:7], v2, s[8:11], s20 offen sc1
    s_mov_b32 s20, 738304
    buffer_store_dwordx4 v[4:7], v2, s[8:11], s20 offen sc1
    s_mov_b32 s20, 835584
    buffer_store_dwordx4 v[4:7], v2, s[8:11], s20 offen sc1
    s_mov_b32 s20, 901120
    buffer_store_dwordx4 v[4:7], v2, s[8:11], s20 offen sc1
    s_mov_b32 s20, 999424
    buffer_store_dwordx4 v[4:7], v2, s[8:11], s20 offen sc1
    s_mov_b32 s20, 409600
    buffer_store_dwordx4 v[4:7], v2, s[8:11], s20 offen sc1
    s_branch IJ_END
IJ_1:
    s_mov_b32 s20, 20975616
    buffer_store_dwordx4 v[4:7], v2, s[8:11], s20 offen sc1
    s_mov_b32 s20, 21024768
    buffer_store_dwordx4 v[4:7], v2, s[8:11], s20 offen sc1
    s_mov_b32 s20, 21073920
    buffer_store_dwordx4 v[4:7], v2, s[8:11], s20 offen sc1
    s_mov_b32 s20, 21123072
    buffer_store_dwordx4 v[4:7], v2, s[8:11], s20 offen sc1
    s_mov_b32 s20, 21204992
    buffer_store_dwordx4 v[4:7], v2, s[8:11], s20 offen sc1
    s_mov_b32 s20, 21254144
    buffer_store_dwordx4 v[4:7], v2, s[8:11], s20 offen sc1
    s_mov_b32 s20, 21303296
    buffer_store_dwordx4 v[4:7], v2, s[8:11], s20 offen sc1
    s_mov_b32 s20, 21516288
    buffer_store_dwordx4 v[4:7], v2, s[8:11], s20 offen sc1
    s_mov_b32 s20, 21565440
    buffer_store_dwordx4 v[4:7], v2, s[8:11], s20 offen sc1
    s_mov_b32 s20, 21614592
    buffer_store_dwordx4 v[4:7], v2, s[8:11], s20 offen sc1
    s_mov_b32 s20, 21696512
    buffer_store_dwordx4 v[4:7], v2, s[8:11], s20 offen sc1
    s_mov_b32 s20, 21745664
    buffer_store_dwordx4 v[4:7], v2, s[8:11], s20 offen sc1
    s_mov_b32 s20, 21794816
    buffer_store_dwordx4 v[4:7], v2, s[8:11], s20 offen sc1
    s_mov_b32 s20, 21843968
    buffer_store_dwordx4 v[4:7], v2, s[8:11], s20 offen sc1
    s_mov_b32 s20, 22056960
    buffer_store_dwordx4 v[4:7], v2, s[8:11], s20 offen sc1
    s_mov_b32 s20, 22106112
    buffer_store_dwordx4 v[4:7], v2, s[8:11], s20 offen sc1
    s_mov_b32 s20, 22155264
    buffer_store_dwordx4 v[4:7], v2, s[8:11], s20 offen sc1
    s_mov_b32 s20, 22237184
    buffer_store_dwordx4 v[4:7], v2, s[8:11], s20 offen sc1
    s_mov_b32 s20, 22286336
    buffer_store_dwordx4 v[4:7], v2, s[8:11], s20 offen sc1
    s_mov_b32 s20, 22335488
    buffer_store_dwordx4 v[4:7], v2, s[8:11], s20 offen sc1
    s_mov_b32 s20, 22548480
    buffer_store_dwordx4 v[4:7], v2, s[8:11], s20 offen sc1
    s_mov_b32 s20, 22597632
    buffer_store_dwordx4 v[4:7], v2, s[8:11], s20 offen sc1
    s_mov_b32 s20, 22646784
    buffer_store_dwordx4 v[4:7], v2, s[8:11], s20 offen sc1
    s_mov_b32 s20, 22695936
    buffer_store_dwordx4 v[4:7], v2, s[8:11], s20 offen sc1
    s_mov_b32 s20, 22777856
    buffer_store_dwordx4 v[4:7], v2, s[8:11], s20 offen sc1
    s_mov_b32 s20, 22827008
    buffer_store_dwordx4 v[4:7], v2, s[8:11], s20 offen sc1
    s_mov_b32 s20, 22876160
    buffer_store_dwordx4 v[4:7], v2, s[8:11], s20 offen sc1
    s_mov_b32 s20, 582656
    buffer_store_dwordx4 v[4:7], v2, s[8:11], s20 offen sc1
    s_mov_b32 s20, 648192
    buffer_store_dwordx4 v[4:7], v2, s[8:11], s20 offen sc1
    s_mov_b32 s20, 746496
    buffer_store_dwordx4 v[4:7], v2, s[8:11], s20 offen sc1
    s_mov_b32 s20, 843776
    buffer_store_dwordx4 v[4:7], v2, s[8:11], s20 offen sc1
    s_mov_b32 s20, 909312
    buffer_store_dwordx4 v[4:7], v2, s[8:11], s20 offen sc1
    s_mov_b32 s20, 1007616
    buffer_store_dwordx4 v[4:7], v2, s[8:11], s20 offen sc1
    s_mov_b32 s20, 413696
    buffer_store_dwordx4 v[4:7], v2, s[8:11], s20 offen sc1
    s_branch IJ_END
IJ_2:
    s_mov_b32 s20, 20979712
    buffer_store_dwordx4 v[4:7], v2, s[8:11], s20 offen sc1
    s_mov_b32 s20, 21028864
    buffer_store_dwordx4 v[4:7], v2, s[8:11], s20 offen sc1
    s_mov_b32 s20, 21078016
    buffer_store_dwordx4 v[4:7], v2, s[8:11], s20 offen sc1
    s_mov_b32 s20, 21127168
    buffer_store_dwordx4 v[4:7], v2, s[8:11], s20 offen sc1
    s_mov_b32 s20, 21209088
    buffer_store_dwordx4 v[4:7], v2, s[8:11], s20 offen sc1
    s_mov_b32 s20, 21258240
    buffer_store_dwordx4 v[4:7], v2, s[8:11], s20 offen sc1
    s_mov_b32 s20, 21307392
    buffer_store_dwordx4 v[4:7], v2, s[8:11], s20 offen sc1
    s_mov_b32 s20, 21520384
    buffer_store_dwordx4 v[4:7], v2, s[8:11], s20 offen sc1
    s_mov_b32 s20, 21569536
    buffer_store_dwordx4 v[4:7], v2, s[8:11], s20 offen sc1
    s_mov_b32 s20, 21618688
    buffer_store_dwordx4 v[4:7], v2, s[8:11], s20 offen sc1
    s_mov_b32 s20, 21700608
    buffer_store_dwordx4 v[4:7], v2, s[8:11], s20 offen sc1
    s_mov_b32 s20, 21749760
    buffer_store_dwordx4 v[4:7], v2, s[8:11], s20 offen sc1
    s_mov_b32 s20, 21798912
    buffer_store_dwordx4 v[4:7], v2, s[8:11], s20 offen sc1
    s_mov_b32 s20, 21848064
    buffer_store_dwordx4 v[4:7], v2, s[8:11], s20 offen sc1
    s_mov_b32 s20, 22061056
    buffer_store_dwordx4 v[4:7], v2, s[8:11], s20 offen sc1
    s_mov_b32 s20, 22110208
    buffer_store_dwordx4 v[4:7], v2, s[8:11], s20 offen sc1
    s_mov_b32 s20, 22159360
    buffer_store_dwordx4 v[4:7], v2, s[8:11], s20 offen sc1
    s_mov_b32 s20, 22241280
    buffer_store_dwordx4 v[4:7], v2, s[8:11], s20 offen sc1
    s_mov_b32 s20, 22290432
    buffer_store_dwordx4 v[4:7], v2, s[8:11], s20 offen sc1
    s_mov_b32 s20, 22339584
    buffer_store_dwordx4 v[4:7], v2, s[8:11], s20 offen sc1
    s_mov_b32 s20, 22552576
    buffer_store_dwordx4 v[4:7], v2, s[8:11], s20 offen sc1
    s_mov_b32 s20, 22601728
    buffer_store_dwordx4 v[4:7], v2, s[8:11], s20 offen sc1
    s_mov_b32 s20, 22650880
    buffer_store_dwordx4 v[4:7], v2, s[8:11], s20 offen sc1
    s_mov_b32 s20, 22700032
    buffer_store_dwordx4 v[4:7], v2, s[8:11], s20 offen sc1
    s_mov_b32 s20, 22781952
    buffer_store_dwordx4 v[4:7], v2, s[8:11], s20 offen sc1
    s_mov_b32 s20, 22831104
    buffer_store_dwordx4 v[4:7], v2, s[8:11], s20 offen sc1
    s_mov_b32 s20, 22880256
    buffer_store_dwordx4 v[4:7], v2, s[8:11], s20 offen sc1
    s_mov_b32 s20, 590848
    buffer_store_dwordx4 v[4:7], v2, s[8:11], s20 offen sc1
    s_mov_b32 s20, 689152
    buffer_store_dwordx4 v[4:7], v2, s[8:11], s20 offen sc1
    s_mov_b32 s20, 754688
    buffer_store_dwordx4 v[4:7], v2, s[8:11], s20 offen sc1
    s_mov_b32 s20, 851968
    buffer_store_dwordx4 v[4:7], v2, s[8:11], s20 offen sc1
    s_mov_b32 s20, 950272
    buffer_store_dwordx4 v[4:7], v2, s[8:11], s20 offen sc1
    s_mov_b32 s20, 1015808
    buffer_store_dwordx4 v[4:7], v2, s[8:11], s20 offen sc1
    s_mov_b32 s20, 417792
    buffer_store_dwordx4 v[4:7], v2, s[8:11], s20 offen sc1
    s_branch IJ_END
IJ_3:
    s_mov_b32 s20, 20983808
    buffer_store_dwordx4 v[4:7], v2, s[8:11], s20 offen sc1
    s_mov_b32 s20, 21032960
    buffer_store_dwordx4 v[4:7], v2, s[8:11], s20 offen sc1
    s_mov_b32 s20, 21082112
    buffer_store_dwordx4 v[4:7], v2, s[8:11], s20 offen sc1
    s_mov_b32 s20, 21131264
    buffer_store_dwordx4 v[4:7], v2, s[8:11], s20 offen sc1
    s_mov_b32 s20, 21213184
    buffer_store_dwordx4 v[4:7], v2, s[8:11], s20 offen sc1
    s_mov_b32 s20, 21262336
    buffer_store_dwordx4 v[4:7], v2, s[8:11], s20 offen sc1
    s_mov_b32 s20, 21311488
    buffer_store_dwordx4 v[4:7], v2, s[8:11], s20 offen sc1
    s_mov_b32 s20, 21524480
    buffer_store_dwordx4 v[4:7], v2, s[8:11], s20 offen sc1
    s_mov_b32 s20, 21573632
    buffer_store_dwordx4 v[4:7], v2, s[8:11], s20 offen sc1
    s_mov_b32 s20, 21622784
    buffer_store_dwordx4 v[4:7], v2, s[8:11], s20 offen sc1
    s_mov_b32 s20, 21704704
    buffer_store_dwordx4 v[4:7], v2, s[8:11], s20 offen sc1
    s_mov_b32 s20, 21753856
    buffer_store_dwordx4 v[4:7], v2, s[8:11], s20 offen sc1
    s_mov_b32 s20, 21803008
    buffer_store_dwordx4 v[4:7], v2, s[8:11], s20 offen sc1
    s_mov_b32 s20, 21852160
    buffer_store_dwordx4 v[4:7], v2, s[8:11], s20 offen sc1
    s_mov_b32 s20, 22065152
    buffer_store_dwordx4 v[4:7], v2, s[8:11], s20 offen sc1
    s_mov_b32 s20, 22114304
    buffer_store_dwordx4 v[4:7], v2, s[8:11], s20 offen sc1
    s_mov_b32 s20, 22163456
    buffer_store_dwordx4 v[4:7], v2, s[8:11], s20 offen sc1
    s_mov_b32 s20, 22245376
    buffer_store_dwordx4 v[4:7], v2, s[8:11], s20 offen sc1
    s_mov_b32 s20, 22294528
    buffer_store_dwordx4 v[4:7], v2, s[8:11], s20 offen sc1
    s_mov_b32 s20, 22343680
    buffer_store_dwordx4 v[4:7], v2, s[8:11], s20 offen sc1
    s_mov_b32 s20, 22556672
    buffer_store_dwordx4 v[4:7], v2, s[8:11], s20 offen sc1
    s_mov_b32 s20, 22605824
    buffer_store_dwordx4 v[4:7], v2, s[8:11], s20 offen sc1
    s_mov_b32 s20, 22654976
    buffer_store_dwordx4 v[4:7], v2, s[8:11], s20 offen sc1
    s_mov_b32 s20, 22704128
    buffer_store_dwordx4 v[4:7], v2, s[8:11], s20 offen sc1
    s_mov_b32 s20, 22786048
    buffer_store_dwordx4 v[4:7], v2, s[8:11], s20 offen sc1
    s_mov_b32 s20, 22835200
    buffer_store_dwordx4 v[4:7], v2, s[8:11], s20 offen sc1
    s_mov_b32 s20, 22884352
    buffer_store_dwordx4 v[4:7], v2, s[8:11], s20 offen sc1
    s_mov_b32 s20, 594944
    buffer_store_dwordx4 v[4:7], v2, s[8:11], s20 offen sc1
    s_mov_b32 s20, 693248
    buffer_store_dwordx4 v[4:7], v2, s[8:11], s20 offen sc1
    s_mov_b32 s20, 758784
    buffer_store_dwordx4 v[4:7], v2, s[8:11], s20 offen sc1
    s_mov_b32 s20, 856064
    buffer_store_dwordx4 v[4:7], v2, s[8:11], s20 offen sc1
    s_mov_b32 s20, 954368
    buffer_store_dwordx4 v[4:7], v2, s[8:11], s20 offen sc1
    s_mov_b32 s20, 1019904
    buffer_store_dwordx4 v[4:7], v2, s[8:11], s20 offen sc1
    s_mov_b32 s20, 421888
    buffer_store_dwordx4 v[4:7], v2, s[8:11], s20 offen sc1
    s_branch IJ_END
IJ_4:
    s_mov_b32 s20, 20987904
    buffer_store_dwordx4 v[4:7], v2, s[8:11], s20 offen sc1
    s_mov_b32 s20, 21037056
    buffer_store_dwordx4 v[4:7], v2, s[8:11], s20 offen sc1
    s_mov_b32 s20, 21086208
    buffer_store_dwordx4 v[4:7], v2, s[8:11], s20 offen sc1
    s_mov_b32 s20, 21168128
    buffer_store_dwordx4 v[4:7], v2, s[8:11], s20 offen sc1
    s_mov_b32 s20, 21217280
    buffer_store_dwordx4 v[4:7], v2, s[8:11], s20 offen sc1
    s_mov_b32 s20, 21266432
    buffer_store_dwordx4 v[4:7], v2, s[8:11], s20 offen sc1
    s_mov_b32 s20, 21315584
    buffer_store_dwordx4 v[4:7], v2, s[8:11], s20 offen sc1
    s_mov_b32 s20, 21528576
    buffer_store_dwordx4 v[4:7], v2, s[8:11], s20 offen sc1
    s_mov_b32 s20, 21577728
    buffer_store_dwordx4 v[4:7], v2, s[8:11], s20 offen sc1
    s_mov_b32 s20, 21626880
    buffer_store_dwordx4 v[4:7], v2, s[8:11], s20 offen sc1
    s_mov_b32 s20, 21708800
    buffer_store_dwordx4 v[4:7], v2, s[8:11], s20 offen sc1
    s_mov_b32 s20, 21757952
    buffer_store_dwordx4 v[4:7], v2, s[8:11], s20 offen sc1
    s_mov_b32 s20, 21807104
    buffer_store_dwordx4 v[4:7], v2, s[8:11], s20 offen sc1
    s_mov_b32 s20, 22020096
    buffer_store_dwordx4 v[4:7], v2, s[8:11], s20 offen sc1
    s_mov_b32 s20, 22069248
    buffer_store_dwordx4 v[4:7], v2, s[8:11], s20 offen sc1
    s_mov_b32 s20, 22118400
    buffer_store_dwordx4 v[4:7], v2, s[8:11], s20 offen sc1
    s_mov_b32 s20, 22167552
    buffer_store_dwordx4 v[4:7], v2, s[8:11], s20 offen sc1
    s_mov_b32 s20, 22249472
    buffer_store_dwordx4 v[4:7], v2, s[8:11], s20 offen sc1
    s_mov_b32 s20, 22298624
    buffer_store_dwordx4 v[4:7], v2, s[8:11], s20 offen sc1
    s_mov_b32 s20, 22347776
    buffer_store_dwordx4 v[4:7], v2, s[8:11], s20 offen sc1
    s_mov_b32 s20, 22560768
    buffer_store_dwordx4 v[4:7], v2, s[8:11], s20 offen sc1
    s_mov_b32 s20, 22609920
    buffer_store_dwordx4 v[4:7], v2, s[8:11], s20 offen sc1
    s_mov_b32 s20, 22659072
    buffer_store_dwordx4 v[4:7], v2, s[8:11], s20 offen sc1
    s_mov_b32 s20, 22740992
    buffer_store_dwordx4 v[4:7], v2, s[8:11], s20 offen sc1
    s_mov_b32 s20, 22790144
    buffer_store_dwordx4 v[4:7], v2, s[8:11], s20 offen sc1
    s_mov_b32 s20, 22839296
    buffer_store_dwordx4 v[4:7], v2, s[8:11], s20 offen sc1
    s_mov_b32 s20, 22888448
    buffer_store_dwordx4 v[4:7], v2, s[8:11], s20 offen sc1
    s_mov_b32 s20, 599040
    buffer_store_dwordx4 v[4:7], v2, s[8:11], s20 offen sc1
    s_mov_b32 s20, 697344
    buffer_store_dwordx4 v[4:7], v2, s[8:11], s20 offen sc1
    s_mov_b32 s20, 762880
    buffer_store_dwordx4 v[4:7], v2, s[8:11], s20 offen sc1
    s_mov_b32 s20, 860160
    buffer_store_dwordx4 v[4:7], v2, s[8:11], s20 offen sc1
    s_mov_b32 s20, 958464
    buffer_store_dwordx4 v[4:7], v2, s[8:11], s20 offen sc1
    s_mov_b32 s20, 1024000
    buffer_store_dwordx4 v[4:7], v2, s[8:11], s20 offen sc1
    s_mov_b32 s20, 425984
    buffer_store_dwordx4 v[4:7], v2, s[8:11], s20 offen sc1
    s_branch IJ_END
IJ_5:
    s_mov_b32 s20, 20992000
    buffer_store_dwordx4 v[4:7], v2, s[8:11], s20 offen sc1
    s_mov_b32 s20, 21041152
    buffer_store_dwordx4 v[4:7], v2, s[8:11], s20 offen sc1
    s_mov_b32 s20, 21090304
    buffer_store_dwordx4 v[4:7], v2, s[8:11], s20 offen sc1
    s_mov_b32 s20, 21172224
    buffer_store_dwordx4 v[4:7], v2, s[8:11], s20 offen sc1
    s_mov_b32 s20, 21221376
    buffer_store_dwordx4 v[4:7], v2, s[8:11], s20 offen sc1
    s_mov_b32 s20, 21270528
    buffer_store_dwordx4 v[4:7], v2, s[8:11], s20 offen sc1
    s_mov_b32 s20, 21319680
    buffer_store_dwordx4 v[4:7], v2, s[8:11], s20 offen sc1
    s_mov_b32 s20, 21532672
    buffer_store_dwordx4 v[4:7], v2, s[8:11], s20 offen sc1
    s_mov_b32 s20, 21581824
    buffer_store_dwordx4 v[4:7], v2, s[8:11], s20 offen sc1
    s_mov_b32 s20, 21630976
    buffer_store_dwordx4 v[4:7], v2, s[8:11], s20 offen sc1
    s_mov_b32 s20, 21712896
    buffer_store_dwordx4 v[4:7], v2, s[8:11], s20 offen sc1
    s_mov_b32 s20, 21762048
    buffer_store_dwordx4 v[4:7], v2, s[8:11], s20 offen sc1
    s_mov_b32 s20, 21811200
    buffer_store_dwordx4 v[4:7], v2, s[8:11], s20 offen sc1
    s_mov_b32 s20, 22024192
    buffer_store_dwordx4 v[4:7], v2, s[8:11], s20 offen sc1
    s_mov_b32 s20, 22073344
    buffer_store_dwordx4 v[4:7], v2, s[8:11], s20 offen sc1
    s_mov_b32 s20, 22122496
    buffer_store_dwordx4 v[4:7], v2, s[8:11], s20 offen sc1
    s_mov_b32 s20, 22171648
    buffer_store_dwordx4 v[4:7], v2, s[8:11], s20 offen sc1
    s_mov_b32 s20, 22253568
    buffer_store_dwordx4 v[4:7], v2, s[8:11], s20 offen sc1
    s_mov_b32 s20, 22302720
    buffer_store_dwordx4 v[4:7], v2, s[8:11], s20 offen sc1
    s_mov_b32 s20, 22351872
    buffer_store_dwordx4 v[4:7], v2, s[8:11], s20 offen sc1
    s_mov_b32 s20, 22564864
    buffer_store_dwordx4 v[4:7], v2, s[8:11], s20 offen sc1
    s_mov_b32 s20, 22614016
    buffer_store_dwordx4 v[4:7], v2, s[8:11], s20 offen sc1
    s_mov_b32 s20, 22663168
    buffer_store_dwordx4 v[4:7], v2, s[8:11], s20 offen sc1
    s_mov_b32 s20, 22745088
    buffer_store_dwordx4 v[4:7], v2, s[8:11], s20 offen sc1
    s_mov_b32 s20, 22794240
    buffer_store_dwordx4 v[4:7], v2, s[8:11], s20 offen sc1
    s_mov_b32 s20, 22843392
    buffer_store_dwordx4 v[4:7], v2, s[8:11], s20 offen sc1
    s_mov_b32 s20, 22892544
    buffer_store_dwordx4 v[4:7], v2, s[8:11], s20 offen sc1
    s_mov_b32 s20, 603136
    buffer_store_dwordx4 v[4:7], v2, s[8:11], s20 offen sc1
    s_mov_b32 s20, 701440
    buffer_store_dwordx4 v[4:7], v2, s[8:11], s20 offen sc1
    s_mov_b32 s20, 766976
    buffer_store_dwordx4 v[4:7], v2, s[8:11], s20 offen sc1
    s_mov_b32 s20, 864256
    buffer_store_dwordx4 v[4:7], v2, s[8:11], s20 offen sc1
    s_mov_b32 s20, 962560
    buffer_store_dwordx4 v[4:7], v2, s[8:11], s20 offen sc1
    s_mov_b32 s20, 1028096
    buffer_store_dwordx4 v[4:7], v2, s[8:11], s20 offen sc1
    s_mov_b32 s20, 430080
    buffer_store_dwordx4 v[4:7], v2, s[8:11], s20 offen sc1
    s_branch IJ_END
IJ_6:
    s_mov_b32 s20, 20996096
    buffer_store_dwordx4 v[4:7], v2, s[8:11], s20 offen sc1
    s_mov_b32 s20, 21045248
    buffer_store_dwordx4 v[4:7], v2, s[8:11], s20 offen sc1
    s_mov_b32 s20, 21094400
    buffer_store_dwordx4 v[4:7], v2, s[8:11], s20 offen sc1
    s_mov_b32 s20, 21176320
    buffer_store_dwordx4 v[4:7], v2, s[8:11], s20 offen sc1
    s_mov_b32 s20, 21225472
    buffer_store_dwordx4 v[4:7], v2, s[8:11], s20 offen sc1
    s_mov_b32 s20, 21274624
    buffer_store_dwordx4 v[4:7], v2, s[8:11], s20 offen sc1
    s_mov_b32 s20, 21323776
    buffer_store_dwordx4 v[4:7], v2, s[8:11], s20 offen sc1
    s_mov_b32 s20, 21536768
    buffer_store_dwordx4 v[4:7], v2, s[8:11], s20 offen sc1
    s_mov_b32 s20, 21585920
    buffer_store_dwordx4 v[4:7], v2, s[8:11], s20 offen sc1
    s_mov_b32 s20, 21635072
    buffer_store_dwordx4 v[4:7], v2, s[8:11], s20 offen sc1
    s_mov_b32 s20, 21716992
    buffer_store_dwordx4 v[4:7], v2, s[8:11], s20 offen sc1
    s_mov_b32 s20, 21766144
    buffer_store_dwordx4 v[4:7], v2, s[8:11], s20 offen sc1
    s_mov_b32 s20, 21815296
    buffer_store_dwordx4 v[4:7], v2, s[8:11], s20 offen sc1
    s_mov_b32 s20, 22028288
    buffer_store_dwordx4 v[4:7], v2, s[8:11], s20 offen sc1
    s_mov_b32 s20, 22077440
    buffer_store_dwordx4 v[4:7], v2, s[8:11], s20 offen sc1
    s_mov_b32 s20, 22126592
    buffer_store_dwordx4 v[4:7], v2, s[8:11], s20 offen sc1
    s_mov_b32 s20, 22175744
    buffer_store_dwordx4 v[4:7], v2, s[8:11], s20 offen sc1
    s_mov_b32 s20, 22257664
    buffer_store_dwordx4 v[4:7], v2, s[8:11], s20 offen sc1
    s_mov_b32 s20, 22306816
    buffer_store_dwordx4 v[4:7], v2, s[8:11], s20 offen sc1
    s_mov_b32 s20, 22355968
    buffer_store_dwordx4 v[4:7], v2, s[8:11], s20 offen sc1
    s_mov_b32 s20, 22568960
    buffer_store_dwordx4 v[4:7], v2, s[8:11], s20 offen sc1
    s_mov_b32 s20, 22618112
    buffer_store_dwordx4 v[4:7], v2, s[8:11], s20 offen sc1
    s_mov_b32 s20, 22667264
    buffer_store_dwordx4 v[4:7], v2, s[8:11], s20 offen sc1
    s_mov_b32 s20, 22749184
    buffer_store_dwordx4 v[4:7], v2, s[8:11], s20 offen sc1
    s_mov_b32 s20, 22798336
    buffer_store_dwordx4 v[4:7], v2, s[8:11], s20 offen sc1
    s_mov_b32 s20, 22847488
    buffer_store_dwordx4 v[4:7], v2, s[8:11], s20 offen sc1
    s_mov_b32 s20, 22896640
    buffer_store_dwordx4 v[4:7], v2, s[8:11], s20 offen sc1
    s_mov_b32 s20, 607232
    buffer_store_dwordx4 v[4:7], v2, s[8:11], s20 offen sc1
    s_mov_b32 s20, 705536
    buffer_store_dwordx4 v[4:7], v2, s[8:11], s20 offen sc1
    s_mov_b32 s20, 771072
    buffer_store_dwordx4 v[4:7], v2, s[8:11], s20 offen sc1
    s_mov_b32 s20, 868352
    buffer_store_dwordx4 v[4:7], v2, s[8:11], s20 offen sc1
    s_mov_b32 s20, 966656
    buffer_store_dwordx4 v[4:7], v2, s[8:11], s20 offen sc1
    s_mov_b32 s20, 1032192
    buffer_store_dwordx4 v[4:7], v2, s[8:11], s20 offen sc1
    s_mov_b32 s20, 434176
    buffer_store_dwordx4 v[4:7], v2, s[8:11], s20 offen sc1
    s_branch IJ_END
IJ_7:
    s_mov_b32 s20, 21000192
    buffer_store_dwordx4 v[4:7], v2, s[8:11], s20 offen sc1
    s_mov_b32 s20, 21049344
    buffer_store_dwordx4 v[4:7], v2, s[8:11], s20 offen sc1
    s_mov_b32 s20, 21098496
    buffer_store_dwordx4 v[4:7], v2, s[8:11], s20 offen sc1
    s_mov_b32 s20, 21180416
    buffer_store_dwordx4 v[4:7], v2, s[8:11], s20 offen sc1
    s_mov_b32 s20, 21229568
    buffer_store_dwordx4 v[4:7], v2, s[8:11], s20 offen sc1
    s_mov_b32 s20, 21278720
    buffer_store_dwordx4 v[4:7], v2, s[8:11], s20 offen sc1
    s_mov_b32 s20, 21327872
    buffer_store_dwordx4 v[4:7], v2, s[8:11], s20 offen sc1
    s_mov_b32 s20, 21540864
    buffer_store_dwordx4 v[4:7], v2, s[8:11], s20 offen sc1
    s_mov_b32 s20, 21590016
    buffer_store_dwordx4 v[4:7], v2, s[8:11], s20 offen sc1
    s_mov_b32 s20, 21639168
    buffer_store_dwordx4 v[4:7], v2, s[8:11], s20 offen sc1
    s_mov_b32 s20, 21721088
    buffer_store_dwordx4 v[4:7], v2, s[8:11], s20 offen sc1
    s_mov_b32 s20, 21770240
    buffer_store_dwordx4 v[4:7], v2, s[8:11], s20 offen sc1
    s_mov_b32 s20, 21819392
    buffer_store_dwordx4 v[4:7], v2, s[8:11], s20 offen sc1
    s_mov_b32 s20, 22032384
    buffer_store_dwordx4 v[4:7], v2, s[8:11], s20 offen sc1
    s_mov_b32 s20, 22081536
    buffer_store_dwordx4 v[4:7], v2, s[8:11], s20 offen sc1
    s_mov_b32 s20, 22130688
    buffer_store_dwordx4 v[4:7], v2, s[8:11], s20 offen sc1
    s_mov_b32 s20, 22179840
    buffer_store_dwordx4 v[4:7], v2, s[8:11], s20 offen sc1
    s_mov_b32 s20, 22261760
    buffer_store_dwordx4 v[4:7], v2, s[8:11], s20 offen sc1
    s_mov_b32 s20, 22310912
    buffer_store_dwordx4 v[4:7], v2, s[8:11], s20 offen sc1
    s_mov_b32 s20, 22360064
    buffer_store_dwordx4 v[4:7], v2, s[8:11], s20 offen sc1
    s_mov_b32 s20, 22573056
    buffer_store_dwordx4 v[4:7], v2, s[8:11], s20 offen sc1
    s_mov_b32 s20, 22622208
    buffer_store_dwordx4 v[4:7], v2, s[8:11], s20 offen sc1
    s_mov_b32 s20, 22671360
    buffer_store_dwordx4 v[4:7], v2, s[8:11], s20 offen sc1
    s_mov_b32 s20, 22753280
    buffer_store_dwordx4 v[4:7], v2, s[8:11], s20 offen sc1
    s_mov_b32 s20, 22802432
    buffer_store_dwordx4 v[4:7], v2, s[8:11], s20 offen sc1
    s_mov_b32 s20, 22851584
    buffer_store_dwordx4 v[4:7], v2, s[8:11], s20 offen sc1
    s_mov_b32 s20, 22900736
    buffer_store_dwordx4 v[4:7], v2, s[8:11], s20 offen sc1
    s_mov_b32 s20, 615424
    buffer_store_dwordx4 v[4:7], v2, s[8:11], s20 offen sc1
    s_mov_b32 s20, 713728
    buffer_store_dwordx4 v[4:7], v2, s[8:11], s20 offen sc1
    s_mov_b32 s20, 779264
    buffer_store_dwordx4 v[4:7], v2, s[8:11], s20 offen sc1
    s_mov_b32 s20, 876544
    buffer_store_dwordx4 v[4:7], v2, s[8:11], s20 offen sc1
    s_mov_b32 s20, 974848
    buffer_store_dwordx4 v[4:7], v2, s[8:11], s20 offen sc1
    s_mov_b32 s20, 1040384
    buffer_store_dwordx4 v[4:7], v2, s[8:11], s20 offen sc1
    s_mov_b32 s20, 438272
    buffer_store_dwordx4 v[4:7], v2, s[8:11], s20 offen sc1
    s_branch IJ_END
IJ_8:
    s_mov_b32 s20, 21004288
    buffer_store_dwordx4 v[4:7], v2, s[8:11], s20 offen sc1
    s_mov_b32 s20, 21053440
    buffer_store_dwordx4 v[4:7], v2, s[8:11], s20 offen sc1
    s_mov_b32 s20, 21102592
    buffer_store_dwordx4 v[4:7], v2, s[8:11], s20 offen sc1
    s_mov_b32 s20, 21184512
    buffer_store_dwordx4 v[4:7], v2, s[8:11], s20 offen sc1
    s_mov_b32 s20, 21233664
    buffer_store_dwordx4 v[4:7], v2, s[8:11], s20 offen sc1
    s_mov_b32 s20, 21282816
    buffer_store_dwordx4 v[4:7], v2, s[8:11], s20 offen sc1
    s_mov_b32 s20, 21495808
    buffer_store_dwordx4 v[4:7], v2, s[8:11], s20 offen sc1
    s_mov_b32 s20, 21544960
    buffer_store_dwordx4 v[4:7], v2, s[8:11], s20 offen sc1
    s_mov_b32 s20, 21594112
    buffer_store_dwordx4 v[4:7], v2, s[8:11], s20 offen sc1
    s_mov_b32 s20, 21643264
    buffer_store_dwordx4 v[4:7], v2, s[8:11], s20 offen sc1
    s_mov_b32 s20, 21725184
    buffer_store_dwordx4 v[4:7], v2, s[8:11], s20 offen sc1
    s_mov_b32 s20, 21774336
    buffer_store_dwordx4 v[4:7], v2, s[8:11], s20 offen sc1
    s_mov_b32 s20, 21823488
    buffer_store_dwordx4 v[4:7], v2, s[8:11], s20 offen sc1
    s_mov_b32 s20, 22036480
    buffer_store_dwordx4 v[4:7], v2, s[8:11], s20 offen sc1
    s_mov_b32 s20, 22085632
    buffer_store_dwordx4 v[4:7], v2, s[8:11], s20 offen sc1
    s_mov_b32 s20, 22134784
    buffer_store_dwordx4 v[4:7], v2, s[8:11], s20 offen sc1
    s_mov_b32 s20, 22216704
    buffer_store_dwordx4 v[4:7], v2, s[8:11], s20 offen sc1
    s_mov_b32 s20, 22265856
    buffer_store_dwordx4 v[4:7], v2, s[8:11], s20 offen sc1
    s_mov_b32 s20, 22315008
    buffer_store_dwordx4 v[4:7], v2, s[8:11], s20 offen sc1
    s_mov_b32 s20, 22364160
    buffer_store_dwordx4 v[4:7], v2, s[8:11], s20 offen sc1
    s_mov_b32 s20, 22577152
    buffer_store_dwordx4 v[4:7], v2, s[8:11], s20 offen sc1
    s_mov_b32 s20, 22626304
    buffer_store_dwordx4 v[4:7], v2, s[8:11], s20 offen sc1
    s_mov_b32 s20, 22675456
    buffer_store_dwordx4 v[4:7], v2, s[8:11], s20 offen sc1
    s_mov_b32 s20, 22757376
    buffer_store_dwordx4 v[4:7], v2, s[8:11], s20 offen sc1
    s_mov_b32 s20, 22806528
    buffer_store_dwordx4 v[4:7], v2, s[8:11], s20 offen sc1
    s_mov_b32 s20, 22855680
    buffer_store_dwordx4 v[4:7], v2, s[8:11], s20 offen sc1
    s_mov_b32 s20, 558080
    buffer_store_dwordx4 v[4:7], v2, s[8:11], s20 offen sc1
    s_mov_b32 s20, 623616
    buffer_store_dwordx4 v[4:7], v2, s[8:11], s20 offen sc1
    s_mov_b32 s20, 721920
    buffer_store_dwordx4 v[4:7], v2, s[8:11], s20 offen sc1
    s_mov_b32 s20, 819200
    buffer_store_dwordx4 v[4:7], v2, s[8:11], s20 offen sc1
    s_mov_b32 s20, 884736
    buffer_store_dwordx4 v[4:7], v2, s[8:11], s20 offen sc1
    s_mov_b32 s20, 983040
    buffer_store_dwordx4 v[4:7], v2, s[8:11], s20 offen sc1
    s_mov_b32 s20, 393216
    buffer_store_dwordx4 v[4:7], v2, s[8:11], s20 offen sc1
    s_mov_b32 s20, 442368
    buffer_store_dwordx4 v[4:7], v2, s[8:11], s20 offen sc1
    s_branch IJ_END
IJ_9:
    s_mov_b32 s20, 21008384
    buffer_store_dwordx4 v[4:7], v2, s[8:11], s20 offen sc1
    s_mov_b32 s20, 21057536
    buffer_store_dwordx4 v[4:7], v2, s[8:11], s20 offen sc1
    s_mov_b32 s20, 21106688
    buffer_store_dwordx4 v[4:7], v2, s[8:11], s20 offen sc1
    s_mov_b32 s20, 21188608
    buffer_store_dwordx4 v[4:7], v2, s[8:11], s20 offen sc1
    s_mov_b32 s20, 21237760
    buffer_store_dwordx4 v[4:7], v2, s[8:11], s20 offen sc1
    s_mov_b32 s20, 21286912
    buffer_store_dwordx4 v[4:7], v2, s[8:11], s20 offen sc1
    s_mov_b32 s20, 21499904
    buffer_store_dwordx4 v[4:7], v2, s[8:11], s20 offen sc1
    s_mov_b32 s20, 21549056
    buffer_store_dwordx4 v[4:7], v2, s[8:11], s20 offen sc1
    s_mov_b32 s20, 21598208
    buffer_store_dwordx4 v[4:7], v2, s[8:11], s20 offen sc1
    s_mov_b32 s20, 21647360
    buffer_store_dwordx4 v[4:7], v2, s[8:11], s20 offen sc1
    s_mov_b32 s20, 21729280
    buffer_store_dwordx4 v[4:7], v2, s[8:11], s20 offen sc1
    s_mov_b32 s20, 21778432
    buffer_store_dwordx4 v[4:7], v2, s[8:11], s20 offen sc1
    s_mov_b32 s20, 21827584
    buffer_store_dwordx4 v[4:7], v2, s[8:11], s20 offen sc1
    s_mov_b32 s20, 22040576
    buffer_store_dwordx4 v[4:7], v2, s[8:11], s20 offen sc1
    s_mov_b32 s20, 22089728
    buffer_store_dwordx4 v[4:7], v2, s[8:11], s20 offen sc1
    s_mov_b32 s20, 22138880
    buffer_store_dwordx4 v[4:7], v2, s[8:11], s20 offen sc1
    s_mov_b32 s20, 22220800
    buffer_store_dwordx4 v[4:7], v2, s[8:11], s20 offen sc1
    s_mov_b32 s20, 22269952
    buffer_store_dwordx4 v[4:7], v2, s[8:11], s20 offen sc1
    s_mov_b32 s20, 22319104
    buffer_store_dwordx4 v[4:7], v2, s[8:11], s20 offen sc1
    s_mov_b32 s20, 22368256
    buffer_store_dwordx4 v[4:7], v2, s[8:11], s20 offen sc1
    s_mov_b32 s20, 22581248
    buffer_store_dwordx4 v[4:7], v2, s[8:11], s20 offen sc1
    s_mov_b32 s20, 22630400
    buffer_store_dwordx4 v[4:7], v2, s[8:11], s20 offen sc1
    s_mov_b32 s20, 22679552
    buffer_store_dwordx4 v[4:7], v2, s[8:11], s20 offen sc1
    s_mov_b32 s20, 22761472
    buffer_store_dwordx4 v[4:7], v2, s[8:11], s20 offen sc1
    s_mov_b32 s20, 22810624
    buffer_store_dwordx4 v[4:7], v2, s[8:11], s20 offen sc1
    s_mov_b32 s20, 22859776
    buffer_store_dwordx4 v[4:7], v2, s[8:11], s20 offen sc1
    s_mov_b32 s20, 562176
    buffer_store_dwordx4 v[4:7], v2, s[8:11], s20 offen sc1
    s_mov_b32 s20, 627712
    buffer_store_dwordx4 v[4:7], v2, s[8:11], s20 offen sc1
    s_mov_b32 s20, 726016
    buffer_store_dwordx4 v[4:7], v2, s[8:11], s20 offen sc1
    s_mov_b32 s20, 823296
    buffer_store_dwordx4 v[4:7], v2, s[8:11], s20 offen sc1
    s_mov_b32 s20, 888832
    buffer_store_dwordx4 v[4:7], v2, s[8:11], s20 offen sc1
    s_mov_b32 s20, 987136
    buffer_store_dwordx4 v[4:7], v2, s[8:11], s20 offen sc1
    s_mov_b32 s20, 397312
    buffer_store_dwordx4 v[4:7], v2, s[8:11], s20 offen sc1
    s_mov_b32 s20, 446464
    buffer_store_dwordx4 v[4:7], v2, s[8:11], s20 offen sc1
    s_branch IJ_END
IJ_10:
    s_mov_b32 s20, 21012480
    buffer_store_dwordx4 v[4:7], v2, s[8:11], s20 offen sc1
    s_mov_b32 s20, 21061632
    buffer_store_dwordx4 v[4:7], v2, s[8:11], s20 offen sc1
    s_mov_b32 s20, 21110784
    buffer_store_dwordx4 v[4:7], v2, s[8:11], s20 offen sc1
    s_mov_b32 s20, 21192704
    buffer_store_dwordx4 v[4:7], v2, s[8:11], s20 offen sc1
    s_mov_b32 s20, 21241856
    buffer_store_dwordx4 v[4:7], v2, s[8:11], s20 offen sc1
    s_mov_b32 s20, 21291008
    buffer_store_dwordx4 v[4:7], v2, s[8:11], s20 offen sc1
    s_mov_b32 s20, 21504000
    buffer_store_dwordx4 v[4:7], v2, s[8:11], s20 offen sc1
    s_mov_b32 s20, 21553152
    buffer_store_dwordx4 v[4:7], v2, s[8:11], s20 offen sc1
    s_mov_b32 s20, 21602304
    buffer_store_dwordx4 v[4:7], v2, s[8:11], s20 offen sc1
    s_mov_b32 s20, 21651456
    buffer_store_dwordx4 v[4:7], v2, s[8:11], s20 offen sc1
    s_mov_b32 s20, 21733376
    buffer_store_dwordx4 v[4:7], v2, s[8:11], s20 offen sc1
    s_mov_b32 s20, 21782528
    buffer_store_dwordx4 v[4:7], v2, s[8:11], s20 offen sc1
    s_mov_b32 s20, 21831680
    buffer_store_dwordx4 v[4:7], v2, s[8:11], s20 offen sc1
    s_mov_b32 s20, 22044672
    buffer_store_dwordx4 v[4:7], v2, s[8:11], s20 offen sc1
    s_mov_b32 s20, 22093824
    buffer_store_dwordx4 v[4:7], v2, s[8:11], s20 offen sc1
    s_mov_b32 s20, 22142976
    buffer_store_dwordx4 v[4:7], v2, s[8:11], s20 offen sc1
    s_mov_b32 s20, 22224896
    buffer_store_dwordx4 v[4:7], v2, s[8:11], s20 offen sc1
    s_mov_b32 s20, 22274048
    buffer_store_dwordx4 v[4:7], v2, s[8:11], s20 offen sc1
    s_mov_b32 s20, 22323200
    buffer_store_dwordx4 v[4:7], v2, s[8:11], s20 offen sc1
    s_mov_b32 s20, 22372352
    buffer_store_dwordx4 v[4:7], v2, s[8:11], s20 offen sc1
    s_mov_b32 s20, 22585344
    buffer_store_dwordx4 v[4:7], v2, s[8:11], s20 offen sc1
    s_mov_b32 s20, 22634496
    buffer_store_dwordx4 v[4:7], v2, s[8:11], s20 offen sc1
    s_mov_b32 s20, 22683648
    buffer_store_dwordx4 v[4:7], v2, s[8:11], s20 offen sc1
    s_mov_b32 s20, 22765568
    buffer_store_dwordx4 v[4:7], v2, s[8:11], s20 offen sc1
    s_mov_b32 s20, 22814720
    buffer_store_dwordx4 v[4:7], v2, s[8:11], s20 offen sc1
    s_mov_b32 s20, 22863872
    buffer_store_dwordx4 v[4:7], v2, s[8:11], s20 offen sc1
    s_mov_b32 s20, 566272
    buffer_store_dwordx4 v[4:7], v2, s[8:11], s20 offen sc1
    s_mov_b32 s20, 631808
    buffer_store_dwordx4 v[4:7], v2, s[8:11], s20 offen sc1
    s_mov_b32 s20, 730112
    buffer_store_dwordx4 v[4:7], v2, s[8:11], s20 offen sc1
    s_mov_b32 s20, 827392
    buffer_store_dwordx4 v[4:7], v2, s[8:11], s20 offen sc1
    s_mov_b32 s20, 892928
    buffer_store_dwordx4 v[4:7], v2, s[8:11], s20 offen sc1
    s_mov_b32 s20, 991232
    buffer_store_dwordx4 v[4:7], v2, s[8:11], s20 offen sc1
    s_mov_b32 s20, 401408
    buffer_store_dwordx4 v[4:7], v2, s[8:11], s20 offen sc1
    s_mov_b32 s20, 450560
    buffer_store_dwordx4 v[4:7], v2, s[8:11], s20 offen sc1
    s_branch IJ_END
IJ_11:
    s_mov_b32 s20, 21016576
    buffer_store_dwordx4 v[4:7], v2, s[8:11], s20 offen sc1
    s_mov_b32 s20, 21065728
    buffer_store_dwordx4 v[4:7], v2, s[8:11], s20 offen sc1
    s_mov_b32 s20, 21114880
    buffer_store_dwordx4 v[4:7], v2, s[8:11], s20 offen sc1
    s_mov_b32 s20, 21196800
    buffer_store_dwordx4 v[4:7], v2, s[8:11], s20 offen sc1
    s_mov_b32 s20, 21245952
    buffer_store_dwordx4 v[4:7], v2, s[8:11], s20 offen sc1
    s_mov_b32 s20, 21295104
    buffer_store_dwordx4 v[4:7], v2, s[8:11], s20 offen sc1
    s_mov_b32 s20, 21508096
    buffer_store_dwordx4 v[4:7], v2, s[8:11], s20 offen sc1
    s_mov_b32 s20, 21557248
    buffer_store_dwordx4 v[4:7], v2, s[8:11], s20 offen sc1
    s_mov_b32 s20, 21606400
    buffer_store_dwordx4 v[4:7], v2, s[8:11], s20 offen sc1
    s_mov_b32 s20, 21655552
    buffer_store_dwordx4 v[4:7], v2, s[8:11], s20 offen sc1
    s_mov_b32 s20, 21737472
    buffer_store_dwordx4 v[4:7], v2, s[8:11], s20 offen sc1
    s_mov_b32 s20, 21786624
    buffer_store_dwordx4 v[4:7], v2, s[8:11], s20 offen sc1
    s_mov_b32 s20, 21835776
    buffer_store_dwordx4 v[4:7], v2, s[8:11], s20 offen sc1
    s_mov_b32 s20, 22048768
    buffer_store_dwordx4 v[4:7], v2, s[8:11], s20 offen sc1
    s_mov_b32 s20, 22097920
    buffer_store_dwordx4 v[4:7], v2, s[8:11], s20 offen sc1
    s_mov_b32 s20, 22147072
    buffer_store_dwordx4 v[4:7], v2, s[8:11], s20 offen sc1
    s_mov_b32 s20, 22228992
    buffer_store_dwordx4 v[4:7], v2, s[8:11], s20 offen sc1
    s_mov_b32 s20, 22278144
    buffer_store_dwordx4 v[4:7], v2, s[8:11], s20 offen sc1
    s_mov_b32 s20, 22327296
    buffer_store_dwordx4 v[4:7], v2, s[8:11], s20 offen sc1
    s_mov_b32 s20, 22376448
    buffer_store_dwordx4 v[4:7], v2, s[8:11], s20 offen sc1
    s_mov_b32 s20, 22589440
    buffer_store_dwordx4 v[4:7], v2, s[8:11], s20 offen sc1
    s_mov_b32 s20, 22638592
    buffer_store_dwordx4 v[4:7], v2, s[8:11], s20 offen sc1
    s_mov_b32 s20, 22687744
    buffer_store_dwordx4 v[4:7], v2, s[8:11], s20 offen sc1
    s_mov_b32 s20, 22769664
    buffer_store_dwordx4 v[4:7], v2, s[8:11], s20 offen sc1
    s_mov_b32 s20, 22818816
    buffer_store_dwordx4 v[4:7], v2, s[8:11], s20 offen sc1
    s_mov_b32 s20, 22867968
    buffer_store_dwordx4 v[4:7], v2, s[8:11], s20 offen sc1
    s_mov_b32 s20, 570368
    buffer_store_dwordx4 v[4:7], v2, s[8:11], s20 offen sc1
    s_mov_b32 s20, 635904
    buffer_store_dwordx4 v[4:7], v2, s[8:11], s20 offen sc1
    s_mov_b32 s20, 734208
    buffer_store_dwordx4 v[4:7], v2, s[8:11], s20 offen sc1
    s_mov_b32 s20, 831488
    buffer_store_dwordx4 v[4:7], v2, s[8:11], s20 offen sc1
    s_mov_b32 s20, 897024
    buffer_store_dwordx4 v[4:7], v2, s[8:11], s20 offen sc1
    s_mov_b32 s20, 995328
    buffer_store_dwordx4 v[4:7], v2, s[8:11], s20 offen sc1
    s_mov_b32 s20, 405504
    buffer_store_dwordx4 v[4:7], v2, s[8:11], s20 offen sc1
    s_mov_b32 s20, 454656
    buffer_store_dwordx4 v[4:7], v2, s[8:11], s20 offen sc1
    s_branch IJ_END
IJ_12:
    s_cmp_eq_u32 s18, 12
    s_mov_b32 s21, 786432
    s_cselect_b32 s21, 525312, s21
    v_bfe_u32 v3, v0, 2, 3
    v_mul_u32_u24 v3, 1280, v3
    v_bfe_u32 v8, v0, 5, 1
    v_mul_u32_u24 v8, 320, v8
    v_add_u32 v3, v3, v8
    v_lshrrev_b32 v8, 6, v0
    v_lshl_add_u32 v3, v8, 4, v3
    v_and_b32 v8, 1, v0
    v_lshl_add_u32 v3, v8, 3, v3
    v_bfe_u32 v8, v0, 1, 1
    v_lshl_add_u32 v3, v8, 1, v3
    v_lshlrev_b32 v9, 2, v0
    buffer_load_ushort v16, v3, s[12:15], 0 offen offset:0
    buffer_load_ushort v17, v3, s[12:15], 0 offen offset:4
    buffer_load_ushort v18, v3, s[12:15], 0 offen offset:640
    buffer_load_ushort v19, v3, s[12:15], 0 offen offset:644
    buffer_load_ushort v20, v3, s[12:15], 0 offen offset:64
    buffer_load_ushort v21, v3, s[12:15], 0 offen offset:68
    buffer_load_ushort v22, v3, s[12:15], 0 offen offset:704
    buffer_load_ushort v23, v3, s[12:15], 0 offen offset:708
    buffer_load_ushort v24, v3, s[12:15], 0 offen offset:128
    buffer_load_ushort v25, v3, s[12:15], 0 offen offset:132
    buffer_load_ushort v26, v3, s[12:15], 0 offen offset:768
    buffer_load_ushort v27, v3, s[12:15], 0 offen offset:772
    buffer_load_ushort v28, v3, s[12:15], 0 offen offset:192
    buffer_load_ushort v29, v3, s[12:15], 0 offen offset:196
    buffer_load_ushort v30, v3, s[12:15], 0 offen offset:832
    buffer_load_ushort v31, v3, s[12:15], 0 offen offset:836
    buffer_load_ushort v32, v3, s[12:15], 0 offen offset:256
    buffer_load_ushort v33, v3, s[12:15], 0 offen offset:260
    buffer_load_ushort v34, v3, s[12:15], 0 offen offset:896
    buffer_load_ushort v35, v3, s[12:15], 0 offen offset:900
    v_mov_b32 v4, 0
    v_mov_b32 v5, 0
    v_mov_b32 v6, 0
    v_mov_b32 v7, 0
    s_add_u32 s20, s21, 131072
    buffer_store_dwordx4 v[4:7], v2, s[8:11], s20 offen sc1
    s_add_u32 s20, s21, 135168
    buffer_store_dwordx4 v[4:7], v2, s[8:11], s20 offen sc1
    s_add_u32 s20, s21, 139264
    buffer_store_dwordx4 v[4:7], v2, s[8:11], s20 offen sc1
    s_add_u32 s20, s21, 143360
    buffer_store_dwordx4 v[4:7], v2, s[8:11], s20 offen sc1
    s_add_u32 s20, s21, 147456
    buffer_store_dwordx4 v[4:7], v2, s[8:11], s20 offen sc1
    s_add_u32 s20, s21, 155648
    buffer_store_dwordx4 v[4:7], v2, s[8:11], s20 offen sc1
    s_waitcnt vmcnt(24)
    v_lshl_or_b32 v16, v17, 16, v16
    v_min_u32 v16, 0xfffffffe, v16
    s_add_u32 s20, s21, 0
    buffer_store_dword v16, v9, s[8:11], s20 offen sc1
    s_add_u32 s20, s21, 8192
    buffer_store_dword v16, v9, s[8:11], s20 offen sc1
    s_waitcnt vmcnt(24)
    v_lshl_or_b32 v18, v19, 16, v18
    v_min_u32 v18, 0xfffffffe, v18
    s_add_u32 s20, s21, 1024
    buffer_store_dword v18, v9, s[8:11], s20 offen sc1
    s_add_u32 s20, s21, 9216
    buffer_store_dword v18, v9, s[8:11], s20 offen sc1
    s_waitcnt vmcnt(24)
    v_lshl_or_b32 v20, v21, 16, v20
    v_min_u32 v20, 0xfffffffe, v20
    s_add_u32 s20, s21, 2048
    buffer_store_dword v20, v9, s[8:11], s20 offen sc1
    s_add_u32 s20, s21, 10240
    buffer_store_dword v20, v9, s[8:11], s20 offen sc1
    s_waitcnt vmcnt(24)
    v_lshl_or_b32 v22, v23, 16, v22
    v_min_u32 v22, 0xfffffffe, v22
    s_add_u32 s20, s21, 3072
    buffer_store_dword v22, v9, s[8:11], s20 offen sc1
    s_add_u32 s20, s21, 11264
    buffer_store_dword v22, v9, s[8:11], s20 offen sc1
    s_waitcnt vmcnt(24)
    v_lshl_or_b32 v24, v25, 16, v24
    v_min_u32 v24, 0xfffffffe, v24
    s_add_u32 s20, s21, 4096
    buffer_store_dword v24, v9, s[8:11], s20 offen sc1
    s_add_u32 s20, s21, 12288
    buffer_store_dword v24, v9, s[8:11], s20 offen sc1
    s_waitcnt vmcnt(24)
    v_lshl_or_b32 v26, v27, 16, v26
    v_min_u32 v26, 0xfffffffe, v26
    s_add_u32 s20, s21, 5120
    buffer_store_dword v26, v9, s[8:11], s20 offen sc1
    s_add_u32 s20, s21, 13312
    buffer_store_dword v26, v9, s[8:11], s20 offen sc1
    s_waitcnt vmcnt(24)
    v_lshl_or_b32 v28, v29, 16, v28
    v_min_u32 v28, 0xfffffffe, v28
    s_add_u32 s20, s21, 6144
    buffer_store_dword v28, v9, s[8:11], s20 offen sc1
    s_add_u32 s20, s21, 14336
    buffer_store_dword v28, v9, s[8:11], s20 offen sc1
    s_waitcnt vmcnt(24)
    v_lshl_or_b32 v30, v31, 16, v30
    v_min_u32 v30, 0xfffffffe, v30
    s_add_u32 s20, s21, 7168
    buffer_store_dword v30, v9, s[8:11], s20 offen sc1
    s_add_u32 s20, s21, 15360
    buffer_store_dword v30, v9, s[8:11], s20 offen sc1
    s_waitcnt vmcnt(24)
    v_lshl_or_b32 v32, v33, 16, v32
    v_min_u32 v32, 0xfffffffe, v32
    s_add_u32 s20, s21, 16384
    buffer_store_dword v32, v9, s[8:11], s20 offen sc1
    s_add_u32 s20, s21, 24576
    buffer_store_dword v32, v9, s[8:11], s20 offen sc1
    s_waitcnt vmcnt(24)
    v_lshl_or_b32 v34, v35, 16, v34
    v_min_u32 v34, 0xfffffffe, v34
    s_add_u32 s20, s21, 17408
    buffer_store_dword v34, v9, s[8:11], s20 offen sc1
    s_add_u32 s20, s21, 25600
    buffer_store_dword v34, v9, s[8:11], s20 offen sc1
IJ_END:
    s_mov_b32 s28, 40
    s_waitcnt vmcnt(0)
    s_barrier
    s_cmp_eq_u32 s17, 0
    s_cbranch_scc0 K_LI
    v_mov_b32 v14, 0
    v_mov_b32 v15, 1
    s_mov_b64 exec, 1
    buffer_atomic_add v15, v14, s[4:7], s28 offen sc0
    s_waitcnt vmcnt(0)
    v_add_u32 v15, 1, v15
    s_nop 0
    v_readfirstlane_b32 s29, v15
    s_nop 0
    s_cmp_eq_u32 s29, 14
    s_cbranch_scc0 K_LI_N
    buffer_store_dword v15, v14, s[4:7], s28 offen offset:128 sc1
K_LI_N:
    s_mov_b64 exec, -1
K_LI:
    s_branch K_LN2
K_MISC:
    s_cmp_eq_u32 s18, 0
    s_cbranch_scc0 K_CAL
    v_lshlrev_b32 v2, 4, v0
    v_mov_b32 v4, 0
    v_mov_b32 v5, 0
    v_mov_b32 v6, 0
    v_mov_b32 v7, 0
    s_mov_b32 s20, 1048576
    buffer_store_dwordx4 v[4:7], v2, s[8:11], s20 offen sc1
    s_mov_b32 s20, 1052672
    buffer_store_dwordx4 v[4:7], v2, s[8:11], s20 offen sc1
    s_mov_b32 s20, 1056768
    buffer_store_dwordx4 v[4:7], v2, s[8:11], s20 offen sc1
    s_mov_b32 s20, 1060864
    buffer_store_dwordx4 v[4:7], v2, s[8:11], s20 offen sc1
    s_mov_b32 s20, 1064960
    buffer_store_dwordx4 v[4:7], v2, s[8:11], s20 offen sc1
    s_mov_b32 s20, 1069056
    buffer_store_dwordx4 v[4:7], v2, s[8:11], s20 offen sc1
    s_mov_b32 s20, 1073152
    buffer_store_dwordx4 v[4:7], v2, s[8:11], s20 offen sc1
    s_mov_b32 s20, 1077248
    buffer_store_dwordx4 v[4:7], v2, s[8:11], s20 offen sc1
    s_mov_b32 s28, 48
    s_mov_b32 s76, 17
    s_branch K_LA0
K_CAL:
    s_cmp_eq_u32 s17, 0
    s_cbranch_scc0 K_G0
    v_mov_b32 v2, 0
    s_mov_b64 exec, 1
    s_mov_b32 s22, -1
    s_mov_b32 s23, -1
    s_mov_b32 s20, 808960
    s_memtime s[24:25]
    s_waitcnt lgkmcnt(0)
    buffer_store_dword v2, v2, s[8:11], s20 offen sc1
    s_waitcnt vmcnt(0)
    s_memtime s[26:27]
    s_waitcnt lgkmcnt(0)
    s_sub_u32 s26, s26, s24
    s_min_u32 s22, s22, s26
    s_mov_b32 s20, 817152
    s_memtime s[24:25]
    s_waitcnt lgkmcnt(0)
    buffer_store_dword v2, v2, s[8:11], s20 offen sc1
    s_waitcnt vmcnt(0)
    s_memtime s[26:27]
    s_waitcnt lgkmcnt(0)
    s_sub_u32 s26, s26, s24
    s_min_u32 s23, s23, s26
    s_mov_b32 s20, 808960
    s_memtime s[24:25]
    s_waitcnt lgkmcnt(0)
    buffer_store_dword v2, v2, s[8:11], s20 offen sc1
    s_waitcnt vmcnt(0)
    s_memtime s[26:27]
    s_waitcnt lgkmcnt(0)
    s_sub_u32 s26, s26, s24
    s_min_u32 s22, s22, s26
    s_mov_b32 s20, 817152
    s_memtime s[24:25]
    s_waitcnt lgkmcnt(0)
    buffer_store_dword v2, v2, s[8:11], s20 offen sc1
    s_waitcnt vmcnt(0)
    s_memtime s[26:27]
    s_waitcnt lgkmcnt(0)
    s_sub_u32 s26, s26, s24
    s_min_u32 s23, s23, s26
    s_mov_b32 s20, 808960
    s_memtime s[24:25]
    s_waitcnt lgkmcnt(0)
    buffer_store_dword v2, v2, s[8:11], s20 offen sc1
    s_waitcnt vmcnt(0)
    s_memtime s[26:27]
    s_waitcnt lgkmcnt(0)
    s_sub_u32 s26, s26, s24
    s_min_u32 s22, s22, s26
    s_mov_b32 s20, 817152
    s_memtime s[24:25]
    s_waitcnt lgkmcnt(0)
    buffer_store_dword v2, v2, s[8:11], s20 offen sc1
    s_waitcnt vmcnt(0)
    s_memtime s[26:27]
    s_waitcnt lgkmcnt(0)
    s_sub_u32 s26, s26, s24
    s_min_u32 s23, s23, s26
    s_cmp_lt_u32 s23, s22
    s_cselect_b32 s20, 1, 0
    s_getreg_b32 s21, hwreg(HW_REG_XCC_ID)
    s_bfe_u32 s21, s21, 0x10002
    s_xor_b32 s20, s20, s21
    s_xor_b32 s20, s20, 2
    v_mov_b32 v3, s20
    buffer_store_dword v3, v2, s[4:7], 0 offen offset:128 sc1
    s_mov_b64 exec, -1
K_G0:
    v_and_b32 v20, 63, v0
    v_lshlrev_b32 v2, 4, v20
    v_and_b32 v21, 0x33, v20
    v_bfe_u32 v22, v20, 2, 1
    v_lshl_or_b32 v21, v22, 3, v21
    v_bfe_u32 v22, v20, 3, 1
    v_lshl_or_b32 v21, v22, 2, v21
    s_lshr_b32 s28, s17, 1
    s_lshl_b32 s28, s28, 14
    v_lshlrev_b32 v22, 4, v21
    v_add_u32 v3, s28, v22
    v_lshrrev_b32 v22, 5, v20
    v_bfe_u32 v23, v20, 2, 2
    v_lshl_add_u32 v24, v22, 3, v23
    v_lshlrev_b32 v24, 7, v24
    v_bfe_u32 v25, v20, 4, 1
    v_lshl_add_u32 v24, v25, 5, v24
    v_and_b32 v25, 1, v20
    v_lshl_add_u32 v24, v25, 4, v24
    v_bfe_u32 v25, v20, 1, 1
    v_lshl_add_u32 v24, v25, 3, v24
    v_lshrrev_b32 v25, 1, v23
    v_lshl_add_u32 v24, v25, 6, v24
    s_and_b32 s28, s17, 1
    s_lshl_b32 s28, s28, 14
    s_add_u32 s28, s28, 32768
    v_add_u32 v4, s28, v24
    v_xor_b32 v5, 64, v4
    v_lshrrev_b32 v24, 3, v20
    v_and_b32 v25, 7, v20
    v_bfe_u32 v26, v20, 4, 1
    v_lshlrev_b32 v26, 2, v26
    v_xor_b32 v25, v25, v26
    v_lshlrev_b32 v25, 4, v25
    v_lshl_add_u32 v6, v24, 13, v25
    v_mul_u32_u24 v24, 3456, v24
    v_add_u32 v7, v24, v25
    v_and_b32 v23, 31, v21
    v_bfe_u32 v24, v23, 2, 1
    v_lshlrev_b32 v24, 12, v24
    v_lshrrev_b32 v25, 3, v23
    v_lshlrev_b32 v25, 2, v25
    v_and_b32 v26, 3, v23
    v_add_u32 v25, v25, v26
    v_lshl_add_u32 v25, v22, 4, v25
    v_lshl_add_u32 v8, v25, 4, v24
    v_and_b32 v24, 1, v23
    v_lshlrev_b32 v24, 10, v24
    v_lshrrev_b32 v25, 1, v23
    v_lshl_add_u32 v25, v22, 4, v25
    v_lshl_add_u32 v9, v25, 4, v24
    v_lshlrev_b32 v10, 4, v21
    s_and_b32 s16, s16, 7
    s_lshl_b32 s16, s16, 2
    s_lshr_b32 s78, 0x32103514, s16
    s_and_b32 s78, s78, 15
    s_mov_b32 s69, s78
    s_lshr_b32 s68, s78, 2
    s_and_b32 s78, s78, 3
    s_mov_b32 s77, 0
    s_mov_b32 s70, 0
    s_sub_u32 s22, s71, 160
    s_cmp_lt_u32 s22, 32
    s_cbranch_scc0 K_SKP
    s_mov_b32 s21, 1
    s_lshr_b32 s20, s22, 4
    s_and_b32 s22, s22, 15
    s_mov_b32 s16, 84
    s_branch K_GO
K_SKP:
K_NEXT:
    s_cmp_eq_u32 s68, 1
    s_cbranch_scc1 K_PH2
    s_lshl_b32 s28, s78, 2
    s_barrier
    v_mov_b32 v14, s28
    v_mov_b32 v15, 1
    v_mov_b32 v13, 163832
    s_cmp_eq_u32 s17, 0
    s_cbranch_scc0 K_T2
    s_mov_b64 exec, 1
    global_atomic_add v12, v14, v15, s[4:5] offset:16 sc0
    s_waitcnt vmcnt(0)
    ds_write_b32 v13, v12
    s_waitcnt lgkmcnt(0)
    s_mov_b64 exec, -1
K_T2:
    s_barrier
    ds_read_b32 v12, v13
    s_waitcnt lgkmcnt(0)
    v_readfirstlane_b32 s18, v12
    s_nop 0
    s_cmp_lt_u32 s18, 48
    s_cbranch_scc0 K_J2
    s_lshr_b32 s21, s18, 3
    s_add_u32 s21, s21, 2
    s_and_b32 s22, s18, 7
    s_lshl_b32 s22, s22, 2
    s_add_u32 s22, s22, s78
    s_lshr_b32 s20, s22, 4
    s_and_b32 s22, s22, 15
    s_lshl_b32 s16, s21, 2
    s_add_u32 s16, s16, 80
    s_branch K_GO
K_J2:
    s_sub_u32 s18, s18, 48
    s_cmp_lt_u32 s18, 64
    s_cbranch_scc1 K_J3
    s_add_u32 s77, s77, 1
    s_cmp_ge_u32 s77, 4
    s_cbranch_scc1 K_PH2
    s_add_u32 s78, s78, 1
    s_and_b32 s78, s78, 3
    s_branch K_NEXT
K_J3:
    s_lshr_b32 s21, s18, 3
    s_and_b32 s22, s18, 7
    s_lshl_b32 s22, s22, 2
    s_add_u32 s22, s22, s78
    s_cmp_ge_u32 s22, 30
    s_cbranch_scc1 K_NEXT
    s_lshl_b32 s16, s21, 8
    s_add_u32 s16, s16, 1056768
    s_mov_b32 s20, 2
    s_cmp_lt_u32 s22, 16
    s_cbranch_scc1 K_GO
    s_mov_b32 s20, 3
    s_sub_u32 s22, s22, 16
K_GO:
    s_mov_b32 s15, 0x20000
    s_mov_b32 s14, 5242880
    s_mov_b64 s[12:13], s[84:85]
    s_cmp_eq_u32 s20, 1
    s_cselect_b64 s[12:13], s[88:89], s[12:13]
    s_cmp_eq_u32 s20, 2
    s_cselect_b64 s[12:13], s[80:81], s[12:13]
    s_lshl_b32 s24, s22, 9
    s_lshl_b32 s28, s17, 7
    s_add_u32 s24, s24, s28
    s_mov_b32 s25, 64512
    s_mov_b32 s26, 262144
    v_mov_b32 v11, v6
    s_cmp_eq_u32 s20, 3
    s_cbranch_scc0 G_NOTF
    s_mov_b32 s14, 2211840
    s_bitcmp1_b32 s17, 0
    s_cselect_b64 s[12:13], s[96:97], s[92:93]
    s_lshl_b32 s24, s22, 8
    s_lshr_b32 s28, s17, 1
    s_lshl_b32 s28, s28, 7
    s_add_u32 s24, s24, s28
    s_mov_b32 s25, 26624
    s_mov_b32 s26, 110592
    v_mov_b32 v11, v7
G_NOTF:
    s_lshl_b32 s23, s21, 3
    s_lshl_b32 s28, s17, 1
    s_add_u32 s23, s23, s28
    s_mul_i32 s23, s23, 40960
    s_add_u32 s23, s23, 88080384
    s_lshl_b32 s27, s17, 13
    s_mov_b32 s30, 0
    s_mov_b32 s19, 32768
    s_barrier
    s_add_u32 m0, s27, s19
    s_mov_b32 s28, s24
    s_add_u32 s24, s24, s26
    buffer_load_dwordx4 v11, s[12:15], s28 offen offset:0 lds
    s_add_u32 s28, s28, s25
    buffer_load_dwordx4 v11, s[12:15], s28 offen offset:1024 lds
    s_add_u32 s28, s28, s25
    buffer_load_dwordx4 v11, s[12:15], s28 offen offset:2048 lds
    s_add_u32 s28, s28, s25
    buffer_load_dwordx4 v11, s[12:15], s28 offen offset:3072 lds
    s_add_u32 m0, m0, 4096
    s_mov_b32 s28, s24
    s_add_u32 s24, s24, s26
    buffer_load_dwordx4 v11, s[12:15], s28 offen offset:0 lds
    s_add_u32 s28, s28, s25
    buffer_load_dwordx4 v11, s[12:15], s28 offen offset:1024 lds
    s_add_u32 s28, s28, s25
    buffer_load_dwordx4 v11, s[12:15], s28 offen offset:2048 lds
    s_add_u32 s28, s28, s25
    buffer_load_dwordx4 v11, s[12:15], s28 offen offset:3072 lds
    s_xor_b32 s19, s19, 65536
    s_add_u32 m0, s27, s19
    s_mov_b32 s28, s24
    s_add_u32 s24, s24, s26
    buffer_load_dwordx4 v11, s[12:15], s28 offen offset:0 lds
    s_add_u32 s28, s28, s25
    buffer_load_dwordx4 v11, s[12:15], s28 offen offset:1024 lds
    s_add_u32 s28, s28, s25
    buffer_load_dwordx4 v11, s[12:15], s28 offen offset:2048 lds
    s_add_u32 s28, s28, s25
    buffer_load_dwordx4 v11, s[12:15], s28 offen offset:3072 lds
    s_add_u32 m0, m0, 4096
    s_mov_b32 s28, s24
    s_add_u32 s24, s24, s26
    buffer_load_dwordx4 v11, s[12:15], s28 offen offset:0 lds
    s_add_u32 s28, s28, s25
    buffer_load_dwordx4 v11, s[12:15], s28 offen offset:1024 lds
    s_add_u32 s28, s28, s25
    buffer_load_dwordx4 v11, s[12:15], s28 offen offset:2048 lds
    s_add_u32 s28, s28, s25
    buffer_load_dwordx4 v11, s[12:15], s28 offen offset:3072 lds
    s_xor_b32 s19, s19, 65536
    s_lshl_b32 s28, s21, 2
    s_add_u32 s28, s28, 176
    s_cmp_eq_u32 s17, 0
    s_cbranch_scc0 K_WL_OK
    v_mov_b32 v14, 0
K_WL:
    buffer_load_dword v15, v14, s[4:7], s28 offen sc1
    s_add_u32 s3, s3, 1
    s_cmp_gt_u32 s3, 2000000
    s_cbranch_scc1 K_END
    s_waitcnt vmcnt(0)
    v_readfirstlane_b32 s29, v15
    s_nop 0
    s_cmp_ge_u32 s29, 1
    s_cbranch_scc1 K_WL_OK
    s_sleep 4
    s_branch K_WL
K_WL_OK:
    s_barrier
    s_add_u32 m0, s27, s30
    s_add_u32 s28, s23, 0
    buffer_load_dwordx4 v2, s[8:11], s28 offen offset:0 sc1 lds
    buffer_load_dwordx4 v2, s[8:11], s28 offen offset:1024 sc1 lds
    buffer_load_dwordx4 v2, s[8:11], s28 offen offset:2048 sc1 lds
    buffer_load_dwordx4 v2, s[8:11], s28 offen offset:3072 sc1 lds
    s_add_u32 m0, m0, 4096
    s_add_u32 s28, s23, 40960
    buffer_load_dwordx4 v2, s[8:11], s28 offen offset:0 sc1 lds
    buffer_load_dwordx4 v2, s[8:11], s28 offen offset:1024 sc1 lds
    buffer_load_dwordx4 v2, s[8:11], s28 offen offset:2048 sc1 lds
    buffer_load_dwordx4 v2, s[8:11], s28 offen offset:3072 sc1 lds
    s_add_u32 s23, s23, 4096
    s_xor_b32 s30, s30, 65536
    v_accvgpr_write_b32 a0, 0
    v_accvgpr_write_b32 a1, 0
    v_accvgpr_write_b32 a2, 0
    v_accvgpr_write_b32 a3, 0
    v_accvgpr_write_b32 a4, 0
    v_accvgpr_write_b32 a5, 0
    v_accvgpr_write_b32 a6, 0
    v_accvgpr_write_b32 a7, 0
    v_accvgpr_write_b32 a8, 0
    v_accvgpr_write_b32 a9, 0
    v_accvgpr_write_b32 a10, 0
    v_accvgpr_write_b32 a11, 0
    v_accvgpr_write_b32 a12, 0
    v_accvgpr_write_b32 a13, 0
    v_accvgpr_write_b32 a14, 0
    v_accvgpr_write_b32 a15, 0
    v_accvgpr_write_b32 a16, 0
    v_accvgpr_write_b32 a17, 0
    v_accvgpr_write_b32 a18, 0
    v_accvgpr_write_b32 a19, 0
    v_accvgpr_write_b32 a20, 0
    v_accvgpr_write_b32 a21, 0
    v_accvgpr_write_b32 a22, 0
    v_accvgpr_write_b32 a23, 0
    v_accvgpr_write_b32 a24, 0
    v_accvgpr_write_b32 a25, 0
    v_accvgpr_write_b32 a26, 0
    v_accvgpr_write_b32 a27, 0
    v_accvgpr_write_b32 a28, 0
    v_accvgpr_write_b32 a29, 0
    v_accvgpr_write_b32 a30, 0
    v_accvgpr_write_b32 a31, 0
    v_accvgpr_write_b32 a32, 0
    v_accvgpr_write_b32 a33, 0
    v_accvgpr_write_b32 a34, 0
    v_accvgpr_write_b32 a35, 0
    v_accvgpr_write_b32 a36, 0
    v_accvgpr_write_b32 a37, 0
    v_accvgpr_write_b32 a38, 0
    v_accvgpr_write_b32 a39, 0
    v_accvgpr_write_b32 a40, 0
    v_accvgpr_write_b32 a41, 0
    v_accvgpr_write_b32 a42, 0
    v_accvgpr_write_b32 a43, 0
    v_accvgpr_write_b32 a44, 0
    v_accvgpr_write_b32 a45, 0
    v_accvgpr_write_b32 a46, 0
    v_accvgpr_write_b32 a47, 0
    v_accvgpr_write_b32 a48, 0
    v_accvgpr_write_b32 a49, 0
    v_accvgpr_write_b32 a50, 0
    v_accvgpr_write_b32 a51, 0
    v_accvgpr_write_b32 a52, 0
    v_accvgpr_write_b32 a53, 0
    v_accvgpr_write_b32 a54, 0
    v_accvgpr_write_b32 a55, 0
    v_accvgpr_write_b32 a56, 0
    v_accvgpr_write_b32 a57, 0
    v_accvgpr_write_b32 a58, 0
    v_accvgpr_write_b32 a59, 0
    v_accvgpr_write_b32 a60, 0
    v_accvgpr_write_b32 a61, 0
    v_accvgpr_write_b32 a62, 0
    v_accvgpr_write_b32 a63, 0
    v_accvgpr_write_b32 a64, 0
    v_accvgpr_write_b32 a65, 0
    v_accvgpr_write_b32 a66, 0
    v_accvgpr_write_b32 a67, 0
    v_accvgpr_write_b32 a68, 0
    v_accvgpr_write_b32 a69, 0
    v_accvgpr_write_b32 a70, 0
    v_accvgpr_write_b32 a71, 0
    v_accvgpr_write_b32 a72, 0
    v_accvgpr_write_b32 a73, 0
    v_accvgpr_write_b32 a74, 0
    v_accvgpr_write_b32 a75, 0
    v_accvgpr_write_b32 a76, 0
    v_accvgpr_write_b32 a77, 0
    v_accvgpr_write_b32 a78, 0
    v_accvgpr_write_b32 a79, 0
    v_accvgpr_write_b32 a80, 0
    v_accvgpr_write_b32 a81, 0
    v_accvgpr_write_b32 a82, 0
    v_accvgpr_write_b32 a83, 0
    v_accvgpr_write_b32 a84, 0
    v_accvgpr_write_b32 a85, 0
    v_accvgpr_write_b32 a86, 0
    v_accvgpr_write_b32 a87, 0
    v_accvgpr_write_b32 a88, 0
    v_accvgpr_write_b32 a89, 0
    v_accvgpr_write_b32 a90, 0
    v_accvgpr_write_b32 a91, 0
    v_accvgpr_write_b32 a92, 0
    v_accvgpr_write_b32 a93, 0
    v_accvgpr_write_b32 a94, 0
    v_accvgpr_write_b32 a95, 0
    v_accvgpr_write_b32 a96, 0
    v_accvgpr_write_b32 a97, 0
    v_accvgpr_write_b32 a98, 0
    v_accvgpr_write_b32 a99, 0
    v_accvgpr_write_b32 a100, 0
    v_accvgpr_write_b32 a101, 0
    v_accvgpr_write_b32 a102, 0
    v_accvgpr_write_b32 a103, 0
    v_accvgpr_write_b32 a104, 0
    v_accvgpr_write_b32 a105, 0
    v_accvgpr_write_b32 a106, 0
    v_accvgpr_write_b32 a107, 0
    v_accvgpr_write_b32 a108, 0
    v_accvgpr_write_b32 a109, 0
    v_accvgpr_write_b32 a110, 0
    v_accvgpr_write_b32 a111, 0
    v_accvgpr_write_b32 a112, 0
    v_accvgpr_write_b32 a113, 0
    v_accvgpr_write_b32 a114, 0
    v_accvgpr_write_b32 a115, 0
    v_accvgpr_write_b32 a116, 0
    v_accvgpr_write_b32 a117, 0
    v_accvgpr_write_b32 a118, 0
    v_accvgpr_write_b32 a119, 0
    v_accvgpr_write_b32 a120, 0
    v_accvgpr_write_b32 a121, 0
    v_accvgpr_write_b32 a122, 0
    v_accvgpr_write_b32 a123, 0
    v_accvgpr_write_b32 a124, 0
    v_accvgpr_write_b32 a125, 0
    v_accvgpr_write_b32 a126, 0
    v_accvgpr_write_b32 a127, 0
    v_accvgpr_write_b32 a128, 0
    v_accvgpr_write_b32 a129, 0
    v_accvgpr_write_b32 a130, 0
    v_accvgpr_write_b32 a131, 0
    v_accvgpr_write_b32 a132, 0
    v_accvgpr_write_b32 a133, 0
    v_accvgpr_write_b32 a134, 0
    v_accvgpr_write_b32 a135, 0
    v_accvgpr_write_b32 a136, 0
    v_accvgpr_write_b32 a137, 0
    v_accvgpr_write_b32 a138, 0
    v_accvgpr_write_b32 a139, 0
    v_accvgpr_write_b32 a140, 0
    v_accvgpr_write_b32 a141, 0
    v_accvgpr_write_b32 a142, 0
    v_accvgpr_write_b32 a143, 0
    v_accvgpr_write_b32 a144, 0
    v_accvgpr_write_b32 a145, 0
    v_accvgpr_write_b32 a146, 0
    v_accvgpr_write_b32 a147, 0
    v_accvgpr_write_b32 a148, 0
    v_accvgpr_write_b32 a149, 0
    v_accvgpr_write_b32 a150, 0
    v_accvgpr_write_b32 a151, 0
    v_accvgpr_write_b32 a152, 0
    v_accvgpr_write_b32 a153, 0
    v_accvgpr_write_b32 a154, 0
    v_accvgpr_write_b32 a155, 0
    v_accvgpr_write_b32 a156, 0
    v_accvgpr_write_b32 a157, 0
    v_accvgpr_write_b32 a158, 0
    v_accvgpr_write_b32 a159, 0
    v_accvgpr_write_b32 a160, 0
    v_accvgpr_write_b32 a161, 0
    v_accvgpr_write_b32 a162, 0
    v_accvgpr_write_b32 a163, 0
    v_accvgpr_write_b32 a164, 0
    v_accvgpr_write_b32 a165, 0
    v_accvgpr_write_b32 a166, 0
    v_accvgpr_write_b32 a167, 0
    v_accvgpr_write_b32 a168, 0
    v_accvgpr_write_b32 a169, 0
    v_accvgpr_write_b32 a170, 0
    v_accvgpr_write_b32 a171, 0
    v_accvgpr_write_b32 a172, 0
    v_accvgpr_write_b32 a173, 0
    v_accvgpr_write_b32 a174, 0
    v_accvgpr_write_b32 a175, 0
    v_accvgpr_write_b32 a176, 0
    v_accvgpr_write_b32 a177, 0
    v_accvgpr_write_b32 a178, 0
    v_accvgpr_write_b32 a179, 0
    v_accvgpr_write_b32 a180, 0
    v_accvgpr_write_b32 a181, 0
    v_accvgpr_write_b32 a182, 0
    v_accvgpr_write_b32 a183, 0
    v_accvgpr_write_b32 a184, 0
    v_accvgpr_write_b32 a185, 0
    v_accvgpr_write_b32 a186, 0
    v_accvgpr_write_b32 a187, 0
    v_accvgpr_write_b32 a188, 0
    v_accvgpr_write_b32 a189, 0
    v_accvgpr_write_b32 a190, 0
    v_accvgpr_write_b32 a191, 0
    v_accvgpr_write_b32 a192, 0
    v_accvgpr_write_b32 a193, 0
    v_accvgpr_write_b32 a194, 0
    v_accvgpr_write_b32 a195, 0
    v_accvgpr_write_b32 a196, 0
    v_accvgpr_write_b32 a197, 0
    v_accvgpr_write_b32 a198, 0
    v_accvgpr_write_b32 a199, 0
    v_accvgpr_write_b32 a200, 0
    v_accvgpr_write_b32 a201, 0
    v_accvgpr_write_b32 a202, 0
    v_accvgpr_write_b32 a203, 0
    v_accvgpr_write_b32 a204, 0
    v_accvgpr_write_b32 a205, 0
    v_accvgpr_write_b32 a206, 0
    v_accvgpr_write_b32 a207, 0
    v_accvgpr_write_b32 a208, 0
    v_accvgpr_write_b32 a209, 0
    v_accvgpr_write_b32 a210, 0
    v_accvgpr_write_b32 a211, 0
    v_accvgpr_write_b32 a212, 0
    v_accvgpr_write_b32 a213, 0
    v_accvgpr_write_b32 a214, 0
    v_accvgpr_write_b32 a215, 0
    v_accvgpr_write_b32 a216, 0
    v_accvgpr_write_b32 a217, 0
    v_accvgpr_write_b32 a218, 0
    v_accvgpr_write_b32 a219, 0
    v_accvgpr_write_b32 a220, 0
    v_accvgpr_write_b32 a221, 0
    v_accvgpr_write_b32 a222, 0
    v_accvgpr_write_b32 a223, 0
    v_accvgpr_write_b32 a224, 0
    v_accvgpr_write_b32 a225, 0
    v_accvgpr_write_b32 a226, 0
    v_accvgpr_write_b32 a227, 0
    v_accvgpr_write_b32 a228, 0
    v_accvgpr_write_b32 a229, 0
    v_accvgpr_write_b32 a230, 0
    v_accvgpr_write_b32 a231, 0
    v_accvgpr_write_b32 a232, 0
    v_accvgpr_write_b32 a233, 0
    v_accvgpr_write_b32 a234, 0
    v_accvgpr_write_b32 a235, 0
    v_accvgpr_write_b32 a236, 0
    v_accvgpr_write_b32 a237, 0
    v_accvgpr_write_b32 a238, 0
    v_accvgpr_write_b32 a239, 0
    v_accvgpr_write_b32 a240, 0
    v_accvgpr_write_b32 a241, 0
    v_accvgpr_write_b32 a242, 0
    v_accvgpr_write_b32 a243, 0
    v_accvgpr_write_b32 a244, 0
    v_accvgpr_write_b32 a245, 0
    v_accvgpr_write_b32 a246, 0
    v_accvgpr_write_b32 a247, 0
    v_accvgpr_write_b32 a248, 0
    v_accvgpr_write_b32 a249, 0
    v_accvgpr_write_b32 a250, 0
    v_accvgpr_write_b32 a251, 0
    v_accvgpr_write_b32 a252, 0
    v_accvgpr_write_b32 a253, 0
    v_accvgpr_write_b32 a254, 0
    v_accvgpr_write_b32 a255, 0
    s_waitcnt vmcnt(0)
    s_barrier
    ds_read_b128 v[16:19], v3 offset:0
    ds_read_b64_tr_b16 v[48:49], v4 offset:0
    ds_read_b64_tr_b16 v[50:51], v4 offset:512
    ds_read_b64_tr_b16 v[52:53], v5 offset:0
    ds_read_b64_tr_b16 v[54:55], v5 offset:512
    ds_read_b128 v[20:23], v3 offset:4096
    ds_read_b64_tr_b16 v[56:57], v4 offset:8192
    ds_read_b64_tr_b16 v[58:59], v4 offset:8704
    ds_read_b64_tr_b16 v[60:61], v5 offset:8192
    ds_read_b64_tr_b16 v[62:63], v5 offset:8704
    ds_read_b128 v[24:27], v3 offset:8192
    ds_read_b128 v[28:31], v3 offset:12288
    s_mov_b32 s31, 0
    s_cmp_eq_u32 s20, 1
    s_cbranch_scc1 G_LV
.p2align 6
G_LK:
    s_waitcnt lgkmcnt(9)
    v_mfma_f32_32x32x16_bf16 a[0:15], v[48:51], v[16:19], a[0:15]
    ds_read_b128 v[32:35], v3 offset:1024
    s_waitcnt lgkmcnt(8)
    v_mfma_f32_32x32x16_bf16 a[16:31], v[52:55], v[16:19], a[16:31]
    ds_read_b64_tr_b16 v[64:65], v4 offset:2048
    s_add_u32 m0, s27, s30
    s_add_u32 s28, s23, 0
    buffer_load_dwordx4 v2, s[8:11], s28 offen offset:0 sc1 lds
    s_waitcnt lgkmcnt(6)
    v_mfma_f32_32x32x16_bf16 a[32:47], v[56:59], v[16:19], a[32:47]
    ds_read_b64_tr_b16 v[66:67], v4 offset:2560
    s_waitcnt lgkmcnt(5)
    v_mfma_f32_32x32x16_bf16 a[48:63], v[60:63], v[16:19], a[48:63]
    ds_read_b64_tr_b16 v[68:69], v5 offset:2048
    buffer_load_dwordx4 v2, s[8:11], s28 offen offset:1024 sc1 lds
    v_mfma_f32_32x32x16_bf16 a[64:79], v[48:51], v[20:23], a[64:79]
    ds_read_b64_tr_b16 v[70:71], v5 offset:2560
    v_mfma_f32_32x32x16_bf16 a[80:95], v[52:55], v[20:23], a[80:95]
    ds_read_b128 v[36:39], v3 offset:5120
    buffer_load_dwordx4 v2, s[8:11], s28 offen offset:2048 sc1 lds
    v_mfma_f32_32x32x16_bf16 a[96:111], v[56:59], v[20:23], a[96:111]
    ds_read_b64_tr_b16 v[72:73], v4 offset:10240
    v_mfma_f32_32x32x16_bf16 a[112:127], v[60:63], v[20:23], a[112:127]
    ds_read_b64_tr_b16 v[74:75], v4 offset:10752
    buffer_load_dwordx4 v2, s[8:11], s28 offen offset:3072 sc1 lds
    s_waitcnt lgkmcnt(9)
    v_mfma_f32_32x32x16_bf16 a[128:143], v[48:51], v[24:27], a[128:143]
    ds_read_b64_tr_b16 v[76:77], v5 offset:10240
    v_mfma_f32_32x32x16_bf16 a[144:159], v[52:55], v[24:27], a[144:159]
    ds_read_b64_tr_b16 v[78:79], v5 offset:10752
    s_add_u32 m0, m0, 4096
    s_add_u32 s28, s23, 40960
    buffer_load_dwordx4 v2, s[8:11], s28 offen offset:0 sc1 lds
    v_mfma_f32_32x32x16_bf16 a[160:175], v[56:59], v[24:27], a[160:175]
    ds_read_b128 v[40:43], v3 offset:9216
    v_mfma_f32_32x32x16_bf16 a[176:191], v[60:63], v[24:27], a[176:191]
    ds_read_b128 v[44:47], v3 offset:13312
    buffer_load_dwordx4 v2, s[8:11], s28 offen offset:1024 sc1 lds
    s_waitcnt lgkmcnt(12)
    v_mfma_f32_32x32x16_bf16 a[192:207], v[48:51], v[28:31], a[192:207]
    v_mfma_f32_32x32x16_bf16 a[208:223], v[52:55], v[28:31], a[208:223]
    buffer_load_dwordx4 v2, s[8:11], s28 offen offset:2048 sc1 lds
    v_mfma_f32_32x32x16_bf16 a[224:239], v[56:59], v[28:31], a[224:239]
    v_mfma_f32_32x32x16_bf16 a[240:255], v[60:63], v[28:31], a[240:255]
    buffer_load_dwordx4 v2, s[8:11], s28 offen offset:3072 sc1 lds
    s_add_u32 s23, s23, 4096
    s_xor_b32 s30, s30, 65536
    s_waitcnt lgkmcnt(9)
    v_mfma_f32_32x32x16_bf16 a[0:15], v[64:67], v[32:35], a[0:15]
    ds_read_b128 v[16:19], v3 offset:2048
    s_waitcnt lgkmcnt(8)
    v_mfma_f32_32x32x16_bf16 a[16:31], v[68:71], v[32:35], a[16:31]
    ds_read_b64_tr_b16 v[48:49], v4 offset:4096
    s_waitcnt lgkmcnt(6)
    v_mfma_f32_32x32x16_bf16 a[32:47], v[72:75], v[32:35], a[32:47]
    ds_read_b64_tr_b16 v[50:51], v4 offset:4608
    s_waitcnt lgkmcnt(5)
    v_mfma_f32_32x32x16_bf16 a[48:63], v[76:79], v[32:35], a[48:63]
    ds_read_b64_tr_b16 v[52:53], v5 offset:4096
    v_mfma_f32_32x32x16_bf16 a[64:79], v[64:67], v[36:39], a[64:79]
    ds_read_b64_tr_b16 v[54:55], v5 offset:4608
    v_mfma_f32_32x32x16_bf16 a[80:95], v[68:71], v[36:39], a[80:95]
    ds_read_b128 v[20:23], v3 offset:6144
    v_mfma_f32_32x32x16_bf16 a[96:111], v[72:75], v[36:39], a[96:111]
    ds_read_b64_tr_b16 v[56:57], v4 offset:12288
    v_mfma_f32_32x32x16_bf16 a[112:127], v[76:79], v[36:39], a[112:127]
    ds_read_b64_tr_b16 v[58:59], v4 offset:12800
    s_waitcnt lgkmcnt(9)
    v_mfma_f32_32x32x16_bf16 a[128:143], v[64:67], v[40:43], a[128:143]
    ds_read_b64_tr_b16 v[60:61], v5 offset:12288
    v_mfma_f32_32x32x16_bf16 a[144:159], v[68:71], v[40:43], a[144:159]
    ds_read_b64_tr_b16 v[62:63], v5 offset:12800
    v_mfma_f32_32x32x16_bf16 a[160:175], v[72:75], v[40:43], a[160:175]
    ds_read_b128 v[24:27], v3 offset:10240
    v_mfma_f32_32x32x16_bf16 a[176:191], v[76:79], v[40:43], a[176:191]
    ds_read_b128 v[28:31], v3 offset:14336
    s_waitcnt lgkmcnt(12)
    v_mfma_f32_32x32x16_bf16 a[192:207], v[64:67], v[44:47], a[192:207]
    v_mfma_f32_32x32x16_bf16 a[208:223], v[68:71], v[44:47], a[208:223]
    v_mfma_f32_32x32x16_bf16 a[224:239], v[72:75], v[44:47], a[224:239]
    v_mfma_f32_32x32x16_bf16 a[240:255], v[76:79], v[44:47], a[240:255]
    s_waitcnt lgkmcnt(9)
    v_mfma_f32_32x32x16_bf16 a[0:15], v[48:51], v[16:19], a[0:15]
    ds_read_b128 v[32:35], v3 offset:3072
    s_waitcnt lgkmcnt(8)
    v_mfma_f32_32x32x16_bf16 a[16:31], v[52:55], v[16:19], a[16:31]
    ds_read_b64_tr_b16 v[64:65], v4 offset:6144
    s_waitcnt lgkmcnt(6)
    v_mfma_f32_32x32x16_bf16 a[32:47], v[56:59], v[16:19], a[32:47]
    ds_read_b64_tr_b16 v[66:67], v4 offset:6656
    s_waitcnt lgkmcnt(5)
    v_mfma_f32_32x32x16_bf16 a[48:63], v[60:63], v[16:19], a[48:63]
    ds_read_b64_tr_b16 v[68:69], v5 offset:6144
    v_mfma_f32_32x32x16_bf16 a[64:79], v[48:51], v[20:23], a[64:79]
    ds_read_b64_tr_b16 v[70:71], v5 offset:6656
    v_mfma_f32_32x32x16_bf16 a[80:95], v[52:55], v[20:23], a[80:95]
    ds_read_b128 v[36:39], v3 offset:7168
    v_mfma_f32_32x32x16_bf16 a[96:111], v[56:59], v[20:23], a[96:111]
    ds_read_b64_tr_b16 v[72:73], v4 offset:14336
    v_mfma_f32_32x32x16_bf16 a[112:127], v[60:63], v[20:23], a[112:127]
    ds_read_b64_tr_b16 v[74:75], v4 offset:14848
    s_waitcnt lgkmcnt(9)
    v_mfma_f32_32x32x16_bf16 a[128:143], v[48:51], v[24:27], a[128:143]
    ds_read_b64_tr_b16 v[76:77], v5 offset:14336
    v_mfma_f32_32x32x16_bf16 a[144:159], v[52:55], v[24:27], a[144:159]
    ds_read_b64_tr_b16 v[78:79], v5 offset:14848
    v_mfma_f32_32x32x16_bf16 a[160:175], v[56:59], v[24:27], a[160:175]
    ds_read_b128 v[40:43], v3 offset:11264
    v_mfma_f32_32x32x16_bf16 a[176:191], v[60:63], v[24:27], a[176:191]
    ds_read_b128 v[44:47], v3 offset:15360
    s_waitcnt lgkmcnt(12)
    v_mfma_f32_32x32x16_bf16 a[192:207], v[48:51], v[28:31], a[192:207]
    v_mfma_f32_32x32x16_bf16 a[208:223], v[52:55], v[28:31], a[208:223]
    v_mfma_f32_32x32x16_bf16 a[224:239], v[56:59], v[28:31], a[224:239]
    v_mfma_f32_32x32x16_bf16 a[240:255], v[60:63], v[28:31], a[240:255]
    s_waitcnt lgkmcnt(9)
    v_mfma_f32_32x32x16_bf16 a[0:15], v[64:67], v[32:35], a[0:15]
    s_waitcnt vmcnt(0) lgkmcnt(0)
    s_barrier
    v_xor_b32 v3, 65536, v3
    v_xor_b32 v4, 65536, v4
    v_xor_b32 v5, 65536, v5
    v_mfma_f32_32x32x16_bf16 a[16:31], v[68:71], v[32:35], a[16:31]
    ds_read_b128 v[16:19], v3 offset:0
    s_add_u32 m0, s27, s19
    s_mov_b32 s28, s24
    s_add_u32 s24, s24, s26
    buffer_load_dwordx4 v11, s[12:15], s28 offen offset:0 lds
    v_mfma_f32_32x32x16_bf16 a[32:47], v[72:75], v[32:35], a[32:47]
    ds_read_b64_tr_b16 v[48:49], v4 offset:0
    v_mfma_f32_32x32x16_bf16 a[48:63], v[76:79], v[32:35], a[48:63]
    ds_read_b64_tr_b16 v[50:51], v4 offset:512
    s_add_u32 s28, s28, s25
    buffer_load_dwordx4 v11, s[12:15], s28 offen offset:1024 lds
    v_mfma_f32_32x32x16_bf16 a[64:79], v[64:67], v[36:39], a[64:79]
    ds_read_b64_tr_b16 v[52:53], v5 offset:0
    v_mfma_f32_32x32x16_bf16 a[80:95], v[68:71], v[36:39], a[80:95]
    ds_read_b64_tr_b16 v[54:55], v5 offset:512
    s_add_u32 s28, s28, s25
    buffer_load_dwordx4 v11, s[12:15], s28 offen offset:2048 lds
    v_mfma_f32_32x32x16_bf16 a[96:111], v[72:75], v[36:39], a[96:111]
    ds_read_b128 v[20:23], v3 offset:4096
    v_mfma_f32_32x32x16_bf16 a[112:127], v[76:79], v[36:39], a[112:127]
    ds_read_b64_tr_b16 v[56:57], v4 offset:8192
    s_add_u32 s28, s28, s25
    buffer_load_dwordx4 v11, s[12:15], s28 offen offset:3072 lds
    v_mfma_f32_32x32x16_bf16 a[128:143], v[64:67], v[40:43], a[128:143]
    ds_read_b64_tr_b16 v[58:59], v4 offset:8704
    v_mfma_f32_32x32x16_bf16 a[144:159], v[68:71], v[40:43], a[144:159]
    ds_read_b64_tr_b16 v[60:61], v5 offset:8192
    s_add_u32 m0, m0, 4096
    s_mov_b32 s28, s24
    s_add_u32 s24, s24, s26
    buffer_load_dwordx4 v11, s[12:15], s28 offen offset:0 lds
    v_mfma_f32_32x32x16_bf16 a[160:175], v[72:75], v[40:43], a[160:175]
    ds_read_b64_tr_b16 v[62:63], v5 offset:8704
    v_mfma_f32_32x32x16_bf16 a[176:191], v[76:79], v[40:43], a[176:191]
    ds_read_b128 v[24:27], v3 offset:8192
    s_add_u32 s28, s28, s25
    buffer_load_dwordx4 v11, s[12:15], s28 offen offset:1024 lds
    v_mfma_f32_32x32x16_bf16 a[192:207], v[64:67], v[44:47], a[192:207]
    ds_read_b128 v[28:31], v3 offset:12288
    v_mfma_f32_32x32x16_bf16 a[208:223], v[68:71], v[44:47], a[208:223]
    s_add_u32 s28, s28, s25
    buffer_load_dwordx4 v11, s[12:15], s28 offen offset:2048 lds
    v_mfma_f32_32x32x16_bf16 a[224:239], v[72:75], v[44:47], a[224:239]
    v_mfma_f32_32x32x16_bf16 a[240:255], v[76:79], v[44:47], a[240:255]
    s_add_u32 s28, s28, s25
    buffer_load_dwordx4 v11, s[12:15], s28 offen offset:3072 lds
    s_xor_b32 s19, s19, 65536
    s_add_u32 s31, s31, 1
    s_cmp_lt_u32 s31, 10
    s_cbranch_scc1 G_LK
    s_branch G_EPI
.p2align 6
G_LV:
    s_waitcnt lgkmcnt(9)
    v_mfma_f32_32x32x16_bf16 a[0:15], v[16:19], v[48:51], a[0:15]
    ds_read_b128 v[32:35], v3 offset:1024
    s_waitcnt lgkmcnt(8)
    v_mfma_f32_32x32x16_bf16 a[16:31], v[16:19], v[52:55], a[16:31]
    ds_read_b64_tr_b16 v[64:65], v4 offset:2048
    s_add_u32 m0, s27, s30
    s_add_u32 s28, s23, 0
    buffer_load_dwordx4 v2, s[8:11], s28 offen offset:0 sc1 lds
    s_waitcnt lgkmcnt(6)
    v_mfma_f32_32x32x16_bf16 a[32:47], v[16:19], v[56:59], a[32:47]
    ds_read_b64_tr_b16 v[66:67], v4 offset:2560
    s_waitcnt lgkmcnt(5)
    v_mfma_f32_32x32x16_bf16 a[48:63], v[16:19], v[60:63], a[48:63]
    ds_read_b64_tr_b16 v[68:69], v5 offset:2048
    buffer_load_dwordx4 v2, s[8:11], s28 offen offset:1024 sc1 lds
    v_mfma_f32_32x32x16_bf16 a[64:79], v[20:23], v[48:51], a[64:79]
    ds_read_b64_tr_b16 v[70:71], v5 offset:2560
    v_mfma_f32_32x32x16_bf16 a[80:95], v[20:23], v[52:55], a[80:95]
    ds_read_b128 v[36:39], v3 offset:5120
    buffer_load_dwordx4 v2, s[8:11], s28 offen offset:2048 sc1 lds
    v_mfma_f32_32x32x16_bf16 a[96:111], v[20:23], v[56:59], a[96:111]
    ds_read_b64_tr_b16 v[72:73], v4 offset:10240
    v_mfma_f32_32x32x16_bf16 a[112:127], v[20:23], v[60:63], a[112:127]
    ds_read_b64_tr_b16 v[74:75], v4 offset:10752
    buffer_load_dwordx4 v2, s[8:11], s28 offen offset:3072 sc1 lds
    s_waitcnt lgkmcnt(9)
    v_mfma_f32_32x32x16_bf16 a[128:143], v[24:27], v[48:51], a[128:143]
    ds_read_b64_tr_b16 v[76:77], v5 offset:10240
    v_mfma_f32_32x32x16_bf16 a[144:159], v[24:27], v[52:55], a[144:159]
    ds_read_b64_tr_b16 v[78:79], v5 offset:10752
    s_add_u32 m0, m0, 4096
    s_add_u32 s28, s23, 40960
    buffer_load_dwordx4 v2, s[8:11], s28 offen offset:0 sc1 lds
    v_mfma_f32_32x32x16_bf16 a[160:175], v[24:27], v[56:59], a[160:175]
    ds_read_b128 v[40:43], v3 offset:9216
    v_mfma_f32_32x32x16_bf16 a[176:191], v[24:27], v[60:63], a[176:191]
    ds_read_b128 v[44:47], v3 offset:13312
    buffer_load_dwordx4 v2, s[8:11], s28 offen offset:1024 sc1 lds
    s_waitcnt lgkmcnt(12)
    v_mfma_f32_32x32x16_bf16 a[192:207], v[28:31], v[48:51], a[192:207]
    v_mfma_f32_32x32x16_bf16 a[208:223], v[28:31], v[52:55], a[208:223]
    buffer_load_dwordx4 v2, s[8:11], s28 offen offset:2048 sc1 lds
    v_mfma_f32_32x32x16_bf16 a[224:239], v[28:31], v[56:59], a[224:239]
    v_mfma_f32_32x32x16_bf16 a[240:255], v[28:31], v[60:63], a[240:255]
    buffer_load_dwordx4 v2, s[8:11], s28 offen offset:3072 sc1 lds
    s_add_u32 s23, s23, 4096
    s_xor_b32 s30, s30, 65536
    s_waitcnt lgkmcnt(9)
    v_mfma_f32_32x32x16_bf16 a[0:15], v[32:35], v[64:67], a[0:15]
    ds_read_b128 v[16:19], v3 offset:2048
    s_waitcnt lgkmcnt(8)
    v_mfma_f32_32x32x16_bf16 a[16:31], v[32:35], v[68:71], a[16:31]
    ds_read_b64_tr_b16 v[48:49], v4 offset:4096
    s_waitcnt lgkmcnt(6)
    v_mfma_f32_32x32x16_bf16 a[32:47], v[32:35], v[72:75], a[32:47]
    ds_read_b64_tr_b16 v[50:51], v4 offset:4608
    s_waitcnt lgkmcnt(5)
    v_mfma_f32_32x32x16_bf16 a[48:63], v[32:35], v[76:79], a[48:63]
    ds_read_b64_tr_b16 v[52:53], v5 offset:4096
    v_mfma_f32_32x32x16_bf16 a[64:79], v[36:39], v[64:67], a[64:79]
    ds_read_b64_tr_b16 v[54:55], v5 offset:4608
    v_mfma_f32_32x32x16_bf16 a[80:95], v[36:39], v[68:71], a[80:95]
    ds_read_b128 v[20:23], v3 offset:6144
    v_mfma_f32_32x32x16_bf16 a[96:111], v[36:39], v[72:75], a[96:111]
    ds_read_b64_tr_b16 v[56:57], v4 offset:12288
    v_mfma_f32_32x32x16_bf16 a[112:127], v[36:39], v[76:79], a[112:127]
    ds_read_b64_tr_b16 v[58:59], v4 offset:12800
    s_waitcnt lgkmcnt(9)
    v_mfma_f32_32x32x16_bf16 a[128:143], v[40:43], v[64:67], a[128:143]
    ds_read_b64_tr_b16 v[60:61], v5 offset:12288
    v_mfma_f32_32x32x16_bf16 a[144:159], v[40:43], v[68:71], a[144:159]
    ds_read_b64_tr_b16 v[62:63], v5 offset:12800
    v_mfma_f32_32x32x16_bf16 a[160:175], v[40:43], v[72:75], a[160:175]
    ds_read_b128 v[24:27], v3 offset:10240
    v_mfma_f32_32x32x16_bf16 a[176:191], v[40:43], v[76:79], a[176:191]
    ds_read_b128 v[28:31], v3 offset:14336
    s_waitcnt lgkmcnt(12)
    v_mfma_f32_32x32x16_bf16 a[192:207], v[44:47], v[64:67], a[192:207]
    v_mfma_f32_32x32x16_bf16 a[208:223], v[44:47], v[68:71], a[208:223]
    v_mfma_f32_32x32x16_bf16 a[224:239], v[44:47], v[72:75], a[224:239]
    v_mfma_f32_32x32x16_bf16 a[240:255], v[44:47], v[76:79], a[240:255]
    s_waitcnt lgkmcnt(9)
    v_mfma_f32_32x32x16_bf16 a[0:15], v[16:19], v[48:51], a[0:15]
    ds_read_b128 v[32:35], v3 offset:3072
    s_waitcnt lgkmcnt(8)
    v_mfma_f32_32x32x16_bf16 a[16:31], v[16:19], v[52:55], a[16:31]
    ds_read_b64_tr_b16 v[64:65], v4 offset:6144
    s_waitcnt lgkmcnt(6)
    v_mfma_f32_32x32x16_bf16 a[32:47], v[16:19], v[56:59], a[32:47]
    ds_read_b64_tr_b16 v[66:67], v4 offset:6656
    s_waitcnt lgkmcnt(5)
    v_mfma_f32_32x32x16_bf16 a[48:63], v[16:19], v[60:63], a[48:63]
    ds_read_b64_tr_b16 v[68:69], v5 offset:6144
    v_mfma_f32_32x32x16_bf16 a[64:79], v[20:23], v[48:51], a[64:79]
    ds_read_b64_tr_b16 v[70:71], v5 offset:6656
    v_mfma_f32_32x32x16_bf16 a[80:95], v[20:23], v[52:55], a[80:95]
    ds_read_b128 v[36:39], v3 offset:7168
    v_mfma_f32_32x32x16_bf16 a[96:111], v[20:23], v[56:59], a[96:111]
    ds_read_b64_tr_b16 v[72:73], v4 offset:14336
    v_mfma_f32_32x32x16_bf16 a[112:127], v[20:23], v[60:63], a[112:127]
    ds_read_b64_tr_b16 v[74:75], v4 offset:14848
    s_waitcnt lgkmcnt(9)
    v_mfma_f32_32x32x16_bf16 a[128:143], v[24:27], v[48:51], a[128:143]
    ds_read_b64_tr_b16 v[76:77], v5 offset:14336
    v_mfma_f32_32x32x16_bf16 a[144:159], v[24:27], v[52:55], a[144:159]
    ds_read_b64_tr_b16 v[78:79], v5 offset:14848
    v_mfma_f32_32x32x16_bf16 a[160:175], v[24:27], v[56:59], a[160:175]
    ds_read_b128 v[40:43], v3 offset:11264
    v_mfma_f32_32x32x16_bf16 a[176:191], v[24:27], v[60:63], a[176:191]
    ds_read_b128 v[44:47], v3 offset:15360
    s_waitcnt lgkmcnt(12)
    v_mfma_f32_32x32x16_bf16 a[192:207], v[28:31], v[48:51], a[192:207]
    v_mfma_f32_32x32x16_bf16 a[208:223], v[28:31], v[52:55], a[208:223]
    v_mfma_f32_32x32x16_bf16 a[224:239], v[28:31], v[56:59], a[224:239]
    v_mfma_f32_32x32x16_bf16 a[240:255], v[28:31], v[60:63], a[240:255]
    s_waitcnt lgkmcnt(9)
    v_mfma_f32_32x32x16_bf16 a[0:15], v[32:35], v[64:67], a[0:15]
    s_waitcnt vmcnt(0) lgkmcnt(0)
    s_barrier
    v_xor_b32 v3, 65536, v3
    v_xor_b32 v4, 65536, v4
    v_xor_b32 v5, 65536, v5
    v_mfma_f32_32x32x16_bf16 a[16:31], v[32:35], v[68:71], a[16:31]
    ds_read_b128 v[16:19], v3 offset:0
    s_add_u32 m0, s27, s19
    s_mov_b32 s28, s24
    s_add_u32 s24, s24, s26
    buffer_load_dwordx4 v11, s[12:15], s28 offen offset:0 lds
    v_mfma_f32_32x32x16_bf16 a[32:47], v[32:35], v[72:75], a[32:47]
    ds_read_b64_tr_b16 v[48:49], v4 offset:0
    v_mfma_f32_32x32x16_bf16 a[48:63], v[32:35], v[76:79], a[48:63]
    ds_read_b64_tr_b16 v[50:51], v4 offset:512
    s_add_u32 s28, s28, s25
    buffer_load_dwordx4 v11, s[12:15], s28 offen offset:1024 lds
    v_mfma_f32_32x32x16_bf16 a[64:79], v[36:39], v[64:67], a[64:79]
    ds_read_b64_tr_b16 v[52:53], v5 offset:0
    v_mfma_f32_32x32x16_bf16 a[80:95], v[36:39], v[68:71], a[80:95]
    ds_read_b64_tr_b16 v[54:55], v5 offset:512
    s_add_u32 s28, s28, s25
    buffer_load_dwordx4 v11, s[12:15], s28 offen offset:2048 lds
    v_mfma_f32_32x32x16_bf16 a[96:111], v[36:39], v[72:75], a[96:111]
    ds_read_b128 v[20:23], v3 offset:4096
    v_mfma_f32_32x32x16_bf16 a[112:127], v[36:39], v[76:79], a[112:127]
    ds_read_b64_tr_b16 v[56:57], v4 offset:8192
    s_add_u32 s28, s28, s25
    buffer_load_dwordx4 v11, s[12:15], s28 offen offset:3072 lds
    v_mfma_f32_32x32x16_bf16 a[128:143], v[40:43], v[64:67], a[128:143]
    ds_read_b64_tr_b16 v[58:59], v4 offset:8704
    v_mfma_f32_32x32x16_bf16 a[144:159], v[40:43], v[68:71], a[144:159]
    ds_read_b64_tr_b16 v[60:61], v5 offset:8192
    s_add_u32 m0, m0, 4096
    s_mov_b32 s28, s24
    s_add_u32 s24, s24, s26
    buffer_load_dwordx4 v11, s[12:15], s28 offen offset:0 lds
    v_mfma_f32_32x32x16_bf16 a[160:175], v[40:43], v[72:75], a[160:175]
    ds_read_b64_tr_b16 v[62:63], v5 offset:8704
    v_mfma_f32_32x32x16_bf16 a[176:191], v[40:43], v[76:79], a[176:191]
    ds_read_b128 v[24:27], v3 offset:8192
    s_add_u32 s28, s28, s25
    buffer_load_dwordx4 v11, s[12:15], s28 offen offset:1024 lds
    v_mfma_f32_32x32x16_bf16 a[192:207], v[44:47], v[64:67], a[192:207]
    ds_read_b128 v[28:31], v3 offset:12288
    v_mfma_f32_32x32x16_bf16 a[208:223], v[44:47], v[68:71], a[208:223]
    s_add_u32 s28, s28, s25
    buffer_load_dwordx4 v11, s[12:15], s28 offen offset:2048 lds
    v_mfma_f32_32x32x16_bf16 a[224:239], v[44:47], v[72:75], a[224:239]
    v_mfma_f32_32x32x16_bf16 a[240:255], v[44:47], v[76:79], a[240:255]
    s_add_u32 s28, s28, s25
    buffer_load_dwordx4 v11, s[12:15], s28 offen offset:3072 lds
    s_xor_b32 s19, s19, 65536
    s_add_u32 s31, s31, 1
    s_cmp_lt_u32 s31, 10
    s_cbranch_scc1 G_LV
    s_waitcnt lgkmcnt(0)
    s_nop 15
    s_lshl_b32 s28, s21, 3
    s_lshr_b32 s29, s17, 1
    s_lshl_b32 s29, s29, 2
    s_add_u32 s28, s28, s29
    s_lshl_b32 s28, s28, 5
    s_lshl_b32 s29, s22, 1
    s_add_u32 s28, s28, s29
    s_and_b32 s29, s17, 1
    s_add_u32 s28, s28, s29
    s_mul_i32 s28, s28, 16384
    s_add_u32 s28, s28, 33562624
    v_accvgpr_read_b32 v80, a0
    v_accvgpr_read_b32 v81, a1
    v_accvgpr_read_b32 v82, a2
    v_accvgpr_read_b32 v83, a3
    v_accvgpr_read_b32 v84, a4
    v_accvgpr_read_b32 v85, a5
    v_accvgpr_read_b32 v86, a6
    v_accvgpr_read_b32 v87, a7
    v_cvt_pk_bf16_f32 v96, v80, v81
    v_cvt_pk_bf16_f32 v97, v82, v83
    v_cvt_pk_bf16_f32 v98, v84, v85
    v_cvt_pk_bf16_f32 v99, v86, v87
    buffer_store_dwordx4 v[96:99], v9, s[8:11], s28 offen offset:0 sc1
    v_accvgpr_read_b32 v88, a8
    v_accvgpr_read_b32 v89, a9
    v_accvgpr_read_b32 v90, a10
    v_accvgpr_read_b32 v91, a11
    v_accvgpr_read_b32 v92, a12
    v_accvgpr_read_b32 v93, a13
    v_accvgpr_read_b32 v94, a14
    v_accvgpr_read_b32 v95, a15
    v_cvt_pk_bf16_f32 v100, v88, v89
    v_cvt_pk_bf16_f32 v101, v90, v91
    v_cvt_pk_bf16_f32 v102, v92, v93
    v_cvt_pk_bf16_f32 v103, v94, v95
    buffer_store_dwordx4 v[100:103], v9, s[8:11], s28 offen offset:512 sc1
    v_accvgpr_read_b32 v80, a16
    v_accvgpr_read_b32 v81, a17
    v_accvgpr_read_b32 v82, a18
    v_accvgpr_read_b32 v83, a19
    v_accvgpr_read_b32 v84, a20
    v_accvgpr_read_b32 v85, a21
    v_accvgpr_read_b32 v86, a22
    v_accvgpr_read_b32 v87, a23
    v_cvt_pk_bf16_f32 v104, v80, v81
    v_cvt_pk_bf16_f32 v105, v82, v83
    v_cvt_pk_bf16_f32 v106, v84, v85
    v_cvt_pk_bf16_f32 v107, v86, v87
    buffer_store_dwordx4 v[104:107], v9, s[8:11], s28 offen offset:2048 sc1
    v_accvgpr_read_b32 v88, a24
    v_accvgpr_read_b32 v89, a25
    v_accvgpr_read_b32 v90, a26
    v_accvgpr_read_b32 v91, a27
    v_accvgpr_read_b32 v92, a28
    v_accvgpr_read_b32 v93, a29
    v_accvgpr_read_b32 v94, a30
    v_accvgpr_read_b32 v95, a31
    v_cvt_pk_bf16_f32 v108, v88, v89
    v_cvt_pk_bf16_f32 v109, v90, v91
    v_cvt_pk_bf16_f32 v110, v92, v93
    v_cvt_pk_bf16_f32 v111, v94, v95
    buffer_store_dwordx4 v[108:111], v9, s[8:11], s28 offen offset:2560 sc1
    s_add_u32 s28, s28, 4096
    v_accvgpr_read_b32 v80, a32
    v_accvgpr_read_b32 v81, a33
    v_accvgpr_read_b32 v82, a34
    v_accvgpr_read_b32 v83, a35
    v_accvgpr_read_b32 v84, a36
    v_accvgpr_read_b32 v85, a37
    v_accvgpr_read_b32 v86, a38
    v_accvgpr_read_b32 v87, a39
    v_cvt_pk_bf16_f32 v112, v80, v81
    v_cvt_pk_bf16_f32 v113, v82, v83
    v_cvt_pk_bf16_f32 v114, v84, v85
    v_cvt_pk_bf16_f32 v115, v86, v87
    buffer_store_dwordx4 v[112:115], v9, s[8:11], s28 offen offset:0 sc1
    v_accvgpr_read_b32 v88, a40
    v_accvgpr_read_b32 v89, a41
    v_accvgpr_read_b32 v90, a42
    v_accvgpr_read_b32 v91, a43
    v_accvgpr_read_b32 v92, a44
    v_accvgpr_read_b32 v93, a45
    v_accvgpr_read_b32 v94, a46
    v_accvgpr_read_b32 v95, a47
    v_cvt_pk_bf16_f32 v116, v88, v89
    v_cvt_pk_bf16_f32 v117, v90, v91
    v_cvt_pk_bf16_f32 v118, v92, v93
    v_cvt_pk_bf16_f32 v119, v94, v95
    buffer_store_dwordx4 v[116:119], v9, s[8:11], s28 offen offset:512 sc1
    v_accvgpr_read_b32 v80, a48
    v_accvgpr_read_b32 v81, a49
    v_accvgpr_read_b32 v82, a50
    v_accvgpr_read_b32 v83, a51
    v_accvgpr_read_b32 v84, a52
    v_accvgpr_read_b32 v85, a53
    v_accvgpr_read_b32 v86, a54
    v_accvgpr_read_b32 v87, a55
    v_cvt_pk_bf16_f32 v120, v80, v81
    v_cvt_pk_bf16_f32 v121, v82, v83
    v_cvt_pk_bf16_f32 v122, v84, v85
    v_cvt_pk_bf16_f32 v123, v86, v87
    buffer_store_dwordx4 v[120:123], v9, s[8:11], s28 offen offset:2048 sc1
    v_accvgpr_read_b32 v88, a56
    v_accvgpr_read_b32 v89, a57
    v_accvgpr_read_b32 v90, a58
    v_accvgpr_read_b32 v91, a59
    v_accvgpr_read_b32 v92, a60
    v_accvgpr_read_b32 v93, a61
    v_accvgpr_read_b32 v94, a62
    v_accvgpr_read_b32 v95, a63
    v_cvt_pk_bf16_f32 v124, v88, v89
    v_cvt_pk_bf16_f32 v125, v90, v91
    v_cvt_pk_bf16_f32 v126, v92, v93
    v_cvt_pk_bf16_f32 v127, v94, v95
    buffer_store_dwordx4 v[124:127], v9, s[8:11], s28 offen offset:2560 sc1
    s_add_u32 s28, s28, 520192
    v_accvgpr_read_b32 v80, a64
    v_accvgpr_read_b32 v81, a65
    v_accvgpr_read_b32 v82, a66
    v_accvgpr_read_b32 v83, a67
    v_accvgpr_read_b32 v84, a68
    v_accvgpr_read_b32 v85, a69
    v_accvgpr_read_b32 v86, a70
    v_accvgpr_read_b32 v87, a71
    v_cvt_pk_bf16_f32 v96, v80, v81
    v_cvt_pk_bf16_f32 v97, v82, v83
    v_cvt_pk_bf16_f32 v98, v84, v85
    v_cvt_pk_bf16_f32 v99, v86, v87
    buffer_store_dwordx4 v[96:99], v9, s[8:11], s28 offen offset:0 sc1
    v_accvgpr_read_b32 v88, a72
    v_accvgpr_read_b32 v89, a73
    v_accvgpr_read_b32 v90, a74
    v_accvgpr_read_b32 v91, a75
    v_accvgpr_read_b32 v92, a76
    v_accvgpr_read_b32 v93, a77
    v_accvgpr_read_b32 v94, a78
    v_accvgpr_read_b32 v95, a79
    v_cvt_pk_bf16_f32 v100, v88, v89
    v_cvt_pk_bf16_f32 v101, v90, v91
    v_cvt_pk_bf16_f32 v102, v92, v93
    v_cvt_pk_bf16_f32 v103, v94, v95
    buffer_store_dwordx4 v[100:103], v9, s[8:11], s28 offen offset:512 sc1
    v_accvgpr_read_b32 v80, a80
    v_accvgpr_read_b32 v81, a81
    v_accvgpr_read_b32 v82, a82
    v_accvgpr_read_b32 v83, a83
    v_accvgpr_read_b32 v84, a84
    v_accvgpr_read_b32 v85, a85
    v_accvgpr_read_b32 v86, a86
    v_accvgpr_read_b32 v87, a87
    v_cvt_pk_bf16_f32 v104, v80, v81
    v_cvt_pk_bf16_f32 v105, v82, v83
    v_cvt_pk_bf16_f32 v106, v84, v85
    v_cvt_pk_bf16_f32 v107, v86, v87
    buffer_store_dwordx4 v[104:107], v9, s[8:11], s28 offen offset:2048 sc1
    v_accvgpr_read_b32 v88, a88
    v_accvgpr_read_b32 v89, a89
    v_accvgpr_read_b32 v90, a90
    v_accvgpr_read_b32 v91, a91
    v_accvgpr_read_b32 v92, a92
    v_accvgpr_read_b32 v93, a93
    v_accvgpr_read_b32 v94, a94
    v_accvgpr_read_b32 v95, a95
    v_cvt_pk_bf16_f32 v108, v88, v89
    v_cvt_pk_bf16_f32 v109, v90, v91
    v_cvt_pk_bf16_f32 v110, v92, v93
    v_cvt_pk_bf16_f32 v111, v94, v95
    buffer_store_dwordx4 v[108:111], v9, s[8:11], s28 offen offset:2560 sc1
    s_add_u32 s28, s28, 4096
    v_accvgpr_read_b32 v80, a96
    v_accvgpr_read_b32 v81, a97
    v_accvgpr_read_b32 v82, a98
    v_accvgpr_read_b32 v83, a99
    v_accvgpr_read_b32 v84, a100
    v_accvgpr_read_b32 v85, a101
    v_accvgpr_read_b32 v86, a102
    v_accvgpr_read_b32 v87, a103
    v_cvt_pk_bf16_f32 v112, v80, v81
    v_cvt_pk_bf16_f32 v113, v82, v83
    v_cvt_pk_bf16_f32 v114, v84, v85
    v_cvt_pk_bf16_f32 v115, v86, v87
    buffer_store_dwordx4 v[112:115], v9, s[8:11], s28 offen offset:0 sc1
    v_accvgpr_read_b32 v88, a104
    v_accvgpr_read_b32 v89, a105
    v_accvgpr_read_b32 v90, a106
    v_accvgpr_read_b32 v91, a107
    v_accvgpr_read_b32 v92, a108
    v_accvgpr_read_b32 v93, a109
    v_accvgpr_read_b32 v94, a110
    v_accvgpr_read_b32 v95, a111
    v_cvt_pk_bf16_f32 v116, v88, v89
    v_cvt_pk_bf16_f32 v117, v90, v91
    v_cvt_pk_bf16_f32 v118, v92, v93
    v_cvt_pk_bf16_f32 v119, v94, v95
    buffer_store_dwordx4 v[116:119], v9, s[8:11], s28 offen offset:512 sc1
    v_accvgpr_read_b32 v80, a112
    v_accvgpr_read_b32 v81, a113
    v_accvgpr_read_b32 v82, a114
    v_accvgpr_read_b32 v83, a115
    v_accvgpr_read_b32 v84, a116
    v_accvgpr_read_b32 v85, a117
    v_accvgpr_read_b32 v86, a118
    v_accvgpr_read_b32 v87, a119
    v_cvt_pk_bf16_f32 v120, v80, v81
    v_cvt_pk_bf16_f32 v121, v82, v83
    v_cvt_pk_bf16_f32 v122, v84, v85
    v_cvt_pk_bf16_f32 v123, v86, v87
    buffer_store_dwordx4 v[120:123], v9, s[8:11], s28 offen offset:2048 sc1
    v_accvgpr_read_b32 v88, a120
    v_accvgpr_read_b32 v89, a121
    v_accvgpr_read_b32 v90, a122
    v_accvgpr_read_b32 v91, a123
    v_accvgpr_read_b32 v92, a124
    v_accvgpr_read_b32 v93, a125
    v_accvgpr_read_b32 v94, a126
    v_accvgpr_read_b32 v95, a127
    v_cvt_pk_bf16_f32 v124, v88, v89
    v_cvt_pk_bf16_f32 v125, v90, v91
    v_cvt_pk_bf16_f32 v126, v92, v93
    v_cvt_pk_bf16_f32 v127, v94, v95
    buffer_store_dwordx4 v[124:127], v9, s[8:11], s28 offen offset:2560 sc1
    s_add_u32 s28, s28, 520192
    v_accvgpr_read_b32 v80, a128
    v_accvgpr_read_b32 v81, a129
    v_accvgpr_read_b32 v82, a130
    v_accvgpr_read_b32 v83, a131
    v_accvgpr_read_b32 v84, a132
    v_accvgpr_read_b32 v85, a133
    v_accvgpr_read_b32 v86, a134
    v_accvgpr_read_b32 v87, a135
    v_cvt_pk_bf16_f32 v96, v80, v81
    v_cvt_pk_bf16_f32 v97, v82, v83
    v_cvt_pk_bf16_f32 v98, v84, v85
    v_cvt_pk_bf16_f32 v99, v86, v87
    buffer_store_dwordx4 v[96:99], v9, s[8:11], s28 offen offset:0 sc1
    v_accvgpr_read_b32 v88, a136
    v_accvgpr_read_b32 v89, a137
    v_accvgpr_read_b32 v90, a138
    v_accvgpr_read_b32 v91, a139
    v_accvgpr_read_b32 v92, a140
    v_accvgpr_read_b32 v93, a141
    v_accvgpr_read_b32 v94, a142
    v_accvgpr_read_b32 v95, a143
    v_cvt_pk_bf16_f32 v100, v88, v89
    v_cvt_pk_bf16_f32 v101, v90, v91
    v_cvt_pk_bf16_f32 v102, v92, v93
    v_cvt_pk_bf16_f32 v103, v94, v95
    buffer_store_dwordx4 v[100:103], v9, s[8:11], s28 offen offset:512 sc1
    v_accvgpr_read_b32 v80, a144
    v_accvgpr_read_b32 v81, a145
    v_accvgpr_read_b32 v82, a146
    v_accvgpr_read_b32 v83, a147
    v_accvgpr_read_b32 v84, a148
    v_accvgpr_read_b32 v85, a149
    v_accvgpr_read_b32 v86, a150
    v_accvgpr_read_b32 v87, a151
    v_cvt_pk_bf16_f32 v104, v80, v81
    v_cvt_pk_bf16_f32 v105, v82, v83
    v_cvt_pk_bf16_f32 v106, v84, v85
    v_cvt_pk_bf16_f32 v107, v86, v87
    buffer_store_dwordx4 v[104:107], v9, s[8:11], s28 offen offset:2048 sc1
    v_accvgpr_read_b32 v88, a152
    v_accvgpr_read_b32 v89, a153
    v_accvgpr_read_b32 v90, a154
    v_accvgpr_read_b32 v91, a155
    v_accvgpr_read_b32 v92, a156
    v_accvgpr_read_b32 v93, a157
    v_accvgpr_read_b32 v94, a158
    v_accvgpr_read_b32 v95, a159
    v_cvt_pk_bf16_f32 v108, v88, v89
    v_cvt_pk_bf16_f32 v109, v90, v91
    v_cvt_pk_bf16_f32 v110, v92, v93
    v_cvt_pk_bf16_f32 v111, v94, v95
    buffer_store_dwordx4 v[108:111], v9, s[8:11], s28 offen offset:2560 sc1
    s_add_u32 s28, s28, 4096
    v_accvgpr_read_b32 v80, a160
    v_accvgpr_read_b32 v81, a161
    v_accvgpr_read_b32 v82, a162
    v_accvgpr_read_b32 v83, a163
    v_accvgpr_read_b32 v84, a164
    v_accvgpr_read_b32 v85, a165
    v_accvgpr_read_b32 v86, a166
    v_accvgpr_read_b32 v87, a167
    v_cvt_pk_bf16_f32 v112, v80, v81
    v_cvt_pk_bf16_f32 v113, v82, v83
    v_cvt_pk_bf16_f32 v114, v84, v85
    v_cvt_pk_bf16_f32 v115, v86, v87
    buffer_store_dwordx4 v[112:115], v9, s[8:11], s28 offen offset:0 sc1
    v_accvgpr_read_b32 v88, a168
    v_accvgpr_read_b32 v89, a169
    v_accvgpr_read_b32 v90, a170
    v_accvgpr_read_b32 v91, a171
    v_accvgpr_read_b32 v92, a172
    v_accvgpr_read_b32 v93, a173
    v_accvgpr_read_b32 v94, a174
    v_accvgpr_read_b32 v95, a175
    v_cvt_pk_bf16_f32 v116, v88, v89
    v_cvt_pk_bf16_f32 v117, v90, v91
    v_cvt_pk_bf16_f32 v118, v92, v93
    v_cvt_pk_bf16_f32 v119, v94, v95
    buffer_store_dwordx4 v[116:119], v9, s[8:11], s28 offen offset:512 sc1
    v_accvgpr_read_b32 v80, a176
    v_accvgpr_read_b32 v81, a177
    v_accvgpr_read_b32 v82, a178
    v_accvgpr_read_b32 v83, a179
    v_accvgpr_read_b32 v84, a180
    v_accvgpr_read_b32 v85, a181
    v_accvgpr_read_b32 v86, a182
    v_accvgpr_read_b32 v87, a183
    v_cvt_pk_bf16_f32 v120, v80, v81
    v_cvt_pk_bf16_f32 v121, v82, v83
    v_cvt_pk_bf16_f32 v122, v84, v85
    v_cvt_pk_bf16_f32 v123, v86, v87
    buffer_store_dwordx4 v[120:123], v9, s[8:11], s28 offen offset:2048 sc1
    v_accvgpr_read_b32 v88, a184
    v_accvgpr_read_b32 v89, a185
    v_accvgpr_read_b32 v90, a186
    v_accvgpr_read_b32 v91, a187
    v_accvgpr_read_b32 v92, a188
    v_accvgpr_read_b32 v93, a189
    v_accvgpr_read_b32 v94, a190
    v_accvgpr_read_b32 v95, a191
    v_cvt_pk_bf16_f32 v124, v88, v89
    v_cvt_pk_bf16_f32 v125, v90, v91
    v_cvt_pk_bf16_f32 v126, v92, v93
    v_cvt_pk_bf16_f32 v127, v94, v95
    buffer_store_dwordx4 v[124:127], v9, s[8:11], s28 offen offset:2560 sc1
    s_add_u32 s28, s28, 520192
    v_accvgpr_read_b32 v80, a192
    v_accvgpr_read_b32 v81, a193
    v_accvgpr_read_b32 v82, a194
    v_accvgpr_read_b32 v83, a195
    v_accvgpr_read_b32 v84, a196
    v_accvgpr_read_b32 v85, a197
    v_accvgpr_read_b32 v86, a198
    v_accvgpr_read_b32 v87, a199
    v_cvt_pk_bf16_f32 v96, v80, v81
    v_cvt_pk_bf16_f32 v97, v82, v83
    v_cvt_pk_bf16_f32 v98, v84, v85
    v_cvt_pk_bf16_f32 v99, v86, v87
    buffer_store_dwordx4 v[96:99], v9, s[8:11], s28 offen offset:0 sc1
    v_accvgpr_read_b32 v88, a200
    v_accvgpr_read_b32 v89, a201
    v_accvgpr_read_b32 v90, a202
    v_accvgpr_read_b32 v91, a203
    v_accvgpr_read_b32 v92, a204
    v_accvgpr_read_b32 v93, a205
    v_accvgpr_read_b32 v94, a206
    v_accvgpr_read_b32 v95, a207
    v_cvt_pk_bf16_f32 v100, v88, v89
    v_cvt_pk_bf16_f32 v101, v90, v91
    v_cvt_pk_bf16_f32 v102, v92, v93
    v_cvt_pk_bf16_f32 v103, v94, v95
    buffer_store_dwordx4 v[100:103], v9, s[8:11], s28 offen offset:512 sc1
    v_accvgpr_read_b32 v80, a208
    v_accvgpr_read_b32 v81, a209
    v_accvgpr_read_b32 v82, a210
    v_accvgpr_read_b32 v83, a211
    v_accvgpr_read_b32 v84, a212
    v_accvgpr_read_b32 v85, a213
    v_accvgpr_read_b32 v86, a214
    v_accvgpr_read_b32 v87, a215
    v_cvt_pk_bf16_f32 v104, v80, v81
    v_cvt_pk_bf16_f32 v105, v82, v83
    v_cvt_pk_bf16_f32 v106, v84, v85
    v_cvt_pk_bf16_f32 v107, v86, v87
    buffer_store_dwordx4 v[104:107], v9, s[8:11], s28 offen offset:2048 sc1
    v_accvgpr_read_b32 v88, a216
    v_accvgpr_read_b32 v89, a217
    v_accvgpr_read_b32 v90, a218
    v_accvgpr_read_b32 v91, a219
    v_accvgpr_read_b32 v92, a220
    v_accvgpr_read_b32 v93, a221
    v_accvgpr_read_b32 v94, a222
    v_accvgpr_read_b32 v95, a223
    v_cvt_pk_bf16_f32 v108, v88, v89
    v_cvt_pk_bf16_f32 v109, v90, v91
    v_cvt_pk_bf16_f32 v110, v92, v93
    v_cvt_pk_bf16_f32 v111, v94, v95
    buffer_store_dwordx4 v[108:111], v9, s[8:11], s28 offen offset:2560 sc1
    s_add_u32 s28, s28, 4096
    v_accvgpr_read_b32 v80, a224
    v_accvgpr_read_b32 v81, a225
    v_accvgpr_read_b32 v82, a226
    v_accvgpr_read_b32 v83, a227
    v_accvgpr_read_b32 v84, a228
    v_accvgpr_read_b32 v85, a229
    v_accvgpr_read_b32 v86, a230
    v_accvgpr_read_b32 v87, a231
    v_cvt_pk_bf16_f32 v112, v80, v81
    v_cvt_pk_bf16_f32 v113, v82, v83
    v_cvt_pk_bf16_f32 v114, v84, v85
    v_cvt_pk_bf16_f32 v115, v86, v87
    buffer_store_dwordx4 v[112:115], v9, s[8:11], s28 offen offset:0 sc1
    v_accvgpr_read_b32 v88, a232
    v_accvgpr_read_b32 v89, a233
    v_accvgpr_read_b32 v90, a234
    v_accvgpr_read_b32 v91, a235
    v_accvgpr_read_b32 v92, a236
    v_accvgpr_read_b32 v93, a237
    v_accvgpr_read_b32 v94, a238
    v_accvgpr_read_b32 v95, a239
    v_cvt_pk_bf16_f32 v116, v88, v89
    v_cvt_pk_bf16_f32 v117, v90, v91
    v_cvt_pk_bf16_f32 v118, v92, v93
    v_cvt_pk_bf16_f32 v119, v94, v95
    buffer_store_dwordx4 v[116:119], v9, s[8:11], s28 offen offset:512 sc1
    v_accvgpr_read_b32 v80, a240
    v_accvgpr_read_b32 v81, a241
    v_accvgpr_read_b32 v82, a242
    v_accvgpr_read_b32 v83, a243
    v_accvgpr_read_b32 v84, a244
    v_accvgpr_read_b32 v85, a245
    v_accvgpr_read_b32 v86, a246
    v_accvgpr_read_b32 v87, a247
    v_cvt_pk_bf16_f32 v120, v80, v81
    v_cvt_pk_bf16_f32 v121, v82, v83
    v_cvt_pk_bf16_f32 v122, v84, v85
    v_cvt_pk_bf16_f32 v123, v86, v87
    buffer_store_dwordx4 v[120:123], v9, s[8:11], s28 offen offset:2048 sc1
    v_accvgpr_read_b32 v88, a248
    v_accvgpr_read_b32 v89, a249
    v_accvgpr_read_b32 v90, a250
    v_accvgpr_read_b32 v91, a251
    v_accvgpr_read_b32 v92, a252
    v_accvgpr_read_b32 v93, a253
    v_accvgpr_read_b32 v94, a254
    v_accvgpr_read_b32 v95, a255
    v_cvt_pk_bf16_f32 v124, v88, v89
    v_cvt_pk_bf16_f32 v125, v90, v91
    v_cvt_pk_bf16_f32 v126, v92, v93
    v_cvt_pk_bf16_f32 v127, v94, v95
    buffer_store_dwordx4 v[124:127], v9, s[8:11], s28 offen offset:2560 sc1
    s_add_u32 s28, s28, 520192
    s_branch G_DONE
G_EPI:
    s_waitcnt lgkmcnt(0)
    s_nop 15
    s_cmp_eq_u32 s20, 3
    s_cbranch_scc1 G_EPF
    s_cmp_eq_u32 s20, 2
    s_cbranch_scc1 G_EPQ
    s_lshl_b32 s28, s21, 3
    s_lshr_b32 s29, s17, 1
    s_lshl_b32 s29, s29, 2
    s_add_u32 s28, s28, s29
    s_lshl_b32 s28, s28, 5
    s_lshl_b32 s29, s22, 1
    s_add_u32 s28, s28, s29
    s_and_b32 s29, s17, 1
    s_add_u32 s28, s28, s29
    s_mul_i32 s28, s28, 16384
    s_add_u32 s28, s28, 33554432
    s_mov_b32 s29, 524288
    s_branch G_EPK
G_EPQ:
    s_lshl_b32 s28, s21, 3
    s_lshr_b32 s29, s17, 1
    s_lshl_b32 s29, s29, 2
    s_add_u32 s28, s28, s29
    s_lshl_b32 s28, s28, 5
    s_lshl_b32 s29, s22, 1
    s_add_u32 s28, s28, s29
    s_and_b32 s29, s17, 1
    s_add_u32 s28, s28, s29
    s_mul_i32 s28, s28, 8192
    s_add_u32 s28, s28, 100663296
    s_mov_b32 s29, 262144
G_EPK:
    v_accvgpr_read_b32 v80, a0
    v_accvgpr_read_b32 v81, a1
    v_accvgpr_read_b32 v82, a2
    v_accvgpr_read_b32 v83, a3
    v_accvgpr_read_b32 v84, a4
    v_accvgpr_read_b32 v85, a5
    v_accvgpr_read_b32 v86, a6
    v_accvgpr_read_b32 v87, a7
    v_cvt_pk_bf16_f32 v96, v80, v81
    v_cvt_pk_bf16_f32 v97, v82, v83
    v_cvt_pk_bf16_f32 v98, v84, v85
    v_cvt_pk_bf16_f32 v99, v86, v87
    buffer_store_dwordx4 v[96:99], v8, s[8:11], s28 offen offset:0 sc1
    v_accvgpr_read_b32 v88, a8
    v_accvgpr_read_b32 v89, a9
    v_accvgpr_read_b32 v90, a10
    v_accvgpr_read_b32 v91, a11
    v_accvgpr_read_b32 v92, a12
    v_accvgpr_read_b32 v93, a13
    v_accvgpr_read_b32 v94, a14
    v_accvgpr_read_b32 v95, a15
    v_cvt_pk_bf16_f32 v100, v88, v89
    v_cvt_pk_bf16_f32 v101, v90, v91
    v_cvt_pk_bf16_f32 v102, v92, v93
    v_cvt_pk_bf16_f32 v103, v94, v95
    buffer_store_dwordx4 v[100:103], v8, s[8:11], s28 offen offset:512 sc1
    v_accvgpr_read_b32 v80, a16
    v_accvgpr_read_b32 v81, a17
    v_accvgpr_read_b32 v82, a18
    v_accvgpr_read_b32 v83, a19
    v_accvgpr_read_b32 v84, a20
    v_accvgpr_read_b32 v85, a21
    v_accvgpr_read_b32 v86, a22
    v_accvgpr_read_b32 v87, a23
    v_cvt_pk_bf16_f32 v104, v80, v81
    v_cvt_pk_bf16_f32 v105, v82, v83
    v_cvt_pk_bf16_f32 v106, v84, v85
    v_cvt_pk_bf16_f32 v107, v86, v87
    buffer_store_dwordx4 v[104:107], v8, s[8:11], s28 offen offset:1024 sc1
    v_accvgpr_read_b32 v88, a24
    v_accvgpr_read_b32 v89, a25
    v_accvgpr_read_b32 v90, a26
    v_accvgpr_read_b32 v91, a27
    v_accvgpr_read_b32 v92, a28
    v_accvgpr_read_b32 v93, a29
    v_accvgpr_read_b32 v94, a30
    v_accvgpr_read_b32 v95, a31
    v_cvt_pk_bf16_f32 v108, v88, v89
    v_cvt_pk_bf16_f32 v109, v90, v91
    v_cvt_pk_bf16_f32 v110, v92, v93
    v_cvt_pk_bf16_f32 v111, v94, v95
    buffer_store_dwordx4 v[108:111], v8, s[8:11], s28 offen offset:1536 sc1
    v_accvgpr_read_b32 v80, a32
    v_accvgpr_read_b32 v81, a33
    v_accvgpr_read_b32 v82, a34
    v_accvgpr_read_b32 v83, a35
    v_accvgpr_read_b32 v84, a36
    v_accvgpr_read_b32 v85, a37
    v_accvgpr_read_b32 v86, a38
    v_accvgpr_read_b32 v87, a39
    v_cvt_pk_bf16_f32 v112, v80, v81
    v_cvt_pk_bf16_f32 v113, v82, v83
    v_cvt_pk_bf16_f32 v114, v84, v85
    v_cvt_pk_bf16_f32 v115, v86, v87
    buffer_store_dwordx4 v[112:115], v8, s[8:11], s28 offen offset:2048 sc1
    v_accvgpr_read_b32 v88, a40
    v_accvgpr_read_b32 v89, a41
    v_accvgpr_read_b32 v90, a42
    v_accvgpr_read_b32 v91, a43
    v_accvgpr_read_b32 v92, a44
    v_accvgpr_read_b32 v93, a45
    v_accvgpr_read_b32 v94, a46
    v_accvgpr_read_b32 v95, a47
    v_cvt_pk_bf16_f32 v116, v88, v89
    v_cvt_pk_bf16_f32 v117, v90, v91
    v_cvt_pk_bf16_f32 v118, v92, v93
    v_cvt_pk_bf16_f32 v119, v94, v95
    buffer_store_dwordx4 v[116:119], v8, s[8:11], s28 offen offset:2560 sc1
    v_accvgpr_read_b32 v80, a48
    v_accvgpr_read_b32 v81, a49
    v_accvgpr_read_b32 v82, a50
    v_accvgpr_read_b32 v83, a51
    v_accvgpr_read_b32 v84, a52
    v_accvgpr_read_b32 v85, a53
    v_accvgpr_read_b32 v86, a54
    v_accvgpr_read_b32 v87, a55
    v_cvt_pk_bf16_f32 v120, v80, v81
    v_cvt_pk_bf16_f32 v121, v82, v83
    v_cvt_pk_bf16_f32 v122, v84, v85
    v_cvt_pk_bf16_f32 v123, v86, v87
    buffer_store_dwordx4 v[120:123], v8, s[8:11], s28 offen offset:3072 sc1
    v_accvgpr_read_b32 v88, a56
    v_accvgpr_read_b32 v89, a57
    v_accvgpr_read_b32 v90, a58
    v_accvgpr_read_b32 v91, a59
    v_accvgpr_read_b32 v92, a60
    v_accvgpr_read_b32 v93, a61
    v_accvgpr_read_b32 v94, a62
    v_accvgpr_read_b32 v95, a63
    v_cvt_pk_bf16_f32 v124, v88, v89
    v_cvt_pk_bf16_f32 v125, v90, v91
    v_cvt_pk_bf16_f32 v126, v92, v93
    v_cvt_pk_bf16_f32 v127, v94, v95
    buffer_store_dwordx4 v[124:127], v8, s[8:11], s28 offen offset:3584 sc1
    s_add_u32 s28, s28, s29
    v_accvgpr_read_b32 v80, a64
    v_accvgpr_read_b32 v81, a65
    v_accvgpr_read_b32 v82, a66
    v_accvgpr_read_b32 v83, a67
    v_accvgpr_read_b32 v84, a68
    v_accvgpr_read_b32 v85, a69
    v_accvgpr_read_b32 v86, a70
    v_accvgpr_read_b32 v87, a71
    v_cvt_pk_bf16_f32 v96, v80, v81
    v_cvt_pk_bf16_f32 v97, v82, v83
    v_cvt_pk_bf16_f32 v98, v84, v85
    v_cvt_pk_bf16_f32 v99, v86, v87
    buffer_store_dwordx4 v[96:99], v8, s[8:11], s28 offen offset:0 sc1
    v_accvgpr_read_b32 v88, a72
    v_accvgpr_read_b32 v89, a73
    v_accvgpr_read_b32 v90, a74
    v_accvgpr_read_b32 v91, a75
    v_accvgpr_read_b32 v92, a76
    v_accvgpr_read_b32 v93, a77
    v_accvgpr_read_b32 v94, a78
    v_accvgpr_read_b32 v95, a79
    v_cvt_pk_bf16_f32 v100, v88, v89
    v_cvt_pk_bf16_f32 v101, v90, v91
    v_cvt_pk_bf16_f32 v102, v92, v93
    v_cvt_pk_bf16_f32 v103, v94, v95
    buffer_store_dwordx4 v[100:103], v8, s[8:11], s28 offen offset:512 sc1
    v_accvgpr_read_b32 v80, a80
    v_accvgpr_read_b32 v81, a81
    v_accvgpr_read_b32 v82, a82
    v_accvgpr_read_b32 v83, a83
    v_accvgpr_read_b32 v84, a84
    v_accvgpr_read_b32 v85, a85
    v_accvgpr_read_b32 v86, a86
    v_accvgpr_read_b32 v87, a87
    v_cvt_pk_bf16_f32 v104, v80, v81
    v_cvt_pk_bf16_f32 v105, v82, v83
    v_cvt_pk_bf16_f32 v106, v84, v85
    v_cvt_pk_bf16_f32 v107, v86, v87
    buffer_store_dwordx4 v[104:107], v8, s[8:11], s28 offen offset:1024 sc1
    v_accvgpr_read_b32 v88, a88
    v_accvgpr_read_b32 v89, a89
    v_accvgpr_read_b32 v90, a90
    v_accvgpr_read_b32 v91, a91
    v_accvgpr_read_b32 v92, a92
    v_accvgpr_read_b32 v93, a93
    v_accvgpr_read_b32 v94, a94
    v_accvgpr_read_b32 v95, a95
    v_cvt_pk_bf16_f32 v108, v88, v89
    v_cvt_pk_bf16_f32 v109, v90, v91
    v_cvt_pk_bf16_f32 v110, v92, v93
    v_cvt_pk_bf16_f32 v111, v94, v95
    buffer_store_dwordx4 v[108:111], v8, s[8:11], s28 offen offset:1536 sc1
    v_accvgpr_read_b32 v80, a96
    v_accvgpr_read_b32 v81, a97
    v_accvgpr_read_b32 v82, a98
    v_accvgpr_read_b32 v83, a99
    v_accvgpr_read_b32 v84, a100
    v_accvgpr_read_b32 v85, a101
    v_accvgpr_read_b32 v86, a102
    v_accvgpr_read_b32 v87, a103
    v_cvt_pk_bf16_f32 v112, v80, v81
    v_cvt_pk_bf16_f32 v113, v82, v83
    v_cvt_pk_bf16_f32 v114, v84, v85
    v_cvt_pk_bf16_f32 v115, v86, v87
    buffer_store_dwordx4 v[112:115], v8, s[8:11], s28 offen offset:2048 sc1
    v_accvgpr_read_b32 v88, a104
    v_accvgpr_read_b32 v89, a105
    v_accvgpr_read_b32 v90, a106
    v_accvgpr_read_b32 v91, a107
    v_accvgpr_read_b32 v92, a108
    v_accvgpr_read_b32 v93, a109
    v_accvgpr_read_b32 v94, a110
    v_accvgpr_read_b32 v95, a111
    v_cvt_pk_bf16_f32 v116, v88, v89
    v_cvt_pk_bf16_f32 v117, v90, v91
    v_cvt_pk_bf16_f32 v118, v92, v93
    v_cvt_pk_bf16_f32 v119, v94, v95
    buffer_store_dwordx4 v[116:119], v8, s[8:11], s28 offen offset:2560 sc1
    v_accvgpr_read_b32 v80, a112
    v_accvgpr_read_b32 v81, a113
    v_accvgpr_read_b32 v82, a114
    v_accvgpr_read_b32 v83, a115
    v_accvgpr_read_b32 v84, a116
    v_accvgpr_read_b32 v85, a117
    v_accvgpr_read_b32 v86, a118
    v_accvgpr_read_b32 v87, a119
    v_cvt_pk_bf16_f32 v120, v80, v81
    v_cvt_pk_bf16_f32 v121, v82, v83
    v_cvt_pk_bf16_f32 v122, v84, v85
    v_cvt_pk_bf16_f32 v123, v86, v87
    buffer_store_dwordx4 v[120:123], v8, s[8:11], s28 offen offset:3072 sc1
    v_accvgpr_read_b32 v88, a120
    v_accvgpr_read_b32 v89, a121
    v_accvgpr_read_b32 v90, a122
    v_accvgpr_read_b32 v91, a123
    v_accvgpr_read_b32 v92, a124
    v_accvgpr_read_b32 v93, a125
    v_accvgpr_read_b32 v94, a126
    v_accvgpr_read_b32 v95, a127
    v_cvt_pk_bf16_f32 v124, v88, v89
    v_cvt_pk_bf16_f32 v125, v90, v91
    v_cvt_pk_bf16_f32 v126, v92, v93
    v_cvt_pk_bf16_f32 v127, v94, v95
    buffer_store_dwordx4 v[124:127], v8, s[8:11], s28 offen offset:3584 sc1
    s_add_u32 s28, s28, s29
    v_accvgpr_read_b32 v80, a128
    v_accvgpr_read_b32 v81, a129
    v_accvgpr_read_b32 v82, a130
    v_accvgpr_read_b32 v83, a131
    v_accvgpr_read_b32 v84, a132
    v_accvgpr_read_b32 v85, a133
    v_accvgpr_read_b32 v86, a134
    v_accvgpr_read_b32 v87, a135
    v_cvt_pk_bf16_f32 v96, v80, v81
    v_cvt_pk_bf16_f32 v97, v82, v83
    v_cvt_pk_bf16_f32 v98, v84, v85
    v_cvt_pk_bf16_f32 v99, v86, v87
    buffer_store_dwordx4 v[96:99], v8, s[8:11], s28 offen offset:0 sc1
    v_accvgpr_read_b32 v88, a136
    v_accvgpr_read_b32 v89, a137
    v_accvgpr_read_b32 v90, a138
    v_accvgpr_read_b32 v91, a139
    v_accvgpr_read_b32 v92, a140
    v_accvgpr_read_b32 v93, a141
    v_accvgpr_read_b32 v94, a142
    v_accvgpr_read_b32 v95, a143
    v_cvt_pk_bf16_f32 v100, v88, v89
    v_cvt_pk_bf16_f32 v101, v90, v91
    v_cvt_pk_bf16_f32 v102, v92, v93
    v_cvt_pk_bf16_f32 v103, v94, v95
    buffer_store_dwordx4 v[100:103], v8, s[8:11], s28 offen offset:512 sc1
    v_accvgpr_read_b32 v80, a144
    v_accvgpr_read_b32 v81, a145
    v_accvgpr_read_b32 v82, a146
    v_accvgpr_read_b32 v83, a147
    v_accvgpr_read_b32 v84, a148
    v_accvgpr_read_b32 v85, a149
    v_accvgpr_read_b32 v86, a150
    v_accvgpr_read_b32 v87, a151
    v_cvt_pk_bf16_f32 v104, v80, v81
    v_cvt_pk_bf16_f32 v105, v82, v83
    v_cvt_pk_bf16_f32 v106, v84, v85
    v_cvt_pk_bf16_f32 v107, v86, v87
    buffer_store_dwordx4 v[104:107], v8, s[8:11], s28 offen offset:1024 sc1
    v_accvgpr_read_b32 v88, a152
    v_accvgpr_read_b32 v89, a153
    v_accvgpr_read_b32 v90, a154
    v_accvgpr_read_b32 v91, a155
    v_accvgpr_read_b32 v92, a156
    v_accvgpr_read_b32 v93, a157
    v_accvgpr_read_b32 v94, a158
    v_accvgpr_read_b32 v95, a159
    v_cvt_pk_bf16_f32 v108, v88, v89
    v_cvt_pk_bf16_f32 v109, v90, v91
    v_cvt_pk_bf16_f32 v110, v92, v93
    v_cvt_pk_bf16_f32 v111, v94, v95
    buffer_store_dwordx4 v[108:111], v8, s[8:11], s28 offen offset:1536 sc1
    v_accvgpr_read_b32 v80, a160
    v_accvgpr_read_b32 v81, a161
    v_accvgpr_read_b32 v82, a162
    v_accvgpr_read_b32 v83, a163
    v_accvgpr_read_b32 v84, a164
    v_accvgpr_read_b32 v85, a165
    v_accvgpr_read_b32 v86, a166
    v_accvgpr_read_b32 v87, a167
    v_cvt_pk_bf16_f32 v112, v80, v81
    v_cvt_pk_bf16_f32 v113, v82, v83
    v_cvt_pk_bf16_f32 v114, v84, v85
    v_cvt_pk_bf16_f32 v115, v86, v87
    buffer_store_dwordx4 v[112:115], v8, s[8:11], s28 offen offset:2048 sc1
    v_accvgpr_read_b32 v88, a168
    v_accvgpr_read_b32 v89, a169
    v_accvgpr_read_b32 v90, a170
    v_accvgpr_read_b32 v91, a171
    v_accvgpr_read_b32 v92, a172
    v_accvgpr_read_b32 v93, a173
    v_accvgpr_read_b32 v94, a174
    v_accvgpr_read_b32 v95, a175
    v_cvt_pk_bf16_f32 v116, v88, v89
    v_cvt_pk_bf16_f32 v117, v90, v91
    v_cvt_pk_bf16_f32 v118, v92, v93
    v_cvt_pk_bf16_f32 v119, v94, v95
    buffer_store_dwordx4 v[116:119], v8, s[8:11], s28 offen offset:2560 sc1
    v_accvgpr_read_b32 v80, a176
    v_accvgpr_read_b32 v81, a177
    v_accvgpr_read_b32 v82, a178
    v_accvgpr_read_b32 v83, a179
    v_accvgpr_read_b32 v84, a180
    v_accvgpr_read_b32 v85, a181
    v_accvgpr_read_b32 v86, a182
    v_accvgpr_read_b32 v87, a183
    v_cvt_pk_bf16_f32 v120, v80, v81
    v_cvt_pk_bf16_f32 v121, v82, v83
    v_cvt_pk_bf16_f32 v122, v84, v85
    v_cvt_pk_bf16_f32 v123, v86, v87
    buffer_store_dwordx4 v[120:123], v8, s[8:11], s28 offen offset:3072 sc1
    v_accvgpr_read_b32 v88, a184
    v_accvgpr_read_b32 v89, a185
    v_accvgpr_read_b32 v90, a186
    v_accvgpr_read_b32 v91, a187
    v_accvgpr_read_b32 v92, a188
    v_accvgpr_read_b32 v93, a189
    v_accvgpr_read_b32 v94, a190
    v_accvgpr_read_b32 v95, a191
    v_cvt_pk_bf16_f32 v124, v88, v89
    v_cvt_pk_bf16_f32 v125, v90, v91
    v_cvt_pk_bf16_f32 v126, v92, v93
    v_cvt_pk_bf16_f32 v127, v94, v95
    buffer_store_dwordx4 v[124:127], v8, s[8:11], s28 offen offset:3584 sc1
    s_add_u32 s28, s28, s29
    v_accvgpr_read_b32 v80, a192
    v_accvgpr_read_b32 v81, a193
    v_accvgpr_read_b32 v82, a194
    v_accvgpr_read_b32 v83, a195
    v_accvgpr_read_b32 v84, a196
    v_accvgpr_read_b32 v85, a197
    v_accvgpr_read_b32 v86, a198
    v_accvgpr_read_b32 v87, a199
    v_cvt_pk_bf16_f32 v96, v80, v81
    v_cvt_pk_bf16_f32 v97, v82, v83
    v_cvt_pk_bf16_f32 v98, v84, v85
    v_cvt_pk_bf16_f32 v99, v86, v87
    buffer_store_dwordx4 v[96:99], v8, s[8:11], s28 offen offset:0 sc1
    v_accvgpr_read_b32 v88, a200
    v_accvgpr_read_b32 v89, a201
    v_accvgpr_read_b32 v90, a202
    v_accvgpr_read_b32 v91, a203
    v_accvgpr_read_b32 v92, a204
    v_accvgpr_read_b32 v93, a205
    v_accvgpr_read_b32 v94, a206
    v_accvgpr_read_b32 v95, a207
    v_cvt_pk_bf16_f32 v100, v88, v89
    v_cvt_pk_bf16_f32 v101, v90, v91
    v_cvt_pk_bf16_f32 v102, v92, v93
    v_cvt_pk_bf16_f32 v103, v94, v95
    buffer_store_dwordx4 v[100:103], v8, s[8:11], s28 offen offset:512 sc1
    v_accvgpr_read_b32 v80, a208
    v_accvgpr_read_b32 v81, a209
    v_accvgpr_read_b32 v82, a210
    v_accvgpr_read_b32 v83, a211
    v_accvgpr_read_b32 v84, a212
    v_accvgpr_read_b32 v85, a213
    v_accvgpr_read_b32 v86, a214
    v_accvgpr_read_b32 v87, a215
    v_cvt_pk_bf16_f32 v104, v80, v81
    v_cvt_pk_bf16_f32 v105, v82, v83
    v_cvt_pk_bf16_f32 v106, v84, v85
    v_cvt_pk_bf16_f32 v107, v86, v87
    buffer_store_dwordx4 v[104:107], v8, s[8:11], s28 offen offset:1024 sc1
    v_accvgpr_read_b32 v88, a216
    v_accvgpr_read_b32 v89, a217
    v_accvgpr_read_b32 v90, a218
    v_accvgpr_read_b32 v91, a219
    v_accvgpr_read_b32 v92, a220
    v_accvgpr_read_b32 v93, a221
    v_accvgpr_read_b32 v94, a222
    v_accvgpr_read_b32 v95, a223
    v_cvt_pk_bf16_f32 v108, v88, v89
    v_cvt_pk_bf16_f32 v109, v90, v91
    v_cvt_pk_bf16_f32 v110, v92, v93
    v_cvt_pk_bf16_f32 v111, v94, v95
    buffer_store_dwordx4 v[108:111], v8, s[8:11], s28 offen offset:1536 sc1
    v_accvgpr_read_b32 v80, a224
    v_accvgpr_read_b32 v81, a225
    v_accvgpr_read_b32 v82, a226
    v_accvgpr_read_b32 v83, a227
    v_accvgpr_read_b32 v84, a228
    v_accvgpr_read_b32 v85, a229
    v_accvgpr_read_b32 v86, a230
    v_accvgpr_read_b32 v87, a231
    v_cvt_pk_bf16_f32 v112, v80, v81
    v_cvt_pk_bf16_f32 v113, v82, v83
    v_cvt_pk_bf16_f32 v114, v84, v85
    v_cvt_pk_bf16_f32 v115, v86, v87
    buffer_store_dwordx4 v[112:115], v8, s[8:11], s28 offen offset:2048 sc1
    v_accvgpr_read_b32 v88, a232
    v_accvgpr_read_b32 v89, a233
    v_accvgpr_read_b32 v90, a234
    v_accvgpr_read_b32 v91, a235
    v_accvgpr_read_b32 v92, a236
    v_accvgpr_read_b32 v93, a237
    v_accvgpr_read_b32 v94, a238
    v_accvgpr_read_b32 v95, a239
    v_cvt_pk_bf16_f32 v116, v88, v89
    v_cvt_pk_bf16_f32 v117, v90, v91
    v_cvt_pk_bf16_f32 v118, v92, v93
    v_cvt_pk_bf16_f32 v119, v94, v95
    buffer_store_dwordx4 v[116:119], v8, s[8:11], s28 offen offset:2560 sc1
    v_accvgpr_read_b32 v80, a240
    v_accvgpr_read_b32 v81, a241
    v_accvgpr_read_b32 v82, a242
    v_accvgpr_read_b32 v83, a243
    v_accvgpr_read_b32 v84, a244
    v_accvgpr_read_b32 v85, a245
    v_accvgpr_read_b32 v86, a246
    v_accvgpr_read_b32 v87, a247
    v_cvt_pk_bf16_f32 v120, v80, v81
    v_cvt_pk_bf16_f32 v121, v82, v83
    v_cvt_pk_bf16_f32 v122, v84, v85
    v_cvt_pk_bf16_f32 v123, v86, v87
    buffer_store_dwordx4 v[120:123], v8, s[8:11], s28 offen offset:3072 sc1
    v_accvgpr_read_b32 v88, a248
    v_accvgpr_read_b32 v89, a249
    v_accvgpr_read_b32 v90, a250
    v_accvgpr_read_b32 v91, a251
    v_accvgpr_read_b32 v92, a252
    v_accvgpr_read_b32 v93, a253
    v_accvgpr_read_b32 v94, a254
    v_accvgpr_read_b32 v95, a255
    v_cvt_pk_bf16_f32 v124, v88, v89
    v_cvt_pk_bf16_f32 v125, v90, v91
    v_cvt_pk_bf16_f32 v126, v92, v93
    v_cvt_pk_bf16_f32 v127, v94, v95
    buffer_store_dwordx4 v[124:127], v8, s[8:11], s28 offen offset:3584 sc1
    s_add_u32 s28, s28, s29
    s_branch G_DONE
G_EPF:
    s_lshl_b32 s29, s22, 1
    s_and_b32 s28, s17, 1
    s_add_u32 s29, s29, s28
    s_cmp_ge_u32 s29, 27
    s_cbranch_scc1 G_DONE
    s_lshl_b32 s29, s29, 12
    s_lshl_b32 s28, s21, 3
    s_lshr_b32 s30, s17, 1
    s_lshl_b32 s30, s30, 2
    s_add_u32 s28, s28, s30
    s_mul_i32 s28, s28, 110592
    s_add_u32 s28, s28, s29
    s_add_u32 s28, s28, 92274688
    v_accvgpr_read_b32 v128, a0
    v_accvgpr_read_b32 v129, a1
    v_accvgpr_read_b32 v130, a2
    v_accvgpr_read_b32 v131, a3
    v_accvgpr_read_b32 v132, a4
    v_accvgpr_read_b32 v133, a5
    v_accvgpr_read_b32 v134, a6
    v_accvgpr_read_b32 v135, a7
    v_accvgpr_read_b32 v136, a32
    v_accvgpr_read_b32 v137, a33
    v_accvgpr_read_b32 v138, a34
    v_accvgpr_read_b32 v139, a35
    v_accvgpr_read_b32 v140, a36
    v_accvgpr_read_b32 v141, a37
    v_accvgpr_read_b32 v142, a38
    v_accvgpr_read_b32 v143, a39
    v_max_f32 v128, 0, v128
    v_max_f32 v129, 0, v129
    v_max_f32 v130, 0, v130
    v_max_f32 v131, 0, v131
    v_max_f32 v132, 0, v132
    v_max_f32 v133, 0, v133
    v_max_f32 v134, 0, v134
    v_max_f32 v135, 0, v135
    v_mul_f32 v128, v128, v136
    v_mul_f32 v129, v129, v137
    v_mul_f32 v130, v130, v138
    v_mul_f32 v131, v131, v139
    v_mul_f32 v132, v132, v140
    v_mul_f32 v133, v133, v141
    v_mul_f32 v134, v134, v142
    v_mul_f32 v135, v135, v143
    v_cvt_pk_bf16_f32 v96, v128, v129
    v_cvt_pk_bf16_f32 v97, v130, v131
    v_cvt_pk_bf16_f32 v98, v132, v133
    v_cvt_pk_bf16_f32 v99, v134, v135
    buffer_store_dwordx4 v[96:99], v10, s[8:11], s28 offen offset:0 sc1
    v_accvgpr_read_b32 v144, a8
    v_accvgpr_read_b32 v145, a9
    v_accvgpr_read_b32 v146, a10
    v_accvgpr_read_b32 v147, a11
    v_accvgpr_read_b32 v148, a12
    v_accvgpr_read_b32 v149, a13
    v_accvgpr_read_b32 v150, a14
    v_accvgpr_read_b32 v151, a15
    v_accvgpr_read_b32 v152, a40
    v_accvgpr_read_b32 v153, a41
    v_accvgpr_read_b32 v154, a42
    v_accvgpr_read_b32 v155, a43
    v_accvgpr_read_b32 v156, a44
    v_accvgpr_read_b32 v157, a45
    v_accvgpr_read_b32 v158, a46
    v_accvgpr_read_b32 v159, a47
    v_max_f32 v144, 0, v144
    v_max_f32 v145, 0, v145
    v_max_f32 v146, 0, v146
    v_max_f32 v147, 0, v147
    v_max_f32 v148, 0, v148
    v_max_f32 v149, 0, v149
    v_max_f32 v150, 0, v150
    v_max_f32 v151, 0, v151
    v_mul_f32 v144, v144, v152
    v_mul_f32 v145, v145, v153
    v_mul_f32 v146, v146, v154
    v_mul_f32 v147, v147, v155
    v_mul_f32 v148, v148, v156
    v_mul_f32 v149, v149, v157
    v_mul_f32 v150, v150, v158
    v_mul_f32 v151, v151, v159
    v_cvt_pk_bf16_f32 v100, v144, v145
    v_cvt_pk_bf16_f32 v101, v146, v147
    v_cvt_pk_bf16_f32 v102, v148, v149
    v_cvt_pk_bf16_f32 v103, v150, v151
    buffer_store_dwordx4 v[100:103], v10, s[8:11], s28 offen offset:1024 sc1
    v_accvgpr_read_b32 v128, a16
    v_accvgpr_read_b32 v129, a17
    v_accvgpr_read_b32 v130, a18
    v_accvgpr_read_b32 v131, a19
    v_accvgpr_read_b32 v132, a20
    v_accvgpr_read_b32 v133, a21
    v_accvgpr_read_b32 v134, a22
    v_accvgpr_read_b32 v135, a23
    v_accvgpr_read_b32 v136, a48
    v_accvgpr_read_b32 v137, a49
    v_accvgpr_read_b32 v138, a50
    v_accvgpr_read_b32 v139, a51
    v_accvgpr_read_b32 v140, a52
    v_accvgpr_read_b32 v141, a53
    v_accvgpr_read_b32 v142, a54
    v_accvgpr_read_b32 v143, a55
    v_max_f32 v128, 0, v128
    v_max_f32 v129, 0, v129
    v_max_f32 v130, 0, v130
    v_max_f32 v131, 0, v131
    v_max_f32 v132, 0, v132
    v_max_f32 v133, 0, v133
    v_max_f32 v134, 0, v134
    v_max_f32 v135, 0, v135
    v_mul_f32 v128, v128, v136
    v_mul_f32 v129, v129, v137
    v_mul_f32 v130, v130, v138
    v_mul_f32 v131, v131, v139
    v_mul_f32 v132, v132, v140
    v_mul_f32 v133, v133, v141
    v_mul_f32 v134, v134, v142
    v_mul_f32 v135, v135, v143
    v_cvt_pk_bf16_f32 v104, v128, v129
    v_cvt_pk_bf16_f32 v105, v130, v131
    v_cvt_pk_bf16_f32 v106, v132, v133
    v_cvt_pk_bf16_f32 v107, v134, v135
    buffer_store_dwordx4 v[104:107], v10, s[8:11], s28 offen offset:2048 sc1
    v_accvgpr_read_b32 v144, a24
    v_accvgpr_read_b32 v145, a25
    v_accvgpr_read_b32 v146, a26
    v_accvgpr_read_b32 v147, a27
    v_accvgpr_read_b32 v148, a28
    v_accvgpr_read_b32 v149, a29
    v_accvgpr_read_b32 v150, a30
    v_accvgpr_read_b32 v151, a31
    v_accvgpr_read_b32 v152, a56
    v_accvgpr_read_b32 v153, a57
    v_accvgpr_read_b32 v154, a58
    v_accvgpr_read_b32 v155, a59
    v_accvgpr_read_b32 v156, a60
    v_accvgpr_read_b32 v157, a61
    v_accvgpr_read_b32 v158, a62
    v_accvgpr_read_b32 v159, a63
    v_max_f32 v144, 0, v144
    v_max_f32 v145, 0, v145
    v_max_f32 v146, 0, v146
    v_max_f32 v147, 0, v147
    v_max_f32 v148, 0, v148
    v_max_f32 v149, 0, v149
    v_max_f32 v150, 0, v150
    v_max_f32 v151, 0, v151
    v_mul_f32 v144, v144, v152
    v_mul_f32 v145, v145, v153
    v_mul_f32 v146, v146, v154
    v_mul_f32 v147, v147, v155
    v_mul_f32 v148, v148, v156
    v_mul_f32 v149, v149, v157
    v_mul_f32 v150, v150, v158
    v_mul_f32 v151, v151, v159
    v_cvt_pk_bf16_f32 v108, v144, v145
    v_cvt_pk_bf16_f32 v109, v146, v147
    v_cvt_pk_bf16_f32 v110, v148, v149
    v_cvt_pk_bf16_f32 v111, v150, v151
    buffer_store_dwordx4 v[108:111], v10, s[8:11], s28 offen offset:3072 sc1
    s_add_u32 s28, s28, 110592
    v_accvgpr_read_b32 v128, a64
    v_accvgpr_read_b32 v129, a65
    v_accvgpr_read_b32 v130, a66
    v_accvgpr_read_b32 v131, a67
    v_accvgpr_read_b32 v132, a68
    v_accvgpr_read_b32 v133, a69
    v_accvgpr_read_b32 v134, a70
    v_accvgpr_read_b32 v135, a71
    v_accvgpr_read_b32 v136, a96
    v_accvgpr_read_b32 v137, a97
    v_accvgpr_read_b32 v138, a98
    v_accvgpr_read_b32 v139, a99
    v_accvgpr_read_b32 v140, a100
    v_accvgpr_read_b32 v141, a101
    v_accvgpr_read_b32 v142, a102
    v_accvgpr_read_b32 v143, a103
    v_max_f32 v128, 0, v128
    v_max_f32 v129, 0, v129
    v_max_f32 v130, 0, v130
    v_max_f32 v131, 0, v131
    v_max_f32 v132, 0, v132
    v_max_f32 v133, 0, v133
    v_max_f32 v134, 0, v134
    v_max_f32 v135, 0, v135
    v_mul_f32 v128, v128, v136
    v_mul_f32 v129, v129, v137
    v_mul_f32 v130, v130, v138
    v_mul_f32 v131, v131, v139
    v_mul_f32 v132, v132, v140
    v_mul_f32 v133, v133, v141
    v_mul_f32 v134, v134, v142
    v_mul_f32 v135, v135, v143
    v_cvt_pk_bf16_f32 v112, v128, v129
    v_cvt_pk_bf16_f32 v113, v130, v131
    v_cvt_pk_bf16_f32 v114, v132, v133
    v_cvt_pk_bf16_f32 v115, v134, v135
    buffer_store_dwordx4 v[112:115], v10, s[8:11], s28 offen offset:0 sc1
    v_accvgpr_read_b32 v144, a72
    v_accvgpr_read_b32 v145, a73
    v_accvgpr_read_b32 v146, a74
    v_accvgpr_read_b32 v147, a75
    v_accvgpr_read_b32 v148, a76
    v_accvgpr_read_b32 v149, a77
    v_accvgpr_read_b32 v150, a78
    v_accvgpr_read_b32 v151, a79
    v_accvgpr_read_b32 v152, a104
    v_accvgpr_read_b32 v153, a105
    v_accvgpr_read_b32 v154, a106
    v_accvgpr_read_b32 v155, a107
    v_accvgpr_read_b32 v156, a108
    v_accvgpr_read_b32 v157, a109
    v_accvgpr_read_b32 v158, a110
    v_accvgpr_read_b32 v159, a111
    v_max_f32 v144, 0, v144
    v_max_f32 v145, 0, v145
    v_max_f32 v146, 0, v146
    v_max_f32 v147, 0, v147
    v_max_f32 v148, 0, v148
    v_max_f32 v149, 0, v149
    v_max_f32 v150, 0, v150
    v_max_f32 v151, 0, v151
    v_mul_f32 v144, v144, v152
    v_mul_f32 v145, v145, v153
    v_mul_f32 v146, v146, v154
    v_mul_f32 v147, v147, v155
    v_mul_f32 v148, v148, v156
    v_mul_f32 v149, v149, v157
    v_mul_f32 v150, v150, v158
    v_mul_f32 v151, v151, v159
    v_cvt_pk_bf16_f32 v116, v144, v145
    v_cvt_pk_bf16_f32 v117, v146, v147
    v_cvt_pk_bf16_f32 v118, v148, v149
    v_cvt_pk_bf16_f32 v119, v150, v151
    buffer_store_dwordx4 v[116:119], v10, s[8:11], s28 offen offset:1024 sc1
    v_accvgpr_read_b32 v128, a80
    v_accvgpr_read_b32 v129, a81
    v_accvgpr_read_b32 v130, a82
    v_accvgpr_read_b32 v131, a83
    v_accvgpr_read_b32 v132, a84
    v_accvgpr_read_b32 v133, a85
    v_accvgpr_read_b32 v134, a86
    v_accvgpr_read_b32 v135, a87
    v_accvgpr_read_b32 v136, a112
    v_accvgpr_read_b32 v137, a113
    v_accvgpr_read_b32 v138, a114
    v_accvgpr_read_b32 v139, a115
    v_accvgpr_read_b32 v140, a116
    v_accvgpr_read_b32 v141, a117
    v_accvgpr_read_b32 v142, a118
    v_accvgpr_read_b32 v143, a119
    v_max_f32 v128, 0, v128
    v_max_f32 v129, 0, v129
    v_max_f32 v130, 0, v130
    v_max_f32 v131, 0, v131
    v_max_f32 v132, 0, v132
    v_max_f32 v133, 0, v133
    v_max_f32 v134, 0, v134
    v_max_f32 v135, 0, v135
    v_mul_f32 v128, v128, v136
    v_mul_f32 v129, v129, v137
    v_mul_f32 v130, v130, v138
    v_mul_f32 v131, v131, v139
    v_mul_f32 v132, v132, v140
    v_mul_f32 v133, v133, v141
    v_mul_f32 v134, v134, v142
    v_mul_f32 v135, v135, v143
    v_cvt_pk_bf16_f32 v120, v128, v129
    v_cvt_pk_bf16_f32 v121, v130, v131
    v_cvt_pk_bf16_f32 v122, v132, v133
    v_cvt_pk_bf16_f32 v123, v134, v135
    buffer_store_dwordx4 v[120:123], v10, s[8:11], s28 offen offset:2048 sc1
    v_accvgpr_read_b32 v144, a88
    v_accvgpr_read_b32 v145, a89
    v_accvgpr_read_b32 v146, a90
    v_accvgpr_read_b32 v147, a91
    v_accvgpr_read_b32 v148, a92
    v_accvgpr_read_b32 v149, a93
    v_accvgpr_read_b32 v150, a94
    v_accvgpr_read_b32 v151, a95
    v_accvgpr_read_b32 v152, a120
    v_accvgpr_read_b32 v153, a121
    v_accvgpr_read_b32 v154, a122
    v_accvgpr_read_b32 v155, a123
    v_accvgpr_read_b32 v156, a124
    v_accvgpr_read_b32 v157, a125
    v_accvgpr_read_b32 v158, a126
    v_accvgpr_read_b32 v159, a127
    v_max_f32 v144, 0, v144
    v_max_f32 v145, 0, v145
    v_max_f32 v146, 0, v146
    v_max_f32 v147, 0, v147
    v_max_f32 v148, 0, v148
    v_max_f32 v149, 0, v149
    v_max_f32 v150, 0, v150
    v_max_f32 v151, 0, v151
    v_mul_f32 v144, v144, v152
    v_mul_f32 v145, v145, v153
    v_mul_f32 v146, v146, v154
    v_mul_f32 v147, v147, v155
    v_mul_f32 v148, v148, v156
    v_mul_f32 v149, v149, v157
    v_mul_f32 v150, v150, v158
    v_mul_f32 v151, v151, v159
    v_cvt_pk_bf16_f32 v124, v144, v145
    v_cvt_pk_bf16_f32 v125, v146, v147
    v_cvt_pk_bf16_f32 v126, v148, v149
    v_cvt_pk_bf16_f32 v127, v150, v151
    buffer_store_dwordx4 v[124:127], v10, s[8:11], s28 offen offset:3072 sc1
    s_add_u32 s28, s28, 110592
    v_accvgpr_read_b32 v128, a128
    v_accvgpr_read_b32 v129, a129
    v_accvgpr_read_b32 v130, a130
    v_accvgpr_read_b32 v131, a131
    v_accvgpr_read_b32 v132, a132
    v_accvgpr_read_b32 v133, a133
    v_accvgpr_read_b32 v134, a134
    v_accvgpr_read_b32 v135, a135
    v_accvgpr_read_b32 v136, a160
    v_accvgpr_read_b32 v137, a161
    v_accvgpr_read_b32 v138, a162
    v_accvgpr_read_b32 v139, a163
    v_accvgpr_read_b32 v140, a164
    v_accvgpr_read_b32 v141, a165
    v_accvgpr_read_b32 v142, a166
    v_accvgpr_read_b32 v143, a167
    v_max_f32 v128, 0, v128
    v_max_f32 v129, 0, v129
    v_max_f32 v130, 0, v130
    v_max_f32 v131, 0, v131
    v_max_f32 v132, 0, v132
    v_max_f32 v133, 0, v133
    v_max_f32 v134, 0, v134
    v_max_f32 v135, 0, v135
    v_mul_f32 v128, v128, v136
    v_mul_f32 v129, v129, v137
    v_mul_f32 v130, v130, v138
    v_mul_f32 v131, v131, v139
    v_mul_f32 v132, v132, v140
    v_mul_f32 v133, v133, v141
    v_mul_f32 v134, v134, v142
    v_mul_f32 v135, v135, v143
    v_cvt_pk_bf16_f32 v96, v128, v129
    v_cvt_pk_bf16_f32 v97, v130, v131
    v_cvt_pk_bf16_f32 v98, v132, v133
    v_cvt_pk_bf16_f32 v99, v134, v135
    buffer_store_dwordx4 v[96:99], v10, s[8:11], s28 offen offset:0 sc1
    v_accvgpr_read_b32 v144, a136
    v_accvgpr_read_b32 v145, a137
    v_accvgpr_read_b32 v146, a138
    v_accvgpr_read_b32 v147, a139
    v_accvgpr_read_b32 v148, a140
    v_accvgpr_read_b32 v149, a141
    v_accvgpr_read_b32 v150, a142
    v_accvgpr_read_b32 v151, a143
    v_accvgpr_read_b32 v152, a168
    v_accvgpr_read_b32 v153, a169
    v_accvgpr_read_b32 v154, a170
    v_accvgpr_read_b32 v155, a171
    v_accvgpr_read_b32 v156, a172
    v_accvgpr_read_b32 v157, a173
    v_accvgpr_read_b32 v158, a174
    v_accvgpr_read_b32 v159, a175
    v_max_f32 v144, 0, v144
    v_max_f32 v145, 0, v145
    v_max_f32 v146, 0, v146
    v_max_f32 v147, 0, v147
    v_max_f32 v148, 0, v148
    v_max_f32 v149, 0, v149
    v_max_f32 v150, 0, v150
    v_max_f32 v151, 0, v151
    v_mul_f32 v144, v144, v152
    v_mul_f32 v145, v145, v153
    v_mul_f32 v146, v146, v154
    v_mul_f32 v147, v147, v155
    v_mul_f32 v148, v148, v156
    v_mul_f32 v149, v149, v157
    v_mul_f32 v150, v150, v158
    v_mul_f32 v151, v151, v159
    v_cvt_pk_bf16_f32 v100, v144, v145
    v_cvt_pk_bf16_f32 v101, v146, v147
    v_cvt_pk_bf16_f32 v102, v148, v149
    v_cvt_pk_bf16_f32 v103, v150, v151
    buffer_store_dwordx4 v[100:103], v10, s[8:11], s28 offen offset:1024 sc1
    v_accvgpr_read_b32 v128, a144
    v_accvgpr_read_b32 v129, a145
    v_accvgpr_read_b32 v130, a146
    v_accvgpr_read_b32 v131, a147
    v_accvgpr_read_b32 v132, a148
    v_accvgpr_read_b32 v133, a149
    v_accvgpr_read_b32 v134, a150
    v_accvgpr_read_b32 v135, a151
    v_accvgpr_read_b32 v136, a176
    v_accvgpr_read_b32 v137, a177
    v_accvgpr_read_b32 v138, a178
    v_accvgpr_read_b32 v139, a179
    v_accvgpr_read_b32 v140, a180
    v_accvgpr_read_b32 v141, a181
    v_accvgpr_read_b32 v142, a182
    v_accvgpr_read_b32 v143, a183
    v_max_f32 v128, 0, v128
    v_max_f32 v129, 0, v129
    v_max_f32 v130, 0, v130
    v_max_f32 v131, 0, v131
    v_max_f32 v132, 0, v132
    v_max_f32 v133, 0, v133
    v_max_f32 v134, 0, v134
    v_max_f32 v135, 0, v135
    v_mul_f32 v128, v128, v136
    v_mul_f32 v129, v129, v137
    v_mul_f32 v130, v130, v138
    v_mul_f32 v131, v131, v139
    v_mul_f32 v132, v132, v140
    v_mul_f32 v133, v133, v141
    v_mul_f32 v134, v134, v142
    v_mul_f32 v135, v135, v143
    v_cvt_pk_bf16_f32 v104, v128, v129
    v_cvt_pk_bf16_f32 v105, v130, v131
    v_cvt_pk_bf16_f32 v106, v132, v133
    v_cvt_pk_bf16_f32 v107, v134, v135
    buffer_store_dwordx4 v[104:107], v10, s[8:11], s28 offen offset:2048 sc1
    v_accvgpr_read_b32 v144, a152
    v_accvgpr_read_b32 v145, a153
    v_accvgpr_read_b32 v146, a154
    v_accvgpr_read_b32 v147, a155
    v_accvgpr_read_b32 v148, a156
    v_accvgpr_read_b32 v149, a157
    v_accvgpr_read_b32 v150, a158
    v_accvgpr_read_b32 v151, a159
    v_accvgpr_read_b32 v152, a184
    v_accvgpr_read_b32 v153, a185
    v_accvgpr_read_b32 v154, a186
    v_accvgpr_read_b32 v155, a187
    v_accvgpr_read_b32 v156, a188
    v_accvgpr_read_b32 v157, a189
    v_accvgpr_read_b32 v158, a190
    v_accvgpr_read_b32 v159, a191
    v_max_f32 v144, 0, v144
    v_max_f32 v145, 0, v145
    v_max_f32 v146, 0, v146
    v_max_f32 v147, 0, v147
    v_max_f32 v148, 0, v148
    v_max_f32 v149, 0, v149
    v_max_f32 v150, 0, v150
    v_max_f32 v151, 0, v151
    v_mul_f32 v144, v144, v152
    v_mul_f32 v145, v145, v153
    v_mul_f32 v146, v146, v154
    v_mul_f32 v147, v147, v155
    v_mul_f32 v148, v148, v156
    v_mul_f32 v149, v149, v157
    v_mul_f32 v150, v150, v158
    v_mul_f32 v151, v151, v159
    v_cvt_pk_bf16_f32 v108, v144, v145
    v_cvt_pk_bf16_f32 v109, v146, v147
    v_cvt_pk_bf16_f32 v110, v148, v149
    v_cvt_pk_bf16_f32 v111, v150, v151
    buffer_store_dwordx4 v[108:111], v10, s[8:11], s28 offen offset:3072 sc1
    s_add_u32 s28, s28, 110592
    v_accvgpr_read_b32 v128, a192
    v_accvgpr_read_b32 v129, a193
    v_accvgpr_read_b32 v130, a194
    v_accvgpr_read_b32 v131, a195
    v_accvgpr_read_b32 v132, a196
    v_accvgpr_read_b32 v133, a197
    v_accvgpr_read_b32 v134, a198
    v_accvgpr_read_b32 v135, a199
    v_accvgpr_read_b32 v136, a224
    v_accvgpr_read_b32 v137, a225
    v_accvgpr_read_b32 v138, a226
    v_accvgpr_read_b32 v139, a227
    v_accvgpr_read_b32 v140, a228
    v_accvgpr_read_b32 v141, a229
    v_accvgpr_read_b32 v142, a230
    v_accvgpr_read_b32 v143, a231
    v_max_f32 v128, 0, v128
    v_max_f32 v129, 0, v129
    v_max_f32 v130, 0, v130
    v_max_f32 v131, 0, v131
    v_max_f32 v132, 0, v132
    v_max_f32 v133, 0, v133
    v_max_f32 v134, 0, v134
    v_max_f32 v135, 0, v135
    v_mul_f32 v128, v128, v136
    v_mul_f32 v129, v129, v137
    v_mul_f32 v130, v130, v138
    v_mul_f32 v131, v131, v139
    v_mul_f32 v132, v132, v140
    v_mul_f32 v133, v133, v141
    v_mul_f32 v134, v134, v142
    v_mul_f32 v135, v135, v143
    v_cvt_pk_bf16_f32 v112, v128, v129
    v_cvt_pk_bf16_f32 v113, v130, v131
    v_cvt_pk_bf16_f32 v114, v132, v133
    v_cvt_pk_bf16_f32 v115, v134, v135
    buffer_store_dwordx4 v[112:115], v10, s[8:11], s28 offen offset:0 sc1
    v_accvgpr_read_b32 v144, a200
    v_accvgpr_read_b32 v145, a201
    v_accvgpr_read_b32 v146, a202
    v_accvgpr_read_b32 v147, a203
    v_accvgpr_read_b32 v148, a204
    v_accvgpr_read_b32 v149, a205
    v_accvgpr_read_b32 v150, a206
    v_accvgpr_read_b32 v151, a207
    v_accvgpr_read_b32 v152, a232
    v_accvgpr_read_b32 v153, a233
    v_accvgpr_read_b32 v154, a234
    v_accvgpr_read_b32 v155, a235
    v_accvgpr_read_b32 v156, a236
    v_accvgpr_read_b32 v157, a237
    v_accvgpr_read_b32 v158, a238
    v_accvgpr_read_b32 v159, a239
    v_max_f32 v144, 0, v144
    v_max_f32 v145, 0, v145
    v_max_f32 v146, 0, v146
    v_max_f32 v147, 0, v147
    v_max_f32 v148, 0, v148
    v_max_f32 v149, 0, v149
    v_max_f32 v150, 0, v150
    v_max_f32 v151, 0, v151
    v_mul_f32 v144, v144, v152
    v_mul_f32 v145, v145, v153
    v_mul_f32 v146, v146, v154
    v_mul_f32 v147, v147, v155
    v_mul_f32 v148, v148, v156
    v_mul_f32 v149, v149, v157
    v_mul_f32 v150, v150, v158
    v_mul_f32 v151, v151, v159
    v_cvt_pk_bf16_f32 v116, v144, v145
    v_cvt_pk_bf16_f32 v117, v146, v147
    v_cvt_pk_bf16_f32 v118, v148, v149
    v_cvt_pk_bf16_f32 v119, v150, v151
    buffer_store_dwordx4 v[116:119], v10, s[8:11], s28 offen offset:1024 sc1
    v_accvgpr_read_b32 v128, a208
    v_accvgpr_read_b32 v129, a209
    v_accvgpr_read_b32 v130, a210
    v_accvgpr_read_b32 v131, a211
    v_accvgpr_read_b32 v132, a212
    v_accvgpr_read_b32 v133, a213
    v_accvgpr_read_b32 v134, a214
    v_accvgpr_read_b32 v135, a215
    v_accvgpr_read_b32 v136, a240
    v_accvgpr_read_b32 v137, a241
    v_accvgpr_read_b32 v138, a242
    v_accvgpr_read_b32 v139, a243
    v_accvgpr_read_b32 v140, a244
    v_accvgpr_read_b32 v141, a245
    v_accvgpr_read_b32 v142, a246
    v_accvgpr_read_b32 v143, a247
    v_max_f32 v128, 0, v128
    v_max_f32 v129, 0, v129
    v_max_f32 v130, 0, v130
    v_max_f32 v131, 0, v131
    v_max_f32 v132, 0, v132
    v_max_f32 v133, 0, v133
    v_max_f32 v134, 0, v134
    v_max_f32 v135, 0, v135
    v_mul_f32 v128, v128, v136
    v_mul_f32 v129, v129, v137
    v_mul_f32 v130, v130, v138
    v_mul_f32 v131, v131, v139
    v_mul_f32 v132, v132, v140
    v_mul_f32 v133, v133, v141
    v_mul_f32 v134, v134, v142
    v_mul_f32 v135, v135, v143
    v_cvt_pk_bf16_f32 v120, v128, v129
    v_cvt_pk_bf16_f32 v121, v130, v131
    v_cvt_pk_bf16_f32 v122, v132, v133
    v_cvt_pk_bf16_f32 v123, v134, v135
    buffer_store_dwordx4 v[120:123], v10, s[8:11], s28 offen offset:2048 sc1
    v_accvgpr_read_b32 v144, a216
    v_accvgpr_read_b32 v145, a217
    v_accvgpr_read_b32 v146, a218
    v_accvgpr_read_b32 v147, a219
    v_accvgpr_read_b32 v148, a220
    v_accvgpr_read_b32 v149, a221
    v_accvgpr_read_b32 v150, a222
    v_accvgpr_read_b32 v151, a223
    v_accvgpr_read_b32 v152, a248
    v_accvgpr_read_b32 v153, a249
    v_accvgpr_read_b32 v154, a250
    v_accvgpr_read_b32 v155, a251
    v_accvgpr_read_b32 v156, a252
    v_accvgpr_read_b32 v157, a253
    v_accvgpr_read_b32 v158, a254
    v_accvgpr_read_b32 v159, a255
    v_max_f32 v144, 0, v144
    v_max_f32 v145, 0, v145
    v_max_f32 v146, 0, v146
    v_max_f32 v147, 0, v147
    v_max_f32 v148, 0, v148
    v_max_f32 v149, 0, v149
    v_max_f32 v150, 0, v150
    v_max_f32 v151, 0, v151
    v_mul_f32 v144, v144, v152
    v_mul_f32 v145, v145, v153
    v_mul_f32 v146, v146, v154
    v_mul_f32 v147, v147, v155
    v_mul_f32 v148, v148, v156
    v_mul_f32 v149, v149, v157
    v_mul_f32 v150, v150, v158
    v_mul_f32 v151, v151, v159
    v_cvt_pk_bf16_f32 v124, v144, v145
    v_cvt_pk_bf16_f32 v125, v146, v147
    v_cvt_pk_bf16_f32 v126, v148, v149
    v_cvt_pk_bf16_f32 v127, v150, v151
    buffer_store_dwordx4 v[124:127], v10, s[8:11], s28 offen offset:3072 sc1
    s_add_u32 s28, s28, 110592
G_DONE:
    s_cmp_ge_u32 s20, 2
    s_cbranch_scc1 K_AE
    s_waitcnt vmcnt(0)
    s_barrier
    s_cmp_eq_u32 s17, 0
    s_cbranch_scc0 K_AD
    v_mov_b32 v14, 0
    v_mov_b32 v15, 1
    s_mov_b64 exec, 1
    buffer_atomic_add v15, v14, s[4:7], s16 offen sc0
    s_waitcnt vmcnt(0)
    v_add_u32 v15, 1, v15
    s_nop 0
    v_readfirstlane_b32 s29, v15
    s_nop 0
    s_cmp_eq_u32 s29, 32
    s_cbranch_scc0 K_AD_N
    buffer_store_dword v15, v14, s[4:7], s16 offen offset:128 sc1
K_AD_N:
    s_mov_b64 exec, -1
K_AD:
    s_branch K_AF
K_AE:
    s_mov_b32 s28, 176
    s_cmp_eq_u32 s17, 0
    s_cbranch_scc0 K_WY_OK
    v_mov_b32 v14, 0
K_WY:
    buffer_load_dword v15, v14, s[4:7], s28 offen sc1
    s_add_u32 s3, s3, 1
    s_cmp_gt_u32 s3, 2000000
    s_cbranch_scc1 K_END
    s_waitcnt vmcnt(0)
    v_readfirstlane_b32 s29, v15
    s_nop 0
    s_cmp_ge_u32 s29, 1
    s_cbranch_scc1 K_WY_OK
    s_sleep 2
    s_branch K_WY
K_WY_OK:
    s_barrier
    s_waitcnt vmcnt(0)
    s_barrier
    s_cmp_eq_u32 s17, 0
    s_cbranch_scc0 K_AF
    v_mov_b32 v14, 0
    v_mov_b32 v15, 1
    s_mov_b64 exec, 1
    buffer_atomic_add v15, v14, s[8:11], s16 offen sc0
    s_waitcnt vmcnt(0)
    v_add_u32 v15, 1, v15
    s_nop 0
    v_readfirstlane_b32 s29, v15
    s_nop 0
    s_cmp_eq_u32 s29, 30
    s_cbranch_scc0 K_AF_N
    buffer_store_dword v15, v14, s[8:11], s16 offen offset:128 sc1
K_AF_N:
    s_mov_b64 exec, -1
K_AF:
    s_add_u32 s79, s79, 1
    s_branch K_NEXT
K_PH2:
    s_mov_b32 s71, 0
    v_mov_b32 v14, 0
K_WT:
    global_load_dwordx2 v[16:17], v14, s[4:5] offset:144 sc1
    s_mov_b32 s22, 32
    s_mov_b32 s23, 32
    s_waitcnt vmcnt(0)
    v_and_b32 v16, v16, v17
    s_nop 0
    v_readfirstlane_b32 s24, v16
    s_nop 0
    s_cmp_eq_u32 s24, 33
    s_cbranch_scc1 K_WG
    s_cmp_eq_u32 s70, 0
    s_cbranch_scc0 K_R3
    s_mov_b32 s70, 1
    s_mov_b32 s28, 8
    s_cmp_eq_u32 s17, 0
    s_cbranch_scc0 K_R3
    v_mov_b32 v14, 0
    v_mov_b32 v15, 1
    s_mov_b64 exec, 1
    buffer_atomic_add v15, v14, s[4:7], s28 offen
    s_mov_b64 exec, -1
K_R3:
    global_load_dwordx4 v[16:19], v14, s[4:5] sc1
    s_add_u32 s3, s3, 1
    s_cmp_gt_u32 s3, 2000000
    s_cbranch_scc1 K_END
    s_waitcnt vmcnt(0)
    v_readfirstlane_b32 s22, v18
    s_sleep 32
    s_cmp_lt_u32 s22, 256
    s_cbranch_scc1 K_WT
    global_load_dwordx4 v[16:19], v14, s[4:5] sc1
    s_waitcnt vmcnt(0)
    v_readfirstlane_b32 s22, v16
    v_readfirstlane_b32 s23, v17
    s_min_u32 s22, s22, 32
    s_min_u32 s23, s23, 32
    s_add_u32 s24, s22, s23
    s_cmp_eq_u32 s24, 64
    s_cbranch_scc1 K_WG
    s_barrier
    v_mov_b32 v14, 0
    v_mov_b32 v15, 1
    v_mov_b32 v13, 163832
    s_cmp_eq_u32 s17, 0
    s_cbranch_scc0 K_T3
    s_mov_b64 exec, 1
    global_atomic_add v12, v14, v15, s[4:5] offset:44 sc0
    s_waitcnt vmcnt(0)
    ds_write_b32 v13, v12
    s_waitcnt lgkmcnt(0)
    s_mov_b64 exec, -1
K_T3:
    s_barrier
    ds_read_b32 v12, v13
    s_waitcnt lgkmcnt(0)
    v_readfirstlane_b32 s24, v12
    s_nop 0
    s_add_u32 s18, s24, s22
    s_mov_b32 s19, 0
    s_cmp_lt_u32 s18, 32
    s_cbranch_scc1 K_TEAM
    s_sub_u32 s18, s18, 32
    s_add_u32 s18, s18, s23
    s_mov_b32 s19, 1
    s_cmp_lt_u32 s18, 32
    s_cbranch_scc1 K_TEAM
K_WG:
    s_mov_b32 s28, 176
    v_mov_b32 v14, 0
K_WZ:
    buffer_load_dword v15, v14, s[4:7], s28 offen sc1
    s_add_u32 s3, s3, 1
    s_cmp_gt_u32 s3, 2000000
    s_cbranch_scc1 K_END
    s_waitcnt vmcnt(0)
    v_readfirstlane_b32 s29, v15
    s_nop 0
    s_cmp_ge_u32 s29, 1
    s_cbranch_scc1 K_WZ_OK
    s_sleep 8
    s_branch K_WZ
K_WZ_OK:
    s_mov_b32 s77, 0
K_SEAT:
    s_lshl_b32 s28, s69, 7
    s_add_u32 s28, s28, 1077248
    s_barrier
    v_mov_b32 v14, s28
    v_mov_b32 v15, 1
    v_mov_b32 v13, 163832
    s_cmp_eq_u32 s17, 0
    s_cbranch_scc0 K_T4
    s_mov_b64 exec, 1
    global_atomic_add v12, v14, v15, s[8:9] offset:0 sc0
    s_waitcnt vmcnt(0)
    ds_write_b32 v13, v12
    s_waitcnt lgkmcnt(0)
    s_mov_b64 exec, -1
K_T4:
    s_barrier
    ds_read_b32 v12, v13
    s_waitcnt lgkmcnt(0)
    v_readfirstlane_b32 s18, v12
    s_nop 0
    s_cmp_lt_u32 s18, 32
    s_cbranch_scc1 K_SAT
    s_cmp_eq_u32 s68, 1
    s_mov_b32 s68, 0
    s_cbranch_scc1 K_NEXT
    s_add_u32 s77, s77, 1
    s_cmp_ge_u32 s77, 6
    s_cbranch_scc1 K_END
    s_add_u32 s69, s69, 1
    s_cmp_eq_u32 s69, 6
    s_cselect_b32 s69, 0, s69
    s_branch K_SEAT
K_SAT:
    s_cmp_lt_u32 s69, 4
    s_cbranch_scc0 K_SA2
    s_cmp_lt_u32 s18, 20
    s_cbranch_scc1 K_OUT
    s_mul_i32 s19, s69, 12
    s_add_u32 s18, s18, s19
K_SA1:
    s_sub_u32 s18, s18, 20
    s_cmp_lt_u32 s18, 20
    s_cbranch_scc1 K_OUT
    s_branch K_SA1
K_SA2:
    s_cmp_ge_u32 s18, 16
    s_cbranch_scc1 K_END
    v_and_b32 v20, 63, v0
    v_lshlrev_b32 v2, 4, v20
    v_lshrrev_b32 v21, 4, v20
    v_and_b32 v22, 15, v20
    v_lshrrev_b32 v24, 1, v21
    v_and_b32 v25, 1, v21
    v_bfe_u32 v26, v20, 3, 1
    s_mul_i32 s28, s17, 4608
    v_lshrrev_b32 v28, 2, v22
    v_xor_b32 v28, v28, v21
    v_lshlrev_b32 v28, 3, v28
    v_lshl_add_u32 v28, v22, 5, v28
    v_add_u32 v3, s28, v28
    v_lshlrev_b32 v28, 2, v21
    v_add_u32 v28, v28, v26
    v_lshlrev_b32 v28, 5, v28
    v_bfe_u32 v30, v20, 2, 1
    v_mul_u32_u24 v29, 576, v30
    v_add_u32 v28, v28, v29
    v_and_b32 v29, 1, v20
    v_xor_b32 v29, v29, v21
    v_lshl_add_u32 v28, v29, 3, v28
    v_add_u32 v4, s28, v28
    v_xor_b32 v18, 16, v4
    v_lshrrev_b32 v28, 2, v22
    v_lshlrev_b32 v28, 3, v28
    v_and_b32 v29, 3, v22
    v_add_u32 v28, v28, v29
    v_lshl_add_u32 v29, v25, 5, v28
    v_lshlrev_b32 v29, 4, v29
    v_lshl_add_u32 v5, v24, 10, v29
    v_lshlrev_b32 v29, 3, v21
    v_sub_u32 v6, v28, v29
    v_mov_b32 v7, 0xf149f2ca
    v_mov_b32 v8, 0x3f803f80
    v_mov_b32 v9, 0x3f803f80
    v_mov_b32 v10, 0x3f803f80
    v_mov_b32 v11, 0x3f803f80
    v_mov_b32 v12, 0x3f003f00
    v_mov_b32 v13, 0x3f003f00
    s_mov_b32 s38, 0x3e0293ee
    v_cmp_le_i32 s[40:41], -4, v6
    v_cmp_le_i32 s[42:43], -3, v6
    v_cmp_le_i32 s[44:45], -2, v6
    v_cmp_le_i32 s[46:47], -1, v6
    v_cmp_le_i32 s[48:49], 0, v6
    v_cmp_le_i32 s[50:51], 1, v6
    v_cmp_le_i32 s[52:53], 2, v6
    v_cmp_le_i32 s[54:55], 3, v6
    v_cmp_le_i32 s[56:57], 4, v6
    v_cmp_le_i32 s[58:59], 5, v6
    v_cmp_le_i32 s[60:61], 6, v6
    v_cmp_le_i32 s[62:63], 7, v6
K_AN:
    s_barrier
    v_mov_b32 v16, 1063424
    v_mov_b32 v17, 1
    v_mov_b32 v15, 163832
    s_cmp_eq_u32 s17, 0
    s_cbranch_scc0 K_T5
    s_mov_b64 exec, 1
    global_atomic_add v14, v16, v17, s[8:9] offset:0 sc0
    s_waitcnt vmcnt(0)
    ds_write_b32 v15, v14
    s_waitcnt lgkmcnt(0)
    s_mov_b64 exec, -1
K_T5:
    s_barrier
    ds_read_b32 v14, v15
    s_waitcnt lgkmcnt(0)
    v_readfirstlane_b32 s18, v14
    s_nop 0
    s_cmp_ge_u32 s18, 512
    s_cbranch_scc1 K_END
    s_lshl_b32 s20, s18, 2
    s_add_u32 s20, s20, s17
    s_lshr_b32 s28, s18, 6
    s_lshl_b32 s28, s28, 2
    s_add_u32 s28, s28, 208
    s_cmp_eq_u32 s17, 0
    s_cbranch_scc0 K_WK_OK
    v_mov_b32 v14, 0
K_WK:
    buffer_load_dword v15, v14, s[4:7], s28 offen sc1
    s_add_u32 s3, s3, 1
    s_cmp_gt_u32 s3, 2000000
    s_cbranch_scc1 K_END
    s_waitcnt vmcnt(0)
    v_readfirstlane_b32 s29, v15
    s_nop 0
    s_cmp_ge_u32 s29, 1
    s_cbranch_scc1 K_WK_OK
    s_sleep 16
    s_branch K_WK
K_WK_OK:
    s_barrier
    s_lshr_b32 s28, s18, 6
    s_lshl_b32 s28, s28, 8
    s_add_u32 s28, s28, 1056896
    s_cmp_eq_u32 s17, 0
    s_cbranch_scc0 K_WA_OK
    v_mov_b32 v14, 0
K_WA:
    buffer_load_dword v15, v14, s[8:11], s28 offen sc1
    s_add_u32 s3, s3, 1
    s_cmp_gt_u32 s3, 2000000
    s_cbranch_scc1 K_END
    s_waitcnt vmcnt(0)
    v_readfirstlane_b32 s29, v15
    s_nop 0
    s_cmp_ge_u32 s29, 1
    s_cbranch_scc1 K_WA_OK
    s_sleep 16
    s_branch K_WA
K_WA_OK:
    s_barrier
    s_lshl_b32 s21, s20, 13
    s_add_u32 s22, s21, 4194304
    s_add_u32 s23, s22, 4096
    s_add_u32 s21, s21, 100663296
    s_add_u32 s24, s21, 4096
    s_lshl_b32 s25, s20, 14
    s_add_u32 s25, s25, 33554432
    buffer_load_dwordx4 v[32:35], v2, s[8:11], s21 offen offset:0 sc1
    buffer_load_dwordx4 v[36:39], v2, s[8:11], s21 offen offset:1024 sc1
    buffer_load_dwordx4 v[40:43], v2, s[8:11], s21 offen offset:2048 sc1
    buffer_load_dwordx4 v[44:47], v2, s[8:11], s21 offen offset:3072 sc1
    buffer_load_dwordx4 v[48:51], v2, s[8:11], s24 offen offset:0 sc1
    buffer_load_dwordx4 v[52:55], v2, s[8:11], s24 offen offset:1024 sc1
    buffer_load_dwordx4 v[56:59], v2, s[8:11], s24 offen offset:2048 sc1
    buffer_load_dwordx4 v[60:63], v2, s[8:11], s24 offen offset:3072 sc1
    buffer_load_dwordx4 v[64:67], v2, s[8:11], s25 offen offset:0 sc1
    buffer_load_dwordx4 v[68:71], v2, s[8:11], s25 offen offset:1024 sc1
    buffer_load_dwordx4 v[72:75], v2, s[8:11], s25 offen offset:2048 sc1
    buffer_load_dwordx4 v[76:79], v2, s[8:11], s25 offen offset:3072 sc1
    s_add_u32 s25, s25, 4096
    buffer_load_dwordx4 v[80:83], v2, s[8:11], s25 offen offset:0 sc1
    buffer_load_dwordx4 v[84:87], v2, s[8:11], s25 offen offset:1024 sc1
    buffer_load_dwordx4 v[88:91], v2, s[8:11], s25 offen offset:2048 sc1
    buffer_load_dwordx4 v[92:95], v2, s[8:11], s25 offen offset:3072 sc1
    s_add_u32 s25, s25, 4096
    buffer_load_dwordx4 v[96:99], v2, s[8:11], s25 offen offset:0 sc1
    buffer_load_dwordx4 v[100:103], v2, s[8:11], s25 offen offset:1024 sc1
    buffer_load_dwordx4 v[104:107], v2, s[8:11], s25 offen offset:2048 sc1
    buffer_load_dwordx4 v[108:111], v2, s[8:11], s25 offen offset:3072 sc1
    s_add_u32 s25, s25, 4096
    buffer_load_dwordx4 v[112:115], v2, s[8:11], s25 offen offset:0 sc1
    buffer_load_dwordx4 v[116:119], v2, s[8:11], s25 offen offset:1024 sc1
    buffer_load_dwordx4 v[120:123], v2, s[8:11], s25 offen offset:2048 sc1
    buffer_load_dwordx4 v[124:127], v2, s[8:11], s25 offen offset:3072 sc1
    s_lshl_b32 s26, s20, 13
    s_add_u32 s26, s26, 117440512
    s_add_u32 s27, s26, 4096
    s_waitcnt vmcnt(15)
    v_mfma_f32_16x16x32_bf16 v[176:179], v[64:67], v[32:35], 0
    s_waitcnt vmcnt(11)
    v_mfma_f32_16x16x32_bf16 v[180:183], v[80:83], v[32:35], 0
    v_mfma_f32_16x16x32_bf16 v[188:191], v[64:67], v[48:51], 0
    v_mfma_f32_16x16x32_bf16 v[192:195], v[80:83], v[48:51], 0
    v_mfma_f32_16x16x32_bf16 v[176:179], v[68:71], v[36:39], v[176:179]
    s_waitcnt vmcnt(10)
    v_mfma_f32_16x16x32_bf16 v[180:183], v[84:87], v[36:39], v[180:183]
    v_mfma_f32_16x16x32_bf16 v[188:191], v[68:71], v[52:55], v[188:191]
    v_mfma_f32_16x16x32_bf16 v[192:195], v[84:87], v[52:55], v[192:195]
    v_mfma_f32_16x16x32_bf16 v[176:179], v[72:75], v[40:43], v[176:179]
    s_waitcnt vmcnt(9)
    v_mfma_f32_16x16x32_bf16 v[180:183], v[88:91], v[40:43], v[180:183]
    v_mfma_f32_16x16x32_bf16 v[188:191], v[72:75], v[56:59], v[188:191]
    v_mfma_f32_16x16x32_bf16 v[192:195], v[88:91], v[56:59], v[192:195]
    v_mfma_f32_16x16x32_bf16 v[176:179], v[76:79], v[44:47], v[176:179]
    s_waitcnt vmcnt(8)
    v_mfma_f32_16x16x32_bf16 v[180:183], v[92:95], v[44:47], v[180:183]
    v_mfma_f32_16x16x32_bf16 v[188:191], v[76:79], v[60:63], v[188:191]
    v_mfma_f32_16x16x32_bf16 v[192:195], v[92:95], v[60:63], v[192:195]
    s_and_b32 s28, s20, 31
    s_lshl_b32 s28, s28, 8
    s_add_u32 s28, s28, 1048576
    s_lshr_b32 s30, s20, 5
    s_add_u32 s30, s30, 2
    v_mov_b32 v14, 0
K_WM:
    buffer_load_dwordx2 v[16:17], v14, s[8:11], s28 offen sc1
    buffer_load_dword v15, v14, s[8:11], s28 offen offset:128 sc1
    s_add_u32 s3, s3, 1
    s_cmp_gt_u32 s3, 2000000
    s_cbranch_scc1 K_END
    s_waitcnt vmcnt(0)
    v_and_b32 v15, v15, v17
    v_max_u32 v15, v15, v16
    s_nop 0
    v_readfirstlane_b32 s29, v15
    s_nop 0
    s_cmp_ge_u32 s29, s30
    s_cbranch_scc1 K_WM_OK
    s_add_u32 s29, s29, 3
    s_cmp_ge_u32 s29, s30
    s_cbranch_scc1 K_WM_S
    s_sleep 48
K_WM_S:
    s_sleep 4
    s_branch K_WM
K_WM_OK:
    buffer_load_dwordx4 v[128:131], v2, s[8:11], s22 offen offset:0 sc1
    buffer_load_dwordx4 v[132:135], v2, s[8:11], s22 offen offset:2048 sc1
    buffer_load_dwordx4 v[136:139], v2, s[8:11], s23 offen offset:0 sc1
    buffer_load_dwordx4 v[140:143], v2, s[8:11], s23 offen offset:2048 sc1
    buffer_load_dwordx4 v[144:147], v2, s[8:11], s22 offen offset:1024 sc1
    buffer_load_dwordx4 v[148:151], v2, s[8:11], s22 offen offset:3072 sc1
    buffer_load_dwordx4 v[152:155], v2, s[8:11], s23 offen offset:1024 sc1
    buffer_load_dwordx4 v[156:159], v2, s[8:11], s23 offen offset:3072 sc1
    s_waitcnt vmcnt(7)
    ds_write_b64 v3, v[128:129] offset:0
    ds_write_b64 v3, v[130:131] offset:576
    s_waitcnt vmcnt(6)
    ds_write_b64 v3, v[132:133] offset:1152
    ds_write_b64 v3, v[134:135] offset:1728
    s_waitcnt vmcnt(5)
    ds_write_b64 v3, v[136:137] offset:2304
    ds_write_b64 v3, v[138:139] offset:2880
    s_waitcnt vmcnt(4)
    ds_write_b64 v3, v[140:141] offset:3456
    ds_write_b64 v3, v[142:143] offset:4032
    s_waitcnt lgkmcnt(0)
    ds_read_b64_tr_b16 v[216:217], v4 offset:0
    ds_read_b64_tr_b16 v[218:219], v4 offset:64
    ds_read_b64_tr_b16 v[220:221], v18 offset:0
    ds_read_b64_tr_b16 v[222:223], v18 offset:64
    ds_read_b64_tr_b16 v[224:225], v4 offset:1152
    ds_read_b64_tr_b16 v[226:227], v4 offset:1216
    ds_read_b64_tr_b16 v[228:229], v18 offset:1152
    ds_read_b64_tr_b16 v[230:231], v18 offset:1216
    ds_read_b64_tr_b16 v[232:233], v4 offset:2304
    ds_read_b64_tr_b16 v[234:235], v4 offset:2368
    ds_read_b64_tr_b16 v[236:237], v18 offset:2304
    ds_read_b64_tr_b16 v[238:239], v18 offset:2368
    ds_read_b64_tr_b16 v[240:241], v4 offset:3456
    ds_read_b64_tr_b16 v[242:243], v4 offset:3520
    ds_read_b64_tr_b16 v[244:245], v18 offset:3456
    ds_read_b64_tr_b16 v[246:247], v18 offset:3520
    s_waitcnt lgkmcnt(14)
    v_mfma_f32_16x16x32_bf16 v[184:187], v[216:219], v[32:35], 0
    v_mfma_f32_16x16x32_bf16 v[196:199], v[216:219], v[48:51], 0
    s_waitcnt lgkmcnt(12)
    v_mfma_f32_16x16x32_bf16 v[184:187], v[220:223], v[32:35], v[184:187]
    v_mfma_f32_16x16x32_bf16 v[196:199], v[220:223], v[48:51], v[196:199]
    s_waitcnt lgkmcnt(10)
    v_mfma_f32_16x16x32_bf16 v[184:187], v[224:227], v[36:39], v[184:187]
    v_mfma_f32_16x16x32_bf16 v[196:199], v[224:227], v[52:55], v[196:199]
    s_waitcnt lgkmcnt(8)
    v_mfma_f32_16x16x32_bf16 v[184:187], v[228:231], v[36:39], v[184:187]
    v_mfma_f32_16x16x32_bf16 v[196:199], v[228:231], v[52:55], v[196:199]
    s_waitcnt lgkmcnt(6)
    v_mfma_f32_16x16x32_bf16 v[184:187], v[232:235], v[40:43], v[184:187]
    v_mfma_f32_16x16x32_bf16 v[196:199], v[232:235], v[56:59], v[196:199]
    s_waitcnt lgkmcnt(4)
    v_mfma_f32_16x16x32_bf16 v[184:187], v[236:239], v[40:43], v[184:187]
    v_mfma_f32_16x16x32_bf16 v[196:199], v[236:239], v[56:59], v[196:199]
    s_waitcnt lgkmcnt(2)
    v_mfma_f32_16x16x32_bf16 v[184:187], v[240:243], v[44:47], v[184:187]
    v_mfma_f32_16x16x32_bf16 v[196:199], v[240:243], v[60:63], v[196:199]
    s_waitcnt lgkmcnt(0)
    v_mfma_f32_16x16x32_bf16 v[184:187], v[244:247], v[44:47], v[184:187]
    v_mfma_f32_16x16x32_bf16 v[196:199], v[244:247], v[60:63], v[196:199]
    v_cndmask_b32 v176, v7, v176, s[48:49]
    v_cndmask_b32 v177, v7, v177, s[50:51]
    v_cndmask_b32 v178, v7, v178, s[52:53]
    v_cndmask_b32 v179, v7, v179, s[54:55]
    v_cndmask_b32 v180, v7, v180, s[56:57]
    v_cndmask_b32 v181, v7, v181, s[58:59]
    v_cndmask_b32 v182, v7, v182, s[60:61]
    v_cndmask_b32 v183, v7, v183, s[62:63]
    v_cndmask_b32 v188, v7, v188, s[40:41]
    v_cndmask_b32 v189, v7, v189, s[42:43]
    v_cndmask_b32 v190, v7, v190, s[44:45]
    v_cndmask_b32 v191, v7, v191, s[46:47]
    v_cndmask_b32 v192, v7, v192, s[48:49]
    v_cndmask_b32 v193, v7, v193, s[50:51]
    v_cndmask_b32 v194, v7, v194, s[52:53]
    v_cndmask_b32 v195, v7, v195, s[54:55]
    v_max_f32 v14, v176, v177
    v_max_f32 v15, v188, v189
    v_max3_f32 v14, v14, v178, v179
    v_max3_f32 v15, v15, v190, v191
    v_max3_f32 v14, v14, v180, v181
    v_max3_f32 v15, v15, v192, v193
    v_max3_f32 v14, v14, v182, v183
    v_max3_f32 v15, v15, v194, v195
    v_max3_f32 v14, v14, v184, v185
    v_max3_f32 v15, v15, v196, v197
    v_max3_f32 v14, v14, v186, v187
    v_max3_f32 v15, v15, v198, v199
    v_mov_b32 v16, v14
    v_mov_b32 v17, v15
    s_nop 0
    v_permlane16_swap_b32 v14, v16
    v_permlane16_swap_b32 v15, v17
    v_max_f32 v14, v14, v16
    v_max_f32 v15, v15, v17
    v_mov_b32 v16, v14
    v_mov_b32 v17, v15
    s_nop 0
    v_permlane32_swap_b32 v14, v16
    v_permlane32_swap_b32 v15, v17
    v_max_f32 v14, v14, v16
    v_max_f32 v15, v15, v17
    v_mul_f32 v14, s38, v14
    v_mul_f32 v15, s38, v15
    v_fma_f32 v176, s38, v176, -v14
    v_fma_f32 v177, s38, v177, -v14
    v_fma_f32 v178, s38, v178, -v14
    v_fma_f32 v179, s38, v179, -v14
    v_fma_f32 v180, s38, v180, -v14
    v_fma_f32 v181, s38, v181, -v14
    v_fma_f32 v182, s38, v182, -v14
    v_fma_f32 v183, s38, v183, -v14
    v_fma_f32 v184, s38, v184, -v14
    v_fma_f32 v185, s38, v185, -v14
    v_fma_f32 v186, s38, v186, -v14
    v_fma_f32 v187, s38, v187, -v14
    v_fma_f32 v188, s38, v188, -v15
    v_fma_f32 v189, s38, v189, -v15
    v_fma_f32 v190, s38, v190, -v15
    v_fma_f32 v191, s38, v191, -v15
    v_fma_f32 v192, s38, v192, -v15
    v_fma_f32 v193, s38, v193, -v15
    v_fma_f32 v194, s38, v194, -v15
    v_fma_f32 v195, s38, v195, -v15
    v_fma_f32 v196, s38, v196, -v15
    v_fma_f32 v197, s38, v197, -v15
    v_fma_f32 v198, s38, v198, -v15
    v_fma_f32 v199, s38, v199, -v15
    v_exp_f32 v176, v176
    v_exp_f32 v177, v177
    v_exp_f32 v178, v178
    v_exp_f32 v179, v179
    v_exp_f32 v180, v180
    v_exp_f32 v181, v181
    v_exp_f32 v182, v182
    v_exp_f32 v183, v183
    v_exp_f32 v184, v184
    v_exp_f32 v185, v185
    v_exp_f32 v186, v186
    v_exp_f32 v187, v187
    v_exp_f32 v188, v188
    v_exp_f32 v189, v189
    v_exp_f32 v190, v190
    v_exp_f32 v191, v191
    v_exp_f32 v192, v192
    v_exp_f32 v193, v193
    v_exp_f32 v194, v194
    v_exp_f32 v195, v195
    v_exp_f32 v196, v196
    v_exp_f32 v197, v197
    v_exp_f32 v198, v198
    v_exp_f32 v199, v199
    v_cvt_pk_bf16_f32 v200, v176, v177
    v_cvt_pk_bf16_f32 v201, v178, v179
    v_cvt_pk_bf16_f32 v202, v180, v181
    v_cvt_pk_bf16_f32 v203, v182, v183
    v_cvt_pk_bf16_f32 v204, v184, v185
    v_cvt_pk_bf16_f32 v205, v186, v187
    v_cvt_pk_bf16_f32 v208, v188, v189
    v_cvt_pk_bf16_f32 v209, v190, v191
    v_cvt_pk_bf16_f32 v210, v192, v193
    v_cvt_pk_bf16_f32 v211, v194, v195
    v_cvt_pk_bf16_f32 v212, v196, v197
    v_cvt_pk_bf16_f32 v213, v198, v199
    v_mfma_f32_16x16x32_bf16 v[176:179], v[8:11], v[200:203], 0
    v_mfma_f32_16x16x32_bf16 v[180:183], v[8:11], v[208:211], 0
    v_mfma_f32_16x16x32_bf16 v[32:35], v[96:99], v[200:203], 0
    v_mfma_f32_16x16x32_bf16 v[36:39], v[100:103], v[200:203], 0
    v_mfma_f32_16x16x32_bf16 v[40:43], v[104:107], v[200:203], 0
    v_mfma_f32_16x16x32_bf16 v[44:47], v[108:111], v[200:203], 0
    v_mfma_f32_16x16x32_bf16 v[48:51], v[112:115], v[200:203], 0
    v_mfma_f32_16x16x32_bf16 v[52:55], v[116:119], v[200:203], 0
    v_mfma_f32_16x16x32_bf16 v[56:59], v[120:123], v[200:203], 0
    v_mfma_f32_16x16x32_bf16 v[60:63], v[124:127], v[200:203], 0
    v_mfma_f32_16x16x16_bf16 v[176:179], v[12:13], v[204:205], v[176:179]
    s_waitcnt vmcnt(3)
    v_mfma_f32_16x16x16_bf16 v[32:35], v[144:145], v[204:205], v[32:35]
    v_mfma_f32_16x16x16_bf16 v[36:39], v[146:147], v[204:205], v[36:39]
    s_waitcnt vmcnt(2)
    v_mfma_f32_16x16x16_bf16 v[40:43], v[148:149], v[204:205], v[40:43]
    v_mfma_f32_16x16x16_bf16 v[44:47], v[150:151], v[204:205], v[44:47]
    s_waitcnt vmcnt(1)
    v_mfma_f32_16x16x16_bf16 v[48:51], v[152:153], v[204:205], v[48:51]
    v_mfma_f32_16x16x16_bf16 v[52:55], v[154:155], v[204:205], v[52:55]
    s_waitcnt vmcnt(0)
    v_mfma_f32_16x16x16_bf16 v[56:59], v[156:157], v[204:205], v[56:59]
    v_mfma_f32_16x16x16_bf16 v[60:63], v[158:159], v[204:205], v[60:63]
    v_mfma_f32_16x16x32_bf16 v[216:219], v[96:99], v[208:211], 0
    v_mfma_f32_16x16x32_bf16 v[220:223], v[100:103], v[208:211], 0
    v_mfma_f32_16x16x32_bf16 v[224:227], v[104:107], v[208:211], 0
    v_mfma_f32_16x16x32_bf16 v[228:231], v[108:111], v[208:211], 0
    v_mfma_f32_16x16x32_bf16 v[232:235], v[112:115], v[208:211], 0
    v_mfma_f32_16x16x32_bf16 v[236:239], v[116:119], v[208:211], 0
    v_mfma_f32_16x16x32_bf16 v[240:243], v[120:123], v[208:211], 0
    v_mfma_f32_16x16x32_bf16 v[244:247], v[124:127], v[208:211], 0
    v_mfma_f32_16x16x16_bf16 v[180:183], v[12:13], v[212:213], v[180:183]
    v_mfma_f32_16x16x16_bf16 v[216:219], v[144:145], v[212:213], v[216:219]
    v_mfma_f32_16x16x16_bf16 v[220:223], v[146:147], v[212:213], v[220:223]
    v_mfma_f32_16x16x16_bf16 v[224:227], v[148:149], v[212:213], v[224:227]
    v_mfma_f32_16x16x16_bf16 v[228:231], v[150:151], v[212:213], v[228:231]
    v_mfma_f32_16x16x16_bf16 v[232:235], v[152:153], v[212:213], v[232:235]
    v_mfma_f32_16x16x16_bf16 v[236:239], v[154:155], v[212:213], v[236:239]
    v_mfma_f32_16x16x16_bf16 v[240:243], v[156:157], v[212:213], v[240:243]
    v_mfma_f32_16x16x16_bf16 v[244:247], v[158:159], v[212:213], v[244:247]
    v_rcp_f32 v14, v176
    v_rcp_f32 v15, v180
    v_mul_f32 v32, v14, v32
    v_mul_f32 v33, v14, v33
    v_mul_f32 v34, v14, v34
    v_mul_f32 v35, v14, v35
    v_mul_f32 v36, v14, v36
    v_mul_f32 v37, v14, v37
    v_mul_f32 v38, v14, v38
    v_mul_f32 v39, v14, v39
    v_cvt_pk_bf16_f32 v64, v32, v36
    v_cvt_pk_bf16_f32 v65, v33, v37
    v_cvt_pk_bf16_f32 v66, v34, v38
    v_cvt_pk_bf16_f32 v67, v35, v39
    buffer_store_dwordx4 v[64:67], v5, s[8:11], s26 offen offset:0 sc1
    v_mul_f32 v40, v14, v40
    v_mul_f32 v41, v14, v41
    v_mul_f32 v42, v14, v42
    v_mul_f32 v43, v14, v43
    v_mul_f32 v44, v14, v44
    v_mul_f32 v45, v14, v45
    v_mul_f32 v46, v14, v46
    v_mul_f32 v47, v14, v47
    v_cvt_pk_bf16_f32 v68, v40, v44
    v_cvt_pk_bf16_f32 v69, v41, v45
    v_cvt_pk_bf16_f32 v70, v42, v46
    v_cvt_pk_bf16_f32 v71, v43, v47
    buffer_store_dwordx4 v[68:71], v5, s[8:11], s26 offen offset:2048 sc1
    v_mul_f32 v48, v14, v48
    v_mul_f32 v49, v14, v49
    v_mul_f32 v50, v14, v50
    v_mul_f32 v51, v14, v51
    v_mul_f32 v52, v14, v52
    v_mul_f32 v53, v14, v53
    v_mul_f32 v54, v14, v54
    v_mul_f32 v55, v14, v55
    v_cvt_pk_bf16_f32 v72, v48, v52
    v_cvt_pk_bf16_f32 v73, v49, v53
    v_cvt_pk_bf16_f32 v74, v50, v54
    v_cvt_pk_bf16_f32 v75, v51, v55
    buffer_store_dwordx4 v[72:75], v5, s[8:11], s27 offen offset:0 sc1
    v_mul_f32 v56, v14, v56
    v_mul_f32 v57, v14, v57
    v_mul_f32 v58, v14, v58
    v_mul_f32 v59, v14, v59
    v_mul_f32 v60, v14, v60
    v_mul_f32 v61, v14, v61
    v_mul_f32 v62, v14, v62
    v_mul_f32 v63, v14, v63
    v_cvt_pk_bf16_f32 v76, v56, v60
    v_cvt_pk_bf16_f32 v77, v57, v61
    v_cvt_pk_bf16_f32 v78, v58, v62
    v_cvt_pk_bf16_f32 v79, v59, v63
    buffer_store_dwordx4 v[76:79], v5, s[8:11], s27 offen offset:2048 sc1
    v_mul_f32 v216, v15, v216
    v_mul_f32 v217, v15, v217
    v_mul_f32 v218, v15, v218
    v_mul_f32 v219, v15, v219
    v_mul_f32 v220, v15, v220
    v_mul_f32 v221, v15, v221
    v_mul_f32 v222, v15, v222
    v_mul_f32 v223, v15, v223
    v_cvt_pk_bf16_f32 v80, v216, v220
    v_cvt_pk_bf16_f32 v81, v217, v221
    v_cvt_pk_bf16_f32 v82, v218, v222
    v_cvt_pk_bf16_f32 v83, v219, v223
    buffer_store_dwordx4 v[80:83], v5, s[8:11], s26 offen offset:64 sc1
    v_mul_f32 v224, v15, v224
    v_mul_f32 v225, v15, v225
    v_mul_f32 v226, v15, v226
    v_mul_f32 v227, v15, v227
    v_mul_f32 v228, v15, v228
    v_mul_f32 v229, v15, v229
    v_mul_f32 v230, v15, v230
    v_mul_f32 v231, v15, v231
    v_cvt_pk_bf16_f32 v84, v224, v228
    v_cvt_pk_bf16_f32 v85, v225, v229
    v_cvt_pk_bf16_f32 v86, v226, v230
    v_cvt_pk_bf16_f32 v87, v227, v231
    buffer_store_dwordx4 v[84:87], v5, s[8:11], s26 offen offset:2112 sc1
    v_mul_f32 v232, v15, v232
    v_mul_f32 v233, v15, v233
    v_mul_f32 v234, v15, v234
    v_mul_f32 v235, v15, v235
    v_mul_f32 v236, v15, v236
    v_mul_f32 v237, v15, v237
    v_mul_f32 v238, v15, v238
    v_mul_f32 v239, v15, v239
    v_cvt_pk_bf16_f32 v88, v232, v236
    v_cvt_pk_bf16_f32 v89, v233, v237
    v_cvt_pk_bf16_f32 v90, v234, v238
    v_cvt_pk_bf16_f32 v91, v235, v239
    buffer_store_dwordx4 v[88:91], v5, s[8:11], s27 offen offset:64 sc1
    v_mul_f32 v240, v15, v240
    v_mul_f32 v241, v15, v241
    v_mul_f32 v242, v15, v242
    v_mul_f32 v243, v15, v243
    v_mul_f32 v244, v15, v244
    v_mul_f32 v245, v15, v245
    v_mul_f32 v246, v15, v246
    v_mul_f32 v247, v15, v247
    v_cvt_pk_bf16_f32 v92, v240, v244
    v_cvt_pk_bf16_f32 v93, v241, v245
    v_cvt_pk_bf16_f32 v94, v242, v246
    v_cvt_pk_bf16_f32 v95, v243, v247
    buffer_store_dwordx4 v[92:95], v5, s[8:11], s27 offen offset:2112 sc1
    s_lshr_b32 s28, s18, 3
    s_lshl_b32 s28, s28, 7
    s_add_u32 s28, s28, 1064960
    s_waitcnt vmcnt(0)
    s_barrier
    s_cmp_eq_u32 s17, 0
    s_cbranch_scc0 K_AO
    v_mov_b32 v14, 0
    v_mov_b32 v15, 1
    s_mov_b64 exec, 1
    buffer_atomic_add v15, v14, s[8:11], s28 offen
    s_mov_b64 exec, -1
K_AO:
    s_lshr_b32 s79, s18, 3
    s_branch K_AN
K_OUT:
    s_load_dwordx2 s[80:81], s[0:1], 40
    s_load_dwordx2 s[84:85], s[0:1], 80
    s_load_dwordx2 s[88:89], s[0:1], 0
    s_load_dwordx2 s[92:93], s[0:1], 88
    s_mov_b32 s82, 5242880
    s_mov_b32 s83, 0x20000
    s_mov_b32 s86, 2211840
    s_mov_b32 s87, 0x20000
    s_mov_b32 s90, 2621440
    s_mov_b32 s91, 0x20000
    s_mov_b32 s94, 2621440
    s_mov_b32 s95, 0x20000
    s_waitcnt lgkmcnt(0)
    v_and_b32 v20, 63, v0
    v_lshlrev_b32 v2, 4, v20
    v_lshrrev_b32 v21, 2, v20
    v_mul_u32_u24 v21, 1280, v21
    v_and_b32 v22, 3, v20
    v_lshl_add_u32 v3, v22, 4, v21
    v_lshrrev_b32 v23, 5, v20
    v_bfe_u32 v24, v20, 2, 2
    v_lshl_add_u32 v24, v23, 3, v24
    v_lshlrev_b32 v24, 6, v24
    v_bfe_u32 v25, v20, 4, 1
    v_lshl_add_u32 v24, v25, 5, v24
    v_lshl_add_u32 v24, v22, 3, v24
    s_lshl_b32 s27, s17, 15
    v_add_u32 v4, s27, v24
    s_lshl_b32 s28, s17, 12
    v_add_u32 v5, s28, v2
    s_lshl_b32 s28, s17, 10
    v_add_u32 v6, s28, v2
    v_and_b32 v24, 31, v20
    v_mul_u32_u24 v24, 1280, v24
    v_lshl_add_u32 v24, v23, 3, v24
    s_lshl_b32 s28, s17, 4
    s_lshl_b32 s29, s18, 6
    s_add_u32 s28, s28, s29
    v_add_u32 v7, s28, v24
    v_cmp_ne_u32 vcc, 0, v0
    v_mov_b32 v145, 0x40000000
    s_nop 0
    v_cndmask_b32 v145, 0, v145, vcc
    s_mul_i32 s24, s17, 1310720
    s_add_u32 s24, s24, s29
    s_mul_i32 s25, s17, 552960
    s_add_u32 s25, s25, s29
    s_add_u32 m0, s27, 0
    s_add_u32 s28, s24, 0
    buffer_load_dwordx4 v3, s[80:83], s28 offen offset:0 lds
    s_add_u32 s28, s24, 19456
    buffer_load_dwordx4 v3, s[80:83], s28 offen offset:1024 lds
    s_add_u32 s28, s24, 38912
    buffer_load_dwordx4 v3, s[80:83], s28 offen offset:2048 lds
    s_add_u32 s28, s24, 58368
    buffer_load_dwordx4 v3, s[80:83], s28 offen offset:3072 lds
    s_add_u32 m0, s27, 4096
    s_add_u32 s28, s24, 81920
    buffer_load_dwordx4 v3, s[80:83], s28 offen offset:0 lds
    s_add_u32 s28, s24, 101376
    buffer_load_dwordx4 v3, s[80:83], s28 offen offset:1024 lds
    s_add_u32 s28, s24, 120832
    buffer_load_dwordx4 v3, s[80:83], s28 offen offset:2048 lds
    s_add_u32 s28, s24, 140288
    buffer_load_dwordx4 v3, s[80:83], s28 offen offset:3072 lds
    s_add_u32 m0, s27, 8192
    s_add_u32 s28, s24, 163840
    buffer_load_dwordx4 v3, s[80:83], s28 offen offset:0 lds
    s_add_u32 s28, s24, 183296
    buffer_load_dwordx4 v3, s[80:83], s28 offen offset:1024 lds
    s_add_u32 s28, s24, 202752
    buffer_load_dwordx4 v3, s[80:83], s28 offen offset:2048 lds
    s_add_u32 s28, s24, 222208
    buffer_load_dwordx4 v3, s[80:83], s28 offen offset:3072 lds
    s_add_u32 m0, s27, 12288
    s_add_u32 s28, s24, 245760
    buffer_load_dwordx4 v3, s[80:83], s28 offen offset:0 lds
    s_add_u32 s28, s24, 265216
    buffer_load_dwordx4 v3, s[80:83], s28 offen offset:1024 lds
    s_add_u32 s28, s24, 284672
    buffer_load_dwordx4 v3, s[80:83], s28 offen offset:2048 lds
    s_add_u32 s28, s24, 304128
    buffer_load_dwordx4 v3, s[80:83], s28 offen offset:3072 lds
    s_add_u32 m0, s27, 16384
    s_add_u32 s28, s24, 327680
    buffer_load_dwordx4 v3, s[80:83], s28 offen offset:0 lds
    s_add_u32 s28, s24, 347136
    buffer_load_dwordx4 v3, s[80:83], s28 offen offset:1024 lds
    s_add_u32 s28, s24, 366592
    buffer_load_dwordx4 v3, s[80:83], s28 offen offset:2048 lds
    s_add_u32 s28, s24, 386048
    buffer_load_dwordx4 v3, s[80:83], s28 offen offset:3072 lds
    s_add_u32 m0, s27, 20480
    s_add_u32 s28, s24, 409600
    buffer_load_dwordx4 v3, s[80:83], s28 offen offset:0 lds
    s_add_u32 s28, s24, 429056
    buffer_load_dwordx4 v3, s[80:83], s28 offen offset:1024 lds
    s_add_u32 s28, s24, 448512
    buffer_load_dwordx4 v3, s[80:83], s28 offen offset:2048 lds
    s_add_u32 s28, s24, 467968
    buffer_load_dwordx4 v3, s[80:83], s28 offen offset:3072 lds
    s_add_u32 m0, s27, 24576
    s_add_u32 s28, s24, 491520
    buffer_load_dwordx4 v3, s[80:83], s28 offen offset:0 lds
    s_add_u32 s28, s24, 510976
    buffer_load_dwordx4 v3, s[80:83], s28 offen offset:1024 lds
    s_add_u32 s28, s24, 530432
    buffer_load_dwordx4 v3, s[80:83], s28 offen offset:2048 lds
    s_add_u32 s28, s24, 549888
    buffer_load_dwordx4 v3, s[80:83], s28 offen offset:3072 lds
    s_add_u32 m0, s27, 28672
    s_add_u32 s28, s24, 573440
    buffer_load_dwordx4 v3, s[80:83], s28 offen offset:0 lds
    s_add_u32 s28, s24, 592896
    buffer_load_dwordx4 v3, s[80:83], s28 offen offset:1024 lds
    s_add_u32 s28, s24, 612352
    buffer_load_dwordx4 v3, s[80:83], s28 offen offset:2048 lds
    s_add_u32 s28, s24, 631808
    buffer_load_dwordx4 v3, s[80:83], s28 offen offset:3072 lds
    s_waitcnt vmcnt(16)
    ds_read_b64_tr_b16 a[0:1], v4 offset:0
    ds_read_b64_tr_b16 a[2:3], v4 offset:256
    ds_read_b64_tr_b16 a[4:5], v4 offset:1024
    ds_read_b64_tr_b16 a[6:7], v4 offset:1280
    ds_read_b64_tr_b16 a[8:9], v4 offset:2048
    ds_read_b64_tr_b16 a[10:11], v4 offset:2304
    ds_read_b64_tr_b16 a[12:13], v4 offset:3072
    ds_read_b64_tr_b16 a[14:15], v4 offset:3328
    ds_read_b64_tr_b16 a[16:17], v4 offset:4096
    ds_read_b64_tr_b16 a[18:19], v4 offset:4352
    ds_read_b64_tr_b16 a[20:21], v4 offset:5120
    ds_read_b64_tr_b16 a[22:23], v4 offset:5376
    ds_read_b64_tr_b16 a[24:25], v4 offset:6144
    ds_read_b64_tr_b16 a[26:27], v4 offset:6400
    ds_read_b64_tr_b16 a[28:29], v4 offset:7168
    ds_read_b64_tr_b16 a[30:31], v4 offset:7424
    ds_read_b64_tr_b16 a[32:33], v4 offset:8192
    ds_read_b64_tr_b16 a[34:35], v4 offset:8448
    ds_read_b64_tr_b16 a[36:37], v4 offset:9216
    ds_read_b64_tr_b16 a[38:39], v4 offset:9472
    ds_read_b64_tr_b16 a[40:41], v4 offset:10240
    ds_read_b64_tr_b16 a[42:43], v4 offset:10496
    ds_read_b64_tr_b16 a[44:45], v4 offset:11264
    ds_read_b64_tr_b16 a[46:47], v4 offset:11520
    ds_read_b64_tr_b16 a[48:49], v4 offset:12288
    ds_read_b64_tr_b16 a[50:51], v4 offset:12544
    ds_read_b64_tr_b16 a[52:53], v4 offset:13312
    ds_read_b64_tr_b16 a[54:55], v4 offset:13568
    ds_read_b64_tr_b16 a[56:57], v4 offset:14336
    ds_read_b64_tr_b16 a[58:59], v4 offset:14592
    ds_read_b64_tr_b16 a[60:61], v4 offset:15360
    ds_read_b64_tr_b16 a[62:63], v4 offset:15616
    s_waitcnt lgkmcnt(0)
    s_add_u32 m0, s27, 0
    s_add_u32 s28, s24, 655360
    buffer_load_dwordx4 v3, s[80:83], s28 offen offset:0 lds
    s_add_u32 s28, s24, 674816
    buffer_load_dwordx4 v3, s[80:83], s28 offen offset:1024 lds
    s_add_u32 s28, s24, 694272
    buffer_load_dwordx4 v3, s[80:83], s28 offen offset:2048 lds
    s_add_u32 s28, s24, 713728
    buffer_load_dwordx4 v3, s[80:83], s28 offen offset:3072 lds
    s_add_u32 m0, s27, 4096
    s_add_u32 s28, s24, 737280
    buffer_load_dwordx4 v3, s[80:83], s28 offen offset:0 lds
    s_add_u32 s28, s24, 756736
    buffer_load_dwordx4 v3, s[80:83], s28 offen offset:1024 lds
    s_add_u32 s28, s24, 776192
    buffer_load_dwordx4 v3, s[80:83], s28 offen offset:2048 lds
    s_add_u32 s28, s24, 795648
    buffer_load_dwordx4 v3, s[80:83], s28 offen offset:3072 lds
    s_add_u32 m0, s27, 8192
    s_add_u32 s28, s24, 819200
    buffer_load_dwordx4 v3, s[80:83], s28 offen offset:0 lds
    s_add_u32 s28, s24, 838656
    buffer_load_dwordx4 v3, s[80:83], s28 offen offset:1024 lds
    s_add_u32 s28, s24, 858112
    buffer_load_dwordx4 v3, s[80:83], s28 offen offset:2048 lds
    s_add_u32 s28, s24, 877568
    buffer_load_dwordx4 v3, s[80:83], s28 offen offset:3072 lds
    s_add_u32 m0, s27, 12288
    s_add_u32 s28, s24, 901120
    buffer_load_dwordx4 v3, s[80:83], s28 offen offset:0 lds
    s_add_u32 s28, s24, 920576
    buffer_load_dwordx4 v3, s[80:83], s28 offen offset:1024 lds
    s_add_u32 s28, s24, 940032
    buffer_load_dwordx4 v3, s[80:83], s28 offen offset:2048 lds
    s_add_u32 s28, s24, 959488
    buffer_load_dwordx4 v3, s[80:83], s28 offen offset:3072 lds
    s_waitcnt vmcnt(16)
    ds_read_b64_tr_b16 a[64:65], v4 offset:16384
    ds_read_b64_tr_b16 a[66:67], v4 offset:16640
    ds_read_b64_tr_b16 a[68:69], v4 offset:17408
    ds_read_b64_tr_b16 a[70:71], v4 offset:17664
    ds_read_b64_tr_b16 a[72:73], v4 offset:18432
    ds_read_b64_tr_b16 a[74:75], v4 offset:18688
    ds_read_b64_tr_b16 a[76:77], v4 offset:19456
    ds_read_b64_tr_b16 a[78:79], v4 offset:19712
    ds_read_b64_tr_b16 a[80:81], v4 offset:20480
    ds_read_b64_tr_b16 a[82:83], v4 offset:20736
    ds_read_b64_tr_b16 a[84:85], v4 offset:21504
    ds_read_b64_tr_b16 a[86:87], v4 offset:21760
    ds_read_b64_tr_b16 a[88:89], v4 offset:22528
    ds_read_b64_tr_b16 a[90:91], v4 offset:22784
    ds_read_b64_tr_b16 a[92:93], v4 offset:23552
    ds_read_b64_tr_b16 a[94:95], v4 offset:23808
    ds_read_b64_tr_b16 a[96:97], v4 offset:24576
    ds_read_b64_tr_b16 a[98:99], v4 offset:24832
    ds_read_b64_tr_b16 a[100:101], v4 offset:25600
    ds_read_b64_tr_b16 a[102:103], v4 offset:25856
    ds_read_b64_tr_b16 a[104:105], v4 offset:26624
    ds_read_b64_tr_b16 a[106:107], v4 offset:26880
    ds_read_b64_tr_b16 a[108:109], v4 offset:27648
    ds_read_b64_tr_b16 a[110:111], v4 offset:27904
    ds_read_b64_tr_b16 a[112:113], v4 offset:28672
    ds_read_b64_tr_b16 a[114:115], v4 offset:28928
    ds_read_b64_tr_b16 a[116:117], v4 offset:29696
    ds_read_b64_tr_b16 a[118:119], v4 offset:29952
    ds_read_b64_tr_b16 a[120:121], v4 offset:30720
    ds_read_b64_tr_b16 a[122:123], v4 offset:30976
    ds_read_b64_tr_b16 a[124:125], v4 offset:31744
    ds_read_b64_tr_b16 a[126:127], v4 offset:32000
    s_waitcnt lgkmcnt(0)
    s_add_u32 m0, s27, 16384
    s_add_u32 s28, s24, 983040
    buffer_load_dwordx4 v3, s[80:83], s28 offen offset:0 lds
    s_add_u32 s28, s24, 1002496
    buffer_load_dwordx4 v3, s[80:83], s28 offen offset:1024 lds
    s_add_u32 s28, s24, 1021952
    buffer_load_dwordx4 v3, s[80:83], s28 offen offset:2048 lds
    s_add_u32 s28, s24, 1041408
    buffer_load_dwordx4 v3, s[80:83], s28 offen offset:3072 lds
    s_add_u32 m0, s27, 20480
    s_add_u32 s28, s24, 1064960
    buffer_load_dwordx4 v3, s[80:83], s28 offen offset:0 lds
    s_add_u32 s28, s24, 1084416
    buffer_load_dwordx4 v3, s[80:83], s28 offen offset:1024 lds
    s_add_u32 s28, s24, 1103872
    buffer_load_dwordx4 v3, s[80:83], s28 offen offset:2048 lds
    s_add_u32 s28, s24, 1123328
    buffer_load_dwordx4 v3, s[80:83], s28 offen offset:3072 lds
    s_add_u32 m0, s27, 24576
    s_add_u32 s28, s24, 1146880
    buffer_load_dwordx4 v3, s[80:83], s28 offen offset:0 lds
    s_add_u32 s28, s24, 1166336
    buffer_load_dwordx4 v3, s[80:83], s28 offen offset:1024 lds
    s_add_u32 s28, s24, 1185792
    buffer_load_dwordx4 v3, s[80:83], s28 offen offset:2048 lds
    s_add_u32 s28, s24, 1205248
    buffer_load_dwordx4 v3, s[80:83], s28 offen offset:3072 lds
    s_add_u32 m0, s27, 28672
    s_add_u32 s28, s24, 1228800
    buffer_load_dwordx4 v3, s[80:83], s28 offen offset:0 lds
    s_add_u32 s28, s24, 1248256
    buffer_load_dwordx4 v3, s[80:83], s28 offen offset:1024 lds
    s_add_u32 s28, s24, 1267712
    buffer_load_dwordx4 v3, s[80:83], s28 offen offset:2048 lds
    s_add_u32 s28, s24, 1287168
    buffer_load_dwordx4 v3, s[80:83], s28 offen offset:3072 lds
    s_waitcnt vmcnt(16)
    ds_read_b64_tr_b16 a[128:129], v4 offset:0
    ds_read_b64_tr_b16 a[130:131], v4 offset:256
    ds_read_b64_tr_b16 a[132:133], v4 offset:1024
    ds_read_b64_tr_b16 a[134:135], v4 offset:1280
    ds_read_b64_tr_b16 a[136:137], v4 offset:2048
    ds_read_b64_tr_b16 a[138:139], v4 offset:2304
    ds_read_b64_tr_b16 a[140:141], v4 offset:3072
    ds_read_b64_tr_b16 a[142:143], v4 offset:3328
    ds_read_b64_tr_b16 a[144:145], v4 offset:4096
    ds_read_b64_tr_b16 a[146:147], v4 offset:4352
    ds_read_b64_tr_b16 a[148:149], v4 offset:5120
    ds_read_b64_tr_b16 a[150:151], v4 offset:5376
    ds_read_b64_tr_b16 a[152:153], v4 offset:6144
    ds_read_b64_tr_b16 a[154:155], v4 offset:6400
    ds_read_b64_tr_b16 a[156:157], v4 offset:7168
    ds_read_b64_tr_b16 a[158:159], v4 offset:7424
    ds_read_b64_tr_b16 a[160:161], v4 offset:8192
    ds_read_b64_tr_b16 a[162:163], v4 offset:8448
    ds_read_b64_tr_b16 a[164:165], v4 offset:9216
    ds_read_b64_tr_b16 a[166:167], v4 offset:9472
    ds_read_b64_tr_b16 a[168:169], v4 offset:10240
    ds_read_b64_tr_b16 a[170:171], v4 offset:10496
    ds_read_b64_tr_b16 a[172:173], v4 offset:11264
    ds_read_b64_tr_b16 a[174:175], v4 offset:11520
    ds_read_b64_tr_b16 a[176:177], v4 offset:12288
    ds_read_b64_tr_b16 a[178:179], v4 offset:12544
    ds_read_b64_tr_b16 a[180:181], v4 offset:13312
    ds_read_b64_tr_b16 a[182:183], v4 offset:13568
    ds_read_b64_tr_b16 a[184:185], v4 offset:14336
    ds_read_b64_tr_b16 a[186:187], v4 offset:14592
    ds_read_b64_tr_b16 a[188:189], v4 offset:15360
    ds_read_b64_tr_b16 a[190:191], v4 offset:15616
    s_waitcnt lgkmcnt(0)
    s_add_u32 m0, s27, 0
    s_add_u32 s28, s25, 0
    buffer_load_dwordx4 v3, s[84:87], s28 offen offset:0 lds
    s_add_u32 s28, s25, 19456
    buffer_load_dwordx4 v3, s[84:87], s28 offen offset:1024 lds
    s_add_u32 s28, s25, 38912
    buffer_load_dwordx4 v3, s[84:87], s28 offen offset:2048 lds
    s_add_u32 s28, s25, 58368
    buffer_load_dwordx4 v3, s[84:87], s28 offen offset:3072 lds
    s_add_u32 m0, s27, 4096
    s_add_u32 s28, s25, 81920
    buffer_load_dwordx4 v3, s[84:87], s28 offen offset:0 lds
    s_add_u32 s28, s25, 101376
    buffer_load_dwordx4 v3, s[84:87], s28 offen offset:1024 lds
    s_add_u32 s28, s25, 120832
    buffer_load_dwordx4 v3, s[84:87], s28 offen offset:2048 lds
    s_add_u32 s28, s25, 140288
    buffer_load_dwordx4 v3, s[84:87], s28 offen offset:3072 lds
    s_add_u32 m0, s27, 8192
    s_add_u32 s28, s25, 163840
    buffer_load_dwordx4 v3, s[84:87], s28 offen offset:0 lds
    s_add_u32 s28, s25, 183296
    buffer_load_dwordx4 v3, s[84:87], s28 offen offset:1024 lds
    s_add_u32 s28, s25, 202752
    buffer_load_dwordx4 v3, s[84:87], s28 offen offset:2048 lds
    s_add_u32 s28, s25, 222208
    buffer_load_dwordx4 v3, s[84:87], s28 offen offset:3072 lds
    s_add_u32 m0, s27, 12288
    s_add_u32 s28, s25, 245760
    buffer_load_dwordx4 v3, s[84:87], s28 offen offset:0 lds
    s_add_u32 s28, s25, 265216
    buffer_load_dwordx4 v3, s[84:87], s28 offen offset:1024 lds
    s_add_u32 s28, s25, 284672
    buffer_load_dwordx4 v3, s[84:87], s28 offen offset:2048 lds
    s_add_u32 s28, s25, 304128
    buffer_load_dwordx4 v3, s[84:87], s28 offen offset:3072 lds
    s_waitcnt vmcnt(16)
    ds_read_b64_tr_b16 a[192:193], v4 offset:16384
    ds_read_b64_tr_b16 a[194:195], v4 offset:16640
    ds_read_b64_tr_b16 a[196:197], v4 offset:17408
    ds_read_b64_tr_b16 a[198:199], v4 offset:17664
    ds_read_b64_tr_b16 a[200:201], v4 offset:18432
    ds_read_b64_tr_b16 a[202:203], v4 offset:18688
    ds_read_b64_tr_b16 a[204:205], v4 offset:19456
    ds_read_b64_tr_b16 a[206:207], v4 offset:19712
    ds_read_b64_tr_b16 a[208:209], v4 offset:20480
    ds_read_b64_tr_b16 a[210:211], v4 offset:20736
    ds_read_b64_tr_b16 a[212:213], v4 offset:21504
    ds_read_b64_tr_b16 a[214:215], v4 offset:21760
    ds_read_b64_tr_b16 a[216:217], v4 offset:22528
    ds_read_b64_tr_b16 a[218:219], v4 offset:22784
    ds_read_b64_tr_b16 a[220:221], v4 offset:23552
    ds_read_b64_tr_b16 a[222:223], v4 offset:23808
    ds_read_b64_tr_b16 a[224:225], v4 offset:24576
    ds_read_b64_tr_b16 a[226:227], v4 offset:24832
    ds_read_b64_tr_b16 a[228:229], v4 offset:25600
    ds_read_b64_tr_b16 a[230:231], v4 offset:25856
    ds_read_b64_tr_b16 a[232:233], v4 offset:26624
    ds_read_b64_tr_b16 a[234:235], v4 offset:26880
    ds_read_b64_tr_b16 a[236:237], v4 offset:27648
    ds_read_b64_tr_b16 a[238:239], v4 offset:27904
    ds_read_b64_tr_b16 a[240:241], v4 offset:28672
    ds_read_b64_tr_b16 a[242:243], v4 offset:28928
    ds_read_b64_tr_b16 a[244:245], v4 offset:29696
    ds_read_b64_tr_b16 a[246:247], v4 offset:29952
    ds_read_b64_tr_b16 a[248:249], v4 offset:30720
    ds_read_b64_tr_b16 a[250:251], v4 offset:30976
    ds_read_b64_tr_b16 a[252:253], v4 offset:31744
    ds_read_b64_tr_b16 a[254:255], v4 offset:32000
    s_waitcnt lgkmcnt(0)
    s_add_u32 m0, s27, 16384
    s_add_u32 s28, s25, 327680
    buffer_load_dwordx4 v3, s[84:87], s28 offen offset:0 lds
    s_add_u32 s28, s25, 347136
    buffer_load_dwordx4 v3, s[84:87], s28 offen offset:1024 lds
    s_add_u32 s28, s25, 366592
    buffer_load_dwordx4 v3, s[84:87], s28 offen offset:2048 lds
    s_add_u32 s28, s25, 386048
    buffer_load_dwordx4 v3, s[84:87], s28 offen offset:3072 lds
    s_add_u32 m0, s27, 20480
    s_add_u32 s28, s25, 409600
    buffer_load_dwordx4 v3, s[84:87], s28 offen offset:0 lds
    s_add_u32 s28, s25, 429056
    buffer_load_dwordx4 v3, s[84:87], s28 offen offset:1024 lds
    s_add_u32 s28, s25, 448512
    buffer_load_dwordx4 v3, s[84:87], s28 offen offset:2048 lds
    s_add_u32 s28, s25, 467968
    buffer_load_dwordx4 v3, s[84:87], s28 offen offset:3072 lds
    s_add_u32 m0, s27, 24576
    s_add_u32 s28, s25, 491520
    buffer_load_dwordx4 v3, s[84:87], s28 offen offset:0 lds
    s_add_u32 s28, s25, 510976
    buffer_load_dwordx4 v3, s[84:87], s28 offen offset:1024 lds
    s_add_u32 s28, s25, 530432
    buffer_load_dwordx4 v3, s[84:87], s28 offen offset:2048 lds
    s_waitcnt vmcnt(11)
    ds_read_b64_tr_b16 v[148:149], v4 offset:0
    ds_read_b64_tr_b16 v[150:151], v4 offset:256
    ds_read_b64_tr_b16 v[152:153], v4 offset:1024
    ds_read_b64_tr_b16 v[154:155], v4 offset:1280
    ds_read_b64_tr_b16 v[156:157], v4 offset:2048
    ds_read_b64_tr_b16 v[158:159], v4 offset:2304
    ds_read_b64_tr_b16 v[160:161], v4 offset:3072
    ds_read_b64_tr_b16 v[162:163], v4 offset:3328
    ds_read_b64_tr_b16 v[164:165], v4 offset:4096
    ds_read_b64_tr_b16 v[166:167], v4 offset:4352
    ds_read_b64_tr_b16 v[168:169], v4 offset:5120
    ds_read_b64_tr_b16 v[170:171], v4 offset:5376
    ds_read_b64_tr_b16 v[172:173], v4 offset:6144
    ds_read_b64_tr_b16 v[174:175], v4 offset:6400
    ds_read_b64_tr_b16 v[176:177], v4 offset:7168
    ds_read_b64_tr_b16 v[178:179], v4 offset:7424
    ds_read_b64_tr_b16 v[180:181], v4 offset:8192
    ds_read_b64_tr_b16 v[182:183], v4 offset:8448
    ds_read_b64_tr_b16 v[184:185], v4 offset:9216
    ds_read_b64_tr_b16 v[186:187], v4 offset:9472
    ds_read_b64_tr_b16 v[188:189], v4 offset:10240
    ds_read_b64_tr_b16 v[190:191], v4 offset:10496
    ds_read_b64_tr_b16 v[192:193], v4 offset:11264
    ds_read_b64_tr_b16 v[194:195], v4 offset:11520
    ds_read_b64_tr_b16 v[196:197], v4 offset:12288
    ds_read_b64_tr_b16 v[198:199], v4 offset:12544
    ds_read_b64_tr_b16 v[200:201], v4 offset:13312
    ds_read_b64_tr_b16 v[202:203], v4 offset:13568
    ds_read_b64_tr_b16 v[204:205], v4 offset:14336
    ds_read_b64_tr_b16 v[206:207], v4 offset:14592
    ds_read_b64_tr_b16 v[208:209], v4 offset:15360
    ds_read_b64_tr_b16 v[210:211], v4 offset:15616
    s_waitcnt lgkmcnt(0)
    s_waitcnt vmcnt(0)
    ds_read_b64_tr_b16 v[212:213], v4 offset:16384
    ds_read_b64_tr_b16 v[214:215], v4 offset:16640
    ds_read_b64_tr_b16 v[216:217], v4 offset:17408
    ds_read_b64_tr_b16 v[218:219], v4 offset:17664
    ds_read_b64_tr_b16 v[220:221], v4 offset:18432
    ds_read_b64_tr_b16 v[222:223], v4 offset:18688
    ds_read_b64_tr_b16 v[224:225], v4 offset:19456
    ds_read_b64_tr_b16 v[226:227], v4 offset:19712
    ds_read_b64_tr_b16 v[228:229], v4 offset:20480
    ds_read_b64_tr_b16 v[230:231], v4 offset:20736
    ds_read_b64_tr_b16 v[232:233], v4 offset:21504
    ds_read_b64_tr_b16 v[234:235], v4 offset:21760
    ds_read_b64_tr_b16 v[236:237], v4 offset:22528
    ds_read_b64_tr_b16 v[238:239], v4 offset:22784
    ds_read_b64_tr_b16 v[240:241], v4 offset:23552
    ds_read_b64_tr_b16 v[242:243], v4 offset:23808
    ds_read_b64_tr_b16 v[244:245], v4 offset:24576
    ds_read_b64_tr_b16 v[246:247], v4 offset:24832
    ds_read_b64_tr_b16 v[248:249], v4 offset:25600
    ds_read_b64_tr_b16 v[250:251], v4 offset:25856
    ds_read_b64_tr_b16 v[252:253], v4 offset:26624
    ds_read_b64_tr_b16 v[254:255], v4 offset:26880
    s_waitcnt lgkmcnt(0)
    s_barrier
    s_lshl_b32 s31, s18, 7
    s_add_u32 s31, s31, 1060864
    s_barrier
    v_mov_b32 v14, s31
    v_mov_b32 v15, 1
    v_mov_b32 v13, 163832
    s_cmp_eq_u32 s17, 0
    s_cbranch_scc0 K_T6
    s_mov_b64 exec, 1
    global_atomic_add v12, v14, v15, s[8:9] offset:0 sc0
    s_waitcnt vmcnt(0)
    ds_write_b32 v13, v12
    s_waitcnt lgkmcnt(0)
    s_mov_b64 exec, -1
K_T6:
    s_barrier
    ds_read_b32 v12, v13
    s_waitcnt lgkmcnt(0)
    v_readfirstlane_b32 s20, v12
    s_mov_b32 s19, 0
K_ON:
    s_cmp_ge_u32 s20, 64
    s_cbranch_scc1 K_END
    s_mul_i32 s21, s20, 110592
    s_mul_i32 s28, s17, 27648
    s_add_u32 s21, s21, s28
    s_add_u32 s21, s21, 92274688
    s_lshl_b32 s22, s20, 18
    s_lshl_b32 s28, s17, 16
    s_add_u32 s22, s22, s28
    s_add_u32 s22, s22, 117440512
    s_mul_i32 s23, s20, 40960
    v_mov_b32 v144, 1
    buffer_atomic_add v144, v145, s[8:11], s31 offen sc0
    buffer_load_dwordx2 v[8:9], v7, s[88:91], s23 offen
    s_cmp_lg_u32 s19, 0
    s_cbranch_scc1 O_FAST
    s_lshr_b32 s28, s20, 3
    s_lshl_b32 s28, s28, 8
    s_add_u32 s28, s28, 1056896
    s_cmp_eq_u32 s17, 0
    s_cbranch_scc0 K_WH_OK
    v_mov_b32 v14, 0
K_WH:
    buffer_load_dword v15, v14, s[8:11], s28 offen sc1
    s_add_u32 s3, s3, 1
    s_cmp_gt_u32 s3, 2000000
    s_cbranch_scc1 K_END
    s_waitcnt vmcnt(0)
    v_readfirstlane_b32 s29, v15
    s_nop 0
    s_cmp_ge_u32 s29, 1
    s_cbranch_scc1 K_WH_OK
    s_sleep 16
    s_branch K_WH
K_WH_OK:
    s_barrier
    s_add_u32 s28, s21, 0
    buffer_load_dwordx4 v[32:35], v2, s[8:11], s28 offen offset:0 sc1
    buffer_load_dwordx4 v[36:39], v2, s[8:11], s28 offen offset:1024 sc1
    buffer_load_dwordx4 v[40:43], v2, s[8:11], s28 offen offset:2048 sc1
    buffer_load_dwordx4 v[44:47], v2, s[8:11], s28 offen offset:3072 sc1
    s_add_u32 s28, s21, 4096
    buffer_load_dwordx4 v[48:51], v2, s[8:11], s28 offen offset:0 sc1
    buffer_load_dwordx4 v[52:55], v2, s[8:11], s28 offen offset:1024 sc1
    buffer_load_dwordx4 v[56:59], v2, s[8:11], s28 offen offset:2048 sc1
    buffer_load_dwordx4 v[60:63], v2, s[8:11], s28 offen offset:3072 sc1
    s_add_u32 s28, s21, 8192
    buffer_load_dwordx4 v[64:67], v2, s[8:11], s28 offen offset:0 sc1
    buffer_load_dwordx4 v[68:71], v2, s[8:11], s28 offen offset:1024 sc1
    buffer_load_dwordx4 v[72:75], v2, s[8:11], s28 offen offset:2048 sc1
    buffer_load_dwordx4 v[76:79], v2, s[8:11], s28 offen offset:3072 sc1
    s_add_u32 s28, s21, 12288
    buffer_load_dwordx4 v[80:83], v2, s[8:11], s28 offen offset:0 sc1
    buffer_load_dwordx4 v[84:87], v2, s[8:11], s28 offen offset:1024 sc1
    buffer_load_dwordx4 v[88:91], v2, s[8:11], s28 offen offset:2048 sc1
    buffer_load_dwordx4 v[92:95], v2, s[8:11], s28 offen offset:3072 sc1
    s_add_u32 s28, s21, 16384
    buffer_load_dwordx4 v[96:99], v2, s[8:11], s28 offen offset:0 sc1
    buffer_load_dwordx4 v[100:103], v2, s[8:11], s28 offen offset:1024 sc1
    buffer_load_dwordx4 v[104:107], v2, s[8:11], s28 offen offset:2048 sc1
    buffer_load_dwordx4 v[108:111], v2, s[8:11], s28 offen offset:3072 sc1
    s_add_u32 s28, s21, 20480
    buffer_load_dwordx4 v[112:115], v2, s[8:11], s28 offen offset:0 sc1
    buffer_load_dwordx4 v[116:119], v2, s[8:11], s28 offen offset:1024 sc1
    buffer_load_dwordx4 v[120:123], v2, s[8:11], s28 offen offset:2048 sc1
    buffer_load_dwordx4 v[124:127], v2, s[8:11], s28 offen offset:3072 sc1
    s_add_u32 s28, s21, 24576
    buffer_load_dwordx4 v[128:131], v2, s[8:11], s28 offen offset:0 sc1
    buffer_load_dwordx4 v[132:135], v2, s[8:11], s28 offen offset:1024 sc1
    buffer_load_dwordx4 v[136:139], v2, s[8:11], s28 offen offset:2048 sc1
    s_waitcnt vmcnt(26)
    v_mfma_f32_32x32x16_bf16 v[16:31], v[148:151], v[32:35], 0
    s_waitcnt vmcnt(25)
    v_mfma_f32_32x32x16_bf16 v[16:31], v[152:155], v[36:39], v[16:31]
    s_waitcnt vmcnt(24)
    v_mfma_f32_32x32x16_bf16 v[16:31], v[156:159], v[40:43], v[16:31]
    s_waitcnt vmcnt(23)
    v_mfma_f32_32x32x16_bf16 v[16:31], v[160:163], v[44:47], v[16:31]
    s_waitcnt vmcnt(22)
    v_mfma_f32_32x32x16_bf16 v[16:31], v[164:167], v[48:51], v[16:31]
    s_waitcnt vmcnt(21)
    v_mfma_f32_32x32x16_bf16 v[16:31], v[168:171], v[52:55], v[16:31]
    s_waitcnt vmcnt(20)
    v_mfma_f32_32x32x16_bf16 v[16:31], v[172:175], v[56:59], v[16:31]
    s_waitcnt vmcnt(19)
    v_mfma_f32_32x32x16_bf16 v[16:31], v[176:179], v[60:63], v[16:31]
    s_waitcnt vmcnt(18)
    v_mfma_f32_32x32x16_bf16 v[16:31], v[180:183], v[64:67], v[16:31]
    s_waitcnt vmcnt(17)
    v_mfma_f32_32x32x16_bf16 v[16:31], v[184:187], v[68:71], v[16:31]
    s_waitcnt vmcnt(16)
    v_mfma_f32_32x32x16_bf16 v[16:31], v[188:191], v[72:75], v[16:31]
    s_waitcnt vmcnt(15)
    v_mfma_f32_32x32x16_bf16 v[16:31], v[192:195], v[76:79], v[16:31]
    s_waitcnt vmcnt(14)
    v_mfma_f32_32x32x16_bf16 v[16:31], v[196:199], v[80:83], v[16:31]
    s_waitcnt vmcnt(13)
    v_mfma_f32_32x32x16_bf16 v[16:31], v[200:203], v[84:87], v[16:31]
    s_waitcnt vmcnt(12)
    v_mfma_f32_32x32x16_bf16 v[16:31], v[204:207], v[88:91], v[16:31]
    s_waitcnt vmcnt(11)
    v_mfma_f32_32x32x16_bf16 v[16:31], v[208:211], v[92:95], v[16:31]
    s_waitcnt vmcnt(10)
    v_mfma_f32_32x32x16_bf16 v[16:31], v[212:215], v[96:99], v[16:31]
    s_waitcnt vmcnt(9)
    v_mfma_f32_32x32x16_bf16 v[16:31], v[216:219], v[100:103], v[16:31]
    s_waitcnt vmcnt(8)
    v_mfma_f32_32x32x16_bf16 v[16:31], v[220:223], v[104:107], v[16:31]
    s_waitcnt vmcnt(7)
    v_mfma_f32_32x32x16_bf16 v[16:31], v[224:227], v[108:111], v[16:31]
    s_waitcnt vmcnt(6)
    v_mfma_f32_32x32x16_bf16 v[16:31], v[228:231], v[112:115], v[16:31]
    s_waitcnt vmcnt(5)
    v_mfma_f32_32x32x16_bf16 v[16:31], v[232:235], v[116:119], v[16:31]
    s_waitcnt vmcnt(4)
    v_mfma_f32_32x32x16_bf16 v[16:31], v[236:239], v[120:123], v[16:31]
    s_waitcnt vmcnt(3)
    v_mfma_f32_32x32x16_bf16 v[16:31], v[240:243], v[124:127], v[16:31]
    s_waitcnt vmcnt(2)
    v_mfma_f32_32x32x16_bf16 v[16:31], v[244:247], v[128:131], v[16:31]
    s_waitcnt vmcnt(1)
    v_mfma_f32_32x32x16_bf16 v[16:31], v[248:251], v[132:135], v[16:31]
    s_waitcnt vmcnt(0)
    v_mfma_f32_32x32x16_bf16 v[16:31], v[252:255], v[136:139], v[16:31]
    s_lshl_b32 s28, s20, 7
    s_add_u32 s28, s28, 1064960
    s_cmp_eq_u32 s17, 0
    s_cbranch_scc0 K_WO_OK
    v_mov_b32 v14, 0
K_WO:
    buffer_load_dword v15, v14, s[8:11], s28 offen sc1
    s_add_u32 s3, s3, 1
    s_cmp_gt_u32 s3, 2000000
    s_cbranch_scc1 K_END
    s_waitcnt vmcnt(0)
    v_readfirstlane_b32 s29, v15
    s_nop 0
    s_cmp_ge_u32 s29, 8
    s_cbranch_scc1 K_WO_OK
    s_sleep 4
    s_branch K_WO
K_WO_OK:
    s_barrier
    s_add_u32 s28, s22, 0
    buffer_load_dwordx4 v[140:143], v2, s[8:11], s28 offen offset:0 sc1
    buffer_load_dwordx4 v[32:35], v2, s[8:11], s28 offen offset:1024 sc1
    buffer_load_dwordx4 v[36:39], v2, s[8:11], s28 offen offset:2048 sc1
    buffer_load_dwordx4 v[40:43], v2, s[8:11], s28 offen offset:3072 sc1
    s_add_u32 s28, s22, 4096
    buffer_load_dwordx4 v[44:47], v2, s[8:11], s28 offen offset:0 sc1
    buffer_load_dwordx4 v[48:51], v2, s[8:11], s28 offen offset:1024 sc1
    buffer_load_dwordx4 v[52:55], v2, s[8:11], s28 offen offset:2048 sc1
    buffer_load_dwordx4 v[56:59], v2, s[8:11], s28 offen offset:3072 sc1
    s_add_u32 s28, s22, 8192
    buffer_load_dwordx4 v[60:63], v2, s[8:11], s28 offen offset:0 sc1
    buffer_load_dwordx4 v[64:67], v2, s[8:11], s28 offen offset:1024 sc1
    buffer_load_dwordx4 v[68:71], v2, s[8:11], s28 offen offset:2048 sc1
    buffer_load_dwordx4 v[72:75], v2, s[8:11], s28 offen offset:3072 sc1
    s_add_u32 s28, s22, 12288
    buffer_load_dwordx4 v[76:79], v2, s[8:11], s28 offen offset:0 sc1
    buffer_load_dwordx4 v[80:83], v2, s[8:11], s28 offen offset:1024 sc1
    buffer_load_dwordx4 v[84:87], v2, s[8:11], s28 offen offset:2048 sc1
    buffer_load_dwordx4 v[88:91], v2, s[8:11], s28 offen offset:3072 sc1
    s_add_u32 s28, s22, 16384
    buffer_load_dwordx4 v[92:95], v2, s[8:11], s28 offen offset:0 sc1
    buffer_load_dwordx4 v[96:99], v2, s[8:11], s28 offen offset:1024 sc1
    buffer_load_dwordx4 v[100:103], v2, s[8:11], s28 offen offset:2048 sc1
    buffer_load_dwordx4 v[104:107], v2, s[8:11], s28 offen offset:3072 sc1
    s_add_u32 s28, s22, 20480
    buffer_load_dwordx4 v[108:111], v2, s[8:11], s28 offen offset:0 sc1
    buffer_load_dwordx4 v[112:115], v2, s[8:11], s28 offen offset:1024 sc1
    buffer_load_dwordx4 v[116:119], v2, s[8:11], s28 offen offset:2048 sc1
    buffer_load_dwordx4 v[120:123], v2, s[8:11], s28 offen offset:3072 sc1
    s_add_u32 s28, s22, 24576
    buffer_load_dwordx4 v[124:127], v2, s[8:11], s28 offen offset:0 sc1
    buffer_load_dwordx4 v[128:131], v2, s[8:11], s28 offen offset:1024 sc1
    buffer_load_dwordx4 v[132:135], v2, s[8:11], s28 offen offset:2048 sc1
    buffer_load_dwordx4 v[136:139], v2, s[8:11], s28 offen offset:3072 sc1
    s_waitcnt vmcnt(27)
    v_mfma_f32_32x32x16_bf16 v[16:31], a[0:3], v[140:143], v[16:31]
    s_add_u32 s28, s22, 28672
    buffer_load_dwordx4 v[140:143], v2, s[8:11], s28 offen offset:0 sc1
    s_waitcnt vmcnt(27)
    v_mfma_f32_32x32x16_bf16 v[16:31], a[4:7], v[32:35], v[16:31]
    buffer_load_dwordx4 v[32:35], v2, s[8:11], s28 offen offset:1024 sc1
    s_waitcnt vmcnt(27)
    v_mfma_f32_32x32x16_bf16 v[16:31], a[8:11], v[36:39], v[16:31]
    buffer_load_dwordx4 v[36:39], v2, s[8:11], s28 offen offset:2048 sc1
    s_waitcnt vmcnt(27)
    v_mfma_f32_32x32x16_bf16 v[16:31], a[12:15], v[40:43], v[16:31]
    buffer_load_dwordx4 v[40:43], v2, s[8:11], s28 offen offset:3072 sc1
    s_waitcnt vmcnt(27)
    v_mfma_f32_32x32x16_bf16 v[16:31], a[16:19], v[44:47], v[16:31]
    s_add_u32 s28, s22, 32768
    buffer_load_dwordx4 v[44:47], v2, s[8:11], s28 offen offset:0 sc1
    s_waitcnt vmcnt(27)
    v_mfma_f32_32x32x16_bf16 v[16:31], a[20:23], v[48:51], v[16:31]
    buffer_load_dwordx4 v[48:51], v2, s[8:11], s28 offen offset:1024 sc1
    s_waitcnt vmcnt(27)
    v_mfma_f32_32x32x16_bf16 v[16:31], a[24:27], v[52:55], v[16:31]
    buffer_load_dwordx4 v[52:55], v2, s[8:11], s28 offen offset:2048 sc1
    s_waitcnt vmcnt(27)
    v_mfma_f32_32x32x16_bf16 v[16:31], a[28:31], v[56:59], v[16:31]
    buffer_load_dwordx4 v[56:59], v2, s[8:11], s28 offen offset:3072 sc1
    s_waitcnt vmcnt(27)
    v_mfma_f32_32x32x16_bf16 v[16:31], a[32:35], v[60:63], v[16:31]
    s_add_u32 s28, s22, 36864
    buffer_load_dwordx4 v[60:63], v2, s[8:11], s28 offen offset:0 sc1
    s_waitcnt vmcnt(27)
    v_mfma_f32_32x32x16_bf16 v[16:31], a[36:39], v[64:67], v[16:31]
    buffer_load_dwordx4 v[64:67], v2, s[8:11], s28 offen offset:1024 sc1
    s_waitcnt vmcnt(27)
    v_mfma_f32_32x32x16_bf16 v[16:31], a[40:43], v[68:71], v[16:31]
    buffer_load_dwordx4 v[68:71], v2, s[8:11], s28 offen offset:2048 sc1
    s_waitcnt vmcnt(27)
    v_mfma_f32_32x32x16_bf16 v[16:31], a[44:47], v[72:75], v[16:31]
    buffer_load_dwordx4 v[72:75], v2, s[8:11], s28 offen offset:3072 sc1
    s_waitcnt vmcnt(27)
    v_mfma_f32_32x32x16_bf16 v[16:31], a[48:51], v[76:79], v[16:31]
    s_add_u32 s28, s22, 40960
    buffer_load_dwordx4 v[76:79], v2, s[8:11], s28 offen offset:0 sc1
    s_waitcnt vmcnt(27)
    v_mfma_f32_32x32x16_bf16 v[16:31], a[52:55], v[80:83], v[16:31]
    buffer_load_dwordx4 v[80:83], v2, s[8:11], s28 offen offset:1024 sc1
    s_waitcnt vmcnt(27)
    v_mfma_f32_32x32x16_bf16 v[16:31], a[56:59], v[84:87], v[16:31]
    buffer_load_dwordx4 v[84:87], v2, s[8:11], s28 offen offset:2048 sc1
    s_waitcnt vmcnt(27)
    v_mfma_f32_32x32x16_bf16 v[16:31], a[60:63], v[88:91], v[16:31]
    buffer_load_dwordx4 v[88:91], v2, s[8:11], s28 offen offset:3072 sc1
    s_waitcnt vmcnt(27)
    v_mfma_f32_32x32x16_bf16 v[16:31], a[64:67], v[92:95], v[16:31]
    s_add_u32 s28, s22, 45056
    buffer_load_dwordx4 v[92:95], v2, s[8:11], s28 offen offset:0 sc1
    s_waitcnt vmcnt(27)
    v_mfma_f32_32x32x16_bf16 v[16:31], a[68:71], v[96:99], v[16:31]
    buffer_load_dwordx4 v[96:99], v2, s[8:11], s28 offen offset:1024 sc1
    s_waitcnt vmcnt(27)
    v_mfma_f32_32x32x16_bf16 v[16:31], a[72:75], v[100:103], v[16:31]
    buffer_load_dwordx4 v[100:103], v2, s[8:11], s28 offen offset:2048 sc1
    s_waitcnt vmcnt(27)
    v_mfma_f32_32x32x16_bf16 v[16:31], a[76:79], v[104:107], v[16:31]
    buffer_load_dwordx4 v[104:107], v2, s[8:11], s28 offen offset:3072 sc1
    s_waitcnt vmcnt(27)
    v_mfma_f32_32x32x16_bf16 v[16:31], a[80:83], v[108:111], v[16:31]
    s_add_u32 s28, s22, 49152
    buffer_load_dwordx4 v[108:111], v2, s[8:11], s28 offen offset:0 sc1
    s_waitcnt vmcnt(27)
    v_mfma_f32_32x32x16_bf16 v[16:31], a[84:87], v[112:115], v[16:31]
    buffer_load_dwordx4 v[112:115], v2, s[8:11], s28 offen offset:1024 sc1
    s_waitcnt vmcnt(27)
    v_mfma_f32_32x32x16_bf16 v[16:31], a[88:91], v[116:119], v[16:31]
    buffer_load_dwordx4 v[116:119], v2, s[8:11], s28 offen offset:2048 sc1
    s_waitcnt vmcnt(27)
    v_mfma_f32_32x32x16_bf16 v[16:31], a[92:95], v[120:123], v[16:31]
    buffer_load_dwordx4 v[120:123], v2, s[8:11], s28 offen offset:3072 sc1
    s_waitcnt vmcnt(27)
    v_mfma_f32_32x32x16_bf16 v[16:31], a[96:99], v[124:127], v[16:31]
    s_add_u32 s28, s22, 53248
    buffer_load_dwordx4 v[124:127], v2, s[8:11], s28 offen offset:0 sc1
    s_waitcnt vmcnt(27)
    v_mfma_f32_32x32x16_bf16 v[16:31], a[100:103], v[128:131], v[16:31]
    buffer_load_dwordx4 v[128:131], v2, s[8:11], s28 offen offset:1024 sc1
    s_waitcnt vmcnt(27)
    v_mfma_f32_32x32x16_bf16 v[16:31], a[104:107], v[132:135], v[16:31]
    buffer_load_dwordx4 v[132:135], v2, s[8:11], s28 offen offset:2048 sc1
    s_waitcnt vmcnt(27)
    v_mfma_f32_32x32x16_bf16 v[16:31], a[108:111], v[136:139], v[16:31]
    buffer_load_dwordx4 v[136:139], v2, s[8:11], s28 offen offset:3072 sc1
    s_waitcnt vmcnt(27)
    v_mfma_f32_32x32x16_bf16 v[16:31], a[112:115], v[140:143], v[16:31]
    s_add_u32 s28, s22, 57344
    buffer_load_dwordx4 v[140:143], v2, s[8:11], s28 offen offset:0 sc1
    s_waitcnt vmcnt(27)
    v_mfma_f32_32x32x16_bf16 v[16:31], a[116:119], v[32:35], v[16:31]
    buffer_load_dwordx4 v[32:35], v2, s[8:11], s28 offen offset:1024 sc1
    s_waitcnt vmcnt(27)
    v_mfma_f32_32x32x16_bf16 v[16:31], a[120:123], v[36:39], v[16:31]
    buffer_load_dwordx4 v[36:39], v2, s[8:11], s28 offen offset:2048 sc1
    s_waitcnt vmcnt(27)
    v_mfma_f32_32x32x16_bf16 v[16:31], a[124:127], v[40:43], v[16:31]
    buffer_load_dwordx4 v[40:43], v2, s[8:11], s28 offen offset:3072 sc1
    s_waitcnt vmcnt(27)
    v_mfma_f32_32x32x16_bf16 v[16:31], a[128:131], v[44:47], v[16:31]
    s_add_u32 s28, s22, 61440
    buffer_load_dwordx4 v[44:47], v2, s[8:11], s28 offen offset:0 sc1
    s_waitcnt vmcnt(27)
    v_mfma_f32_32x32x16_bf16 v[16:31], a[132:135], v[48:51], v[16:31]
    buffer_load_dwordx4 v[48:51], v2, s[8:11], s28 offen offset:1024 sc1
    s_waitcnt vmcnt(27)
    v_mfma_f32_32x32x16_bf16 v[16:31], a[136:139], v[52:55], v[16:31]
    buffer_load_dwordx4 v[52:55], v2, s[8:11], s28 offen offset:2048 sc1
    s_waitcnt vmcnt(27)
    v_mfma_f32_32x32x16_bf16 v[16:31], a[140:143], v[56:59], v[16:31]
    buffer_load_dwordx4 v[56:59], v2, s[8:11], s28 offen offset:3072 sc1
    s_waitcnt vmcnt(27)
    v_mfma_f32_32x32x16_bf16 v[16:31], a[144:147], v[60:63], v[16:31]
    s_waitcnt vmcnt(26)
    v_mfma_f32_32x32x16_bf16 v[16:31], a[148:151], v[64:67], v[16:31]
    s_waitcnt vmcnt(25)
    v_mfma_f32_32x32x16_bf16 v[16:31], a[152:155], v[68:71], v[16:31]
    s_waitcnt vmcnt(24)
    v_mfma_f32_32x32x16_bf16 v[16:31], a[156:159], v[72:75], v[16:31]
    s_waitcnt vmcnt(23)
    v_mfma_f32_32x32x16_bf16 v[16:31], a[160:163], v[76:79], v[16:31]
    s_waitcnt vmcnt(22)
    v_mfma_f32_32x32x16_bf16 v[16:31], a[164:167], v[80:83], v[16:31]
    s_waitcnt vmcnt(21)
    v_mfma_f32_32x32x16_bf16 v[16:31], a[168:171], v[84:87], v[16:31]
    s_waitcnt vmcnt(20)
    v_mfma_f32_32x32x16_bf16 v[16:31], a[172:175], v[88:91], v[16:31]
    v_min_u32 v146, 63, v144
    v_lshl_add_u32 v146, v146, 7, v145
    s_mov_b32 s29, 1064960
    buffer_load_dword v147, v146, s[8:11], s29 offen sc1
    s_waitcnt vmcnt(20)
    v_mfma_f32_32x32x16_bf16 v[16:31], a[176:179], v[92:95], v[16:31]
    s_waitcnt vmcnt(19)
    v_mfma_f32_32x32x16_bf16 v[16:31], a[180:183], v[96:99], v[16:31]
    s_waitcnt vmcnt(18)
    v_mfma_f32_32x32x16_bf16 v[16:31], a[184:187], v[100:103], v[16:31]
    s_waitcnt vmcnt(17)
    v_mfma_f32_32x32x16_bf16 v[16:31], a[188:191], v[104:107], v[16:31]
    s_waitcnt vmcnt(16)
    v_mfma_f32_32x32x16_bf16 v[16:31], a[192:195], v[108:111], v[16:31]
    s_waitcnt vmcnt(15)
    v_mfma_f32_32x32x16_bf16 v[16:31], a[196:199], v[112:115], v[16:31]
    s_waitcnt vmcnt(14)
    v_mfma_f32_32x32x16_bf16 v[16:31], a[200:203], v[116:119], v[16:31]
    s_waitcnt vmcnt(13)
    v_mfma_f32_32x32x16_bf16 v[16:31], a[204:207], v[120:123], v[16:31]
    s_waitcnt vmcnt(12)
    v_mfma_f32_32x32x16_bf16 v[16:31], a[208:211], v[124:127], v[16:31]
    s_waitcnt vmcnt(11)
    v_mfma_f32_32x32x16_bf16 v[16:31], a[212:215], v[128:131], v[16:31]
    s_waitcnt vmcnt(10)
    v_mfma_f32_32x32x16_bf16 v[16:31], a[216:219], v[132:135], v[16:31]
    s_waitcnt vmcnt(9)
    v_mfma_f32_32x32x16_bf16 v[16:31], a[220:223], v[136:139], v[16:31]
    s_waitcnt vmcnt(8)
    v_mfma_f32_32x32x16_bf16 v[16:31], a[224:227], v[140:143], v[16:31]
    s_waitcnt vmcnt(7)
    v_mfma_f32_32x32x16_bf16 v[16:31], a[228:231], v[32:35], v[16:31]
    s_waitcnt vmcnt(6)
    v_mfma_f32_32x32x16_bf16 v[16:31], a[232:235], v[36:39], v[16:31]
    s_waitcnt vmcnt(5)
    v_mfma_f32_32x32x16_bf16 v[16:31], a[236:239], v[40:43], v[16:31]
    s_waitcnt vmcnt(4)
    v_mfma_f32_32x32x16_bf16 v[16:31], a[240:243], v[44:47], v[16:31]
    s_waitcnt vmcnt(3)
    v_mfma_f32_32x32x16_bf16 v[16:31], a[244:247], v[48:51], v[16:31]
    s_waitcnt vmcnt(2)
    v_mfma_f32_32x32x16_bf16 v[16:31], a[248:251], v[52:55], v[16:31]
    s_waitcnt vmcnt(1)
    v_mfma_f32_32x32x16_bf16 v[16:31], a[252:255], v[56:59], v[16:31]
    s_branch O_JOIN
O_FAST:
    s_add_u32 s28, s21, 0
    buffer_load_dwordx4 v[32:35], v2, s[8:11], s28 offen offset:0 sc1
    buffer_load_dwordx4 v[36:39], v2, s[8:11], s28 offen offset:1024 sc1
    buffer_load_dwordx4 v[40:43], v2, s[8:11], s28 offen offset:2048 sc1
    buffer_load_dwordx4 v[44:47], v2, s[8:11], s28 offen offset:3072 sc1
    s_add_u32 s28, s21, 4096
    buffer_load_dwordx4 v[48:51], v2, s[8:11], s28 offen offset:0 sc1
    buffer_load_dwordx4 v[52:55], v2, s[8:11], s28 offen offset:1024 sc1
    buffer_load_dwordx4 v[56:59], v2, s[8:11], s28 offen offset:2048 sc1
    buffer_load_dwordx4 v[60:63], v2, s[8:11], s28 offen offset:3072 sc1
    s_add_u32 s28, s21, 8192
    buffer_load_dwordx4 v[64:67], v2, s[8:11], s28 offen offset:0 sc1
    buffer_load_dwordx4 v[68:71], v2, s[8:11], s28 offen offset:1024 sc1
    buffer_load_dwordx4 v[72:75], v2, s[8:11], s28 offen offset:2048 sc1
    buffer_load_dwordx4 v[76:79], v2, s[8:11], s28 offen offset:3072 sc1
    s_add_u32 s28, s21, 12288
    buffer_load_dwordx4 v[80:83], v2, s[8:11], s28 offen offset:0 sc1
    buffer_load_dwordx4 v[84:87], v2, s[8:11], s28 offen offset:1024 sc1
    buffer_load_dwordx4 v[88:91], v2, s[8:11], s28 offen offset:2048 sc1
    buffer_load_dwordx4 v[92:95], v2, s[8:11], s28 offen offset:3072 sc1
    s_add_u32 s28, s21, 16384
    buffer_load_dwordx4 v[96:99], v2, s[8:11], s28 offen offset:0 sc1
    buffer_load_dwordx4 v[100:103], v2, s[8:11], s28 offen offset:1024 sc1
    buffer_load_dwordx4 v[104:107], v2, s[8:11], s28 offen offset:2048 sc1
    buffer_load_dwordx4 v[108:111], v2, s[8:11], s28 offen offset:3072 sc1
    s_add_u32 s28, s21, 20480
    buffer_load_dwordx4 v[112:115], v2, s[8:11], s28 offen offset:0 sc1
    buffer_load_dwordx4 v[116:119], v2, s[8:11], s28 offen offset:1024 sc1
    buffer_load_dwordx4 v[120:123], v2, s[8:11], s28 offen offset:2048 sc1
    buffer_load_dwordx4 v[124:127], v2, s[8:11], s28 offen offset:3072 sc1
    s_add_u32 s28, s21, 24576
    buffer_load_dwordx4 v[128:131], v2, s[8:11], s28 offen offset:0 sc1
    buffer_load_dwordx4 v[132:135], v2, s[8:11], s28 offen offset:1024 sc1
    buffer_load_dwordx4 v[136:139], v2, s[8:11], s28 offen offset:2048 sc1
    s_waitcnt vmcnt(26)
    v_mfma_f32_32x32x16_bf16 v[16:31], v[148:151], v[32:35], 0
    s_add_u32 s28, s22, 0
    buffer_load_dwordx4 v[140:143], v2, s[8:11], s28 offen offset:0 sc1
    buffer_load_dwordx4 v[32:35], v2, s[8:11], s28 offen offset:1024 sc1
    s_waitcnt vmcnt(27)
    v_mfma_f32_32x32x16_bf16 v[16:31], v[152:155], v[36:39], v[16:31]
    buffer_load_dwordx4 v[36:39], v2, s[8:11], s28 offen offset:2048 sc1
    s_waitcnt vmcnt(27)
    v_mfma_f32_32x32x16_bf16 v[16:31], v[156:159], v[40:43], v[16:31]
    buffer_load_dwordx4 v[40:43], v2, s[8:11], s28 offen offset:3072 sc1
    s_waitcnt vmcnt(27)
    v_mfma_f32_32x32x16_bf16 v[16:31], v[160:163], v[44:47], v[16:31]
    s_add_u32 s28, s22, 4096
    buffer_load_dwordx4 v[44:47], v2, s[8:11], s28 offen offset:0 sc1
    s_waitcnt vmcnt(27)
    v_mfma_f32_32x32x16_bf16 v[16:31], v[164:167], v[48:51], v[16:31]
    buffer_load_dwordx4 v[48:51], v2, s[8:11], s28 offen offset:1024 sc1
    s_waitcnt vmcnt(27)
    v_mfma_f32_32x32x16_bf16 v[16:31], v[168:171], v[52:55], v[16:31]
    buffer_load_dwordx4 v[52:55], v2, s[8:11], s28 offen offset:2048 sc1
    s_waitcnt vmcnt(27)
    v_mfma_f32_32x32x16_bf16 v[16:31], v[172:175], v[56:59], v[16:31]
    buffer_load_dwordx4 v[56:59], v2, s[8:11], s28 offen offset:3072 sc1
    s_waitcnt vmcnt(27)
    v_mfma_f32_32x32x16_bf16 v[16:31], v[176:179], v[60:63], v[16:31]
    s_add_u32 s28, s22, 8192
    buffer_load_dwordx4 v[60:63], v2, s[8:11], s28 offen offset:0 sc1
    s_waitcnt vmcnt(27)
    v_mfma_f32_32x32x16_bf16 v[16:31], v[180:183], v[64:67], v[16:31]
    buffer_load_dwordx4 v[64:67], v2, s[8:11], s28 offen offset:1024 sc1
    s_waitcnt vmcnt(27)
    v_mfma_f32_32x32x16_bf16 v[16:31], v[184:187], v[68:71], v[16:31]
    buffer_load_dwordx4 v[68:71], v2, s[8:11], s28 offen offset:2048 sc1
    s_waitcnt vmcnt(27)
    v_mfma_f32_32x32x16_bf16 v[16:31], v[188:191], v[72:75], v[16:31]
    buffer_load_dwordx4 v[72:75], v2, s[8:11], s28 offen offset:3072 sc1
    s_waitcnt vmcnt(27)
    v_mfma_f32_32x32x16_bf16 v[16:31], v[192:195], v[76:79], v[16:31]
    s_add_u32 s28, s22, 12288
    buffer_load_dwordx4 v[76:79], v2, s[8:11], s28 offen offset:0 sc1
    s_waitcnt vmcnt(27)
    v_mfma_f32_32x32x16_bf16 v[16:31], v[196:199], v[80:83], v[16:31]
    buffer_load_dwordx4 v[80:83], v2, s[8:11], s28 offen offset:1024 sc1
    s_waitcnt vmcnt(27)
    v_mfma_f32_32x32x16_bf16 v[16:31], v[200:203], v[84:87], v[16:31]
    buffer_load_dwordx4 v[84:87], v2, s[8:11], s28 offen offset:2048 sc1
    s_waitcnt vmcnt(27)
    v_mfma_f32_32x32x16_bf16 v[16:31], v[204:207], v[88:91], v[16:31]
    buffer_load_dwordx4 v[88:91], v2, s[8:11], s28 offen offset:3072 sc1
    s_waitcnt vmcnt(27)
    v_mfma_f32_32x32x16_bf16 v[16:31], v[208:211], v[92:95], v[16:31]
    s_add_u32 s28, s22, 16384
    buffer_load_dwordx4 v[92:95], v2, s[8:11], s28 offen offset:0 sc1
    s_waitcnt vmcnt(27)
    v_mfma_f32_32x32x16_bf16 v[16:31], v[212:215], v[96:99], v[16:31]
    buffer_load_dwordx4 v[96:99], v2, s[8:11], s28 offen offset:1024 sc1
    s_waitcnt vmcnt(27)
    v_mfma_f32_32x32x16_bf16 v[16:31], v[216:219], v[100:103], v[16:31]
    buffer_load_dwordx4 v[100:103], v2, s[8:11], s28 offen offset:2048 sc1
    s_waitcnt vmcnt(27)
    v_mfma_f32_32x32x16_bf16 v[16:31], v[220:223], v[104:107], v[16:31]
    buffer_load_dwordx4 v[104:107], v2, s[8:11], s28 offen offset:3072 sc1
    s_waitcnt vmcnt(27)
    v_mfma_f32_32x32x16_bf16 v[16:31], v[224:227], v[108:111], v[16:31]
    s_add_u32 s28, s22, 20480
    buffer_load_dwordx4 v[108:111], v2, s[8:11], s28 offen offset:0 sc1
    s_waitcnt vmcnt(27)
    v_mfma_f32_32x32x16_bf16 v[16:31], v[228:231], v[112:115], v[16:31]
    buffer_load_dwordx4 v[112:115], v2, s[8:11], s28 offen offset:1024 sc1
    s_waitcnt vmcnt(27)
    v_mfma_f32_32x32x16_bf16 v[16:31], v[232:235], v[116:119], v[16:31]
    buffer_load_dwordx4 v[116:119], v2, s[8:11], s28 offen offset:2048 sc1
    s_waitcnt vmcnt(27)
    v_mfma_f32_32x32x16_bf16 v[16:31], v[236:239], v[120:123], v[16:31]
    buffer_load_dwordx4 v[120:123], v2, s[8:11], s28 offen offset:3072 sc1
    s_waitcnt vmcnt(27)
    v_mfma_f32_32x32x16_bf16 v[16:31], v[240:243], v[124:127], v[16:31]
    s_add_u32 s28, s22, 24576
    buffer_load_dwordx4 v[124:127], v2, s[8:11], s28 offen offset:0 sc1
    s_waitcnt vmcnt(27)
    v_mfma_f32_32x32x16_bf16 v[16:31], v[244:247], v[128:131], v[16:31]
    buffer_load_dwordx4 v[128:131], v2, s[8:11], s28 offen offset:1024 sc1
    s_waitcnt vmcnt(27)
    v_mfma_f32_32x32x16_bf16 v[16:31], v[248:251], v[132:135], v[16:31]
    buffer_load_dwordx4 v[132:135], v2, s[8:11], s28 offen offset:2048 sc1
    s_waitcnt vmcnt(27)
    v_mfma_f32_32x32x16_bf16 v[16:31], v[252:255], v[136:139], v[16:31]
    buffer_load_dwordx4 v[136:139], v2, s[8:11], s28 offen offset:3072 sc1
    s_waitcnt vmcnt(27)
    v_mfma_f32_32x32x16_bf16 v[16:31], a[0:3], v[140:143], v[16:31]
    s_add_u32 s28, s22, 28672
    buffer_load_dwordx4 v[140:143], v2, s[8:11], s28 offen offset:0 sc1
    s_waitcnt vmcnt(27)
    v_mfma_f32_32x32x16_bf16 v[16:31], a[4:7], v[32:35], v[16:31]
    buffer_load_dwordx4 v[32:35], v2, s[8:11], s28 offen offset:1024 sc1
    s_waitcnt vmcnt(27)
    v_mfma_f32_32x32x16_bf16 v[16:31], a[8:11], v[36:39], v[16:31]
    buffer_load_dwordx4 v[36:39], v2, s[8:11], s28 offen offset:2048 sc1
    s_waitcnt vmcnt(27)
    v_mfma_f32_32x32x16_bf16 v[16:31], a[12:15], v[40:43], v[16:31]
    buffer_load_dwordx4 v[40:43], v2, s[8:11], s28 offen offset:3072 sc1
    s_waitcnt vmcnt(27)
    v_mfma_f32_32x32x16_bf16 v[16:31], a[16:19], v[44:47], v[16:31]
    s_add_u32 s28, s22, 32768
    buffer_load_dwordx4 v[44:47], v2, s[8:11], s28 offen offset:0 sc1
    s_waitcnt vmcnt(27)
    v_mfma_f32_32x32x16_bf16 v[16:31], a[20:23], v[48:51], v[16:31]
    buffer_load_dwordx4 v[48:51], v2, s[8:11], s28 offen offset:1024 sc1
    s_waitcnt vmcnt(27)
    v_mfma_f32_32x32x16_bf16 v[16:31], a[24:27], v[52:55], v[16:31]
    buffer_load_dwordx4 v[52:55], v2, s[8:11], s28 offen offset:2048 sc1
    s_waitcnt vmcnt(27)
    v_mfma_f32_32x32x16_bf16 v[16:31], a[28:31], v[56:59], v[16:31]
    buffer_load_dwordx4 v[56:59], v2, s[8:11], s28 offen offset:3072 sc1
    s_waitcnt vmcnt(27)
    v_mfma_f32_32x32x16_bf16 v[16:31], a[32:35], v[60:63], v[16:31]
    s_add_u32 s28, s22, 36864
    buffer_load_dwordx4 v[60:63], v2, s[8:11], s28 offen offset:0 sc1
    s_waitcnt vmcnt(27)
    v_mfma_f32_32x32x16_bf16 v[16:31], a[36:39], v[64:67], v[16:31]
    buffer_load_dwordx4 v[64:67], v2, s[8:11], s28 offen offset:1024 sc1
    s_waitcnt vmcnt(27)
    v_mfma_f32_32x32x16_bf16 v[16:31], a[40:43], v[68:71], v[16:31]
    buffer_load_dwordx4 v[68:71], v2, s[8:11], s28 offen offset:2048 sc1
    s_waitcnt vmcnt(27)
    v_mfma_f32_32x32x16_bf16 v[16:31], a[44:47], v[72:75], v[16:31]
    buffer_load_dwordx4 v[72:75], v2, s[8:11], s28 offen offset:3072 sc1
    s_waitcnt vmcnt(27)
    v_mfma_f32_32x32x16_bf16 v[16:31], a[48:51], v[76:79], v[16:31]
    s_add_u32 s28, s22, 40960
    buffer_load_dwordx4 v[76:79], v2, s[8:11], s28 offen offset:0 sc1
    s_waitcnt vmcnt(27)
    v_mfma_f32_32x32x16_bf16 v[16:31], a[52:55], v[80:83], v[16:31]
    buffer_load_dwordx4 v[80:83], v2, s[8:11], s28 offen offset:1024 sc1
    s_waitcnt vmcnt(27)
    v_mfma_f32_32x32x16_bf16 v[16:31], a[56:59], v[84:87], v[16:31]
    buffer_load_dwordx4 v[84:87], v2, s[8:11], s28 offen offset:2048 sc1
    s_waitcnt vmcnt(27)
    v_mfma_f32_32x32x16_bf16 v[16:31], a[60:63], v[88:91], v[16:31]
    buffer_load_dwordx4 v[88:91], v2, s[8:11], s28 offen offset:3072 sc1
    s_waitcnt vmcnt(27)
    v_mfma_f32_32x32x16_bf16 v[16:31], a[64:67], v[92:95], v[16:31]
    s_add_u32 s28, s22, 45056
    buffer_load_dwordx4 v[92:95], v2, s[8:11], s28 offen offset:0 sc1
    s_waitcnt vmcnt(27)
    v_mfma_f32_32x32x16_bf16 v[16:31], a[68:71], v[96:99], v[16:31]
    buffer_load_dwordx4 v[96:99], v2, s[8:11], s28 offen offset:1024 sc1
    s_waitcnt vmcnt(27)
    v_mfma_f32_32x32x16_bf16 v[16:31], a[72:75], v[100:103], v[16:31]
    buffer_load_dwordx4 v[100:103], v2, s[8:11], s28 offen offset:2048 sc1
    s_waitcnt vmcnt(27)
    v_mfma_f32_32x32x16_bf16 v[16:31], a[76:79], v[104:107], v[16:31]
    buffer_load_dwordx4 v[104:107], v2, s[8:11], s28 offen offset:3072 sc1
    s_waitcnt vmcnt(27)
    v_mfma_f32_32x32x16_bf16 v[16:31], a[80:83], v[108:111], v[16:31]
    s_add_u32 s28, s22, 49152
    buffer_load_dwordx4 v[108:111], v2, s[8:11], s28 offen offset:0 sc1
    s_waitcnt vmcnt(27)
    v_mfma_f32_32x32x16_bf16 v[16:31], a[84:87], v[112:115], v[16:31]
    buffer_load_dwordx4 v[112:115], v2, s[8:11], s28 offen offset:1024 sc1
    s_waitcnt vmcnt(27)
    v_mfma_f32_32x32x16_bf16 v[16:31], a[88:91], v[116:119], v[16:31]
    buffer_load_dwordx4 v[116:119], v2, s[8:11], s28 offen offset:2048 sc1
    s_waitcnt vmcnt(27)
    v_mfma_f32_32x32x16_bf16 v[16:31], a[92:95], v[120:123], v[16:31]
    buffer_load_dwordx4 v[120:123], v2, s[8:11], s28 offen offset:3072 sc1
    s_waitcnt vmcnt(27)
    v_mfma_f32_32x32x16_bf16 v[16:31], a[96:99], v[124:127], v[16:31]
    s_add_u32 s28, s22, 53248
    buffer_load_dwordx4 v[124:127], v2, s[8:11], s28 offen offset:0 sc1
    s_waitcnt vmcnt(27)
    v_mfma_f32_32x32x16_bf16 v[16:31], a[100:103], v[128:131], v[16:31]
    buffer_load_dwordx4 v[128:131], v2, s[8:11], s28 offen offset:1024 sc1
    s_waitcnt vmcnt(27)
    v_mfma_f32_32x32x16_bf16 v[16:31], a[104:107], v[132:135], v[16:31]
    buffer_load_dwordx4 v[132:135], v2, s[8:11], s28 offen offset:2048 sc1
    s_waitcnt vmcnt(27)
    v_mfma_f32_32x32x16_bf16 v[16:31], a[108:111], v[136:139], v[16:31]
    buffer_load_dwordx4 v[136:139], v2, s[8:11], s28 offen offset:3072 sc1
    s_waitcnt vmcnt(27)
    v_mfma_f32_32x32x16_bf16 v[16:31], a[112:115], v[140:143], v[16:31]
    s_add_u32 s28, s22, 57344
    buffer_load_dwordx4 v[140:143], v2, s[8:11], s28 offen offset:0 sc1
    s_waitcnt vmcnt(27)
    v_mfma_f32_32x32x16_bf16 v[16:31], a[116:119], v[32:35], v[16:31]
    buffer_load_dwordx4 v[32:35], v2, s[8:11], s28 offen offset:1024 sc1
    s_waitcnt vmcnt(27)
    v_mfma_f32_32x32x16_bf16 v[16:31], a[120:123], v[36:39], v[16:31]
    buffer_load_dwordx4 v[36:39], v2, s[8:11], s28 offen offset:2048 sc1
    s_waitcnt vmcnt(27)
    v_mfma_f32_32x32x16_bf16 v[16:31], a[124:127], v[40:43], v[16:31]
    buffer_load_dwordx4 v[40:43], v2, s[8:11], s28 offen offset:3072 sc1
    s_waitcnt vmcnt(27)
    v_mfma_f32_32x32x16_bf16 v[16:31], a[128:131], v[44:47], v[16:31]
    s_add_u32 s28, s22, 61440
    buffer_load_dwordx4 v[44:47], v2, s[8:11], s28 offen offset:0 sc1
    s_waitcnt vmcnt(27)
    v_mfma_f32_32x32x16_bf16 v[16:31], a[132:135], v[48:51], v[16:31]
    buffer_load_dwordx4 v[48:51], v2, s[8:11], s28 offen offset:1024 sc1
    s_waitcnt vmcnt(27)
    v_mfma_f32_32x32x16_bf16 v[16:31], a[136:139], v[52:55], v[16:31]
    buffer_load_dwordx4 v[52:55], v2, s[8:11], s28 offen offset:2048 sc1
    s_waitcnt vmcnt(27)
    v_mfma_f32_32x32x16_bf16 v[16:31], a[140:143], v[56:59], v[16:31]
    buffer_load_dwordx4 v[56:59], v2, s[8:11], s28 offen offset:3072 sc1
    s_waitcnt vmcnt(27)
    v_mfma_f32_32x32x16_bf16 v[16:31], a[144:147], v[60:63], v[16:31]
    s_waitcnt vmcnt(26)
    v_mfma_f32_32x32x16_bf16 v[16:31], a[148:151], v[64:67], v[16:31]
    s_waitcnt vmcnt(25)
    v_mfma_f32_32x32x16_bf16 v[16:31], a[152:155], v[68:71], v[16:31]
    s_waitcnt vmcnt(24)
    v_mfma_f32_32x32x16_bf16 v[16:31], a[156:159], v[72:75], v[16:31]
    s_waitcnt vmcnt(23)
    v_mfma_f32_32x32x16_bf16 v[16:31], a[160:163], v[76:79], v[16:31]
    s_waitcnt vmcnt(22)
    v_mfma_f32_32x32x16_bf16 v[16:31], a[164:167], v[80:83], v[16:31]
    s_waitcnt vmcnt(21)
    v_mfma_f32_32x32x16_bf16 v[16:31], a[168:171], v[84:87], v[16:31]
    s_waitcnt vmcnt(20)
    v_mfma_f32_32x32x16_bf16 v[16:31], a[172:175], v[88:91], v[16:31]
    v_min_u32 v146, 63, v144
    v_lshl_add_u32 v146, v146, 7, v145
    s_mov_b32 s29, 1064960
    buffer_load_dword v147, v146, s[8:11], s29 offen sc1
    s_waitcnt vmcnt(20)
    v_mfma_f32_32x32x16_bf16 v[16:31], a[176:179], v[92:95], v[16:31]
    s_waitcnt vmcnt(19)
    v_mfma_f32_32x32x16_bf16 v[16:31], a[180:183], v[96:99], v[16:31]
    s_waitcnt vmcnt(18)
    v_mfma_f32_32x32x16_bf16 v[16:31], a[184:187], v[100:103], v[16:31]
    s_waitcnt vmcnt(17)
    v_mfma_f32_32x32x16_bf16 v[16:31], a[188:191], v[104:107], v[16:31]
    s_waitcnt vmcnt(16)
    v_mfma_f32_32x32x16_bf16 v[16:31], a[192:195], v[108:111], v[16:31]
    s_waitcnt vmcnt(15)
    v_mfma_f32_32x32x16_bf16 v[16:31], a[196:199], v[112:115], v[16:31]
    s_waitcnt vmcnt(14)
    v_mfma_f32_32x32x16_bf16 v[16:31], a[200:203], v[116:119], v[16:31]
    s_waitcnt vmcnt(13)
    v_mfma_f32_32x32x16_bf16 v[16:31], a[204:207], v[120:123], v[16:31]
    s_waitcnt vmcnt(12)
    v_mfma_f32_32x32x16_bf16 v[16:31], a[208:211], v[124:127], v[16:31]
    s_waitcnt vmcnt(11)
    v_mfma_f32_32x32x16_bf16 v[16:31], a[212:215], v[128:131], v[16:31]
    s_waitcnt vmcnt(10)
    v_mfma_f32_32x32x16_bf16 v[16:31], a[216:219], v[132:135], v[16:31]
    s_waitcnt vmcnt(9)
    v_mfma_f32_32x32x16_bf16 v[16:31], a[220:223], v[136:139], v[16:31]
    s_waitcnt vmcnt(8)
    v_mfma_f32_32x32x16_bf16 v[16:31], a[224:227], v[140:143], v[16:31]
    s_waitcnt vmcnt(7)
    v_mfma_f32_32x32x16_bf16 v[16:31], a[228:231], v[32:35], v[16:31]
    s_waitcnt vmcnt(6)
    v_mfma_f32_32x32x16_bf16 v[16:31], a[232:235], v[36:39], v[16:31]
    s_waitcnt vmcnt(5)
    v_mfma_f32_32x32x16_bf16 v[16:31], a[236:239], v[40:43], v[16:31]
    s_waitcnt vmcnt(4)
    v_mfma_f32_32x32x16_bf16 v[16:31], a[240:243], v[44:47], v[16:31]
    s_waitcnt vmcnt(3)
    v_mfma_f32_32x32x16_bf16 v[16:31], a[244:247], v[48:51], v[16:31]
    s_waitcnt vmcnt(2)
    v_mfma_f32_32x32x16_bf16 v[16:31], a[248:251], v[52:55], v[16:31]
    s_waitcnt vmcnt(1)
    v_mfma_f32_32x32x16_bf16 v[16:31], a[252:255], v[56:59], v[16:31]
O_JOIN:
    s_barrier
    s_nop 10
    ds_write_b128 v5, v[16:19] offset:0
    ds_write_b128 v5, v[20:23] offset:1024
    ds_write_b128 v5, v[24:27] offset:2048
    ds_write_b128 v5, v[28:31] offset:3072
    s_waitcnt vmcnt(0)
    v_lshl_or_b32 v146, v147, 16, v144
    ds_write_b32 v5, v146 offset:32768
    s_waitcnt lgkmcnt(0)
    s_barrier
    v_mov_b32 v14, 0
    ds_read_b128 v[32:35], v6 offset:0
    ds_read_b128 v[36:39], v6 offset:4096
    ds_read_b128 v[40:43], v6 offset:8192
    ds_read_b128 v[44:47], v6 offset:12288
    ds_read_b32 v15, v14 offset:32768
    v_lshlrev_b32 v10, 16, v8
    v_and_b32 v11, 0xffff0000, v8
    v_lshlrev_b32 v12, 16, v9
    v_and_b32 v13, 0xffff0000, v9
    s_waitcnt lgkmcnt(4)
    v_add_f32 v10, v10, v32
    v_add_f32 v11, v11, v33
    v_add_f32 v12, v12, v34
    v_add_f32 v13, v13, v35
    s_waitcnt lgkmcnt(3)
    v_add_f32 v10, v10, v36
    v_add_f32 v11, v11, v37
    v_add_f32 v12, v12, v38
    v_add_f32 v13, v13, v39
    s_waitcnt lgkmcnt(2)
    v_add_f32 v10, v10, v40
    v_add_f32 v11, v11, v41
    v_add_f32 v12, v12, v42
    v_add_f32 v13, v13, v43
    s_waitcnt lgkmcnt(1)
    v_add_f32 v10, v10, v44
    v_add_f32 v11, v11, v45
    v_add_f32 v12, v12, v46
    v_add_f32 v13, v13, v47
    v_cvt_pk_bf16_f32 v10, v10, v11
    v_cvt_pk_bf16_f32 v11, v12, v13
    buffer_store_dwordx2 v[10:11], v7, s[92:95], s23 offen
    s_waitcnt lgkmcnt(0)
    v_readfirstlane_b32 s19, v15
    s_mov_b32 s30, s20
    s_and_b32 s20, s19, 0xffff
    s_lshr_b32 s19, s19, 19
    s_branch K_ON
K_END:
T_EXIT:
    s_endpgm
K_TEAM:
    s_load_dwordx2 s[92:93], s[0:1], 40
    s_mov_b32 s94, 5242880
    s_mov_b32 s95, 0x20000
    s_waitcnt lgkmcnt(0)
    s_barrier
    s_and_b32 s20, s18, 1
    s_lshr_b32 s18, s18, 1
    s_lshl_b32 s28, s19, 4
    s_add_u32 s18, s18, s28
    v_and_b32 v20, 63, v0
    v_lshrrev_b32 v21, 4, v20
    v_and_b32 v22, 15, v20
    v_and_b32 v23, 7, v20
    v_lshrrev_b32 v24, 1, v21
    v_and_b32 v25, 1, v21
    v_bfe_u32 v26, v20, 3, 1
    v_bfe_u32 v27, v20, 2, 1
    v_lshlrev_b32 v6, 4, v20
    s_xor_b32 s28, s17, 0
    s_lshl_b32 s28, s28, 10
    v_add_u32 v2, s28, v6
    s_xor_b32 s28, s17, 1
    s_lshl_b32 s28, s28, 10
    v_add_u32 v3, s28, v6
    s_xor_b32 s28, s17, 2
    s_lshl_b32 s28, s28, 10
    v_add_u32 v4, s28, v6
    s_xor_b32 s28, s17, 3
    s_lshl_b32 s28, s28, 10
    v_add_u32 v5, s28, v6
    s_lshr_b32 s28, s17, 1
    s_lshl_b32 s28, s28, 10
    s_and_b32 s29, s17, 1
    s_lshl_b32 s29, s29, 3
    s_add_u32 s28, s28, s29
    v_add_u32 v7, s28, v6
    v_mov_b32 v29, 0x8888
    v_mov_b32 v31, 0xdddd
    v_cmp_eq_u32 vcc, 1, v26
    s_nop 1
    v_cndmask_b32 v8, v29, v31, vcc
    v_lshlrev_b32 v28, 4, v22
    v_mul_u32_u24 v29, 288, v24
    v_add_u32 v28, v28, v29
    v_xor_b32 v29, v25, v26
    v_lshl_add_u32 v28, v29, 3, v28
    s_mul_i32 s28, s17, 576
    s_add_u32 s28, s28, 20480
    v_add_u32 v9, s28, v28
    v_lshlrev_b32 v28, 2, v21
    v_add_u32 v30, v28, v26
    v_lshlrev_b32 v28, 4, v30
    v_mul_u32_u24 v29, 288, v27
    v_add_u32 v28, v28, v29
    v_and_b32 v29, 1, v20
    v_xor_b32 v29, v29, v24
    v_lshl_add_u32 v28, v29, 3, v28
    v_add_u32 v10, 20480, v28
    s_lshl_b32 s28, s18, 1
    s_add_u32 s28, s28, s20
    s_lshl_b32 s28, s28, 2
    s_add_u32 s28, s28, s17
    s_mul_i32 s50, s28, 81920
    s_add_u32 s50, s50, 67108864
    s_lshl_b32 s39, s18, 13
    s_lshl_b32 s29, s17, 11
    s_add_u32 s39, s39, s29
    s_add_u32 s39, s39, 4194304
    s_lshl_b32 s38, s18, 14
    s_add_u32 s38, s38, 33554432
    s_lshl_b32 s48, s18, 11
    s_add_u32 s48, s48, 393216
    s_lshl_b32 s51, s19, 17
    s_add_u32 s51, s51, 525312
    s_xor_b32 s21, s19, 1
    s_lshl_b32 s21, s21, 17
    s_add_u32 s21, s21, 786432
    s_sub_u32 s28, s21, s51
    v_mul_lo_u32 v28, s28, v24
    v_and_b32 v29, 0x1ff, v6
    v_add_u32 v182, v28, v29
    s_lshl_b32 s36, s17, 10
    s_lshl_b32 s37, s17, 9
    s_add_u32 s37, s37, 16384
    s_mov_b32 s30, 0
    s_mov_b32 s31, 0
    s_and_b32 s22, s18, 15
    s_mul_i32 s23, s19, 0x30000
    s_mov_b32 s76, s23
    s_mul_i32 s24, s17, 1
    s_mul_i32 s25, s22, 4
    s_add_u32 s24, s24, s25
    s_and_b32 s24, s24, 63
    s_mul_i32 s25, s17, 0
    s_add_u32 s24, s24, s25
    s_add_u32 s25, s22, 64
    s_cmp_eq_u32 s17, 0
    s_cselect_b32 s63, 1, 0
    s_lshl_b32 s60, s24, 11
    s_add_u32 s23, s23, 20971520
    s_add_u32 s60, s60, s23
    s_lshl_b32 s66, s25, 11
    s_add_u32 s66, s66, s23
    s_lshl_b32 s67, s24, 7
    s_lshl_b32 s68, s25, 7
    s_add_u32 s68, s68, 8192
    s_add_u32 s69, s51, 261120
    v_and_b32 v29, 3, v22
    v_lshl_add_u32 v32, v25, 2, v29
    v_lshlrev_b32 v32, 4, v32
    v_lshl_add_u32 v32, v27, 3, v32
    v_lshl_add_u32 v191, v24, 2, v32
    s_cmp_eq_u32 s20, 1
    s_cbranch_scc1 K_VO
    v_lshrrev_b32 v28, 2, v22
    v_xor_b32 v28, v28, v21
    v_lshlrev_b32 v28, 3, v28
    v_lshl_add_u32 v28, v22, 5, v28
    s_mul_i32 s28, s17, 1152
    s_add_u32 s28, s28, 23040
    v_add_u32 v14, s28, v28
    v_and_b32 v28, 3, v20
    v_xor_b32 v28, v28, v21
    v_lshlrev_b32 v28, 3, v28
    v_lshl_add_u32 v28, v30, 5, v28
    v_mul_u32_u24 v29, 576, v27
    v_add_u32 v28, v28, v29
    v_add_u32 v15, 23040, v28
    v_lshlrev_b32 v28, 8, v24
    v_lshl_add_u32 v28, v23, 4, v28
    v_lshl_add_u32 v28, v25, 3, v28
    s_lshl_b32 s28, s17, 7
    v_add_u32 v28, s28, v28
    v_lshlrev_b32 v29, 6, v25
    v_lshl_add_u32 v29, v23, 3, v29
    v_lshl_add_u32 v29, v24, 2, v29
    v_add_u32 v29, 512, v29
    s_cmp_lt_u32 s17, 2
    s_cselect_b64 vcc, -1, 0
    v_cndmask_b32 v1, v29, v28, vcc
    s_mov_b32 s64, 0x3e0293ee
    s_mov_b32 s65, 0x42200000
    s_and_b32 s28, s17, 1
    s_lshl_b32 s28, s28, 12
    s_add_u32 s38, s38, s28
    v_lshrrev_b32 v31, 1, v23
    v_and_b32 v32, 1, v20
    v_lshlrev_b32 v32, 4, v32
    v_mov_b32 v33, 0x3f80
    v_lshlrev_b32 v33, v32, v33
    v_cmp_eq_u32 vcc, 0, v31
    s_nop 1
    v_cndmask_b32 v184, 0, v33, vcc
    v_cmp_eq_u32 vcc, 1, v31
    s_nop 1
    v_cndmask_b32 v185, 0, v33, vcc
    v_cmp_eq_u32 vcc, 2, v31
    s_nop 1
    v_cndmask_b32 v186, 0, v33, vcc
    v_cmp_eq_u32 vcc, 3, v31
    s_nop 1
    v_cndmask_b32 v187, 0, v33, vcc
    v_cmp_eq_u32 vcc, v25, v26
    s_nop 1
    v_cndmask_b32 v184, 0, v184, vcc
    v_cndmask_b32 v185, 0, v185, vcc
    v_cndmask_b32 v186, 0, v186, vcc
    v_cndmask_b32 v187, 0, v187, vcc
    v_lshrrev_b32 v31, 1, v23
    v_and_b32 v32, 1, v20
    v_lshlrev_b32 v32, 4, v32
    v_mov_b32 v33, 0x3f80
    v_lshlrev_b32 v33, v32, v33
    v_cmp_eq_u32 vcc, 0, v31
    s_nop 1
    v_cndmask_b32 v148, 0, v33, vcc
    v_cmp_eq_u32 vcc, 1, v31
    s_nop 1
    v_cndmask_b32 v149, 0, v33, vcc
    v_cmp_eq_u32 vcc, 2, v31
    s_nop 1
    v_cndmask_b32 v150, 0, v33, vcc
    v_cmp_eq_u32 vcc, 3, v31
    s_nop 1
    v_cndmask_b32 v151, 0, v33, vcc
    v_mov_b64 v[36:37], -1
    v_mov_b64 v[38:39], -1
    v_mov_b32 v40, 0
    v_mov_b32 v41, 1
    v_lshlrev_b32 v44, 13, v21
    v_lshl_add_u32 v44, v22, 4, v44
    v_lshlrev_b32 v52, 4, v25
    v_add_u32 v52, v52, v24
    v_lshlrev_b32 v52, 8, v52
    v_lshl_add_u32 v52, v22, 2, v52
    s_lshl_b32 s28, s17, 6
    v_add_u32 v52, s28, v52
    v_mul_u32_u24 v45, 5120, v21
    v_lshl_add_u32 v45, v22, 2, v45
    s_mul_i32 s28, s17, 320
    v_add_u32 v45, s28, v45
    s_lshl_b32 s40, s18, 8
    s_and_b32 s29, s17, 1
    s_mul_i32 s42, s29, 2621440
    s_add_u32 s42, s42, s40
    s_lshr_b32 s29, s17, 1
    s_mul_i32 s43, s29, 262144
    s_add_u32 s43, s43, s42
    s_mul_i32 s44, s29, 1310720
    s_add_u32 s44, s44, s42
    s_mul_i32 s41, s18, 163840
    s_mul_i32 s28, s17, 10240
    s_add_u32 s41, s41, s28
    s_lshl_b32 s45, s17, 14
    s_mov_b32 s46, 0x05040100
    s_mov_b32 s47, 0x07060302
    s_mov_b32 s75, 0x20000
    s_mov_b32 s74, 5242880
    s_cmp_lt_u32 s17, 2
    s_cselect_b64 s[72:73], s[80:81], s[84:85]
    s_xor_b32 s28, s17, 0
    s_lshl_b32 s28, s28, 14
    v_add_u32 v48, s28, v52
    s_xor_b32 s28, s17, 1
    s_lshl_b32 s28, s28, 14
    v_add_u32 v49, s28, v52
    s_xor_b32 s28, s17, 2
    s_lshl_b32 s28, s28, 14
    v_add_u32 v50, s28, v52
    s_xor_b32 s28, s17, 3
    s_lshl_b32 s28, s28, 14
    v_add_u32 v51, s28, v52
    s_add_u32 m0, s45, 0
    s_add_u32 s28, s43, 0
    buffer_load_dwordx4 v44, s[80:83], s28 offen offset:0 lds
    s_add_u32 s28, s43, 31744
    buffer_load_dwordx4 v44, s[80:83], s28 offen offset:1024 lds
    s_add_u32 s28, s43, 63488
    buffer_load_dwordx4 v44, s[80:83], s28 offen offset:2048 lds
    s_add_u32 s28, s43, 95232
    buffer_load_dwordx4 v44, s[80:83], s28 offen offset:3072 lds
    s_add_u32 m0, s45, 4096
    s_add_u32 s28, s43, 131072
    buffer_load_dwordx4 v44, s[80:83], s28 offen offset:0 lds
    s_add_u32 s28, s43, 162816
    buffer_load_dwordx4 v44, s[80:83], s28 offen offset:1024 lds
    s_add_u32 s28, s43, 194560
    buffer_load_dwordx4 v44, s[80:83], s28 offen offset:2048 lds
    s_add_u32 s28, s43, 226304
    buffer_load_dwordx4 v44, s[80:83], s28 offen offset:3072 lds
    s_add_u32 m0, s45, 8192
    s_add_u32 s28, s43, 1310720
    buffer_load_dwordx4 v44, s[80:83], s28 offen offset:0 lds
    s_add_u32 s28, s43, 1342464
    buffer_load_dwordx4 v44, s[80:83], s28 offen offset:1024 lds
    s_add_u32 s28, s43, 1374208
    buffer_load_dwordx4 v44, s[80:83], s28 offen offset:2048 lds
    s_add_u32 s28, s43, 1405952
    buffer_load_dwordx4 v44, s[80:83], s28 offen offset:3072 lds
    s_add_u32 m0, s45, 12288
    s_add_u32 s28, s43, 1441792
    buffer_load_dwordx4 v44, s[80:83], s28 offen offset:0 lds
    s_add_u32 s28, s43, 1473536
    buffer_load_dwordx4 v44, s[80:83], s28 offen offset:1024 lds
    s_add_u32 s28, s43, 1505280
    buffer_load_dwordx4 v44, s[80:83], s28 offen offset:2048 lds
    s_add_u32 s28, s43, 1537024
    buffer_load_dwordx4 v44, s[80:83], s28 offen offset:3072 lds
    s_add_u32 m0, s45, 65536
    s_add_u32 s28, s43, 0
    buffer_load_dwordx4 v44, s[84:87], s28 offen offset:0 lds
    s_add_u32 s28, s43, 31744
    buffer_load_dwordx4 v44, s[84:87], s28 offen offset:1024 lds
    s_add_u32 s28, s43, 63488
    buffer_load_dwordx4 v44, s[84:87], s28 offen offset:2048 lds
    s_add_u32 s28, s43, 95232
    buffer_load_dwordx4 v44, s[84:87], s28 offen offset:3072 lds
    s_add_u32 m0, s45, 69632
    s_add_u32 s28, s43, 131072
    buffer_load_dwordx4 v44, s[84:87], s28 offen offset:0 lds
    s_add_u32 s28, s43, 162816
    buffer_load_dwordx4 v44, s[84:87], s28 offen offset:1024 lds
    s_add_u32 s28, s43, 194560
    buffer_load_dwordx4 v44, s[84:87], s28 offen offset:2048 lds
    s_add_u32 s28, s43, 226304
    buffer_load_dwordx4 v44, s[84:87], s28 offen offset:3072 lds
    s_add_u32 m0, s45, 73728
    s_add_u32 s28, s43, 1310720
    buffer_load_dwordx4 v44, s[84:87], s28 offen offset:0 lds
    s_add_u32 s28, s43, 1342464
    buffer_load_dwordx4 v44, s[84:87], s28 offen offset:1024 lds
    s_add_u32 s28, s43, 1374208
    buffer_load_dwordx4 v44, s[84:87], s28 offen offset:2048 lds
    s_add_u32 s28, s43, 1405952
    buffer_load_dwordx4 v44, s[84:87], s28 offen offset:3072 lds
    s_add_u32 m0, s45, 77824
    s_add_u32 s28, s43, 1441792
    buffer_load_dwordx4 v44, s[84:87], s28 offen offset:0 lds
    s_add_u32 s28, s43, 1473536
    buffer_load_dwordx4 v44, s[84:87], s28 offen offset:1024 lds
    s_add_u32 s28, s43, 1505280
    buffer_load_dwordx4 v44, s[84:87], s28 offen offset:2048 lds
    s_add_u32 s28, s43, 1537024
    buffer_load_dwordx4 v44, s[84:87], s28 offen offset:3072 lds
    s_waitcnt vmcnt(16)
    s_barrier
    s_cmp_eq_u32 s17, 0
    s_cbranch_scc0 TQ_SKA
    s_mov_b64 exec, 1
    global_atomic_add v42, v40, v41, s[4:5] offset:12 sc0
    s_mov_b64 exec, -1
TQ_SKA:
    ds_read2st64_b32 v[76:77], v48 offset0:0 offset1:32
    ds_read2st64_b32 v[78:79], v48 offset0:2 offset1:34
    ds_read2st64_b32 v[80:81], v48 offset0:4 offset1:36
    ds_read2st64_b32 v[82:83], v48 offset0:6 offset1:38
    ds_read2st64_b32 v[84:85], v48 offset0:8 offset1:40
    ds_read2st64_b32 v[86:87], v48 offset0:10 offset1:42
    ds_read2st64_b32 v[88:89], v48 offset0:12 offset1:44
    ds_read2st64_b32 v[90:91], v48 offset0:14 offset1:46
    ds_read2st64_b32 v[100:101], v49 offset0:0 offset1:32
    ds_read2st64_b32 v[102:103], v49 offset0:2 offset1:34
    ds_read2st64_b32 v[104:105], v49 offset0:4 offset1:36
    ds_read2st64_b32 v[106:107], v49 offset0:6 offset1:38
    ds_read2st64_b32 v[108:109], v49 offset0:8 offset1:40
    ds_read2st64_b32 v[110:111], v49 offset0:10 offset1:42
    ds_read2st64_b32 v[112:113], v49 offset0:12 offset1:44
    ds_read2st64_b32 v[114:115], v49 offset0:14 offset1:46
    ds_read2st64_b32 v[132:133], v50 offset0:0 offset1:32
    ds_read2st64_b32 v[134:135], v50 offset0:2 offset1:34
    ds_read2st64_b32 v[136:137], v50 offset0:4 offset1:36
    ds_read2st64_b32 v[138:139], v50 offset0:6 offset1:38
    ds_read2st64_b32 v[140:141], v50 offset0:8 offset1:40
    ds_read2st64_b32 v[142:143], v50 offset0:10 offset1:42
    ds_read2st64_b32 v[144:145], v50 offset0:12 offset1:44
    ds_read2st64_b32 v[146:147], v50 offset0:14 offset1:46
    ds_read2st64_b32 v[160:161], v51 offset0:0 offset1:32
    ds_read2st64_b32 v[162:163], v51 offset0:2 offset1:34
    ds_read2st64_b32 v[164:165], v51 offset0:4 offset1:36
    ds_read2st64_b32 v[166:167], v51 offset0:6 offset1:38
    ds_read2st64_b32 v[168:169], v51 offset0:8 offset1:40
    ds_read2st64_b32 v[170:171], v51 offset0:10 offset1:42
    ds_read2st64_b32 v[172:173], v51 offset0:12 offset1:44
    ds_read2st64_b32 v[174:175], v51 offset0:14 offset1:46
    s_waitcnt lgkmcnt(15)
    v_perm_b32 v46, v77, v76, s46
    v_perm_b32 v47, v77, v76, s47
    v_accvgpr_write_b32 a0, v46
    v_accvgpr_write_b32 a8, v47
    v_perm_b32 v46, v79, v78, s46
    v_perm_b32 v47, v79, v78, s47
    v_accvgpr_write_b32 a1, v46
    v_accvgpr_write_b32 a9, v47
    v_perm_b32 v46, v81, v80, s46
    v_perm_b32 v47, v81, v80, s47
    v_accvgpr_write_b32 a2, v46
    v_accvgpr_write_b32 a10, v47
    v_perm_b32 v46, v83, v82, s46
    v_perm_b32 v47, v83, v82, s47
    v_accvgpr_write_b32 a3, v46
    v_accvgpr_write_b32 a11, v47
    v_perm_b32 v46, v85, v84, s46
    v_perm_b32 v47, v85, v84, s47
    v_accvgpr_write_b32 a4, v46
    v_accvgpr_write_b32 a12, v47
    v_perm_b32 v46, v87, v86, s46
    v_perm_b32 v47, v87, v86, s47
    v_accvgpr_write_b32 a5, v46
    v_accvgpr_write_b32 a13, v47
    v_perm_b32 v46, v89, v88, s46
    v_perm_b32 v47, v89, v88, s47
    v_accvgpr_write_b32 a6, v46
    v_accvgpr_write_b32 a14, v47
    v_perm_b32 v46, v91, v90, s46
    v_perm_b32 v47, v91, v90, s47
    v_accvgpr_write_b32 a7, v46
    v_accvgpr_write_b32 a15, v47
    v_perm_b32 v46, v101, v100, s46
    v_perm_b32 v47, v101, v100, s47
    v_accvgpr_write_b32 a32, v46
    v_accvgpr_write_b32 a40, v47
    v_perm_b32 v46, v103, v102, s46
    v_perm_b32 v47, v103, v102, s47
    v_accvgpr_write_b32 a33, v46
    v_accvgpr_write_b32 a41, v47
    v_perm_b32 v46, v105, v104, s46
    v_perm_b32 v47, v105, v104, s47
    v_accvgpr_write_b32 a34, v46
    v_accvgpr_write_b32 a42, v47
    v_perm_b32 v46, v107, v106, s46
    v_perm_b32 v47, v107, v106, s47
    v_accvgpr_write_b32 a35, v46
    v_accvgpr_write_b32 a43, v47
    v_perm_b32 v46, v109, v108, s46
    v_perm_b32 v47, v109, v108, s47
    v_accvgpr_write_b32 a36, v46
    v_accvgpr_write_b32 a44, v47
    v_perm_b32 v46, v111, v110, s46
    v_perm_b32 v47, v111, v110, s47
    v_accvgpr_write_b32 a37, v46
    v_accvgpr_write_b32 a45, v47
    v_perm_b32 v46, v113, v112, s46
    v_perm_b32 v47, v113, v112, s47
    v_accvgpr_write_b32 a38, v46
    v_accvgpr_write_b32 a46, v47
    v_perm_b32 v46, v115, v114, s46
    v_perm_b32 v47, v115, v114, s47
    v_accvgpr_write_b32 a39, v46
    v_accvgpr_write_b32 a47, v47
    v_perm_b32 v46, v133, v132, s46
    v_perm_b32 v47, v133, v132, s47
    v_accvgpr_write_b32 a64, v46
    v_accvgpr_write_b32 a72, v47
    s_waitcnt lgkmcnt(14)
    v_perm_b32 v46, v135, v134, s46
    v_perm_b32 v47, v135, v134, s47
    v_accvgpr_write_b32 a65, v46
    v_accvgpr_write_b32 a73, v47
    s_waitcnt lgkmcnt(13)
    v_perm_b32 v46, v137, v136, s46
    v_perm_b32 v47, v137, v136, s47
    v_accvgpr_write_b32 a66, v46
    v_accvgpr_write_b32 a74, v47
    s_waitcnt lgkmcnt(12)
    v_perm_b32 v46, v139, v138, s46
    v_perm_b32 v47, v139, v138, s47
    v_accvgpr_write_b32 a67, v46
    v_accvgpr_write_b32 a75, v47
    s_waitcnt lgkmcnt(11)
    v_perm_b32 v46, v141, v140, s46
    v_perm_b32 v47, v141, v140, s47
    v_accvgpr_write_b32 a68, v46
    v_accvgpr_write_b32 a76, v47
    s_waitcnt lgkmcnt(10)
    v_perm_b32 v46, v143, v142, s46
    v_perm_b32 v47, v143, v142, s47
    v_accvgpr_write_b32 a69, v46
    v_accvgpr_write_b32 a77, v47
    s_waitcnt lgkmcnt(9)
    v_perm_b32 v46, v145, v144, s46
    v_perm_b32 v47, v145, v144, s47
    v_accvgpr_write_b32 a70, v46
    v_accvgpr_write_b32 a78, v47
    s_waitcnt lgkmcnt(8)
    v_perm_b32 v46, v147, v146, s46
    v_perm_b32 v47, v147, v146, s47
    v_accvgpr_write_b32 a71, v46
    v_accvgpr_write_b32 a79, v47
    s_waitcnt lgkmcnt(7)
    v_perm_b32 v46, v161, v160, s46
    v_perm_b32 v47, v161, v160, s47
    v_accvgpr_write_b32 a96, v46
    v_accvgpr_write_b32 a104, v47
    s_waitcnt lgkmcnt(6)
    v_perm_b32 v46, v163, v162, s46
    v_perm_b32 v47, v163, v162, s47
    v_accvgpr_write_b32 a97, v46
    v_accvgpr_write_b32 a105, v47
    s_waitcnt lgkmcnt(5)
    v_perm_b32 v46, v165, v164, s46
    v_perm_b32 v47, v165, v164, s47
    v_accvgpr_write_b32 a98, v46
    v_accvgpr_write_b32 a106, v47
    s_waitcnt lgkmcnt(4)
    v_perm_b32 v46, v167, v166, s46
    v_perm_b32 v47, v167, v166, s47
    v_accvgpr_write_b32 a99, v46
    v_accvgpr_write_b32 a107, v47
    s_waitcnt lgkmcnt(3)
    v_perm_b32 v46, v169, v168, s46
    v_perm_b32 v47, v169, v168, s47
    v_accvgpr_write_b32 a100, v46
    v_accvgpr_write_b32 a108, v47
    s_waitcnt lgkmcnt(2)
    v_perm_b32 v46, v171, v170, s46
    v_perm_b32 v47, v171, v170, s47
    v_accvgpr_write_b32 a101, v46
    v_accvgpr_write_b32 a109, v47
    s_waitcnt lgkmcnt(1)
    v_perm_b32 v46, v173, v172, s46
    v_perm_b32 v47, v173, v172, s47
    v_accvgpr_write_b32 a102, v46
    v_accvgpr_write_b32 a110, v47
    s_waitcnt lgkmcnt(0)
    v_perm_b32 v46, v175, v174, s46
    v_perm_b32 v47, v175, v174, s47
    v_accvgpr_write_b32 a103, v46
    v_accvgpr_write_b32 a111, v47
    s_waitcnt lgkmcnt(0)
    s_barrier
    s_add_u32 m0, s45, 0
    s_add_u32 s28, s43, 524288
    buffer_load_dwordx4 v44, s[80:83], s28 offen offset:0 lds
    s_add_u32 s28, s43, 556032
    buffer_load_dwordx4 v44, s[80:83], s28 offen offset:1024 lds
    s_add_u32 s28, s43, 587776
    buffer_load_dwordx4 v44, s[80:83], s28 offen offset:2048 lds
    s_add_u32 s28, s43, 619520
    buffer_load_dwordx4 v44, s[80:83], s28 offen offset:3072 lds
    s_add_u32 m0, s45, 4096
    s_add_u32 s28, s43, 655360
    buffer_load_dwordx4 v44, s[80:83], s28 offen offset:0 lds
    s_add_u32 s28, s43, 687104
    buffer_load_dwordx4 v44, s[80:83], s28 offen offset:1024 lds
    s_add_u32 s28, s43, 718848
    buffer_load_dwordx4 v44, s[80:83], s28 offen offset:2048 lds
    s_add_u32 s28, s43, 750592
    buffer_load_dwordx4 v44, s[80:83], s28 offen offset:3072 lds
    s_add_u32 m0, s45, 8192
    s_add_u32 s28, s43, 1835008
    buffer_load_dwordx4 v44, s[80:83], s28 offen offset:0 lds
    s_add_u32 s28, s43, 1866752
    buffer_load_dwordx4 v44, s[80:83], s28 offen offset:1024 lds
    s_add_u32 s28, s43, 1898496
    buffer_load_dwordx4 v44, s[80:83], s28 offen offset:2048 lds
    s_add_u32 s28, s43, 1930240
    buffer_load_dwordx4 v44, s[80:83], s28 offen offset:3072 lds
    s_add_u32 m0, s45, 12288
    s_add_u32 s28, s43, 1966080
    buffer_load_dwordx4 v44, s[80:83], s28 offen offset:0 lds
    s_add_u32 s28, s43, 1997824
    buffer_load_dwordx4 v44, s[80:83], s28 offen offset:1024 lds
    s_add_u32 s28, s43, 2029568
    buffer_load_dwordx4 v44, s[80:83], s28 offen offset:2048 lds
    s_add_u32 s28, s43, 2061312
    buffer_load_dwordx4 v44, s[80:83], s28 offen offset:3072 lds
    v_xor_b32 v45, 0x10000, v45
    v_xor_b32 v48, 0x10000, v48
    v_xor_b32 v49, 0x10000, v49
    v_xor_b32 v50, 0x10000, v50
    v_xor_b32 v51, 0x10000, v51
    v_xor_b32 v52, 0x10000, v52
    s_waitcnt vmcnt(16)
    s_barrier
    s_cmp_eq_u32 s17, 0
    s_cbranch_scc0 TQ_SKB
    v_readfirstlane_b32 s28, v42
    s_nop 0
    s_cmp_eq_u32 s28, 63
    s_cbranch_scc0 TQ_SKB
    s_mov_b64 exec, 1
    global_load_dwordx2 v[42:43], v40, s[4:5] sc1
    s_waitcnt vmcnt(0)
    v_min_u32 v42, v42, v43
    v_min_u32 v42, 32, v42
    v_add_u32 v42, 1, v42
    global_store_dword v40, v42, s[4:5] offset:140 sc1
    s_mov_b64 exec, -1
TQ_SKB:
    ds_read2st64_b32 v[76:77], v48 offset0:0 offset1:32
    ds_read2st64_b32 v[78:79], v48 offset0:2 offset1:34
    ds_read2st64_b32 v[80:81], v48 offset0:4 offset1:36
    ds_read2st64_b32 v[82:83], v48 offset0:6 offset1:38
    ds_read2st64_b32 v[84:85], v48 offset0:8 offset1:40
    ds_read2st64_b32 v[86:87], v48 offset0:10 offset1:42
    ds_read2st64_b32 v[88:89], v48 offset0:12 offset1:44
    ds_read2st64_b32 v[90:91], v48 offset0:14 offset1:46
    ds_read2st64_b32 v[100:101], v49 offset0:0 offset1:32
    ds_read2st64_b32 v[102:103], v49 offset0:2 offset1:34
    ds_read2st64_b32 v[104:105], v49 offset0:4 offset1:36
    ds_read2st64_b32 v[106:107], v49 offset0:6 offset1:38
    ds_read2st64_b32 v[108:109], v49 offset0:8 offset1:40
    ds_read2st64_b32 v[110:111], v49 offset0:10 offset1:42
    ds_read2st64_b32 v[112:113], v49 offset0:12 offset1:44
    ds_read2st64_b32 v[114:115], v49 offset0:14 offset1:46
    ds_read2st64_b32 v[132:133], v50 offset0:0 offset1:32
    ds_read2st64_b32 v[134:135], v50 offset0:2 offset1:34
    ds_read2st64_b32 v[136:137], v50 offset0:4 offset1:36
    ds_read2st64_b32 v[138:139], v50 offset0:6 offset1:38
    ds_read2st64_b32 v[140:141], v50 offset0:8 offset1:40
    ds_read2st64_b32 v[142:143], v50 offset0:10 offset1:42
    ds_read2st64_b32 v[144:145], v50 offset0:12 offset1:44
    ds_read2st64_b32 v[146:147], v50 offset0:14 offset1:46
    ds_read2st64_b32 v[160:161], v51 offset0:0 offset1:32
    ds_read2st64_b32 v[162:163], v51 offset0:2 offset1:34
    ds_read2st64_b32 v[164:165], v51 offset0:4 offset1:36
    ds_read2st64_b32 v[166:167], v51 offset0:6 offset1:38
    ds_read2st64_b32 v[168:169], v51 offset0:8 offset1:40
    ds_read2st64_b32 v[170:171], v51 offset0:10 offset1:42
    ds_read2st64_b32 v[172:173], v51 offset0:12 offset1:44
    ds_read2st64_b32 v[174:175], v51 offset0:14 offset1:46
    s_waitcnt lgkmcnt(15)
    v_perm_b32 v46, v77, v76, s46
    v_perm_b32 v47, v77, v76, s47
    v_accvgpr_write_b32 a16, v46
    v_accvgpr_write_b32 a24, v47
    v_perm_b32 v46, v79, v78, s46
    v_perm_b32 v47, v79, v78, s47
    v_accvgpr_write_b32 a17, v46
    v_accvgpr_write_b32 a25, v47
    v_perm_b32 v46, v81, v80, s46
    v_perm_b32 v47, v81, v80, s47
    v_accvgpr_write_b32 a18, v46
    v_accvgpr_write_b32 a26, v47
    v_perm_b32 v46, v83, v82, s46
    v_perm_b32 v47, v83, v82, s47
    v_accvgpr_write_b32 a19, v46
    v_accvgpr_write_b32 a27, v47
    v_perm_b32 v46, v85, v84, s46
    v_perm_b32 v47, v85, v84, s47
    v_accvgpr_write_b32 a20, v46
    v_accvgpr_write_b32 a28, v47
    v_perm_b32 v46, v87, v86, s46
    v_perm_b32 v47, v87, v86, s47
    v_accvgpr_write_b32 a21, v46
    v_accvgpr_write_b32 a29, v47
    v_perm_b32 v46, v89, v88, s46
    v_perm_b32 v47, v89, v88, s47
    v_accvgpr_write_b32 a22, v46
    v_accvgpr_write_b32 a30, v47
    v_perm_b32 v46, v91, v90, s46
    v_perm_b32 v47, v91, v90, s47
    v_accvgpr_write_b32 a23, v46
    v_accvgpr_write_b32 a31, v47
    v_perm_b32 v46, v101, v100, s46
    v_perm_b32 v47, v101, v100, s47
    v_accvgpr_write_b32 a48, v46
    v_accvgpr_write_b32 a56, v47
    v_perm_b32 v46, v103, v102, s46
    v_perm_b32 v47, v103, v102, s47
    v_accvgpr_write_b32 a49, v46
    v_accvgpr_write_b32 a57, v47
    v_perm_b32 v46, v105, v104, s46
    v_perm_b32 v47, v105, v104, s47
    v_accvgpr_write_b32 a50, v46
    v_accvgpr_write_b32 a58, v47
    v_perm_b32 v46, v107, v106, s46
    v_perm_b32 v47, v107, v106, s47
    v_accvgpr_write_b32 a51, v46
    v_accvgpr_write_b32 a59, v47
    v_perm_b32 v46, v109, v108, s46
    v_perm_b32 v47, v109, v108, s47
    v_accvgpr_write_b32 a52, v46
    v_accvgpr_write_b32 a60, v47
    v_perm_b32 v46, v111, v110, s46
    v_perm_b32 v47, v111, v110, s47
    v_accvgpr_write_b32 a53, v46
    v_accvgpr_write_b32 a61, v47
    v_perm_b32 v46, v113, v112, s46
    v_perm_b32 v47, v113, v112, s47
    v_accvgpr_write_b32 a54, v46
    v_accvgpr_write_b32 a62, v47
    v_perm_b32 v46, v115, v114, s46
    v_perm_b32 v47, v115, v114, s47
    v_accvgpr_write_b32 a55, v46
    v_accvgpr_write_b32 a63, v47
    v_perm_b32 v46, v133, v132, s46
    v_perm_b32 v47, v133, v132, s47
    v_accvgpr_write_b32 a80, v46
    v_accvgpr_write_b32 a88, v47
    s_waitcnt lgkmcnt(14)
    v_perm_b32 v46, v135, v134, s46
    v_perm_b32 v47, v135, v134, s47
    v_accvgpr_write_b32 a81, v46
    v_accvgpr_write_b32 a89, v47
    s_waitcnt lgkmcnt(13)
    v_perm_b32 v46, v137, v136, s46
    v_perm_b32 v47, v137, v136, s47
    v_accvgpr_write_b32 a82, v46
    v_accvgpr_write_b32 a90, v47
    s_waitcnt lgkmcnt(12)
    v_perm_b32 v46, v139, v138, s46
    v_perm_b32 v47, v139, v138, s47
    v_accvgpr_write_b32 a83, v46
    v_accvgpr_write_b32 a91, v47
    s_waitcnt lgkmcnt(11)
    v_perm_b32 v46, v141, v140, s46
    v_perm_b32 v47, v141, v140, s47
    v_accvgpr_write_b32 a84, v46
    v_accvgpr_write_b32 a92, v47
    s_waitcnt lgkmcnt(10)
    v_perm_b32 v46, v143, v142, s46
    v_perm_b32 v47, v143, v142, s47
    v_accvgpr_write_b32 a85, v46
    v_accvgpr_write_b32 a93, v47
    s_waitcnt lgkmcnt(9)
    v_perm_b32 v46, v145, v144, s46
    v_perm_b32 v47, v145, v144, s47
    v_accvgpr_write_b32 a86, v46
    v_accvgpr_write_b32 a94, v47
    s_waitcnt lgkmcnt(8)
    v_perm_b32 v46, v147, v146, s46
    v_perm_b32 v47, v147, v146, s47
    v_accvgpr_write_b32 a87, v46
    v_accvgpr_write_b32 a95, v47
    s_waitcnt lgkmcnt(7)
    v_perm_b32 v46, v161, v160, s46
    v_perm_b32 v47, v161, v160, s47
    v_accvgpr_write_b32 a112, v46
    v_accvgpr_write_b32 a120, v47
    s_waitcnt lgkmcnt(6)
    v_perm_b32 v46, v163, v162, s46
    v_perm_b32 v47, v163, v162, s47
    v_accvgpr_write_b32 a113, v46
    v_accvgpr_write_b32 a121, v47
    s_waitcnt lgkmcnt(5)
    v_perm_b32 v46, v165, v164, s46
    v_perm_b32 v47, v165, v164, s47
    v_accvgpr_write_b32 a114, v46
    v_accvgpr_write_b32 a122, v47
    s_waitcnt lgkmcnt(4)
    v_perm_b32 v46, v167, v166, s46
    v_perm_b32 v47, v167, v166, s47
    v_accvgpr_write_b32 a115, v46
    v_accvgpr_write_b32 a123, v47
    s_waitcnt lgkmcnt(3)
    v_perm_b32 v46, v169, v168, s46
    v_perm_b32 v47, v169, v168, s47
    v_accvgpr_write_b32 a116, v46
    v_accvgpr_write_b32 a124, v47
    s_waitcnt lgkmcnt(2)
    v_perm_b32 v46, v171, v170, s46
    v_perm_b32 v47, v171, v170, s47
    v_accvgpr_write_b32 a117, v46
    v_accvgpr_write_b32 a125, v47
    s_waitcnt lgkmcnt(1)
    v_perm_b32 v46, v173, v172, s46
    v_perm_b32 v47, v173, v172, s47
    v_accvgpr_write_b32 a118, v46
    v_accvgpr_write_b32 a126, v47
    s_waitcnt lgkmcnt(0)
    v_perm_b32 v46, v175, v174, s46
    v_perm_b32 v47, v175, v174, s47
    v_accvgpr_write_b32 a119, v46
    v_accvgpr_write_b32 a127, v47
    s_waitcnt lgkmcnt(0)
    s_barrier
    s_add_u32 m0, s45, 65536
    s_add_u32 s28, s43, 524288
    buffer_load_dwordx4 v44, s[84:87], s28 offen offset:0 lds
    s_add_u32 s28, s43, 556032
    buffer_load_dwordx4 v44, s[84:87], s28 offen offset:1024 lds
    s_add_u32 s28, s43, 587776
    buffer_load_dwordx4 v44, s[84:87], s28 offen offset:2048 lds
    s_add_u32 s28, s43, 619520
    buffer_load_dwordx4 v44, s[84:87], s28 offen offset:3072 lds
    s_add_u32 m0, s45, 69632
    s_add_u32 s28, s43, 655360
    buffer_load_dwordx4 v44, s[84:87], s28 offen offset:0 lds
    s_add_u32 s28, s43, 687104
    buffer_load_dwordx4 v44, s[84:87], s28 offen offset:1024 lds
    s_add_u32 s28, s43, 718848
    buffer_load_dwordx4 v44, s[84:87], s28 offen offset:2048 lds
    s_add_u32 s28, s43, 750592
    buffer_load_dwordx4 v44, s[84:87], s28 offen offset:3072 lds
    s_add_u32 m0, s45, 73728
    s_add_u32 s28, s43, 1835008
    buffer_load_dwordx4 v44, s[84:87], s28 offen offset:0 lds
    s_add_u32 s28, s43, 1866752
    buffer_load_dwordx4 v44, s[84:87], s28 offen offset:1024 lds
    s_add_u32 s28, s43, 1898496
    buffer_load_dwordx4 v44, s[84:87], s28 offen offset:2048 lds
    s_add_u32 s28, s43, 1930240
    buffer_load_dwordx4 v44, s[84:87], s28 offen offset:3072 lds
    s_add_u32 m0, s45, 77824
    s_add_u32 s28, s43, 1966080
    buffer_load_dwordx4 v44, s[84:87], s28 offen offset:0 lds
    s_add_u32 s28, s43, 1997824
    buffer_load_dwordx4 v44, s[84:87], s28 offen offset:1024 lds
    s_add_u32 s28, s43, 2029568
    buffer_load_dwordx4 v44, s[84:87], s28 offen offset:2048 lds
    s_add_u32 s28, s43, 2061312
    buffer_load_dwordx4 v44, s[84:87], s28 offen offset:3072 lds
    v_xor_b32 v45, 0x10000, v45
    v_xor_b32 v48, 0x10000, v48
    v_xor_b32 v49, 0x10000, v49
    v_xor_b32 v50, 0x10000, v50
    v_xor_b32 v51, 0x10000, v51
    v_xor_b32 v52, 0x10000, v52
    s_waitcnt vmcnt(16)
    s_barrier
    v_and_b32 v34, 31, v20
    v_lshlrev_b32 v34, 2, v34
    global_load_dword v35, v34, s[4:5] offset:128 sc1
    ds_read2st64_b32 v[76:77], v48 offset0:0 offset1:32
    ds_read2st64_b32 v[78:79], v48 offset0:2 offset1:34
    ds_read2st64_b32 v[80:81], v48 offset0:4 offset1:36
    ds_read2st64_b32 v[82:83], v48 offset0:6 offset1:38
    ds_read2st64_b32 v[84:85], v48 offset0:8 offset1:40
    ds_read2st64_b32 v[86:87], v48 offset0:10 offset1:42
    ds_read2st64_b32 v[88:89], v48 offset0:12 offset1:44
    ds_read2st64_b32 v[90:91], v48 offset0:14 offset1:46
    ds_read2st64_b32 v[100:101], v49 offset0:0 offset1:32
    ds_read2st64_b32 v[102:103], v49 offset0:2 offset1:34
    ds_read2st64_b32 v[104:105], v49 offset0:4 offset1:36
    ds_read2st64_b32 v[106:107], v49 offset0:6 offset1:38
    ds_read2st64_b32 v[108:109], v49 offset0:8 offset1:40
    ds_read2st64_b32 v[110:111], v49 offset0:10 offset1:42
    ds_read2st64_b32 v[112:113], v49 offset0:12 offset1:44
    ds_read2st64_b32 v[114:115], v49 offset0:14 offset1:46
    ds_read2st64_b32 v[132:133], v50 offset0:0 offset1:32
    ds_read2st64_b32 v[134:135], v50 offset0:2 offset1:34
    ds_read2st64_b32 v[136:137], v50 offset0:4 offset1:36
    ds_read2st64_b32 v[138:139], v50 offset0:6 offset1:38
    ds_read2st64_b32 v[140:141], v50 offset0:8 offset1:40
    ds_read2st64_b32 v[142:143], v50 offset0:10 offset1:42
    ds_read2st64_b32 v[144:145], v50 offset0:12 offset1:44
    ds_read2st64_b32 v[146:147], v50 offset0:14 offset1:46
    ds_read2st64_b32 v[160:161], v51 offset0:0 offset1:32
    ds_read2st64_b32 v[162:163], v51 offset0:2 offset1:34
    ds_read2st64_b32 v[164:165], v51 offset0:4 offset1:36
    ds_read2st64_b32 v[166:167], v51 offset0:6 offset1:38
    ds_read2st64_b32 v[168:169], v51 offset0:8 offset1:40
    ds_read2st64_b32 v[170:171], v51 offset0:10 offset1:42
    ds_read2st64_b32 v[172:173], v51 offset0:12 offset1:44
    ds_read2st64_b32 v[174:175], v51 offset0:14 offset1:46
    s_waitcnt lgkmcnt(15)
    v_perm_b32 v46, v77, v76, s46
    v_perm_b32 v47, v77, v76, s47
    v_accvgpr_write_b32 a128, v46
    v_accvgpr_write_b32 a136, v47
    v_perm_b32 v46, v79, v78, s46
    v_perm_b32 v47, v79, v78, s47
    v_accvgpr_write_b32 a129, v46
    v_accvgpr_write_b32 a137, v47
    v_perm_b32 v46, v81, v80, s46
    v_perm_b32 v47, v81, v80, s47
    v_accvgpr_write_b32 a130, v46
    v_accvgpr_write_b32 a138, v47
    v_perm_b32 v46, v83, v82, s46
    v_perm_b32 v47, v83, v82, s47
    v_accvgpr_write_b32 a131, v46
    v_accvgpr_write_b32 a139, v47
    v_perm_b32 v46, v85, v84, s46
    v_perm_b32 v47, v85, v84, s47
    v_accvgpr_write_b32 a132, v46
    v_accvgpr_write_b32 a140, v47
    v_perm_b32 v46, v87, v86, s46
    v_perm_b32 v47, v87, v86, s47
    v_accvgpr_write_b32 a133, v46
    v_accvgpr_write_b32 a141, v47
    v_perm_b32 v46, v89, v88, s46
    v_perm_b32 v47, v89, v88, s47
    v_accvgpr_write_b32 a134, v46
    v_accvgpr_write_b32 a142, v47
    v_perm_b32 v46, v91, v90, s46
    v_perm_b32 v47, v91, v90, s47
    v_accvgpr_write_b32 a135, v46
    v_accvgpr_write_b32 a143, v47
    v_perm_b32 v46, v101, v100, s46
    v_perm_b32 v47, v101, v100, s47
    v_accvgpr_write_b32 a160, v46
    v_accvgpr_write_b32 a168, v47
    v_perm_b32 v46, v103, v102, s46
    v_perm_b32 v47, v103, v102, s47
    v_accvgpr_write_b32 a161, v46
    v_accvgpr_write_b32 a169, v47
    v_perm_b32 v46, v105, v104, s46
    v_perm_b32 v47, v105, v104, s47
    v_accvgpr_write_b32 a162, v46
    v_accvgpr_write_b32 a170, v47
    v_perm_b32 v46, v107, v106, s46
    v_perm_b32 v47, v107, v106, s47
    v_accvgpr_write_b32 a163, v46
    v_accvgpr_write_b32 a171, v47
    v_perm_b32 v46, v109, v108, s46
    v_perm_b32 v47, v109, v108, s47
    v_accvgpr_write_b32 a164, v46
    v_accvgpr_write_b32 a172, v47
    v_perm_b32 v46, v111, v110, s46
    v_perm_b32 v47, v111, v110, s47
    v_accvgpr_write_b32 a165, v46
    v_accvgpr_write_b32 a173, v47
    v_perm_b32 v46, v113, v112, s46
    v_perm_b32 v47, v113, v112, s47
    v_accvgpr_write_b32 a166, v46
    v_accvgpr_write_b32 a174, v47
    v_perm_b32 v46, v115, v114, s46
    v_perm_b32 v47, v115, v114, s47
    v_accvgpr_write_b32 a167, v46
    v_accvgpr_write_b32 a175, v47
    v_perm_b32 v46, v133, v132, s46
    v_perm_b32 v47, v133, v132, s47
    v_accvgpr_write_b32 a192, v46
    v_accvgpr_write_b32 a200, v47
    s_waitcnt lgkmcnt(14)
    v_perm_b32 v46, v135, v134, s46
    v_perm_b32 v47, v135, v134, s47
    v_accvgpr_write_b32 a193, v46
    v_accvgpr_write_b32 a201, v47
    s_waitcnt lgkmcnt(13)
    v_perm_b32 v46, v137, v136, s46
    v_perm_b32 v47, v137, v136, s47
    v_accvgpr_write_b32 a194, v46
    v_accvgpr_write_b32 a202, v47
    s_waitcnt lgkmcnt(12)
    v_perm_b32 v46, v139, v138, s46
    v_perm_b32 v47, v139, v138, s47
    v_accvgpr_write_b32 a195, v46
    v_accvgpr_write_b32 a203, v47
    s_waitcnt lgkmcnt(11)
    v_perm_b32 v46, v141, v140, s46
    v_perm_b32 v47, v141, v140, s47
    v_accvgpr_write_b32 a196, v46
    v_accvgpr_write_b32 a204, v47
    s_waitcnt lgkmcnt(10)
    v_perm_b32 v46, v143, v142, s46
    v_perm_b32 v47, v143, v142, s47
    v_accvgpr_write_b32 a197, v46
    v_accvgpr_write_b32 a205, v47
    s_waitcnt lgkmcnt(9)
    v_perm_b32 v46, v145, v144, s46
    v_perm_b32 v47, v145, v144, s47
    v_accvgpr_write_b32 a198, v46
    v_accvgpr_write_b32 a206, v47
    s_waitcnt lgkmcnt(8)
    v_perm_b32 v46, v147, v146, s46
    v_perm_b32 v47, v147, v146, s47
    v_accvgpr_write_b32 a199, v46
    v_accvgpr_write_b32 a207, v47
    s_waitcnt lgkmcnt(7)
    v_perm_b32 v46, v161, v160, s46
    v_perm_b32 v47, v161, v160, s47
    v_accvgpr_write_b32 a224, v46
    v_accvgpr_write_b32 a232, v47
    s_waitcnt lgkmcnt(6)
    v_perm_b32 v46, v163, v162, s46
    v_perm_b32 v47, v163, v162, s47
    v_accvgpr_write_b32 a225, v46
    v_accvgpr_write_b32 a233, v47
    s_waitcnt lgkmcnt(5)
    v_perm_b32 v46, v165, v164, s46
    v_perm_b32 v47, v165, v164, s47
    v_accvgpr_write_b32 a226, v46
    v_accvgpr_write_b32 a234, v47
    s_waitcnt lgkmcnt(4)
    v_perm_b32 v46, v167, v166, s46
    v_perm_b32 v47, v167, v166, s47
    v_accvgpr_write_b32 a227, v46
    v_accvgpr_write_b32 a235, v47
    s_waitcnt lgkmcnt(3)
    v_perm_b32 v46, v169, v168, s46
    v_perm_b32 v47, v169, v168, s47
    v_accvgpr_write_b32 a228, v46
    v_accvgpr_write_b32 a236, v47
    s_waitcnt lgkmcnt(2)
    v_perm_b32 v46, v171, v170, s46
    v_perm_b32 v47, v171, v170, s47
    v_accvgpr_write_b32 a229, v46
    v_accvgpr_write_b32 a237, v47
    s_waitcnt lgkmcnt(1)
    v_perm_b32 v46, v173, v172, s46
    v_perm_b32 v47, v173, v172, s47
    v_accvgpr_write_b32 a230, v46
    v_accvgpr_write_b32 a238, v47
    s_waitcnt lgkmcnt(0)
    v_perm_b32 v46, v175, v174, s46
    v_perm_b32 v47, v175, v174, s47
    v_accvgpr_write_b32 a231, v46
    v_accvgpr_write_b32 a239, v47
    s_waitcnt lgkmcnt(0)
    s_barrier
    s_add_u32 m0, s45, 0
    s_add_u32 s28, s42, 1048576
    buffer_load_dwordx4 v44, s[72:75], s28 offen offset:0 lds
    s_add_u32 s28, s42, 1080320
    buffer_load_dwordx4 v44, s[72:75], s28 offen offset:1024 lds
    s_add_u32 s28, s42, 1112064
    buffer_load_dwordx4 v44, s[72:75], s28 offen offset:2048 lds
    s_add_u32 s28, s42, 1143808
    buffer_load_dwordx4 v44, s[72:75], s28 offen offset:3072 lds
    s_add_u32 m0, s45, 4096
    s_add_u32 s28, s42, 1179648
    buffer_load_dwordx4 v44, s[72:75], s28 offen offset:0 lds
    s_add_u32 s28, s42, 1211392
    buffer_load_dwordx4 v44, s[72:75], s28 offen offset:1024 lds
    s_add_u32 s28, s42, 1243136
    buffer_load_dwordx4 v44, s[72:75], s28 offen offset:2048 lds
    s_add_u32 s28, s42, 1274880
    buffer_load_dwordx4 v44, s[72:75], s28 offen offset:3072 lds
    s_add_u32 m0, s45, 8192
    s_add_u32 s28, s42, 2359296
    buffer_load_dwordx4 v44, s[72:75], s28 offen offset:0 lds
    s_add_u32 s28, s42, 2391040
    buffer_load_dwordx4 v44, s[72:75], s28 offen offset:1024 lds
    s_add_u32 s28, s42, 2422784
    buffer_load_dwordx4 v44, s[72:75], s28 offen offset:2048 lds
    s_add_u32 s28, s42, 2454528
    buffer_load_dwordx4 v44, s[72:75], s28 offen offset:3072 lds
    s_add_u32 m0, s45, 12288
    s_add_u32 s28, s42, 2490368
    buffer_load_dwordx4 v44, s[72:75], s28 offen offset:0 lds
    s_add_u32 s28, s42, 2522112
    buffer_load_dwordx4 v44, s[72:75], s28 offen offset:1024 lds
    s_add_u32 s28, s42, 2553856
    buffer_load_dwordx4 v44, s[72:75], s28 offen offset:2048 lds
    s_add_u32 s28, s42, 2585600
    buffer_load_dwordx4 v44, s[72:75], s28 offen offset:3072 lds
    v_xor_b32 v45, 0x10000, v45
    v_xor_b32 v48, 0x10000, v48
    v_xor_b32 v49, 0x10000, v49
    v_xor_b32 v50, 0x10000, v50
    v_xor_b32 v51, 0x10000, v51
    v_xor_b32 v52, 0x10000, v52
    s_waitcnt vmcnt(16)
    s_barrier
TQ_TB:
    v_readlane_b32 s28, v35, 3
    v_readlane_b32 s29, v35, 4
    v_readlane_b32 s20, v35, 5
    s_nop 0
    s_and_b32 s29, s29, s20
    s_max_u32 s28, s28, s29
    v_readlane_b32 s29, v35, 0
    v_readlane_b32 s20, v35, 10
    v_readlane_b32 s27, v35, 12
    s_nop 0
    s_min_u32 s20, s20, s27
    s_min_u32 s20, s20, s28
    s_min_u32 s20, s20, s29
    s_cmp_lg_u32 s20, 0
    s_cbranch_scc1 TQ_TG
    s_cmp_lg_u32 s28, 0
    s_cbranch_scc1 TQ_RG
    s_cmp_eq_u32 s71, 1
    s_cbranch_scc0 TQ_RG
    s_mov_b32 s71, 0
    s_mov_b32 s28, 8
    s_cmp_eq_u32 s17, 0
    s_cbranch_scc0 TQ_RG
    v_mov_b32 v40, 0
    v_mov_b32 v41, 1
    s_mov_b64 exec, 1
    buffer_atomic_add v41, v40, s[4:7], s28 offen
    s_mov_b64 exec, -1
TQ_RG:
    s_add_u32 s30, s30, 1
    s_cmp_gt_u32 s30, 600000
    s_cbranch_scc1 T_EXIT
    s_sleep 2
    global_load_dword v35, v34, s[4:5] offset:128 sc1
    s_waitcnt vmcnt(0)
    s_branch TQ_TB
TQ_TG:
    s_and_b32 s29, s29, 1
    s_lshl_b32 s29, s29, 13
    s_add_u32 s51, s51, s29
    s_add_u32 s21, s21, s29
    s_add_u32 s69, s69, s29
    s_cmp_eq_u32 s28, 33
    s_cselect_b32 s20, 1, 0
    v_lshlrev_b32 v34, 3, v6
    s_and_b32 s28, s18, 15
    s_mul_i32 s28, s28, 10240
    s_lshl_b32 s29, s17, 19
    s_add_u32 s28, s28, s29
    s_mul_i32 s29, s19, 0x30000
    s_add_u32 s28, s28, s29
    s_add_u32 s28, s28, 20971520
    buffer_load_dword v35, v34, s[8:11], s28 offen sc1
    buffer_load_dword v35, v34, s[8:11], s28 offen offset:2048 sc1
    s_lshl_b32 s27, s18, 6
    s_add_u32 s27, s27, 1073152
    v_and_b32 v31, 0, v20
    v_mul_i32_i24 v31, -2048, v31
    v_add_u32 v31, s27, v31
    buffer_load_dwordx2 v[32:33], v31, s[8:11], 0 offen sc1
    ds_read2st64_b32 v[76:77], v48 offset0:0 offset1:32
    ds_read2st64_b32 v[78:79], v48 offset0:2 offset1:34
    ds_read2st64_b32 v[80:81], v48 offset0:4 offset1:36
    ds_read2st64_b32 v[82:83], v48 offset0:6 offset1:38
    ds_read2st64_b32 v[84:85], v48 offset0:8 offset1:40
    ds_read2st64_b32 v[86:87], v48 offset0:10 offset1:42
    ds_read2st64_b32 v[88:89], v48 offset0:12 offset1:44
    ds_read2st64_b32 v[90:91], v48 offset0:14 offset1:46
    ds_read2st64_b32 v[100:101], v49 offset0:0 offset1:32
    ds_read2st64_b32 v[102:103], v49 offset0:2 offset1:34
    ds_read2st64_b32 v[104:105], v49 offset0:4 offset1:36
    ds_read2st64_b32 v[106:107], v49 offset0:6 offset1:38
    ds_read2st64_b32 v[108:109], v49 offset0:8 offset1:40
    ds_read2st64_b32 v[110:111], v49 offset0:10 offset1:42
    ds_read2st64_b32 v[112:113], v49 offset0:12 offset1:44
    ds_read2st64_b32 v[114:115], v49 offset0:14 offset1:46
    ds_read2st64_b32 v[132:133], v50 offset0:0 offset1:32
    ds_read2st64_b32 v[134:135], v50 offset0:2 offset1:34
    ds_read2st64_b32 v[136:137], v50 offset0:4 offset1:36
    ds_read2st64_b32 v[138:139], v50 offset0:6 offset1:38
    ds_read2st64_b32 v[140:141], v50 offset0:8 offset1:40
    ds_read2st64_b32 v[142:143], v50 offset0:10 offset1:42
    ds_read2st64_b32 v[144:145], v50 offset0:12 offset1:44
    ds_read2st64_b32 v[146:147], v50 offset0:14 offset1:46
    ds_read2st64_b32 v[160:161], v51 offset0:0 offset1:32
    ds_read2st64_b32 v[162:163], v51 offset0:2 offset1:34
    ds_read2st64_b32 v[164:165], v51 offset0:4 offset1:36
    ds_read2st64_b32 v[166:167], v51 offset0:6 offset1:38
    ds_read2st64_b32 v[168:169], v51 offset0:8 offset1:40
    ds_read2st64_b32 v[170:171], v51 offset0:10 offset1:42
    ds_read2st64_b32 v[172:173], v51 offset0:12 offset1:44
    ds_read2st64_b32 v[174:175], v51 offset0:14 offset1:46
    s_waitcnt lgkmcnt(15)
    v_perm_b32 v46, v77, v76, s46
    v_perm_b32 v47, v77, v76, s47
    v_accvgpr_write_b32 a144, v46
    v_accvgpr_write_b32 a152, v47
    v_perm_b32 v46, v79, v78, s46
    v_perm_b32 v47, v79, v78, s47
    v_accvgpr_write_b32 a145, v46
    v_accvgpr_write_b32 a153, v47
    v_perm_b32 v46, v81, v80, s46
    v_perm_b32 v47, v81, v80, s47
    v_accvgpr_write_b32 a146, v46
    v_accvgpr_write_b32 a154, v47
    v_perm_b32 v46, v83, v82, s46
    v_perm_b32 v47, v83, v82, s47
    v_accvgpr_write_b32 a147, v46
    v_accvgpr_write_b32 a155, v47
    v_perm_b32 v46, v85, v84, s46
    v_perm_b32 v47, v85, v84, s47
    v_accvgpr_write_b32 a148, v46
    v_accvgpr_write_b32 a156, v47
    v_perm_b32 v46, v87, v86, s46
    v_perm_b32 v47, v87, v86, s47
    v_accvgpr_write_b32 a149, v46
    v_accvgpr_write_b32 a157, v47
    v_perm_b32 v46, v89, v88, s46
    v_perm_b32 v47, v89, v88, s47
    v_accvgpr_write_b32 a150, v46
    v_accvgpr_write_b32 a158, v47
    v_perm_b32 v46, v91, v90, s46
    v_perm_b32 v47, v91, v90, s47
    v_accvgpr_write_b32 a151, v46
    v_accvgpr_write_b32 a159, v47
    v_perm_b32 v46, v101, v100, s46
    v_perm_b32 v47, v101, v100, s47
    v_accvgpr_write_b32 a176, v46
    v_accvgpr_write_b32 a184, v47
    v_perm_b32 v46, v103, v102, s46
    v_perm_b32 v47, v103, v102, s47
    v_accvgpr_write_b32 a177, v46
    v_accvgpr_write_b32 a185, v47
    v_perm_b32 v46, v105, v104, s46
    v_perm_b32 v47, v105, v104, s47
    v_accvgpr_write_b32 a178, v46
    v_accvgpr_write_b32 a186, v47
    v_perm_b32 v46, v107, v106, s46
    v_perm_b32 v47, v107, v106, s47
    v_accvgpr_write_b32 a179, v46
    v_accvgpr_write_b32 a187, v47
    v_perm_b32 v46, v109, v108, s46
    v_perm_b32 v47, v109, v108, s47
    v_accvgpr_write_b32 a180, v46
    v_accvgpr_write_b32 a188, v47
    v_perm_b32 v46, v111, v110, s46
    v_perm_b32 v47, v111, v110, s47
    v_accvgpr_write_b32 a181, v46
    v_accvgpr_write_b32 a189, v47
    v_perm_b32 v46, v113, v112, s46
    v_perm_b32 v47, v113, v112, s47
    v_accvgpr_write_b32 a182, v46
    v_accvgpr_write_b32 a190, v47
    v_perm_b32 v46, v115, v114, s46
    v_perm_b32 v47, v115, v114, s47
    v_accvgpr_write_b32 a183, v46
    v_accvgpr_write_b32 a191, v47
    v_perm_b32 v46, v133, v132, s46
    v_perm_b32 v47, v133, v132, s47
    v_accvgpr_write_b32 a208, v46
    v_accvgpr_write_b32 a216, v47
    s_waitcnt lgkmcnt(14)
    v_perm_b32 v46, v135, v134, s46
    v_perm_b32 v47, v135, v134, s47
    v_accvgpr_write_b32 a209, v46
    v_accvgpr_write_b32 a217, v47
    s_waitcnt lgkmcnt(13)
    v_perm_b32 v46, v137, v136, s46
    v_perm_b32 v47, v137, v136, s47
    v_accvgpr_write_b32 a210, v46
    v_accvgpr_write_b32 a218, v47
    s_waitcnt lgkmcnt(12)
    v_perm_b32 v46, v139, v138, s46
    v_perm_b32 v47, v139, v138, s47
    v_accvgpr_write_b32 a211, v46
    v_accvgpr_write_b32 a219, v47
    s_waitcnt lgkmcnt(11)
    v_perm_b32 v46, v141, v140, s46
    v_perm_b32 v47, v141, v140, s47
    v_accvgpr_write_b32 a212, v46
    v_accvgpr_write_b32 a220, v47
    s_waitcnt lgkmcnt(10)
    v_perm_b32 v46, v143, v142, s46
    v_perm_b32 v47, v143, v142, s47
    v_accvgpr_write_b32 a213, v46
    v_accvgpr_write_b32 a221, v47
    s_waitcnt lgkmcnt(9)
    v_perm_b32 v46, v145, v144, s46
    v_perm_b32 v47, v145, v144, s47
    v_accvgpr_write_b32 a214, v46
    v_accvgpr_write_b32 a222, v47
    s_waitcnt lgkmcnt(8)
    v_perm_b32 v46, v147, v146, s46
    v_perm_b32 v47, v147, v146, s47
    v_accvgpr_write_b32 a215, v46
    v_accvgpr_write_b32 a223, v47
    s_waitcnt lgkmcnt(7)
    v_perm_b32 v46, v161, v160, s46
    v_perm_b32 v47, v161, v160, s47
    v_accvgpr_write_b32 a240, v46
    v_accvgpr_write_b32 a248, v47
    s_waitcnt lgkmcnt(6)
    v_perm_b32 v46, v163, v162, s46
    v_perm_b32 v47, v163, v162, s47
    v_accvgpr_write_b32 a241, v46
    v_accvgpr_write_b32 a249, v47
    s_waitcnt lgkmcnt(5)
    v_perm_b32 v46, v165, v164, s46
    v_perm_b32 v47, v165, v164, s47
    v_accvgpr_write_b32 a242, v46
    v_accvgpr_write_b32 a250, v47
    s_waitcnt lgkmcnt(4)
    v_perm_b32 v46, v167, v166, s46
    v_perm_b32 v47, v167, v166, s47
    v_accvgpr_write_b32 a243, v46
    v_accvgpr_write_b32 a251, v47
    s_waitcnt lgkmcnt(3)
    v_perm_b32 v46, v169, v168, s46
    v_perm_b32 v47, v169, v168, s47
    v_accvgpr_write_b32 a244, v46
    v_accvgpr_write_b32 a252, v47
    s_waitcnt lgkmcnt(2)
    v_perm_b32 v46, v171, v170, s46
    v_perm_b32 v47, v171, v170, s47
    v_accvgpr_write_b32 a245, v46
    v_accvgpr_write_b32 a253, v47
    s_waitcnt lgkmcnt(1)
    v_perm_b32 v46, v173, v172, s46
    v_perm_b32 v47, v173, v172, s47
    v_accvgpr_write_b32 a246, v46
    v_accvgpr_write_b32 a254, v47
    s_waitcnt lgkmcnt(0)
    v_perm_b32 v46, v175, v174, s46
    v_perm_b32 v47, v175, v174, s47
    v_accvgpr_write_b32 a247, v46
    v_accvgpr_write_b32 a255, v47
    s_waitcnt lgkmcnt(0)
    s_barrier
    v_xor_b32 v45, 0x10000, v45
    v_xor_b32 v48, 0x10000, v48
    v_xor_b32 v49, 0x10000, v49
    v_xor_b32 v50, 0x10000, v50
    v_xor_b32 v51, 0x10000, v51
    v_xor_b32 v52, 0x10000, v52
    s_waitcnt vmcnt(0)
    s_barrier
TQ_WK:
    v_and_b32 v32, v32, v33
    v_cmp_ne_u32 vcc, 1, v32
    s_nop 0
    s_cbranch_vccz TQ_WL
    buffer_load_dwordx2 v[32:33], v31, s[8:11], 0 offen sc1
    s_add_u32 s30, s30, 1
    s_cmp_gt_u32 s30, 600000
    s_cbranch_scc1 T_EXIT
    s_waitcnt vmcnt(0)
    s_branch TQ_WK
TQ_WL:
    buffer_load_dwordx4 v[116:119], v6, s[8:11], s38 offen offset:0 sc1
    buffer_load_dwordx4 v[120:123], v6, s[8:11], s38 offen offset:1024 sc1
    buffer_load_dwordx4 v[124:127], v6, s[8:11], s38 offen offset:2048 sc1
    buffer_load_dwordx4 v[128:131], v6, s[8:11], s38 offen offset:3072 sc1
    ds_read2st64_b32 v[76:77], v52 offset0:0 offset1:32
    ds_read2st64_b32 v[78:79], v52 offset0:2 offset1:34
    ds_read2st64_b32 v[80:81], v52 offset0:4 offset1:36
    ds_read2st64_b32 v[82:83], v52 offset0:6 offset1:38
    ds_read2st64_b32 v[84:85], v52 offset0:8 offset1:40
    ds_read2st64_b32 v[86:87], v52 offset0:10 offset1:42
    ds_read2st64_b32 v[88:89], v52 offset0:12 offset1:44
    ds_read2st64_b32 v[90:91], v52 offset0:14 offset1:46
    ds_read2st64_b32 v[100:101], v52 offset0:64 offset1:96
    ds_read2st64_b32 v[102:103], v52 offset0:66 offset1:98
    ds_read2st64_b32 v[104:105], v52 offset0:68 offset1:100
    ds_read2st64_b32 v[106:107], v52 offset0:70 offset1:102
    ds_read2st64_b32 v[108:109], v52 offset0:72 offset1:104
    ds_read2st64_b32 v[110:111], v52 offset0:74 offset1:106
    ds_read2st64_b32 v[112:113], v52 offset0:76 offset1:108
    ds_read2st64_b32 v[114:115], v52 offset0:78 offset1:110
    ds_read2st64_b32 v[132:133], v52 offset0:128 offset1:160
    ds_read2st64_b32 v[134:135], v52 offset0:130 offset1:162
    ds_read2st64_b32 v[136:137], v52 offset0:132 offset1:164
    ds_read2st64_b32 v[138:139], v52 offset0:134 offset1:166
    ds_read2st64_b32 v[140:141], v52 offset0:136 offset1:168
    ds_read2st64_b32 v[142:143], v52 offset0:138 offset1:170
    ds_read2st64_b32 v[144:145], v52 offset0:140 offset1:172
    ds_read2st64_b32 v[146:147], v52 offset0:142 offset1:174
    ds_read2st64_b32 v[160:161], v52 offset0:192 offset1:224
    ds_read2st64_b32 v[162:163], v52 offset0:194 offset1:226
    ds_read2st64_b32 v[164:165], v52 offset0:196 offset1:228
    ds_read2st64_b32 v[166:167], v52 offset0:198 offset1:230
    ds_read2st64_b32 v[168:169], v52 offset0:200 offset1:232
    ds_read2st64_b32 v[170:171], v52 offset0:202 offset1:234
    ds_read2st64_b32 v[172:173], v52 offset0:204 offset1:236
    ds_read2st64_b32 v[174:175], v52 offset0:206 offset1:238
    s_waitcnt lgkmcnt(15)
    v_perm_b32 v192, v77, v76, s46
    v_perm_b32 v200, v77, v76, s47
    v_perm_b32 v193, v79, v78, s46
    v_perm_b32 v201, v79, v78, s47
    v_perm_b32 v194, v81, v80, s46
    v_perm_b32 v202, v81, v80, s47
    v_perm_b32 v195, v83, v82, s46
    v_perm_b32 v203, v83, v82, s47
    v_perm_b32 v196, v85, v84, s46
    v_perm_b32 v204, v85, v84, s47
    v_perm_b32 v197, v87, v86, s46
    v_perm_b32 v205, v87, v86, s47
    v_perm_b32 v198, v89, v88, s46
    v_perm_b32 v206, v89, v88, s47
    v_perm_b32 v199, v91, v90, s46
    v_perm_b32 v207, v91, v90, s47
    v_perm_b32 v224, v101, v100, s46
    v_perm_b32 v232, v101, v100, s47
    v_perm_b32 v225, v103, v102, s46
    v_perm_b32 v233, v103, v102, s47
    v_perm_b32 v226, v105, v104, s46
    v_perm_b32 v234, v105, v104, s47
    v_perm_b32 v227, v107, v106, s46
    v_perm_b32 v235, v107, v106, s47
    v_perm_b32 v228, v109, v108, s46
    v_perm_b32 v236, v109, v108, s47
    v_perm_b32 v229, v111, v110, s46
    v_perm_b32 v237, v111, v110, s47
    v_perm_b32 v230, v113, v112, s46
    v_perm_b32 v238, v113, v112, s47
    v_perm_b32 v231, v115, v114, s46
    v_perm_b32 v239, v115, v114, s47
    v_perm_b32 v208, v133, v132, s46
    v_perm_b32 v216, v133, v132, s47
    s_waitcnt lgkmcnt(14)
    v_perm_b32 v209, v135, v134, s46
    v_perm_b32 v217, v135, v134, s47
    s_waitcnt lgkmcnt(13)
    v_perm_b32 v210, v137, v136, s46
    v_perm_b32 v218, v137, v136, s47
    s_waitcnt lgkmcnt(12)
    v_perm_b32 v211, v139, v138, s46
    v_perm_b32 v219, v139, v138, s47
    s_waitcnt lgkmcnt(11)
    v_perm_b32 v212, v141, v140, s46
    v_perm_b32 v220, v141, v140, s47
    s_waitcnt lgkmcnt(10)
    v_perm_b32 v213, v143, v142, s46
    v_perm_b32 v221, v143, v142, s47
    s_waitcnt lgkmcnt(9)
    v_perm_b32 v214, v145, v144, s46
    v_perm_b32 v222, v145, v144, s47
    s_waitcnt lgkmcnt(8)
    v_perm_b32 v215, v147, v146, s46
    v_perm_b32 v223, v147, v146, s47
    s_waitcnt lgkmcnt(7)
    v_perm_b32 v240, v161, v160, s46
    v_perm_b32 v248, v161, v160, s47
    s_waitcnt lgkmcnt(6)
    v_perm_b32 v241, v163, v162, s46
    v_perm_b32 v249, v163, v162, s47
    s_waitcnt lgkmcnt(5)
    v_perm_b32 v242, v165, v164, s46
    v_perm_b32 v250, v165, v164, s47
    s_waitcnt lgkmcnt(4)
    v_perm_b32 v243, v167, v166, s46
    v_perm_b32 v251, v167, v166, s47
    s_waitcnt lgkmcnt(3)
    v_perm_b32 v244, v169, v168, s46
    v_perm_b32 v252, v169, v168, s47
    s_waitcnt lgkmcnt(2)
    v_perm_b32 v245, v171, v170, s46
    v_perm_b32 v253, v171, v170, s47
    s_waitcnt lgkmcnt(1)
    v_perm_b32 v246, v173, v172, s46
    v_perm_b32 v254, v173, v172, s47
    s_waitcnt lgkmcnt(0)
    v_perm_b32 v247, v175, v174, s46
    v_perm_b32 v255, v175, v174, s47
    s_waitcnt lgkmcnt(0)
    s_barrier
    v_xor_b32 v45, 0x10000, v45
    v_xor_b32 v48, 0x10000, v48
    v_xor_b32 v49, 0x10000, v49
    v_xor_b32 v50, 0x10000, v50
    v_xor_b32 v51, 0x10000, v51
    v_xor_b32 v52, 0x10000, v52
    v_mov_b32 v28, 0
    v_mov_b32 v29, 28160
    ds_write_b32 v29, v28
    s_lshr_b32 s28, s17, 1
    s_lshl_b32 s28, s28, 30
    v_add_u32 v0, s28, v6
    s_sub_u32 s39, s39, 262144
    s_waitcnt lgkmcnt(0)
    s_cmp_eq_u32 s20, 0
    s_cbranch_scc1 SQ_LOOP
.p2align 6
TQ_LOOP:
    s_and_b32 s28, s31, 3
    s_lshl_b32 s28, s28, 15
    s_add_u32 s32, s28, s51
    s_add_u32 s33, s32, s36
    s_add_u32 s34, s33, 4096
    s_add_u32 s35, s32, s37
    v_mov_b64 v[100:101], 0
    v_mov_b64 v[102:103], 0
    v_mov_b64 v[104:105], 0
    v_mov_b64 v[106:107], 0
    v_mov_b64 v[108:109], 0
    v_mov_b64 v[110:111], 0
    v_mov_b64 v[112:113], 0
    v_mov_b64 v[114:115], 0
    s_and_b32 s28, s31, 1
    s_mul_i32 s49, s28, 0x80008000
    s_add_u32 s73, s32, s67
    s_add_u32 s72, s73, 261120
    s_add_u32 s74, s31, 3
    s_and_b32 s74, s74, 3
    s_lshl_b32 s74, s74, 19
    s_add_u32 s74, s74, s60
    s_cmp_eq_u32 s31, 0
    s_cbranch_scc1 TQ_G0
    v_mov_b64 v[116:117], v[76:77]
    v_mov_b64 v[118:119], v[78:79]
    v_mov_b64 v[120:121], v[80:81]
    v_mov_b64 v[122:123], v[82:83]
    v_mov_b64 v[124:125], v[84:85]
    v_mov_b64 v[126:127], v[86:87]
    v_mov_b64 v[128:129], v[88:89]
    v_mov_b64 v[130:131], v[90:91]
    s_sleep 8
    buffer_load_dwordx4 v[16:19], v6, s[8:11], s74 offen offset:0 sc1
    buffer_load_dwordx4 v[20:23], v6, s[8:11], s74 offen offset:1024 sc1
    s_sleep 1
    buffer_load_dwordx4 v[16:19], v6, s[8:11], s74 offen offset:0 sc1
    buffer_load_dwordx4 v[20:23], v6, s[8:11], s74 offen offset:1024 sc1
TQ_RE:
    s_waitcnt vmcnt(3)
    v_max_u32 v12, v16, v17
    v_max_u32 v13, v18, v19
    v_mfma_f32_16x16x32_bf16 v[24:27], v[16:19], v[148:151], 0
    s_waitcnt vmcnt(2)
    v_max3_u32 v12, v12, v20, v21
    v_max3_u32 v13, v13, v22, v23
    v_mfma_f32_16x16x32_bf16 v[24:27], v[20:23], v[148:151], v[24:27]
    v_max_u32 v12, v12, v13
    v_cmp_eq_u32 vcc, -1, v12
    s_nop 0
    s_cbranch_vccnz TQ_RES
    s_nop 3
    v_permlane32_swap_b32 v24, v26
    v_permlane32_swap_b32 v25, v27
    v_add_f32 v24, v24, v26
    v_add_f32 v25, v25, v27
    v_cvt_pk_bf16_f32 v24, v24, v25
    buffer_store_dword v24, v191, s[8:11], s73 offen
    s_barrier
    buffer_store_dword v24, v191, s[8:11], s72 offen sc1
    s_sleep 7
TQ_G0:
    buffer_load_dwordx4 v[56:59], v182, s[8:11], s33 offen offset:0 sc1
    buffer_load_dwordx4 v[60:63], v182, s[8:11], s33 offen offset:512 sc1
    buffer_load_dwordx4 v[64:67], v182, s[8:11], s34 offen offset:0 sc1
    buffer_load_dwordx4 v[68:71], v182, s[8:11], s34 offen offset:512 sc1
    buffer_load_dwordx4 v[72:75], v182, s[8:11], s35 offen offset:0 sc1
TQ_GA:
    s_nop 0
    s_waitcnt vmcnt(4)
    v_max_u32 v12, v56, v57
    v_max_u32 v13, v58, v59
    v_mfma_f32_16x16x32_bf16 v[160:163], v[184:187], v[56:59], 0
    s_waitcnt vmcnt(3)
    v_max3_u32 v12, v12, v60, v61
    v_max3_u32 v13, v13, v62, v63
    v_mfma_f32_16x16x32_bf16 v[164:167], v[184:187], v[60:63], 0
    s_waitcnt vmcnt(2)
    v_max3_u32 v12, v12, v64, v65
    v_max3_u32 v13, v13, v66, v67
    v_mfma_f32_16x16x32_bf16 v[168:171], v[184:187], v[64:67], 0
    s_waitcnt vmcnt(1)
    v_max3_u32 v12, v12, v68, v69
    v_max3_u32 v13, v13, v70, v71
    v_mfma_f32_16x16x32_bf16 v[172:175], v[184:187], v[68:71], 0
    v_cvt_pk_bf16_f32 v16, v160, v161
    v_cvt_pk_bf16_f32 v17, v162, v163
    s_waitcnt vmcnt(0)
    v_max3_u32 v12, v12, v72, v73
    v_max3_u32 v13, v13, v74, v75
    v_mfma_f32_16x16x32_bf16 v[176:179], v[184:187], v[72:75], 0
    v_max_u32 v12, v12, v13
    v_cvt_pk_bf16_f32 v18, v164, v165
    v_cmp_eq_u32 vcc, -1, v12
    v_cvt_pk_bf16_f32 v19, v166, v167
    s_cbranch_vccnz TQ_GAS
    ds_write_b128 v2, v[16:19]
    v_cvt_pk_bf16_f32 v32, v168, v169
    v_smfmac_f32_16x16x64_bf16 v[100:103], v[16:19], a[0:7], v8
    v_cvt_pk_bf16_f32 v33, v170, v171
    v_cvt_pk_bf16_f32 v34, v172, v173
    v_smfmac_f32_16x16x64_bf16 v[104:107], v[16:19], a[8:15], v8
    v_cvt_pk_bf16_f32 v35, v174, v175
    v_cvt_pk_bf16_f32 v98, v176, v177
    v_smfmac_f32_16x16x64_bf16 v[108:111], v[16:19], a[16:23], v8
    ds_write_b128 v2, v[32:35] offset:4096
    v_cvt_pk_bf16_f32 v99, v178, v179
    v_smfmac_f32_16x16x64_bf16 v[112:115], v[16:19], a[24:31], v8
    ds_write_b64 v7, v[98:99] offset:8192
    s_waitcnt lgkmcnt(2)
    s_barrier
    ds_read_b128 v[20:23], v3
    v_smfmac_f32_16x16x64_bf16 v[100:103], v[32:35], a[128:135], v8
    ds_read_b128 v[24:27], v4
    s_add_u32 s28, s31, 2
    s_and_b32 s29, s28, 0x42
    s_cbranch_scc0 TQ_CK
TQ_CKR:
    s_add_u32 s38, s38, 524288
    v_smfmac_f32_16x16x64_bf16 v[104:107], v[32:35], a[136:143], v8
    ds_read_b128 v[28:31], v5
    buffer_load_dwordx4 v[76:79], v0, s[8:11], s38 offen offset:0 sc1
    v_smfmac_f32_16x16x64_bf16 v[108:111], v[32:35], a[144:151], v8
    v_smfmac_f32_16x16x64_bf16 v[112:115], v[32:35], a[152:159], v8
    buffer_load_dwordx4 v[80:83], v0, s[8:11], s38 offen offset:1024 sc1
    s_waitcnt lgkmcnt(2)
    v_smfmac_f32_16x16x64_bf16 v[100:103], v[20:23], a[32:39], v8
    s_barrier
    ds_read_b128 v[36:39], v3 offset:4096
    v_smfmac_f32_16x16x64_bf16 v[104:107], v[20:23], a[40:47], v8
    ds_read_b128 v[40:43], v4 offset:4096
    buffer_load_dwordx4 v[84:87], v0, s[8:11], s38 offen offset:2048 sc1
    s_waitcnt lgkmcnt(3)
    v_smfmac_f32_16x16x64_bf16 v[100:103], v[24:27], a[64:71], v8
    ds_read_b128 v[44:47], v5 offset:4096
    v_smfmac_f32_16x16x64_bf16 v[104:107], v[24:27], a[72:79], v8
    ds_read_b128 v[48:51], v6 offset:8192
    buffer_load_dwordx4 v[88:91], v0, s[8:11], s38 offen offset:3072 sc1
    s_waitcnt lgkmcnt(4)
    v_smfmac_f32_16x16x64_bf16 v[100:103], v[28:31], a[96:103], v8
    ds_read_b128 v[52:55], v6 offset:9216
    v_smfmac_f32_16x16x64_bf16 v[104:107], v[28:31], a[104:111], v8
    buffer_store_dwordx4 v[156:159], v6, s[8:11], s39 offen sc1
    s_add_u32 s39, s39, 262144
    s_waitcnt lgkmcnt(4)
    v_smfmac_f32_16x16x64_bf16 v[100:103], v[36:39], a[160:167], v8
    v_smfmac_f32_16x16x64_bf16 v[104:107], v[36:39], a[168:175], v8
    s_waitcnt lgkmcnt(3)
    v_smfmac_f32_16x16x64_bf16 v[100:103], v[40:43], a[192:199], v8
    v_smfmac_f32_16x16x64_bf16 v[104:107], v[40:43], a[200:207], v8
    s_waitcnt lgkmcnt(2)
    v_smfmac_f32_16x16x64_bf16 v[100:103], v[44:47], a[224:231], v8
    v_smfmac_f32_16x16x64_bf16 v[104:107], v[44:47], a[232:239], v8
    s_waitcnt lgkmcnt(1)
    v_smfmac_f32_16x16x64_bf16 v[100:103], v[48:51], v[192:199], v8
    v_smfmac_f32_16x16x64_bf16 v[104:107], v[48:51], v[200:207], v8
    s_waitcnt lgkmcnt(0)
    v_smfmac_f32_16x16x64_bf16 v[100:103], v[52:55], v[224:231], v8
    v_smfmac_f32_16x16x64_bf16 v[104:107], v[52:55], v[232:239], v8
    v_smfmac_f32_16x16x64_bf16 v[108:111], v[20:23], a[48:55], v8
    v_smfmac_f32_16x16x64_bf16 v[112:115], v[20:23], a[56:63], v8
    v_permlane32_swap_b32 v100, v104
    v_permlane32_swap_b32 v101, v105
    v_smfmac_f32_16x16x64_bf16 v[108:111], v[24:27], a[80:87], v8
    v_permlane32_swap_b32 v102, v106
    v_permlane32_swap_b32 v103, v107
    v_smfmac_f32_16x16x64_bf16 v[112:115], v[24:27], a[88:95], v8
    v_add_f32 v100, v100, v104
    v_add_f32 v101, v101, v105
    v_add_f32 v102, v102, v106
    v_smfmac_f32_16x16x64_bf16 v[108:111], v[28:31], a[112:119], v8
    v_add_f32 v103, v103, v107
    v_cvt_pk_bf16_f32 v100, v100, v101
    v_cvt_pk_bf16_f32 v101, v102, v103
    ds_write_b64 v9, v[100:101]
    v_smfmac_f32_16x16x64_bf16 v[112:115], v[28:31], a[120:127], v8
    v_smfmac_f32_16x16x64_bf16 v[108:111], v[36:39], a[176:183], v8
    v_smfmac_f32_16x16x64_bf16 v[112:115], v[36:39], a[184:191], v8
    v_smfmac_f32_16x16x64_bf16 v[108:111], v[40:43], a[208:215], v8
    v_smfmac_f32_16x16x64_bf16 v[112:115], v[40:43], a[216:223], v8
    s_waitcnt lgkmcnt(0)
    s_barrier
    ds_read_b64_tr_b16 v[132:133], v10 offset:0
    v_smfmac_f32_16x16x64_bf16 v[108:111], v[44:47], a[240:247], v8
    ds_read_b64_tr_b16 v[134:135], v10 offset:32
    ds_read_b64_tr_b16 v[136:137], v10 offset:576
    v_smfmac_f32_16x16x64_bf16 v[108:111], v[48:51], v[208:215], v8
    ds_read_b64_tr_b16 v[138:139], v10 offset:608
    v_smfmac_f32_16x16x64_bf16 v[108:111], v[52:55], v[240:247], v8
    ds_read_b64_tr_b16 v[140:141], v10 offset:1152
    ds_read_b64_tr_b16 v[142:143], v10 offset:1184
    v_smfmac_f32_16x16x64_bf16 v[112:115], v[44:47], a[248:255], v8
    ds_read_b64_tr_b16 v[144:145], v10 offset:1728
    ds_read_b64_tr_b16 v[146:147], v10 offset:1760
    v_smfmac_f32_16x16x64_bf16 v[112:115], v[48:51], v[216:223], v8
    v_cvt_pk_bf16_f32 v156, v108, v109
    v_smfmac_f32_16x16x64_bf16 v[112:115], v[52:55], v[248:255], v8
    v_cvt_pk_bf16_f32 v157, v110, v111
    ds_write_b64 v14, v[156:157]
    s_cmp_eq_u32 s31, 63
    s_nop 4
    v_cvt_pk_bf16_f32 v158, v112, v113
    v_cvt_pk_bf16_f32 v159, v114, v115
    ds_write_b64 v14, v[158:159] offset:576
    s_cbranch_scc1 TQ_LAST
    s_cmp_lt_u32 s17, 2
    s_cbranch_scc0 TQ_MM
    s_waitcnt lgkmcnt(8)
    v_mfma_f32_16x16x32_bf16 v[16:19], v[116:119], v[132:135], 0
    s_waitcnt lgkmcnt(6)
    v_mfma_f32_16x16x32_bf16 v[16:19], v[120:123], v[136:139], v[16:19]
    s_waitcnt lgkmcnt(4)
    v_mfma_f32_16x16x32_bf16 v[16:19], v[124:127], v[140:143], v[16:19]
    s_waitcnt lgkmcnt(2)
    v_mfma_f32_16x16x32_bf16 v[16:19], v[128:131], v[144:147], v[16:19]
    s_waitcnt lgkmcnt(0)
    s_barrier
    s_nop 5
    v_mul_f32 v20, s64, v16
    v_mul_f32 v21, s64, v17
    v_mul_f32 v22, s64, v18
    v_mul_f32 v23, s64, v19
    v_exp_f32 v152, v20
    v_exp_f32 v153, v21
    v_exp_f32 v154, v22
    v_exp_f32 v155, v23
    v_cmp_nge_f32 s[40:41], s65, abs(v20)
    v_cmp_nge_f32 s[42:43], s65, abs(v21)
    v_cmp_nge_f32 s[44:45], s65, abs(v22)
    v_cmp_nge_f32 s[46:47], s65, abs(v23)
    v_cvt_pk_bf16_f32 v152, v152, v153
    v_cvt_pk_bf16_f32 v153, v154, v155
    s_or_b64 vcc, s[40:41], s[42:43]
    s_or_b64 vcc, vcc, s[44:45]
    s_or_b64 vcc, vcc, s[46:47]
    v_or_b32 v152, s49, v152
    v_or_b32 v153, s49, v153
    s_cbranch_vccnz TQ_T_BAD
TQ_T_SEND:
    buffer_store_dwordx2 v[152:153], v1, s[8:11], s48 offen
TQ_J:
    v_mov_b32 v12, 28160
    s_waitcnt lgkmcnt(0)
    s_barrier
    ds_read_b32 v13, v12
    s_waitcnt vmcnt(1)
    s_cmp_eq_u32 s17, 3
    s_cbranch_scc0 TQ_FLR
    s_lshl_b32 s28, s18, 8
    s_add_u32 s28, s28, 1048576
    v_mov_b32 v96, 0
    v_mov_b32 v97, s31
    s_mov_b64 exec, 1
    buffer_store_dword v97, v96, s[8:11], s28 offen sc1
    s_mov_b64 exec, -1
TQ_FLR:
    v_mov_b64 v[132:133], -1
    v_mov_b64 v[134:135], -1
    s_add_u32 s72, s31, 3
    s_and_b32 s72, s72, 3
    s_lshl_b32 s72, s72, 15
    s_add_u32 s72, s72, s51
    s_add_u32 s73, s31, 2
    s_and_b32 s73, s73, 3
    s_lshl_b32 s73, s73, 19
    s_add_u32 s28, s72, s67
    buffer_store_dword v132, v191, s[8:11], s28 offen
    s_add_u32 s28, s28, 261120
    buffer_store_dword v132, v191, s[8:11], s28 offen sc1
    s_add_u32 s28, s73, s60
    buffer_store_dwordx4 v[132:135], v6, s[8:11], s28 offen
    buffer_store_dwordx4 v[132:135], v6, s[8:11], s28 offen offset:1024
    s_cmp_eq_u32 s63, 0
    s_cbranch_scc1 TQ_NA2
    s_add_u32 s28, s72, s68
    buffer_store_dword v132, v191, s[8:11], s28 offen
    s_add_u32 s28, s28, 261120
    buffer_store_dword v132, v191, s[8:11], s28 offen sc1
    s_add_u32 s28, s73, s66
    buffer_store_dwordx4 v[132:135], v6, s[8:11], s28 offen
    buffer_store_dwordx4 v[132:135], v6, s[8:11], s28 offen offset:1024
TQ_NA2:
    s_add_u32 s31, s31, 1
    s_waitcnt lgkmcnt(0)
    v_cmp_ne_u32 vcc, 0, v13
    s_nop 0
    s_cbranch_vccnz TQ_SLOW
    s_branch TQ_LOOP
TQ_LAST:
    buffer_store_dwordx4 v[156:159], v6, s[8:11], s39 offen sc1
    s_waitcnt vmcnt(0)
    s_barrier
    s_cmp_eq_u32 s17, 0
    s_cbranch_scc0 TQ_LA
    s_lshl_b32 s28, s18, 8
    s_add_u32 s28, s28, 1048580
    v_mov_b32 v96, 0
    v_mov_b32 v97, 128
    s_mov_b64 exec, 1
    buffer_store_dword v97, v96, s[8:11], s28 offen sc1
    s_mov_b64 exec, -1
TQ_LA:
    s_branch T_EXIT
TQ_SLOW:
    v_max_f32 v13, v16, v17
    v_max3_f32 v13, v13, v18, v19
    v_and_b32 v132, 0x70, v2
    v_lshlrev_b32 v132, 2, v132
    v_lshrrev_b32 v133, 8, v2
    v_lshl_add_u32 v133, v133, 2, v132
    ds_write_b32 v133, v13 offset:27648
    s_waitcnt lgkmcnt(0)
    s_barrier
    v_mov_b32 v13, 0
    ds_write_b32 v12, v13
    ds_read_b128 v[136:139], v132 offset:27648
    ds_read_b128 v[140:143], v132 offset:27664
    ds_read_b128 v[144:147], v132 offset:27680
    s_waitcnt lgkmcnt(2)
    v_max3_f32 v13, v136, v137, v138
    s_waitcnt lgkmcnt(1)
    v_max3_f32 v13, v13, v139, v140
    v_max3_f32 v13, v13, v141, v142
    s_waitcnt lgkmcnt(0)
    v_max3_f32 v13, v13, v143, v144
    v_max3_f32 v13, v13, v145, v146
    v_max_f32 v13, v13, v147
    v_sub_f32 v152, v16, v13
    v_sub_f32 v153, v17, v13
    v_sub_f32 v154, v18, v13
    v_sub_f32 v155, v19, v13
    v_mul_f32 v152, s64, v152
    v_mul_f32 v153, s64, v153
    v_mul_f32 v154, s64, v154
    v_mul_f32 v155, s64, v155
    v_exp_f32 v152, v152
    v_exp_f32 v153, v153
    v_exp_f32 v154, v154
    v_exp_f32 v155, v155
    v_cvt_pk_bf16_f32 v152, v152, v153
    v_cvt_pk_bf16_f32 v153, v154, v155
    v_and_b32 v152, 0x7fff7fff, v152
    v_and_b32 v153, 0x7fff7fff, v153
    s_cmp_lt_u32 s17, 2
    s_cbranch_scc0 TQ_SLOWM
    buffer_store_dwordx2 v[152:153], v1, s[8:11], s48 offen offset:1024
    s_branch TQ_LOOP
TQ_SLOWM:
    buffer_store_dword v152, v1, s[8:11], s48 offen offset:1024
    s_branch TQ_LOOP
TQ_RES:
    buffer_load_dwordx4 v[16:19], v6, s[8:11], s74 offen offset:0 sc1
    buffer_load_dwordx4 v[20:23], v6, s[8:11], s74 offen offset:1024 sc1
    s_add_u32 s30, s30, 1
    s_cmp_gt_u32 s30, 600000
    s_cbranch_scc1 T_EXIT
    s_branch TQ_RE
TQ_GAS:
    buffer_load_dwordx4 v[56:59], v182, s[8:11], s33 offen offset:0 sc1
    buffer_load_dwordx4 v[60:63], v182, s[8:11], s33 offen offset:512 sc1
    buffer_load_dwordx4 v[64:67], v182, s[8:11], s34 offen offset:0 sc1
    buffer_load_dwordx4 v[68:71], v182, s[8:11], s34 offen offset:512 sc1
    buffer_load_dwordx4 v[72:75], v182, s[8:11], s35 offen offset:0 sc1
    s_add_u32 s30, s30, 1
    s_cmp_gt_u32 s30, 600000
    s_cbranch_scc1 T_EXIT
    s_branch TQ_GA
TQ_CK:
    s_bitcmp1_b32 s28, 0
    s_cselect_b32 s29, 1, 0
    s_lshr_b32 s28, s28, 3
    s_lshl_b32 s28, s28, 2
    s_add_u32 s28, s28, 208
    s_cmp_eq_u32 s29, 1
    s_cbranch_scc1 TQ_CKT
    v_mov_b32 v96, 0
    buffer_load_dword v190, v96, s[4:7], s28 offen sc1
    s_branch TQ_CKR
TQ_CKT:
    v_readfirstlane_b32 s29, v190
    s_nop 0
    s_cmp_ge_u32 s29, 1
    s_cbranch_scc1 TQ_CKR
    v_mov_b32 v96, 0
TQ_CKW:
    buffer_load_dword v190, v96, s[4:7], s28 offen sc1
    s_add_u32 s3, s3, 1
    s_cmp_gt_u32 s3, 2000000
    s_cbranch_scc1 K_END
    s_waitcnt vmcnt(0)
    v_readfirstlane_b32 s29, v190
    s_nop 0
    s_cmp_ge_u32 s29, 1
    s_cbranch_scc1 TQ_CKW_OK
    s_sleep 2
    s_branch TQ_CKW
TQ_CKW_OK:
    s_branch TQ_CKR
TQ_T_BAD:
    s_or_b32 s28, s49, 0x7fc07fc0
    v_mov_b32 v152, s28
    v_mov_b32 v153, s28
    v_mov_b32 v12, 28160
    v_mov_b32 v13, 1
    ds_write_b32 v12, v13
    s_branch TQ_T_SEND
TQ_M_BAD:
    s_or_b32 s28, s49, 0x7fc07fc0
    v_mov_b32 v152, s28
    v_mov_b32 v153, s28
    v_mov_b32 v12, 28160
    v_mov_b32 v13, 1
    ds_write_b32 v12, v13
    s_branch TQ_M_SEND
TQ_MM:
    s_waitcnt lgkmcnt(0)
    s_barrier
    ds_read_b64_tr_b16 v[116:117], v15 offset:0
    ds_read_b64_tr_b16 v[118:119], v15 offset:64
    ds_read_b64_tr_b16 v[120:121], v15 offset:1152
    ds_read_b64_tr_b16 v[122:123], v15 offset:1216
    ds_read_b64_tr_b16 v[124:125], v15 offset:2304
    ds_read_b64_tr_b16 v[126:127], v15 offset:2368
    ds_read_b64_tr_b16 v[128:129], v15 offset:3456
    ds_read_b64_tr_b16 v[130:131], v15 offset:3520
    s_waitcnt lgkmcnt(6)
    v_mfma_f32_16x16x32_bf16 v[16:19], v[116:119], v[132:135], 0
    s_waitcnt lgkmcnt(4)
    v_mfma_f32_16x16x32_bf16 v[16:19], v[120:123], v[136:139], v[16:19]
    s_waitcnt lgkmcnt(2)
    v_mfma_f32_16x16x32_bf16 v[16:19], v[124:127], v[140:143], v[16:19]
    s_waitcnt lgkmcnt(0)
    v_mfma_f32_16x16x32_bf16 v[16:19], v[128:131], v[144:147], v[16:19]
    s_nop 7
    v_permlane32_swap_b32 v16, v18
    v_permlane32_swap_b32 v17, v19
    v_add_f32 v16, v16, v18
    v_add_f32 v17, v17, v19
    v_mul_f32 v20, s64, v16
    v_mul_f32 v21, s64, v17
    v_exp_f32 v152, v20
    v_exp_f32 v153, v21
    v_cmp_nge_f32 s[40:41], s65, abs(v20)
    v_cmp_nge_f32 s[42:43], s65, abs(v21)
    v_cvt_pk_bf16_f32 v152, v152, v153
    s_or_b64 vcc, s[40:41], s[42:43]
    v_or_b32 v152, s49, v152
    s_cbranch_vccnz TQ_M_BAD
TQ_M_SEND:
    buffer_store_dword v152, v1, s[8:11], s48 offen
    v_mov_b32 v18, v16
    v_mov_b32 v19, v17
    s_branch TQ_J
K_VO:
    v_lshrrev_b32 v28, 2, v22
    v_and_b32 v29, 3, v22
    v_lshlrev_b32 v31, 1, v28
    s_lshr_b32 s28, s17, 1
    s_lshl_b32 s28, s28, 3
    s_and_b32 s29, s17, 1
    s_add_u32 s28, s28, s29
    v_add_u32 v31, s28, v31
    v_lshlrev_b32 v31, 11, v31
    v_lshl_add_u32 v31, v24, 3, v31
    v_lshlrev_b32 v32, 2, v28
    v_add_u32 v32, s17, v32
    v_xor_b32 v32, s22, v32
    v_lshl_add_u32 v31, v32, 7, v31
    v_lshl_add_u32 v32, v25, 2, v29
    v_lshlrev_b32 v32, 4, v32
    v_add_u32 v31, v31, v32
    v_add_u32 v14, s76, v31
    v_lshlrev_b32 v31, 7, v25
    v_lshl_add_u32 v1, v23, 4, v31
    v_xor_b32 v31, v24, v26
    v_lshl_add_u32 v1, v31, 30, v1
    v_lshlrev_b32 v31, 10, v27
    v_lshl_add_u32 v31, v30, 4, v31
    v_and_b32 v32, 1, v20
    v_lshl_add_u32 v31, v32, 3, v31
    v_add_u32 v190, 131072, v31
    s_mov_b32 s64, 0x00ff00ff
    s_mov_b32 s65, 0xff00ff00
    v_lshrrev_b32 v31, 1, v23
    v_and_b32 v32, 1, v20
    v_lshlrev_b32 v32, 4, v32
    v_mov_b32 v33, 0x3f80
    v_lshlrev_b32 v33, v32, v33
    v_cmp_eq_u32 vcc, 0, v31
    s_nop 1
    v_cndmask_b32 v184, 0, v33, vcc
    v_cmp_eq_u32 vcc, 1, v31
    s_nop 1
    v_cndmask_b32 v185, 0, v33, vcc
    v_cmp_eq_u32 vcc, 2, v31
    s_nop 1
    v_cndmask_b32 v186, 0, v33, vcc
    v_cmp_eq_u32 vcc, 3, v31
    s_nop 1
    v_cndmask_b32 v187, 0, v33, vcc
    v_mov_b32 v178, 0x3f803f80
    v_mov_b32 v179, 0x3f803f80
    v_mov_b32 v180, 0x3f803f80
    v_mov_b32 v181, 0x3f803f80
    v_mov_b32 v164, 0
    v_mov_b32 v165, 0
    v_mov_b32 v166, 0
    v_mov_b32 v167, 0
    v_mov_b32 v168, 0
    v_mov_b32 v169, 0
    v_mov_b32 v170, 0
    v_mov_b32 v171, 0
    v_mov_b32 v172, 0
    v_mov_b32 v173, 0
    v_mov_b32 v174, 0
    v_mov_b32 v175, 0
    v_lshrrev_b32 v31, 1, v23
    v_and_b32 v32, 1, v20
    v_lshlrev_b32 v32, 4, v32
    v_mov_b32 v33, 0x3f80
    v_lshlrev_b32 v33, v32, v33
    v_cmp_eq_u32 vcc, 0, v31
    s_nop 1
    v_cndmask_b32 v118, 0, v33, vcc
    v_cmp_eq_u32 vcc, 1, v31
    s_nop 1
    v_cndmask_b32 v119, 0, v33, vcc
    v_cmp_eq_u32 vcc, 2, v31
    s_nop 1
    v_cndmask_b32 v120, 0, v33, vcc
    v_cmp_eq_u32 vcc, 3, v31
    s_nop 1
    v_cndmask_b32 v121, 0, v33, vcc
    v_cmp_eq_u32 vcc, v25, v26
    s_nop 1
    v_cndmask_b32 v118, 0, v118, vcc
    v_cndmask_b32 v119, 0, v119, vcc
    v_cndmask_b32 v120, 0, v120, vcc
    v_cndmask_b32 v121, 0, v121, vcc
    s_add_u32 s38, s38, 8192
    s_lshl_b32 s28, s17, 11
    s_add_u32 s38, s38, s28
    s_add_u32 s70, s28, 131072
    v_mov_b32 v36, -1
    v_mov_b32 v37, -1
    v_mov_b32 v38, -1
    v_mov_b32 v39, -1
    v_lshrrev_b32 v0, 1, v1
    v_lshlrev_b32 v122, 1, v6
    v_mov_b32 v40, 0
    v_mov_b32 v41, 1
    v_lshlrev_b32 v44, 13, v21
    v_lshl_add_u32 v44, v22, 4, v44
    v_lshlrev_b32 v52, 4, v25
    v_add_u32 v52, v52, v24
    v_lshlrev_b32 v52, 8, v52
    v_lshl_add_u32 v52, v22, 2, v52
    s_lshl_b32 s28, s17, 6
    v_add_u32 v52, s28, v52
    v_mul_u32_u24 v45, 5120, v21
    v_lshl_add_u32 v45, v22, 2, v45
    s_mul_i32 s28, s17, 320
    v_add_u32 v45, s28, v45
    s_lshl_b32 s40, s18, 8
    s_and_b32 s29, s17, 1
    s_mul_i32 s42, s29, 2621440
    s_add_u32 s42, s42, s40
    s_lshr_b32 s29, s17, 1
    s_mul_i32 s43, s29, 262144
    s_add_u32 s43, s43, s42
    s_mul_i32 s44, s29, 1310720
    s_add_u32 s44, s44, s42
    s_mul_i32 s41, s18, 163840
    s_mul_i32 s28, s17, 10240
    s_add_u32 s41, s41, s28
    s_lshl_b32 s45, s17, 14
    s_mov_b32 s46, 0x05040100
    s_mov_b32 s47, 0x07060302
    s_mov_b32 s75, 0x20000
    s_mov_b32 s74, 5242880
    s_cmp_lt_u32 s17, 2
    s_cselect_b64 s[72:73], s[80:81], s[84:85]
    s_xor_b32 s28, s17, 0
    s_lshl_b32 s28, s28, 14
    v_add_u32 v48, s28, v52
    s_xor_b32 s28, s17, 1
    s_lshl_b32 s28, s28, 14
    v_add_u32 v49, s28, v52
    s_xor_b32 s28, s17, 2
    s_lshl_b32 s28, s28, 14
    v_add_u32 v50, s28, v52
    s_xor_b32 s28, s17, 3
    s_lshl_b32 s28, s28, 14
    v_add_u32 v51, s28, v52
    s_add_u32 m0, s45, 0
    s_add_u32 s28, s43, 0
    buffer_load_dwordx4 v44, s[88:91], s28 offen offset:0 lds
    s_add_u32 s28, s43, 31744
    buffer_load_dwordx4 v44, s[88:91], s28 offen offset:1024 lds
    s_add_u32 s28, s43, 63488
    buffer_load_dwordx4 v44, s[88:91], s28 offen offset:2048 lds
    s_add_u32 s28, s43, 95232
    buffer_load_dwordx4 v44, s[88:91], s28 offen offset:3072 lds
    s_add_u32 m0, s45, 4096
    s_add_u32 s28, s43, 131072
    buffer_load_dwordx4 v44, s[88:91], s28 offen offset:0 lds
    s_add_u32 s28, s43, 162816
    buffer_load_dwordx4 v44, s[88:91], s28 offen offset:1024 lds
    s_add_u32 s28, s43, 194560
    buffer_load_dwordx4 v44, s[88:91], s28 offen offset:2048 lds
    s_add_u32 s28, s43, 226304
    buffer_load_dwordx4 v44, s[88:91], s28 offen offset:3072 lds
    s_add_u32 m0, s45, 8192
    s_add_u32 s28, s43, 1310720
    buffer_load_dwordx4 v44, s[88:91], s28 offen offset:0 lds
    s_add_u32 s28, s43, 1342464
    buffer_load_dwordx4 v44, s[88:91], s28 offen offset:1024 lds
    s_add_u32 s28, s43, 1374208
    buffer_load_dwordx4 v44, s[88:91], s28 offen offset:2048 lds
    s_add_u32 s28, s43, 1405952
    buffer_load_dwordx4 v44, s[88:91], s28 offen offset:3072 lds
    s_add_u32 m0, s45, 12288
    s_add_u32 s28, s43, 1441792
    buffer_load_dwordx4 v44, s[88:91], s28 offen offset:0 lds
    s_add_u32 s28, s43, 1473536
    buffer_load_dwordx4 v44, s[88:91], s28 offen offset:1024 lds
    s_add_u32 s28, s43, 1505280
    buffer_load_dwordx4 v44, s[88:91], s28 offen offset:2048 lds
    s_add_u32 s28, s43, 1537024
    buffer_load_dwordx4 v44, s[88:91], s28 offen offset:3072 lds
    s_mul_i32 s29, s17, 10240
    s_add_u32 m0, s29, 65536
    s_add_u32 s28, s41, 0
    buffer_load_dwordx4 v6, s[92:95], s28 offen offset:0 lds
    buffer_load_dwordx4 v6, s[92:95], s28 offen offset:1024 lds
    buffer_load_dwordx4 v6, s[92:95], s28 offen offset:2048 lds
    buffer_load_dwordx4 v6, s[92:95], s28 offen offset:3072 lds
    s_add_u32 m0, s29, 69632
    s_add_u32 s28, s41, 4096
    buffer_load_dwordx4 v6, s[92:95], s28 offen offset:0 lds
    buffer_load_dwordx4 v6, s[92:95], s28 offen offset:1024 lds
    buffer_load_dwordx4 v6, s[92:95], s28 offen offset:2048 lds
    buffer_load_dwordx4 v6, s[92:95], s28 offen offset:3072 lds
    s_add_u32 m0, s29, 73728
    s_add_u32 s28, s41, 8192
    buffer_load_dwordx4 v6, s[92:95], s28 offen offset:0 lds
    buffer_load_dwordx4 v6, s[92:95], s28 offen offset:1024 lds
    s_waitcnt vmcnt(10)
    s_barrier
    s_cmp_eq_u32 s17, 0
    s_cbranch_scc0 TV_SKA
    s_mov_b64 exec, 1
    global_atomic_add v42, v40, v41, s[4:5] offset:12 sc0
    s_mov_b64 exec, -1
TV_SKA:
    ds_read2st64_b32 v[76:77], v48 offset0:0 offset1:32
    ds_read2st64_b32 v[78:79], v48 offset0:2 offset1:34
    ds_read2st64_b32 v[80:81], v48 offset0:4 offset1:36
    ds_read2st64_b32 v[82:83], v48 offset0:6 offset1:38
    ds_read2st64_b32 v[84:85], v48 offset0:8 offset1:40
    ds_read2st64_b32 v[86:87], v48 offset0:10 offset1:42
    ds_read2st64_b32 v[88:89], v48 offset0:12 offset1:44
    ds_read2st64_b32 v[90:91], v48 offset0:14 offset1:46
    ds_read2st64_b32 v[92:93], v49 offset0:0 offset1:32
    ds_read2st64_b32 v[94:95], v49 offset0:2 offset1:34
    ds_read2st64_b32 v[96:97], v49 offset0:4 offset1:36
    ds_read2st64_b32 v[98:99], v49 offset0:6 offset1:38
    ds_read2st64_b32 v[100:101], v49 offset0:8 offset1:40
    ds_read2st64_b32 v[102:103], v49 offset0:10 offset1:42
    ds_read2st64_b32 v[104:105], v49 offset0:12 offset1:44
    ds_read2st64_b32 v[106:107], v49 offset0:14 offset1:46
    ds_read2st64_b32 v[124:125], v50 offset0:0 offset1:32
    ds_read2st64_b32 v[126:127], v50 offset0:2 offset1:34
    ds_read2st64_b32 v[128:129], v50 offset0:4 offset1:36
    ds_read2st64_b32 v[130:131], v50 offset0:6 offset1:38
    ds_read2st64_b32 v[132:133], v50 offset0:8 offset1:40
    ds_read2st64_b32 v[134:135], v50 offset0:10 offset1:42
    ds_read2st64_b32 v[136:137], v50 offset0:12 offset1:44
    ds_read2st64_b32 v[138:139], v50 offset0:14 offset1:46
    ds_read2st64_b32 v[140:141], v51 offset0:0 offset1:32
    ds_read2st64_b32 v[142:143], v51 offset0:2 offset1:34
    ds_read2st64_b32 v[144:145], v51 offset0:4 offset1:36
    ds_read2st64_b32 v[146:147], v51 offset0:6 offset1:38
    ds_read2st64_b32 v[148:149], v51 offset0:8 offset1:40
    ds_read2st64_b32 v[150:151], v51 offset0:10 offset1:42
    ds_read2st64_b32 v[152:153], v51 offset0:12 offset1:44
    ds_read2st64_b32 v[154:155], v51 offset0:14 offset1:46
    s_waitcnt lgkmcnt(15)
    v_perm_b32 v46, v77, v76, s46
    v_perm_b32 v47, v77, v76, s47
    v_accvgpr_write_b32 a0, v46
    v_accvgpr_write_b32 a8, v47
    v_perm_b32 v46, v79, v78, s46
    v_perm_b32 v47, v79, v78, s47
    v_accvgpr_write_b32 a1, v46
    v_accvgpr_write_b32 a9, v47
    v_perm_b32 v46, v81, v80, s46
    v_perm_b32 v47, v81, v80, s47
    v_accvgpr_write_b32 a2, v46
    v_accvgpr_write_b32 a10, v47
    v_perm_b32 v46, v83, v82, s46
    v_perm_b32 v47, v83, v82, s47
    v_accvgpr_write_b32 a3, v46
    v_accvgpr_write_b32 a11, v47
    v_perm_b32 v46, v85, v84, s46
    v_perm_b32 v47, v85, v84, s47
    v_accvgpr_write_b32 a4, v46
    v_accvgpr_write_b32 a12, v47
    v_perm_b32 v46, v87, v86, s46
    v_perm_b32 v47, v87, v86, s47
    v_accvgpr_write_b32 a5, v46
    v_accvgpr_write_b32 a13, v47
    v_perm_b32 v46, v89, v88, s46
    v_perm_b32 v47, v89, v88, s47
    v_accvgpr_write_b32 a6, v46
    v_accvgpr_write_b32 a14, v47
    v_perm_b32 v46, v91, v90, s46
    v_perm_b32 v47, v91, v90, s47
    v_accvgpr_write_b32 a7, v46
    v_accvgpr_write_b32 a15, v47
    v_perm_b32 v46, v93, v92, s46
    v_perm_b32 v47, v93, v92, s47
    v_accvgpr_write_b32 a16, v46
    v_accvgpr_write_b32 a24, v47
    v_perm_b32 v46, v95, v94, s46
    v_perm_b32 v47, v95, v94, s47
    v_accvgpr_write_b32 a17, v46
    v_accvgpr_write_b32 a25, v47
    v_perm_b32 v46, v97, v96, s46
    v_perm_b32 v47, v97, v96, s47
    v_accvgpr_write_b32 a18, v46
    v_accvgpr_write_b32 a26, v47
    v_perm_b32 v46, v99, v98, s46
    v_perm_b32 v47, v99, v98, s47
    v_accvgpr_write_b32 a19, v46
    v_accvgpr_write_b32 a27, v47
    v_perm_b32 v46, v101, v100, s46
    v_perm_b32 v47, v101, v100, s47
    v_accvgpr_write_b32 a20, v46
    v_accvgpr_write_b32 a28, v47
    v_perm_b32 v46, v103, v102, s46
    v_perm_b32 v47, v103, v102, s47
    v_accvgpr_write_b32 a21, v46
    v_accvgpr_write_b32 a29, v47
    v_perm_b32 v46, v105, v104, s46
    v_perm_b32 v47, v105, v104, s47
    v_accvgpr_write_b32 a22, v46
    v_accvgpr_write_b32 a30, v47
    v_perm_b32 v46, v107, v106, s46
    v_perm_b32 v47, v107, v106, s47
    v_accvgpr_write_b32 a23, v46
    v_accvgpr_write_b32 a31, v47
    v_perm_b32 v46, v125, v124, s46
    v_perm_b32 v47, v125, v124, s47
    v_accvgpr_write_b32 a32, v46
    v_accvgpr_write_b32 a40, v47
    s_waitcnt lgkmcnt(14)
    v_perm_b32 v46, v127, v126, s46
    v_perm_b32 v47, v127, v126, s47
    v_accvgpr_write_b32 a33, v46
    v_accvgpr_write_b32 a41, v47
    s_waitcnt lgkmcnt(13)
    v_perm_b32 v46, v129, v128, s46
    v_perm_b32 v47, v129, v128, s47
    v_accvgpr_write_b32 a34, v46
    v_accvgpr_write_b32 a42, v47
    s_waitcnt lgkmcnt(12)
    v_perm_b32 v46, v131, v130, s46
    v_perm_b32 v47, v131, v130, s47
    v_accvgpr_write_b32 a35, v46
    v_accvgpr_write_b32 a43, v47
    s_waitcnt lgkmcnt(11)
    v_perm_b32 v46, v133, v132, s46
    v_perm_b32 v47, v133, v132, s47
    v_accvgpr_write_b32 a36, v46
    v_accvgpr_write_b32 a44, v47
    s_waitcnt lgkmcnt(10)
    v_perm_b32 v46, v135, v134, s46
    v_perm_b32 v47, v135, v134, s47
    v_accvgpr_write_b32 a37, v46
    v_accvgpr_write_b32 a45, v47
    s_waitcnt lgkmcnt(9)
    v_perm_b32 v46, v137, v136, s46
    v_perm_b32 v47, v137, v136, s47
    v_accvgpr_write_b32 a38, v46
    v_accvgpr_write_b32 a46, v47
    s_waitcnt lgkmcnt(8)
    v_perm_b32 v46, v139, v138, s46
    v_perm_b32 v47, v139, v138, s47
    v_accvgpr_write_b32 a39, v46
    v_accvgpr_write_b32 a47, v47
    s_waitcnt lgkmcnt(7)
    v_perm_b32 v46, v141, v140, s46
    v_perm_b32 v47, v141, v140, s47
    v_accvgpr_write_b32 a48, v46
    v_accvgpr_write_b32 a56, v47
    s_waitcnt lgkmcnt(6)
    v_perm_b32 v46, v143, v142, s46
    v_perm_b32 v47, v143, v142, s47
    v_accvgpr_write_b32 a49, v46
    v_accvgpr_write_b32 a57, v47
    s_waitcnt lgkmcnt(5)
    v_perm_b32 v46, v145, v144, s46
    v_perm_b32 v47, v145, v144, s47
    v_accvgpr_write_b32 a50, v46
    v_accvgpr_write_b32 a58, v47
    s_waitcnt lgkmcnt(4)
    v_perm_b32 v46, v147, v146, s46
    v_perm_b32 v47, v147, v146, s47
    v_accvgpr_write_b32 a51, v46
    v_accvgpr_write_b32 a59, v47
    s_waitcnt lgkmcnt(3)
    v_perm_b32 v46, v149, v148, s46
    v_perm_b32 v47, v149, v148, s47
    v_accvgpr_write_b32 a52, v46
    v_accvgpr_write_b32 a60, v47
    s_waitcnt lgkmcnt(2)
    v_perm_b32 v46, v151, v150, s46
    v_perm_b32 v47, v151, v150, s47
    v_accvgpr_write_b32 a53, v46
    v_accvgpr_write_b32 a61, v47
    s_waitcnt lgkmcnt(1)
    v_perm_b32 v46, v153, v152, s46
    v_perm_b32 v47, v153, v152, s47
    v_accvgpr_write_b32 a54, v46
    v_accvgpr_write_b32 a62, v47
    s_waitcnt lgkmcnt(0)
    v_perm_b32 v46, v155, v154, s46
    v_perm_b32 v47, v155, v154, s47
    v_accvgpr_write_b32 a55, v46
    v_accvgpr_write_b32 a63, v47
    s_waitcnt lgkmcnt(0)
    s_barrier
    s_add_u32 m0, s45, 0
    s_add_u32 s28, s43, 524288
    buffer_load_dwordx4 v44, s[88:91], s28 offen offset:0 lds
    s_add_u32 s28, s43, 556032
    buffer_load_dwordx4 v44, s[88:91], s28 offen offset:1024 lds
    s_add_u32 s28, s43, 587776
    buffer_load_dwordx4 v44, s[88:91], s28 offen offset:2048 lds
    s_add_u32 s28, s43, 619520
    buffer_load_dwordx4 v44, s[88:91], s28 offen offset:3072 lds
    s_add_u32 m0, s45, 4096
    s_add_u32 s28, s43, 655360
    buffer_load_dwordx4 v44, s[88:91], s28 offen offset:0 lds
    s_add_u32 s28, s43, 687104
    buffer_load_dwordx4 v44, s[88:91], s28 offen offset:1024 lds
    s_add_u32 s28, s43, 718848
    buffer_load_dwordx4 v44, s[88:91], s28 offen offset:2048 lds
    s_add_u32 s28, s43, 750592
    buffer_load_dwordx4 v44, s[88:91], s28 offen offset:3072 lds
    s_add_u32 m0, s45, 8192
    s_add_u32 s28, s43, 1835008
    buffer_load_dwordx4 v44, s[88:91], s28 offen offset:0 lds
    s_add_u32 s28, s43, 1866752
    buffer_load_dwordx4 v44, s[88:91], s28 offen offset:1024 lds
    s_add_u32 s28, s43, 1898496
    buffer_load_dwordx4 v44, s[88:91], s28 offen offset:2048 lds
    s_add_u32 s28, s43, 1930240
    buffer_load_dwordx4 v44, s[88:91], s28 offen offset:3072 lds
    s_add_u32 m0, s45, 12288
    s_add_u32 s28, s43, 1966080
    buffer_load_dwordx4 v44, s[88:91], s28 offen offset:0 lds
    s_add_u32 s28, s43, 1997824
    buffer_load_dwordx4 v44, s[88:91], s28 offen offset:1024 lds
    s_add_u32 s28, s43, 2029568
    buffer_load_dwordx4 v44, s[88:91], s28 offen offset:2048 lds
    s_add_u32 s28, s43, 2061312
    buffer_load_dwordx4 v44, s[88:91], s28 offen offset:3072 lds
    v_xor_b32 v45, 0x10000, v45
    v_xor_b32 v48, 0x10000, v48
    v_xor_b32 v49, 0x10000, v49
    v_xor_b32 v50, 0x10000, v50
    v_xor_b32 v51, 0x10000, v51
    v_xor_b32 v52, 0x10000, v52
    s_waitcnt vmcnt(16)
    s_barrier
    s_cmp_eq_u32 s17, 0
    s_cbranch_scc0 TV_SKB
    v_readfirstlane_b32 s28, v42
    s_nop 0
    s_cmp_eq_u32 s28, 63
    s_cbranch_scc0 TV_SKB
    s_mov_b64 exec, 1
    global_load_dwordx2 v[42:43], v40, s[4:5] sc1
    s_waitcnt vmcnt(0)
    v_min_u32 v42, v42, v43
    v_min_u32 v42, 32, v42
    v_add_u32 v42, 1, v42
    global_store_dword v40, v42, s[4:5] offset:140 sc1
    s_mov_b64 exec, -1
TV_SKB:
    ds_read_b32 a160, v45 offset:0
    ds_read_b32 a161, v45 offset:1280
    ds_read_b32 a162, v45 offset:2560
    ds_read_b32 a163, v45 offset:3840
    ds_read_b32 a164, v45 offset:20480
    ds_read_b32 a165, v45 offset:21760
    ds_read_b32 a166, v45 offset:23040
    ds_read_b32 a167, v45 offset:24320
    ds_read_b32 a192, v45 offset:64
    ds_read_b32 a193, v45 offset:1344
    ds_read_b32 a194, v45 offset:2624
    ds_read_b32 a195, v45 offset:3904
    ds_read_b32 a196, v45 offset:20544
    ds_read_b32 a197, v45 offset:21824
    ds_read_b32 a198, v45 offset:23104
    ds_read_b32 a199, v45 offset:24384
    ds_read_b32 a224, v45 offset:128
    ds_read_b32 a225, v45 offset:1408
    ds_read_b32 a226, v45 offset:2688
    ds_read_b32 a227, v45 offset:3968
    ds_read_b32 a228, v45 offset:20608
    ds_read_b32 a229, v45 offset:21888
    ds_read_b32 a230, v45 offset:23168
    ds_read_b32 a231, v45 offset:24448
    ds_read_b32 v192, v45 offset:192
    ds_read_b32 v193, v45 offset:1472
    ds_read_b32 v194, v45 offset:2752
    ds_read_b32 v195, v45 offset:4032
    ds_read_b32 v196, v45 offset:20672
    ds_read_b32 v197, v45 offset:21952
    ds_read_b32 v198, v45 offset:23232
    ds_read_b32 v199, v45 offset:24512
    ds_read_b32 v224, v45 offset:256
    ds_read_b32 v225, v45 offset:1536
    ds_read_b32 v226, v45 offset:2816
    ds_read_b32 v227, v45 offset:4096
    ds_read_b32 v228, v45 offset:20736
    ds_read_b32 v229, v45 offset:22016
    ds_read_b32 v230, v45 offset:23296
    ds_read_b32 v231, v45 offset:24576
    s_waitcnt lgkmcnt(0)
    s_barrier
    s_mul_i32 s29, s17, 10240
    s_add_u32 m0, s29, 65536
    s_add_u32 s28, s41, 40960
    buffer_load_dwordx4 v6, s[92:95], s28 offen offset:0 lds
    buffer_load_dwordx4 v6, s[92:95], s28 offen offset:1024 lds
    buffer_load_dwordx4 v6, s[92:95], s28 offen offset:2048 lds
    buffer_load_dwordx4 v6, s[92:95], s28 offen offset:3072 lds
    s_add_u32 m0, s29, 69632
    s_add_u32 s28, s41, 45056
    buffer_load_dwordx4 v6, s[92:95], s28 offen offset:0 lds
    buffer_load_dwordx4 v6, s[92:95], s28 offen offset:1024 lds
    buffer_load_dwordx4 v6, s[92:95], s28 offen offset:2048 lds
    buffer_load_dwordx4 v6, s[92:95], s28 offen offset:3072 lds
    s_add_u32 m0, s29, 73728
    s_add_u32 s28, s41, 49152
    buffer_load_dwordx4 v6, s[92:95], s28 offen offset:0 lds
    buffer_load_dwordx4 v6, s[92:95], s28 offen offset:1024 lds
    v_xor_b32 v45, 0x10000, v45
    v_xor_b32 v48, 0x10000, v48
    v_xor_b32 v49, 0x10000, v49
    v_xor_b32 v50, 0x10000, v50
    v_xor_b32 v51, 0x10000, v51
    v_xor_b32 v52, 0x10000, v52
    s_waitcnt vmcnt(10)
    s_barrier
    ds_read2st64_b32 v[76:77], v48 offset0:0 offset1:32
    ds_read2st64_b32 v[78:79], v48 offset0:2 offset1:34
    ds_read2st64_b32 v[80:81], v48 offset0:4 offset1:36
    ds_read2st64_b32 v[82:83], v48 offset0:6 offset1:38
    ds_read2st64_b32 v[84:85], v48 offset0:8 offset1:40
    ds_read2st64_b32 v[86:87], v48 offset0:10 offset1:42
    ds_read2st64_b32 v[88:89], v48 offset0:12 offset1:44
    ds_read2st64_b32 v[90:91], v48 offset0:14 offset1:46
    ds_read2st64_b32 v[92:93], v49 offset0:0 offset1:32
    ds_read2st64_b32 v[94:95], v49 offset0:2 offset1:34
    ds_read2st64_b32 v[96:97], v49 offset0:4 offset1:36
    ds_read2st64_b32 v[98:99], v49 offset0:6 offset1:38
    ds_read2st64_b32 v[100:101], v49 offset0:8 offset1:40
    ds_read2st64_b32 v[102:103], v49 offset0:10 offset1:42
    ds_read2st64_b32 v[104:105], v49 offset0:12 offset1:44
    ds_read2st64_b32 v[106:107], v49 offset0:14 offset1:46
    ds_read2st64_b32 v[124:125], v50 offset0:0 offset1:32
    ds_read2st64_b32 v[126:127], v50 offset0:2 offset1:34
    ds_read2st64_b32 v[128:129], v50 offset0:4 offset1:36
    ds_read2st64_b32 v[130:131], v50 offset0:6 offset1:38
    ds_read2st64_b32 v[132:133], v50 offset0:8 offset1:40
    ds_read2st64_b32 v[134:135], v50 offset0:10 offset1:42
    ds_read2st64_b32 v[136:137], v50 offset0:12 offset1:44
    ds_read2st64_b32 v[138:139], v50 offset0:14 offset1:46
    ds_read2st64_b32 v[140:141], v51 offset0:0 offset1:32
    ds_read2st64_b32 v[142:143], v51 offset0:2 offset1:34
    ds_read2st64_b32 v[144:145], v51 offset0:4 offset1:36
    ds_read2st64_b32 v[146:147], v51 offset0:6 offset1:38
    ds_read2st64_b32 v[148:149], v51 offset0:8 offset1:40
    ds_read2st64_b32 v[150:151], v51 offset0:10 offset1:42
    ds_read2st64_b32 v[152:153], v51 offset0:12 offset1:44
    ds_read2st64_b32 v[154:155], v51 offset0:14 offset1:46
    s_waitcnt lgkmcnt(15)
    v_perm_b32 v46, v77, v76, s46
    v_perm_b32 v47, v77, v76, s47
    v_accvgpr_write_b32 a64, v46
    v_accvgpr_write_b32 a72, v47
    v_perm_b32 v46, v79, v78, s46
    v_perm_b32 v47, v79, v78, s47
    v_accvgpr_write_b32 a65, v46
    v_accvgpr_write_b32 a73, v47
    v_perm_b32 v46, v81, v80, s46
    v_perm_b32 v47, v81, v80, s47
    v_accvgpr_write_b32 a66, v46
    v_accvgpr_write_b32 a74, v47
    v_perm_b32 v46, v83, v82, s46
    v_perm_b32 v47, v83, v82, s47
    v_accvgpr_write_b32 a67, v46
    v_accvgpr_write_b32 a75, v47
    v_perm_b32 v46, v85, v84, s46
    v_perm_b32 v47, v85, v84, s47
    v_accvgpr_write_b32 a68, v46
    v_accvgpr_write_b32 a76, v47
    v_perm_b32 v46, v87, v86, s46
    v_perm_b32 v47, v87, v86, s47
    v_accvgpr_write_b32 a69, v46
    v_accvgpr_write_b32 a77, v47
    v_perm_b32 v46, v89, v88, s46
    v_perm_b32 v47, v89, v88, s47
    v_accvgpr_write_b32 a70, v46
    v_accvgpr_write_b32 a78, v47
    v_perm_b32 v46, v91, v90, s46
    v_perm_b32 v47, v91, v90, s47
    v_accvgpr_write_b32 a71, v46
    v_accvgpr_write_b32 a79, v47
    v_perm_b32 v46, v93, v92, s46
    v_perm_b32 v47, v93, v92, s47
    v_accvgpr_write_b32 a80, v46
    v_accvgpr_write_b32 a88, v47
    v_perm_b32 v46, v95, v94, s46
    v_perm_b32 v47, v95, v94, s47
    v_accvgpr_write_b32 a81, v46
    v_accvgpr_write_b32 a89, v47
    v_perm_b32 v46, v97, v96, s46
    v_perm_b32 v47, v97, v96, s47
    v_accvgpr_write_b32 a82, v46
    v_accvgpr_write_b32 a90, v47
    v_perm_b32 v46, v99, v98, s46
    v_perm_b32 v47, v99, v98, s47
    v_accvgpr_write_b32 a83, v46
    v_accvgpr_write_b32 a91, v47
    v_perm_b32 v46, v101, v100, s46
    v_perm_b32 v47, v101, v100, s47
    v_accvgpr_write_b32 a84, v46
    v_accvgpr_write_b32 a92, v47
    v_perm_b32 v46, v103, v102, s46
    v_perm_b32 v47, v103, v102, s47
    v_accvgpr_write_b32 a85, v46
    v_accvgpr_write_b32 a93, v47
    v_perm_b32 v46, v105, v104, s46
    v_perm_b32 v47, v105, v104, s47
    v_accvgpr_write_b32 a86, v46
    v_accvgpr_write_b32 a94, v47
    v_perm_b32 v46, v107, v106, s46
    v_perm_b32 v47, v107, v106, s47
    v_accvgpr_write_b32 a87, v46
    v_accvgpr_write_b32 a95, v47
    v_perm_b32 v46, v125, v124, s46
    v_perm_b32 v47, v125, v124, s47
    v_accvgpr_write_b32 a96, v46
    v_accvgpr_write_b32 a104, v47
    s_waitcnt lgkmcnt(14)
    v_perm_b32 v46, v127, v126, s46
    v_perm_b32 v47, v127, v126, s47
    v_accvgpr_write_b32 a97, v46
    v_accvgpr_write_b32 a105, v47
    s_waitcnt lgkmcnt(13)
    v_perm_b32 v46, v129, v128, s46
    v_perm_b32 v47, v129, v128, s47
    v_accvgpr_write_b32 a98, v46
    v_accvgpr_write_b32 a106, v47
    s_waitcnt lgkmcnt(12)
    v_perm_b32 v46, v131, v130, s46
    v_perm_b32 v47, v131, v130, s47
    v_accvgpr_write_b32 a99, v46
    v_accvgpr_write_b32 a107, v47
    s_waitcnt lgkmcnt(11)
    v_perm_b32 v46, v133, v132, s46
    v_perm_b32 v47, v133, v132, s47
    v_accvgpr_write_b32 a100, v46
    v_accvgpr_write_b32 a108, v47
    s_waitcnt lgkmcnt(10)
    v_perm_b32 v46, v135, v134, s46
    v_perm_b32 v47, v135, v134, s47
    v_accvgpr_write_b32 a101, v46
    v_accvgpr_write_b32 a109, v47
    s_waitcnt lgkmcnt(9)
    v_perm_b32 v46, v137, v136, s46
    v_perm_b32 v47, v137, v136, s47
    v_accvgpr_write_b32 a102, v46
    v_accvgpr_write_b32 a110, v47
    s_waitcnt lgkmcnt(8)
    v_perm_b32 v46, v139, v138, s46
    v_perm_b32 v47, v139, v138, s47
    v_accvgpr_write_b32 a103, v46
    v_accvgpr_write_b32 a111, v47
    s_waitcnt lgkmcnt(7)
    v_perm_b32 v46, v141, v140, s46
    v_perm_b32 v47, v141, v140, s47
    v_accvgpr_write_b32 a112, v46
    v_accvgpr_write_b32 a120, v47
    s_waitcnt lgkmcnt(6)
    v_perm_b32 v46, v143, v142, s46
    v_perm_b32 v47, v143, v142, s47
    v_accvgpr_write_b32 a113, v46
    v_accvgpr_write_b32 a121, v47
    s_waitcnt lgkmcnt(5)
    v_perm_b32 v46, v145, v144, s46
    v_perm_b32 v47, v145, v144, s47
    v_accvgpr_write_b32 a114, v46
    v_accvgpr_write_b32 a122, v47
    s_waitcnt lgkmcnt(4)
    v_perm_b32 v46, v147, v146, s46
    v_perm_b32 v47, v147, v146, s47
    v_accvgpr_write_b32 a115, v46
    v_accvgpr_write_b32 a123, v47
    s_waitcnt lgkmcnt(3)
    v_perm_b32 v46, v149, v148, s46
    v_perm_b32 v47, v149, v148, s47
    v_accvgpr_write_b32 a116, v46
    v_accvgpr_write_b32 a124, v47
    s_waitcnt lgkmcnt(2)
    v_perm_b32 v46, v151, v150, s46
    v_perm_b32 v47, v151, v150, s47
    v_accvgpr_write_b32 a117, v46
    v_accvgpr_write_b32 a125, v47
    s_waitcnt lgkmcnt(1)
    v_perm_b32 v46, v153, v152, s46
    v_perm_b32 v47, v153, v152, s47
    v_accvgpr_write_b32 a118, v46
    v_accvgpr_write_b32 a126, v47
    s_waitcnt lgkmcnt(0)
    v_perm_b32 v46, v155, v154, s46
    v_perm_b32 v47, v155, v154, s47
    v_accvgpr_write_b32 a119, v46
    v_accvgpr_write_b32 a127, v47
    s_waitcnt lgkmcnt(0)
    s_barrier
    s_and_b32 s29, s17, 1
    s_lshl_b32 s29, s29, 14
    s_lshr_b32 s28, s17, 1
    s_lshl_b32 s28, s28, 13
    s_add_u32 s29, s29, s28
    s_add_u32 m0, s29, 0
    s_add_u32 s28, s44, 1048576
    buffer_load_dwordx4 v44, s[88:91], s28 offen offset:0 lds
    s_add_u32 s28, s44, 1080320
    buffer_load_dwordx4 v44, s[88:91], s28 offen offset:1024 lds
    s_add_u32 s28, s44, 1112064
    buffer_load_dwordx4 v44, s[88:91], s28 offen offset:2048 lds
    s_add_u32 s28, s44, 1143808
    buffer_load_dwordx4 v44, s[88:91], s28 offen offset:3072 lds
    s_add_u32 m0, s29, 4096
    s_add_u32 s28, s44, 1179648
    buffer_load_dwordx4 v44, s[88:91], s28 offen offset:0 lds
    s_add_u32 s28, s44, 1211392
    buffer_load_dwordx4 v44, s[88:91], s28 offen offset:1024 lds
    s_add_u32 s28, s44, 1243136
    buffer_load_dwordx4 v44, s[88:91], s28 offen offset:2048 lds
    s_add_u32 s28, s44, 1274880
    buffer_load_dwordx4 v44, s[88:91], s28 offen offset:3072 lds
    v_xor_b32 v45, 0x10000, v45
    v_xor_b32 v48, 0x10000, v48
    v_xor_b32 v49, 0x10000, v49
    v_xor_b32 v50, 0x10000, v50
    v_xor_b32 v51, 0x10000, v51
    v_xor_b32 v52, 0x10000, v52
    s_waitcnt vmcnt(8)
    s_barrier
    ds_read_b32 a168, v45 offset:0
    ds_read_b32 a169, v45 offset:1280
    ds_read_b32 a170, v45 offset:2560
    ds_read_b32 a171, v45 offset:3840
    ds_read_b32 a172, v45 offset:20480
    ds_read_b32 a173, v45 offset:21760
    ds_read_b32 a174, v45 offset:23040
    ds_read_b32 a175, v45 offset:24320
    ds_read_b32 a200, v45 offset:64
    ds_read_b32 a201, v45 offset:1344
    ds_read_b32 a202, v45 offset:2624
    ds_read_b32 a203, v45 offset:3904
    ds_read_b32 a204, v45 offset:20544
    ds_read_b32 a205, v45 offset:21824
    ds_read_b32 a206, v45 offset:23104
    ds_read_b32 a207, v45 offset:24384
    ds_read_b32 a232, v45 offset:128
    ds_read_b32 a233, v45 offset:1408
    ds_read_b32 a234, v45 offset:2688
    ds_read_b32 a235, v45 offset:3968
    ds_read_b32 a236, v45 offset:20608
    ds_read_b32 a237, v45 offset:21888
    ds_read_b32 a238, v45 offset:23168
    ds_read_b32 a239, v45 offset:24448
    ds_read_b32 v200, v45 offset:192
    ds_read_b32 v201, v45 offset:1472
    ds_read_b32 v202, v45 offset:2752
    ds_read_b32 v203, v45 offset:4032
    ds_read_b32 v204, v45 offset:20672
    ds_read_b32 v205, v45 offset:21952
    ds_read_b32 v206, v45 offset:23232
    ds_read_b32 v207, v45 offset:24512
    ds_read_b32 v232, v45 offset:256
    ds_read_b32 v233, v45 offset:1536
    ds_read_b32 v234, v45 offset:2816
    ds_read_b32 v235, v45 offset:4096
    ds_read_b32 v236, v45 offset:20736
    ds_read_b32 v237, v45 offset:22016
    ds_read_b32 v238, v45 offset:23296
    ds_read_b32 v239, v45 offset:24576
    s_waitcnt lgkmcnt(0)
    s_barrier
    s_mul_i32 s29, s17, 10240
    s_add_u32 m0, s29, 65536
    s_add_u32 s28, s41, 81920
    buffer_load_dwordx4 v6, s[92:95], s28 offen offset:0 lds
    buffer_load_dwordx4 v6, s[92:95], s28 offen offset:1024 lds
    buffer_load_dwordx4 v6, s[92:95], s28 offen offset:2048 lds
    buffer_load_dwordx4 v6, s[92:95], s28 offen offset:3072 lds
    s_add_u32 m0, s29, 69632
    s_add_u32 s28, s41, 86016
    buffer_load_dwordx4 v6, s[92:95], s28 offen offset:0 lds
    buffer_load_dwordx4 v6, s[92:95], s28 offen offset:1024 lds
    buffer_load_dwordx4 v6, s[92:95], s28 offen offset:2048 lds
    buffer_load_dwordx4 v6, s[92:95], s28 offen offset:3072 lds
    s_add_u32 m0, s29, 73728
    s_add_u32 s28, s41, 90112
    buffer_load_dwordx4 v6, s[92:95], s28 offen offset:0 lds
    buffer_load_dwordx4 v6, s[92:95], s28 offen offset:1024 lds
    v_xor_b32 v45, 0x10000, v45
    v_xor_b32 v48, 0x10000, v48
    v_xor_b32 v49, 0x10000, v49
    v_xor_b32 v50, 0x10000, v50
    v_xor_b32 v51, 0x10000, v51
    v_xor_b32 v52, 0x10000, v52
    s_waitcnt vmcnt(10)
    s_barrier
    v_and_b32 v34, 31, v20
    v_lshlrev_b32 v34, 2, v34
    global_load_dword v35, v34, s[4:5] offset:128 sc1
    ds_read2st64_b32 v[76:77], v52 offset0:0 offset1:32
    ds_read2st64_b32 v[78:79], v52 offset0:2 offset1:34
    ds_read2st64_b32 v[80:81], v52 offset0:4 offset1:36
    ds_read2st64_b32 v[82:83], v52 offset0:6 offset1:38
    ds_read2st64_b32 v[84:85], v52 offset0:8 offset1:40
    ds_read2st64_b32 v[86:87], v52 offset0:10 offset1:42
    ds_read2st64_b32 v[88:89], v52 offset0:12 offset1:44
    ds_read2st64_b32 v[90:91], v52 offset0:14 offset1:46
    ds_read2st64_b32 v[92:93], v52 offset0:64 offset1:96
    ds_read2st64_b32 v[94:95], v52 offset0:66 offset1:98
    ds_read2st64_b32 v[96:97], v52 offset0:68 offset1:100
    ds_read2st64_b32 v[98:99], v52 offset0:70 offset1:102
    ds_read2st64_b32 v[100:101], v52 offset0:72 offset1:104
    ds_read2st64_b32 v[102:103], v52 offset0:74 offset1:106
    ds_read2st64_b32 v[104:105], v52 offset0:76 offset1:108
    ds_read2st64_b32 v[106:107], v52 offset0:78 offset1:110
    s_waitcnt lgkmcnt(15)
    v_perm_b32 v46, v77, v76, s46
    v_perm_b32 v47, v77, v76, s47
    v_accvgpr_write_b32 a128, v46
    v_accvgpr_write_b32 a136, v47
    s_waitcnt lgkmcnt(14)
    v_perm_b32 v46, v79, v78, s46
    v_perm_b32 v47, v79, v78, s47
    v_accvgpr_write_b32 a129, v46
    v_accvgpr_write_b32 a137, v47
    s_waitcnt lgkmcnt(13)
    v_perm_b32 v46, v81, v80, s46
    v_perm_b32 v47, v81, v80, s47
    v_accvgpr_write_b32 a130, v46
    v_accvgpr_write_b32 a138, v47
    s_waitcnt lgkmcnt(12)
    v_perm_b32 v46, v83, v82, s46
    v_perm_b32 v47, v83, v82, s47
    v_accvgpr_write_b32 a131, v46
    v_accvgpr_write_b32 a139, v47
    s_waitcnt lgkmcnt(11)
    v_perm_b32 v46, v85, v84, s46
    v_perm_b32 v47, v85, v84, s47
    v_accvgpr_write_b32 a132, v46
    v_accvgpr_write_b32 a140, v47
    s_waitcnt lgkmcnt(10)
    v_perm_b32 v46, v87, v86, s46
    v_perm_b32 v47, v87, v86, s47
    v_accvgpr_write_b32 a133, v46
    v_accvgpr_write_b32 a141, v47
    s_waitcnt lgkmcnt(9)
    v_perm_b32 v46, v89, v88, s46
    v_perm_b32 v47, v89, v88, s47
    v_accvgpr_write_b32 a134, v46
    v_accvgpr_write_b32 a142, v47
    s_waitcnt lgkmcnt(8)
    v_perm_b32 v46, v91, v90, s46
    v_perm_b32 v47, v91, v90, s47
    v_accvgpr_write_b32 a135, v46
    v_accvgpr_write_b32 a143, v47
    s_waitcnt lgkmcnt(7)
    v_perm_b32 v46, v93, v92, s46
    v_perm_b32 v47, v93, v92, s47
    v_accvgpr_write_b32 a144, v46
    v_accvgpr_write_b32 a152, v47
    s_waitcnt lgkmcnt(6)
    v_perm_b32 v46, v95, v94, s46
    v_perm_b32 v47, v95, v94, s47
    v_accvgpr_write_b32 a145, v46
    v_accvgpr_write_b32 a153, v47
    s_waitcnt lgkmcnt(5)
    v_perm_b32 v46, v97, v96, s46
    v_perm_b32 v47, v97, v96, s47
    v_accvgpr_write_b32 a146, v46
    v_accvgpr_write_b32 a154, v47
    s_waitcnt lgkmcnt(4)
    v_perm_b32 v46, v99, v98, s46
    v_perm_b32 v47, v99, v98, s47
    v_accvgpr_write_b32 a147, v46
    v_accvgpr_write_b32 a155, v47
    s_waitcnt lgkmcnt(3)
    v_perm_b32 v46, v101, v100, s46
    v_perm_b32 v47, v101, v100, s47
    v_accvgpr_write_b32 a148, v46
    v_accvgpr_write_b32 a156, v47
    s_waitcnt lgkmcnt(2)
    v_perm_b32 v46, v103, v102, s46
    v_perm_b32 v47, v103, v102, s47
    v_accvgpr_write_b32 a149, v46
    v_accvgpr_write_b32 a157, v47
    s_waitcnt lgkmcnt(1)
    v_perm_b32 v46, v105, v104, s46
    v_perm_b32 v47, v105, v104, s47
    v_accvgpr_write_b32 a150, v46
    v_accvgpr_write_b32 a158, v47
    s_waitcnt lgkmcnt(0)
    v_perm_b32 v46, v107, v106, s46
    v_perm_b32 v47, v107, v106, s47
    v_accvgpr_write_b32 a151, v46
    v_accvgpr_write_b32 a159, v47
    s_waitcnt lgkmcnt(0)
    s_barrier
    s_mul_i32 s29, s17, 10240
    s_add_u32 m0, s29, 0
    s_add_u32 s28, s41, 122880
    buffer_load_dwordx4 v6, s[92:95], s28 offen offset:0 lds
    buffer_load_dwordx4 v6, s[92:95], s28 offen offset:1024 lds
    buffer_load_dwordx4 v6, s[92:95], s28 offen offset:2048 lds
    buffer_load_dwordx4 v6, s[92:95], s28 offen offset:3072 lds
    s_add_u32 m0, s29, 4096
    s_add_u32 s28, s41, 126976
    buffer_load_dwordx4 v6, s[92:95], s28 offen offset:0 lds
    buffer_load_dwordx4 v6, s[92:95], s28 offen offset:1024 lds
    buffer_load_dwordx4 v6, s[92:95], s28 offen offset:2048 lds
    buffer_load_dwordx4 v6, s[92:95], s28 offen offset:3072 lds
    s_add_u32 m0, s29, 8192
    s_add_u32 s28, s41, 131072
    buffer_load_dwordx4 v6, s[92:95], s28 offen offset:0 lds
    buffer_load_dwordx4 v6, s[92:95], s28 offen offset:1024 lds
    v_xor_b32 v45, 0x10000, v45
    v_xor_b32 v48, 0x10000, v48
    v_xor_b32 v49, 0x10000, v49
    v_xor_b32 v50, 0x10000, v50
    v_xor_b32 v51, 0x10000, v51
    v_xor_b32 v52, 0x10000, v52
    s_waitcnt vmcnt(10)
    s_barrier
TV_TB:
    v_readlane_b32 s28, v35, 3
    v_readlane_b32 s29, v35, 4
    v_readlane_b32 s20, v35, 5
    s_nop 0
    s_and_b32 s29, s29, s20
    s_max_u32 s28, s28, s29
    v_readlane_b32 s29, v35, 0
    v_readlane_b32 s20, v35, 10
    v_readlane_b32 s27, v35, 12
    s_nop 0
    s_min_u32 s20, s20, s27
    s_min_u32 s20, s20, s28
    s_min_u32 s20, s20, s29
    s_cmp_lg_u32 s20, 0
    s_cbranch_scc1 TV_TG
    s_cmp_lg_u32 s28, 0
    s_cbranch_scc1 TV_RG
    s_cmp_eq_u32 s71, 1
    s_cbranch_scc0 TV_RG
    s_mov_b32 s71, 0
    s_mov_b32 s28, 8
    s_cmp_eq_u32 s17, 0
    s_cbranch_scc0 TV_RG
    v_mov_b32 v40, 0
    v_mov_b32 v41, 1
    s_mov_b64 exec, 1
    buffer_atomic_add v41, v40, s[4:7], s28 offen
    s_mov_b64 exec, -1
TV_RG:
    s_add_u32 s30, s30, 1
    s_cmp_gt_u32 s30, 600000
    s_cbranch_scc1 T_EXIT
    s_sleep 2
    global_load_dword v35, v34, s[4:5] offset:128 sc1
    s_waitcnt vmcnt(0)
    s_branch TV_TB
TV_TG:
    s_and_b32 s29, s29, 1
    s_lshl_b32 s29, s29, 13
    s_add_u32 s51, s51, s29
    s_add_u32 s21, s21, s29
    s_add_u32 s69, s69, s29
    s_cmp_eq_u32 s28, 33
    s_cselect_b32 s20, 1, 0
    v_lshlrev_b32 v34, 3, v6
    s_lshl_b32 s28, s17, 15
    s_add_u32 s28, s28, s51
    buffer_load_dword v35, v34, s[8:11], s28 offen sc1
    s_add_u32 s28, s28, 16384
    buffer_load_dwordx4 v[36:39], v6, s[8:11], s28 offen sc1
    buffer_load_dwordx4 v[36:39], v6, s[8:11], s28 offen offset:1024 sc1
    buffer_load_dwordx4 v[36:39], v6, s[8:11], s48 offen sc1
    s_lshl_b32 s27, s18, 6
    s_add_u32 s27, s27, 1075200
    v_and_b32 v31, 1, v20
    v_mul_i32_i24 v31, -2048, v31
    v_add_u32 v31, s27, v31
    buffer_load_dwordx2 v[32:33], v31, s[8:11], 0 offen sc1
    ds_read_b32 a176, v45 offset:0
    ds_read_b32 a177, v45 offset:1280
    ds_read_b32 a178, v45 offset:2560
    ds_read_b32 a179, v45 offset:3840
    ds_read_b32 a180, v45 offset:20480
    ds_read_b32 a181, v45 offset:21760
    ds_read_b32 a182, v45 offset:23040
    ds_read_b32 a183, v45 offset:24320
    ds_read_b32 a208, v45 offset:64
    ds_read_b32 a209, v45 offset:1344
    ds_read_b32 a210, v45 offset:2624
    ds_read_b32 a211, v45 offset:3904
    ds_read_b32 a212, v45 offset:20544
    ds_read_b32 a213, v45 offset:21824
    ds_read_b32 a214, v45 offset:23104
    ds_read_b32 a215, v45 offset:24384
    ds_read_b32 a240, v45 offset:128
    ds_read_b32 a241, v45 offset:1408
    ds_read_b32 a242, v45 offset:2688
    ds_read_b32 a243, v45 offset:3968
    ds_read_b32 a244, v45 offset:20608
    ds_read_b32 a245, v45 offset:21888
    ds_read_b32 a246, v45 offset:23168
    ds_read_b32 a247, v45 offset:24448
    ds_read_b32 v208, v45 offset:192
    ds_read_b32 v209, v45 offset:1472
    ds_read_b32 v210, v45 offset:2752
    ds_read_b32 v211, v45 offset:4032
    ds_read_b32 v212, v45 offset:20672
    ds_read_b32 v213, v45 offset:21952
    ds_read_b32 v214, v45 offset:23232
    ds_read_b32 v215, v45 offset:24512
    ds_read_b32 v240, v45 offset:256
    ds_read_b32 v241, v45 offset:1536
    ds_read_b32 v242, v45 offset:2816
    ds_read_b32 v243, v45 offset:4096
    ds_read_b32 v244, v45 offset:20736
    ds_read_b32 v245, v45 offset:22016
    ds_read_b32 v246, v45 offset:23296
    ds_read_b32 v247, v45 offset:24576
    s_waitcnt lgkmcnt(0)
    s_barrier
    v_xor_b32 v45, 0x10000, v45
    v_xor_b32 v48, 0x10000, v48
    v_xor_b32 v49, 0x10000, v49
    v_xor_b32 v50, 0x10000, v50
    v_xor_b32 v51, 0x10000, v51
    v_xor_b32 v52, 0x10000, v52
    s_waitcnt vmcnt(0)
    s_barrier
TV_WK:
    v_and_b32 v32, v32, v33
    v_cmp_ne_u32 vcc, 1, v32
    s_nop 0
    s_cbranch_vccz TV_WL
    buffer_load_dwordx2 v[32:33], v31, s[8:11], 0 offen sc1
    s_add_u32 s30, s30, 1
    s_cmp_gt_u32 s30, 600000
    s_cbranch_scc1 T_EXIT
    s_waitcnt vmcnt(0)
    s_branch TV_WK
TV_WL:
    s_mov_b32 m0, s70
    s_nop 0
    buffer_load_dwordx4 v6, s[8:11], s38 offen sc1 lds
    buffer_load_dwordx4 v6, s[8:11], s38 offen offset:1024 sc1 lds
    s_add_u32 s38, s38, 524288
    s_xor_b32 s70, s70, 8192
    ds_read_b32 a184, v45 offset:0
    ds_read_b32 a185, v45 offset:1280
    ds_read_b32 a186, v45 offset:2560
    ds_read_b32 a187, v45 offset:3840
    ds_read_b32 a188, v45 offset:20480
    ds_read_b32 a189, v45 offset:21760
    ds_read_b32 a190, v45 offset:23040
    ds_read_b32 a191, v45 offset:24320
    ds_read_b32 a216, v45 offset:64
    ds_read_b32 a217, v45 offset:1344
    ds_read_b32 a218, v45 offset:2624
    ds_read_b32 a219, v45 offset:3904
    ds_read_b32 a220, v45 offset:20544
    ds_read_b32 a221, v45 offset:21824
    ds_read_b32 a222, v45 offset:23104
    ds_read_b32 a223, v45 offset:24384
    ds_read_b32 a248, v45 offset:128
    ds_read_b32 a249, v45 offset:1408
    ds_read_b32 a250, v45 offset:2688
    ds_read_b32 a251, v45 offset:3968
    ds_read_b32 a252, v45 offset:20608
    ds_read_b32 a253, v45 offset:21888
    ds_read_b32 a254, v45 offset:23168
    ds_read_b32 a255, v45 offset:24448
    ds_read_b32 v216, v45 offset:192
    ds_read_b32 v217, v45 offset:1472
    ds_read_b32 v218, v45 offset:2752
    ds_read_b32 v219, v45 offset:4032
    ds_read_b32 v220, v45 offset:20672
    ds_read_b32 v221, v45 offset:21952
    ds_read_b32 v222, v45 offset:23232
    ds_read_b32 v223, v45 offset:24512
    ds_read_b32 v248, v45 offset:256
    ds_read_b32 v249, v45 offset:1536
    ds_read_b32 v250, v45 offset:2816
    ds_read_b32 v251, v45 offset:4096
    ds_read_b32 v252, v45 offset:20736
    ds_read_b32 v253, v45 offset:22016
    ds_read_b32 v254, v45 offset:23296
    ds_read_b32 v255, v45 offset:24576
    s_waitcnt lgkmcnt(0)
    s_barrier
    v_xor_b32 v45, 0x10000, v45
    v_xor_b32 v48, 0x10000, v48
    v_xor_b32 v49, 0x10000, v49
    v_xor_b32 v50, 0x10000, v50
    v_xor_b32 v51, 0x10000, v51
    v_xor_b32 v52, 0x10000, v52
    s_sub_u32 s39, s39, 262144
    v_mov_b64 v[124:125], 0
    v_mov_b64 v[126:127], 0
    v_mov_b64 v[128:129], 0
    v_mov_b64 v[130:131], 0
    v_mov_b64 v[132:133], 0
    v_mov_b64 v[134:135], 0
    v_mov_b64 v[136:137], 0
    v_mov_b64 v[138:139], 0
    v_mov_b64 v[140:141], 0
    v_mov_b64 v[142:143], 0
    v_mov_b64 v[144:145], 0
    v_mov_b64 v[146:147], 0
    v_mov_b64 v[148:149], 0
    v_mov_b64 v[150:151], 0
    v_mov_b64 v[152:153], 0
    v_mov_b64 v[154:155], 0
    v_mov_b64 v[156:157], 0
    v_mov_b64 v[158:159], 0
    v_mov_b64 v[160:161], 0
    v_mov_b64 v[162:163], 0
    s_waitcnt vmcnt(0)
    s_barrier
    ds_read_b64_tr_b16 v[16:17], v190 offset:0
    ds_read_b64_tr_b16 v[18:19], v190 offset:32
    ds_read_b64_tr_b16 v[20:21], v190 offset:2048
    ds_read_b64_tr_b16 v[22:23], v190 offset:2080
    ds_read_b64_tr_b16 v[24:25], v190 offset:4096
    ds_read_b64_tr_b16 v[26:27], v190 offset:4128
    ds_read_b64_tr_b16 v[28:29], v190 offset:6144
    ds_read_b64_tr_b16 v[30:31], v190 offset:6176
    s_waitcnt lgkmcnt(6)
    v_smfmac_f32_16x16x64_bf16 v[124:127], v[16:19], a[160:167], v8
    ds_read_b64_tr_b16 v[32:33], v190 offset:256
    s_waitcnt lgkmcnt(5)
    v_smfmac_f32_16x16x64_bf16 v[124:127], v[20:23], a[168:175], v8
    ds_read_b64_tr_b16 v[34:35], v190 offset:288
    s_waitcnt lgkmcnt(4)
    v_smfmac_f32_16x16x64_bf16 v[124:127], v[24:27], a[176:183], v8
    ds_read_b64_tr_b16 v[36:37], v190 offset:2304
    s_waitcnt lgkmcnt(3)
    v_smfmac_f32_16x16x64_bf16 v[124:127], v[28:31], a[184:191], v8
    ds_read_b64_tr_b16 v[38:39], v190 offset:2336
    v_smfmac_f32_16x16x64_bf16 v[128:131], v[16:19], a[192:199], v8
    ds_read_b64_tr_b16 v[40:41], v190 offset:4352
    v_smfmac_f32_16x16x64_bf16 v[128:131], v[20:23], a[200:207], v8
    ds_read_b64_tr_b16 v[42:43], v190 offset:4384
    v_smfmac_f32_16x16x64_bf16 v[128:131], v[24:27], a[208:215], v8
    ds_read_b64_tr_b16 v[44:45], v190 offset:6400
    v_smfmac_f32_16x16x64_bf16 v[128:131], v[28:31], a[216:223], v8
    ds_read_b64_tr_b16 v[46:47], v190 offset:6432
    v_smfmac_f32_16x16x64_bf16 v[132:135], v[16:19], a[224:231], v8
    v_smfmac_f32_16x16x64_bf16 v[132:135], v[20:23], a[232:239], v8
    v_smfmac_f32_16x16x64_bf16 v[132:135], v[24:27], a[240:247], v8
    v_smfmac_f32_16x16x64_bf16 v[132:135], v[28:31], a[248:255], v8
    v_smfmac_f32_16x16x64_bf16 v[136:139], v[16:19], v[192:199], v8
    v_smfmac_f32_16x16x64_bf16 v[136:139], v[20:23], v[200:207], v8
    v_smfmac_f32_16x16x64_bf16 v[136:139], v[24:27], v[208:215], v8
    v_smfmac_f32_16x16x64_bf16 v[136:139], v[28:31], v[216:223], v8
    v_smfmac_f32_16x16x64_bf16 v[140:143], v[16:19], v[224:231], v8
    v_smfmac_f32_16x16x64_bf16 v[140:143], v[20:23], v[232:239], v8
    v_smfmac_f32_16x16x64_bf16 v[140:143], v[24:27], v[240:247], v8
    v_smfmac_f32_16x16x64_bf16 v[140:143], v[28:31], v[248:255], v8
    s_and_b32 s28, s31, 3
    s_lshl_b32 s28, s28, 15
    s_add_u32 s32, s28, s51
    s_add_u32 s33, s32, s36
    s_add_u32 s34, s33, 4096
    s_add_u32 s35, s32, s37
    s_xor_b32 s28, s63, 1
    s_lshl_b32 s28, s28, 30
    v_add_u32 v15, s28, v6
    s_waitcnt lgkmcnt(0)
    s_nop 7
    s_cmp_eq_u32 s20, 0
    s_cbranch_scc1 SV_LOOP
.p2align 6
TV_LOOP:
    v_smfmac_f32_16x16x64_bf16 v[144:147], v[32:35], a[160:167], v8
    ds_read_b64_tr_b16 v[16:17], v190 offset:512
    v_cvt_pk_bf16_f32 v68, v124, v125
    v_smfmac_f32_16x16x64_bf16 v[144:147], v[36:39], a[168:175], v8
    ds_read_b64_tr_b16 v[18:19], v190 offset:544
    v_cvt_pk_bf16_f32 v69, v126, v127
    v_smfmac_f32_16x16x64_bf16 v[144:147], v[40:43], a[176:183], v8
    ds_read_b64_tr_b16 v[20:21], v190 offset:2560
    v_mov_b64 v[124:125], 0
    v_smfmac_f32_16x16x64_bf16 v[144:147], v[44:47], a[184:191], v8
    ds_read_b64_tr_b16 v[22:23], v190 offset:2592
    v_mov_b64 v[126:127], 0
    v_smfmac_f32_16x16x64_bf16 v[148:151], v[32:35], a[192:199], v8
    ds_read_b64_tr_b16 v[24:25], v190 offset:4608
    v_cvt_pk_bf16_f32 v78, v128, v129
    v_smfmac_f32_16x16x64_bf16 v[148:151], v[36:39], a[200:207], v8
    ds_read_b64_tr_b16 v[26:27], v190 offset:4640
    v_cvt_pk_bf16_f32 v79, v130, v131
    v_smfmac_f32_16x16x64_bf16 v[148:151], v[40:43], a[208:215], v8
    ds_read_b64_tr_b16 v[28:29], v190 offset:6656
    v_mov_b64 v[128:129], 0
    v_smfmac_f32_16x16x64_bf16 v[148:151], v[44:47], a[216:223], v8
    s_barrier
    s_add_u32 s28, s31, 2
    s_and_b32 s29, s28, 0x42
    s_cbranch_scc0 TV_CK
TV_CKR:
    ds_read_b64_tr_b16 v[30:31], v190 offset:6688
    v_mov_b64 v[130:131], 0
    v_smfmac_f32_16x16x64_bf16 v[152:155], v[32:35], a[224:231], v8
    s_mov_b32 m0, s70
    s_nop 0
    buffer_load_dwordx4 v6, s[8:11], s38 offen sc1 lds
    v_cvt_pk_bf16_f32 v88, v132, v133
    v_smfmac_f32_16x16x64_bf16 v[152:155], v[36:39], a[232:239], v8
    buffer_load_dwordx4 v6, s[8:11], s38 offen offset:1024 sc1 lds
    s_add_u32 s38, s38, 524288
    v_cvt_pk_bf16_f32 v89, v134, v135
    v_smfmac_f32_16x16x64_bf16 v[152:155], v[40:43], a[240:247], v8
    s_xor_b32 s70, s70, 8192
    buffer_store_dwordx4 v[64:67], v6, s[8:11], s39 offen offset:1024 sc1
    v_mov_b64 v[132:133], 0
    v_smfmac_f32_16x16x64_bf16 v[152:155], v[44:47], a[248:255], v8
    s_add_u32 s39, s39, 262144
    s_and_b32 s49, s31, 1
    v_mov_b64 v[134:135], 0
    v_smfmac_f32_16x16x64_bf16 v[156:159], v[32:35], v[192:199], v8
    s_add_u32 s28, s31, 1
    s_and_b32 s28, s28, 3
    v_cvt_pk_bf16_f32 v98, v136, v137
    v_smfmac_f32_16x16x64_bf16 v[156:159], v[36:39], v[200:207], v8
    s_lshl_b32 s28, s28, 15
    s_add_u32 s61, s28, s51
    v_cvt_pk_bf16_f32 v99, v138, v139
    v_smfmac_f32_16x16x64_bf16 v[156:159], v[40:43], v[208:215], v8
    s_add_u32 s62, s28, s69
    s_and_b32 s28, s31, 3
    v_mov_b64 v[136:137], 0
    v_smfmac_f32_16x16x64_bf16 v[156:159], v[44:47], v[216:223], v8
    s_lshl_b32 s28, s28, 19
    s_add_u32 s76, s28, s60
    v_mov_b64 v[138:139], 0
    v_smfmac_f32_16x16x64_bf16 v[160:163], v[32:35], v[224:231], v8
    s_add_u32 s77, s28, s66
    s_add_u32 s22, s28, 20971520
    v_cvt_pk_bf16_f32 v108, v140, v141
    v_smfmac_f32_16x16x64_bf16 v[160:163], v[36:39], v[232:239], v8
    s_add_u32 s23, s28, 21004288
    s_add_u32 s24, s28, 21037056
    v_cvt_pk_bf16_f32 v109, v142, v143
    v_smfmac_f32_16x16x64_bf16 v[160:163], v[40:43], v[240:247], v8
    s_add_u32 s25, s28, 21069824
    s_add_u32 s26, s28, 21102592
    v_mov_b64 v[140:141], 0
    v_smfmac_f32_16x16x64_bf16 v[160:163], v[44:47], v[248:255], v8
    s_waitcnt lgkmcnt(6)
    v_mov_b64 v[142:143], 0
    v_smfmac_f32_16x16x64_bf16 v[124:127], v[16:19], a[160:167], v8
    ds_read_b64_tr_b16 v[32:33], v190 offset:768
    s_waitcnt lgkmcnt(5)
    v_cvt_pk_bf16_f32 v70, v144, v145
    v_smfmac_f32_16x16x64_bf16 v[124:127], v[20:23], a[168:175], v8
    ds_read_b64_tr_b16 v[34:35], v190 offset:800
    s_waitcnt lgkmcnt(4)
    v_cvt_pk_bf16_f32 v71, v146, v147
    v_smfmac_f32_16x16x64_bf16 v[124:127], v[24:27], a[176:183], v8
    ds_read_b64_tr_b16 v[36:37], v190 offset:2816
    s_waitcnt lgkmcnt(3)
    v_mov_b64 v[144:145], 0
    v_smfmac_f32_16x16x64_bf16 v[124:127], v[28:31], a[184:191], v8
    ds_read_b64_tr_b16 v[38:39], v190 offset:2848
    v_mov_b64 v[146:147], 0
    v_smfmac_f32_16x16x64_bf16 v[128:131], v[16:19], a[192:199], v8
    ds_read_b64_tr_b16 v[40:41], v190 offset:4864
    v_cvt_pk_bf16_f32 v80, v148, v149
    v_smfmac_f32_16x16x64_bf16 v[128:131], v[20:23], a[200:207], v8
    ds_read_b64_tr_b16 v[42:43], v190 offset:4896
    v_cvt_pk_bf16_f32 v81, v150, v151
    v_smfmac_f32_16x16x64_bf16 v[128:131], v[24:27], a[208:215], v8
    ds_read_b64_tr_b16 v[44:45], v190 offset:6912
    v_mov_b64 v[148:149], 0
    v_smfmac_f32_16x16x64_bf16 v[128:131], v[28:31], a[216:223], v8
    ds_read_b64_tr_b16 v[46:47], v190 offset:6944
    v_mov_b64 v[150:151], 0
    v_smfmac_f32_16x16x64_bf16 v[132:135], v[16:19], a[224:231], v8
    v_cvt_pk_bf16_f32 v90, v152, v153
    v_smfmac_f32_16x16x64_bf16 v[132:135], v[20:23], a[232:239], v8
    v_cvt_pk_bf16_f32 v91, v154, v155
    v_smfmac_f32_16x16x64_bf16 v[132:135], v[24:27], a[240:247], v8
    v_mov_b64 v[152:153], 0
    v_smfmac_f32_16x16x64_bf16 v[132:135], v[28:31], a[248:255], v8
    v_mov_b64 v[154:155], 0
    v_smfmac_f32_16x16x64_bf16 v[136:139], v[16:19], v[192:199], v8
    v_cvt_pk_bf16_f32 v100, v156, v157
    v_smfmac_f32_16x16x64_bf16 v[136:139], v[20:23], v[200:207], v8
    v_cvt_pk_bf16_f32 v101, v158, v159
    v_smfmac_f32_16x16x64_bf16 v[136:139], v[24:27], v[208:215], v8
    v_mov_b64 v[156:157], 0
    v_smfmac_f32_16x16x64_bf16 v[136:139], v[28:31], v[216:223], v8
    v_mov_b64 v[158:159], 0
    v_smfmac_f32_16x16x64_bf16 v[140:143], v[16:19], v[224:231], v8
    v_cvt_pk_bf16_f32 v110, v160, v161
    v_smfmac_f32_16x16x64_bf16 v[140:143], v[20:23], v[232:239], v8
    v_cvt_pk_bf16_f32 v111, v162, v163
    v_smfmac_f32_16x16x64_bf16 v[140:143], v[24:27], v[240:247], v8
    v_mov_b64 v[160:161], 0
    v_smfmac_f32_16x16x64_bf16 v[140:143], v[28:31], v[248:255], v8
    s_waitcnt lgkmcnt(6)
    v_mov_b64 v[162:163], 0
    v_smfmac_f32_16x16x64_bf16 v[144:147], v[32:35], a[160:167], v8
    s_waitcnt lgkmcnt(4)
    v_cvt_pk_bf16_f32 v72, v124, v125
    v_smfmac_f32_16x16x64_bf16 v[144:147], v[36:39], a[168:175], v8
    s_waitcnt lgkmcnt(2)
    v_cvt_pk_bf16_f32 v73, v126, v127
    v_smfmac_f32_16x16x64_bf16 v[144:147], v[40:43], a[176:183], v8
    s_waitcnt lgkmcnt(0)
    v_cvt_pk_bf16_f32 v82, v128, v129
    v_smfmac_f32_16x16x64_bf16 v[144:147], v[44:47], a[184:191], v8
    v_cvt_pk_bf16_f32 v83, v130, v131
    v_smfmac_f32_16x16x64_bf16 v[148:151], v[32:35], a[192:199], v8
    v_cvt_pk_bf16_f32 v92, v132, v133
    v_smfmac_f32_16x16x64_bf16 v[148:151], v[36:39], a[200:207], v8
    v_cvt_pk_bf16_f32 v93, v134, v135
    v_smfmac_f32_16x16x64_bf16 v[148:151], v[40:43], a[208:215], v8
    v_cvt_pk_bf16_f32 v102, v136, v137
    v_smfmac_f32_16x16x64_bf16 v[148:151], v[44:47], a[216:223], v8
    v_cvt_pk_bf16_f32 v103, v138, v139
    v_smfmac_f32_16x16x64_bf16 v[152:155], v[32:35], a[224:231], v8
    v_cvt_pk_bf16_f32 v112, v140, v141
    v_smfmac_f32_16x16x64_bf16 v[152:155], v[36:39], a[232:239], v8
    v_cvt_pk_bf16_f32 v113, v142, v143
    v_smfmac_f32_16x16x64_bf16 v[152:155], v[40:43], a[240:247], v8
    v_mov_b64 v[56:57], 0
    v_smfmac_f32_16x16x64_bf16 v[152:155], v[44:47], a[248:255], v8
    v_mov_b64 v[58:59], 0
    v_smfmac_f32_16x16x64_bf16 v[156:159], v[32:35], v[192:199], v8
    v_mov_b64 v[60:61], 0
    v_smfmac_f32_16x16x64_bf16 v[156:159], v[36:39], v[200:207], v8
    v_mov_b64 v[62:63], 0
    v_smfmac_f32_16x16x64_bf16 v[156:159], v[40:43], v[208:215], v8
    buffer_load_dwordx4 v[16:19], v182, s[8:11], s33 offen offset:0 sc1
    buffer_load_dwordx4 v[20:23], v182, s[8:11], s33 offen offset:512 sc1
    buffer_load_dwordx4 v[24:27], v182, s[8:11], s34 offen offset:0 sc1
    buffer_load_dwordx4 v[28:31], v182, s[8:11], s34 offen offset:512 sc1
    buffer_load_dwordx4 v[52:55], v182, s[8:11], s35 offen offset:0 sc1
    v_smfmac_f32_16x16x64_bf16 v[156:159], v[44:47], v[216:223], v8
    v_smfmac_f32_16x16x64_bf16 v[160:163], v[32:35], v[224:231], v8
    v_smfmac_f32_16x16x64_bf16 v[160:163], v[36:39], v[232:239], v8
    v_smfmac_f32_16x16x64_bf16 v[160:163], v[40:43], v[240:247], v8
    v_smfmac_f32_16x16x64_bf16 v[160:163], v[44:47], v[248:255], v8
TV_GA:
    s_nop 0
    s_waitcnt vmcnt(4)
    v_max_u32 v12, v16, v17
    v_max_u32 v13, v18, v19
    v_mfma_f32_16x16x32_bf16 v[124:127], v[118:121], v[16:19], 0
    s_waitcnt vmcnt(3)
    v_max3_u32 v12, v12, v20, v21
    v_max3_u32 v13, v13, v22, v23
    v_mfma_f32_16x16x32_bf16 v[128:131], v[118:121], v[20:23], 0
    s_waitcnt vmcnt(2)
    v_max3_u32 v12, v12, v24, v25
    v_max3_u32 v13, v13, v26, v27
    v_mfma_f32_16x16x32_bf16 v[132:135], v[118:121], v[24:27], 0
    s_waitcnt vmcnt(1)
    v_max3_u32 v12, v12, v28, v29
    v_max3_u32 v13, v13, v30, v31
    v_mfma_f32_16x16x32_bf16 v[136:139], v[118:121], v[28:31], 0
    v_cvt_pk_bf16_f32 v48, v124, v125
    v_cvt_pk_bf16_f32 v49, v126, v127
    s_waitcnt vmcnt(0)
    v_max3_u32 v12, v12, v52, v53
    v_max3_u32 v13, v13, v54, v55
    v_mfma_f32_16x16x32_bf16 v[140:143], v[118:121], v[52:55], 0
    v_max_u32 v12, v12, v13
    v_cvt_pk_bf16_f32 v50, v128, v129
    v_cmp_eq_u32 vcc, -1, v12
    v_cvt_pk_bf16_f32 v51, v130, v131
    s_cbranch_vccnz TV_GAS
    ds_write_b128 v2, v[48:51]
    v_cvt_pk_bf16_f32 v52, v132, v133
    v_cvt_pk_bf16_f32 v53, v134, v135
    v_cvt_pk_bf16_f32 v54, v136, v137
    v_cvt_pk_bf16_f32 v55, v138, v139
    v_smfmac_f32_16x16x64_bf16 v[56:59], v[48:51], a[0:7], v8
    ds_write_b128 v2, v[52:55] offset:4096
    v_cvt_pk_bf16_f32 v176, v140, v141
    v_cvt_pk_bf16_f32 v177, v142, v143
    v_smfmac_f32_16x16x64_bf16 v[60:63], v[48:51], a[8:15], v8
    ds_write_b64 v7, v[176:177] offset:8192
    v_smfmac_f32_16x16x64_bf16 v[56:59], v[52:55], a[64:71], v8
    v_mov_b64 v[124:125], 0
    v_smfmac_f32_16x16x64_bf16 v[60:63], v[52:55], a[72:79], v8
    v_mov_b64 v[126:127], 0
    s_waitcnt lgkmcnt(0)
    s_barrier
    ds_read_b128 v[16:19], v3 offset:0
    ds_read_b128 v[20:23], v4 offset:0
    ds_read_b128 v[24:27], v5 offset:0
    ds_read_b128 v[28:31], v3 offset:4096
    s_waitcnt lgkmcnt(3)
    v_smfmac_f32_16x16x64_bf16 v[56:59], v[16:19], a[16:23], v8
    v_mov_b64 v[128:129], 0
    v_smfmac_f32_16x16x64_bf16 v[60:63], v[16:19], a[24:31], v8
    ds_read_b128 v[16:19], v4 offset:4096
    s_waitcnt lgkmcnt(3)
    v_mov_b64 v[130:131], 0
    v_smfmac_f32_16x16x64_bf16 v[56:59], v[20:23], a[32:39], v8
    v_mov_b64 v[132:133], 0
    v_smfmac_f32_16x16x64_bf16 v[60:63], v[20:23], a[40:47], v8
    ds_read_b128 v[20:23], v5 offset:4096
    s_waitcnt lgkmcnt(3)
    v_mov_b64 v[134:135], 0
    v_smfmac_f32_16x16x64_bf16 v[56:59], v[24:27], a[48:55], v8
    v_mov_b64 v[136:137], 0
    v_smfmac_f32_16x16x64_bf16 v[60:63], v[24:27], a[56:63], v8
    ds_read_b128 v[24:27], v6 offset:8192
    s_waitcnt lgkmcnt(3)
    v_mov_b64 v[138:139], 0
    v_smfmac_f32_16x16x64_bf16 v[56:59], v[28:31], a[80:87], v8
    v_mov_b64 v[140:141], 0
    v_smfmac_f32_16x16x64_bf16 v[60:63], v[28:31], a[88:95], v8
    ds_read_b128 v[28:31], v6 offset:9216
    s_waitcnt lgkmcnt(3)
    v_mov_b64 v[142:143], 0
    v_smfmac_f32_16x16x64_bf16 v[56:59], v[16:19], a[96:103], v8
    v_cvt_pk_bf16_f32 v74, v144, v145
    v_smfmac_f32_16x16x64_bf16 v[60:63], v[16:19], a[104:111], v8
    s_waitcnt lgkmcnt(2)
    v_cvt_pk_bf16_f32 v75, v146, v147
    v_smfmac_f32_16x16x64_bf16 v[56:59], v[20:23], a[112:119], v8
    v_cvt_pk_bf16_f32 v84, v148, v149
    v_smfmac_f32_16x16x64_bf16 v[60:63], v[20:23], a[120:127], v8
    s_waitcnt lgkmcnt(1)
    v_cvt_pk_bf16_f32 v85, v150, v151
    v_smfmac_f32_16x16x64_bf16 v[56:59], v[24:27], a[128:135], v8
    v_cvt_pk_bf16_f32 v94, v152, v153
    v_smfmac_f32_16x16x64_bf16 v[60:63], v[24:27], a[136:143], v8
    s_waitcnt lgkmcnt(0)
    v_cvt_pk_bf16_f32 v95, v154, v155
    v_smfmac_f32_16x16x64_bf16 v[56:59], v[28:31], a[144:151], v8
    v_cvt_pk_bf16_f32 v104, v156, v157
    v_smfmac_f32_16x16x64_bf16 v[60:63], v[28:31], a[152:159], v8
    v_cvt_pk_bf16_f32 v105, v158, v159
    v_cvt_pk_bf16_f32 v114, v160, v161
    v_cvt_pk_bf16_f32 v115, v162, v163
    s_cmp_eq_u32 s31, 63
    v_cvt_pk_bf16_f32 v64, v56, v57
    v_cvt_pk_bf16_f32 v65, v58, v59
    s_nop 1
    v_cvt_pk_bf16_f32 v66, v60, v61
    v_cvt_pk_bf16_f32 v67, v62, v63
    s_cbranch_scc1 TV_LAST
    v_permlane32_swap_b32 v56, v60
    v_permlane32_swap_b32 v57, v61
    v_permlane32_swap_b32 v58, v62
    v_permlane32_swap_b32 v59, v63
    v_add_f32 v56, v56, v60
    v_add_f32 v57, v57, v61
    v_add_f32 v58, v58, v62
    v_add_f32 v59, v59, v63
    v_cvt_pk_bf16_f32 v56, v56, v57
    v_cvt_pk_bf16_f32 v57, v58, v59
    ds_write_b64 v9, v[56:57]
    v_xor_b32 v190, 8192, v190
    s_waitcnt lgkmcnt(0)
    s_barrier
    ds_read_b64_tr_b16 v[16:17], v10 offset:0
    ds_read_b64_tr_b16 v[18:19], v10 offset:32
    ds_read_b64_tr_b16 v[20:21], v10 offset:576
    ds_read_b64_tr_b16 v[22:23], v10 offset:608
    ds_read_b64_tr_b16 v[24:25], v10 offset:1152
    ds_read_b64_tr_b16 v[26:27], v10 offset:1184
    ds_read_b64_tr_b16 v[28:29], v10 offset:1728
    ds_read_b64_tr_b16 v[30:31], v10 offset:1760
    s_waitcnt lgkmcnt(6)
    v_smfmac_f32_16x16x64_bf16 v[124:127], v[16:19], a[160:167], v8
    s_waitcnt lgkmcnt(4)
    v_smfmac_f32_16x16x64_bf16 v[124:127], v[20:23], a[168:175], v8
    s_waitcnt lgkmcnt(2)
    v_smfmac_f32_16x16x64_bf16 v[124:127], v[24:27], a[176:183], v8
    s_waitcnt lgkmcnt(0)
    v_smfmac_f32_16x16x64_bf16 v[124:127], v[28:31], a[184:191], v8
    v_smfmac_f32_16x16x64_bf16 v[128:131], v[16:19], a[192:199], v8
    v_smfmac_f32_16x16x64_bf16 v[128:131], v[20:23], a[200:207], v8
    v_cvt_pk_bf16_f32 v76, v124, v125
    v_smfmac_f32_16x16x64_bf16 v[128:131], v[24:27], a[208:215], v8
    v_cvt_pk_bf16_f32 v77, v126, v127
    v_smfmac_f32_16x16x64_bf16 v[128:131], v[28:31], a[216:223], v8
    v_mov_b64 v[124:125], 0
    v_smfmac_f32_16x16x64_bf16 v[132:135], v[16:19], a[224:231], v8
    buffer_load_dwordx4 v[164:167], v1, s[8:11], s48 offen offset:0 sc1
    v_mov_b64 v[126:127], 0
    v_smfmac_f32_16x16x64_bf16 v[132:135], v[20:23], a[232:239], v8
    buffer_load_dwordx4 v[168:171], v1, s[8:11], s48 offen offset:256 sc1
    v_cvt_pk_bf16_f32 v86, v128, v129
    v_smfmac_f32_16x16x64_bf16 v[132:135], v[24:27], a[240:247], v8
    buffer_load_dwordx2 v[172:173], v0, s[8:11], s48 offen offset:512 sc1
    v_cvt_pk_bf16_f32 v87, v130, v131
    v_smfmac_f32_16x16x64_bf16 v[132:135], v[28:31], a[248:255], v8
    v_mov_b64 v[128:129], 0
    v_smfmac_f32_16x16x64_bf16 v[136:139], v[16:19], v[192:199], v8
    v_mov_b64 v[130:131], 0
    v_smfmac_f32_16x16x64_bf16 v[136:139], v[20:23], v[200:207], v8
    v_cvt_pk_bf16_f32 v96, v132, v133
    v_smfmac_f32_16x16x64_bf16 v[136:139], v[24:27], v[208:215], v8
    v_cvt_pk_bf16_f32 v97, v134, v135
    v_smfmac_f32_16x16x64_bf16 v[136:139], v[28:31], v[216:223], v8
    v_mov_b64 v[132:133], 0
    v_smfmac_f32_16x16x64_bf16 v[140:143], v[16:19], v[224:231], v8
    buffer_load_dwordx4 v[164:167], v1, s[8:11], s48 offen offset:0 sc1
    v_mov_b64 v[134:135], 0
    v_smfmac_f32_16x16x64_bf16 v[140:143], v[20:23], v[232:239], v8
    buffer_load_dwordx4 v[168:171], v1, s[8:11], s48 offen offset:256 sc1
    v_cvt_pk_bf16_f32 v106, v136, v137
    v_smfmac_f32_16x16x64_bf16 v[140:143], v[24:27], v[240:247], v8
    buffer_load_dwordx2 v[172:173], v0, s[8:11], s48 offen offset:512 sc1
    v_cvt_pk_bf16_f32 v107, v138, v139
    v_smfmac_f32_16x16x64_bf16 v[140:143], v[28:31], v[248:255], v8
    v_mov_b64 v[136:137], 0
    ds_read_b64_tr_b16 v[16:17], v190 offset:0
    ds_read_b64_tr_b16 v[18:19], v190 offset:32
    ds_read_b64_tr_b16 v[20:21], v190 offset:2048
    ds_read_b64_tr_b16 v[22:23], v190 offset:2080
    ds_read_b64_tr_b16 v[24:25], v190 offset:4096
    ds_read_b64_tr_b16 v[26:27], v190 offset:4128
    ds_read_b64_tr_b16 v[28:29], v190 offset:6144
    ds_read_b64_tr_b16 v[30:31], v190 offset:6176
    v_mov_b64 v[138:139], 0
    v_cvt_pk_bf16_f32 v116, v140, v141
    v_cvt_pk_bf16_f32 v117, v142, v143
    v_mov_b64 v[140:141], 0
    v_mov_b64 v[142:143], 0
    s_nop 1
    s_cmp_eq_u32 s49, 1
    s_cbranch_scc1 TV_PT1
TV_PT0:
    s_waitcnt vmcnt(3)
    v_min3_i32 v12, v164, v165, v166
    v_min3_i32 v13, v167, v168, v169
    v_min3_i32 v11, v170, v171, v172
    v_mfma_f32_16x16x32_bf16 v[56:59], v[164:167], v[178:181], 0
    v_min3_i32 v12, v12, v13, v173
    v_mfma_f32_16x16x32_bf16 v[56:59], v[168:171], v[178:181], v[56:59]
    v_min_i32 v12, v12, v11
    v_mfma_f32_16x16x32_bf16 v[56:59], v[172:175], v[178:181], v[56:59]
    v_cmp_gt_i32 vcc, 0, v12
    v_mfma_f32_16x16x32_bf16 v[160:163], v[164:167], v[108:111], 0
    s_cbranch_vccnz TV_PTS0
TV_PTG:
    v_mfma_f32_16x16x32_bf16 v[160:163], v[168:171], v[112:115], v[160:163]
    v_rcp_f32 v60, v56
    v_mfma_f32_16x16x32_bf16 v[160:163], v[172:175], v[116:119], v[160:163]
    v_rcp_f32 v61, v57
    v_mfma_f32_16x16x32_bf16 v[144:147], v[164:167], v[68:71], 0
    v_rcp_f32 v62, v58
    v_mfma_f32_16x16x32_bf16 v[144:147], v[168:171], v[72:75], v[144:147]
    v_rcp_f32 v63, v59
    v_cmp_u_f32 vcc, v56, v56
    v_mfma_f32_16x16x32_bf16 v[144:147], v[172:175], v[76:79], v[144:147]
    s_cbranch_vccnz TV_SLOW
TV_GO:
    v_mul_f32 v160, v60, v160
    v_mul_f32 v161, v61, v161
    v_mfma_f32_16x16x32_bf16 v[148:151], v[164:167], v[78:81], 0
    v_mul_f32 v162, v62, v162
    v_mul_f32 v163, v63, v163
    v_mfma_f32_16x16x32_bf16 v[148:151], v[168:171], v[82:85], v[148:151]
    v_cvt_pk_bf16_f32 v160, v160, v161
    v_cvt_pk_bf16_f32 v161, v162, v163
    v_mfma_f32_16x16x32_bf16 v[148:151], v[172:175], v[86:89], v[148:151]
    buffer_store_dwordx2 v[160:161], v14, s[8:11], s26 offen
    v_mul_f32 v144, v60, v144
    v_mul_f32 v145, v61, v145
    v_mfma_f32_16x16x32_bf16 v[152:155], v[164:167], v[88:91], 0
    v_mul_f32 v146, v62, v146
    v_mul_f32 v147, v63, v147
    v_mfma_f32_16x16x32_bf16 v[152:155], v[168:171], v[92:95], v[152:155]
    v_cvt_pk_bf16_f32 v144, v144, v145
    v_cvt_pk_bf16_f32 v145, v146, v147
    v_mfma_f32_16x16x32_bf16 v[152:155], v[172:175], v[96:99], v[152:155]
    buffer_store_dwordx2 v[144:145], v14, s[8:11], s22 offen
    v_mul_f32 v148, v60, v148
    v_mul_f32 v149, v61, v149
    v_mfma_f32_16x16x32_bf16 v[156:159], v[164:167], v[98:101], 0
    v_mul_f32 v150, v62, v150
    v_mul_f32 v151, v63, v151
    v_mfma_f32_16x16x32_bf16 v[156:159], v[168:171], v[102:105], v[156:159]
    v_cvt_pk_bf16_f32 v148, v148, v149
    v_cvt_pk_bf16_f32 v149, v150, v151
    v_mfma_f32_16x16x32_bf16 v[156:159], v[172:175], v[106:109], v[156:159]
    buffer_store_dwordx2 v[148:149], v14, s[8:11], s23 offen
    v_pk_mul_f32 v[152:153], v[152:153], v[60:61]
    v_pk_mul_f32 v[154:155], v[154:155], v[62:63]
    v_cvt_pk_bf16_f32 v152, v152, v153
    v_cvt_pk_bf16_f32 v153, v154, v155
    buffer_store_dwordx2 v[152:153], v14, s[8:11], s24 offen
    s_nop 1
    v_pk_mul_f32 v[156:157], v[156:157], v[60:61]
    v_pk_mul_f32 v[158:159], v[158:159], v[62:63]
    v_cvt_pk_bf16_f32 v156, v156, v157
    v_cvt_pk_bf16_f32 v157, v158, v159
    buffer_store_dwordx2 v[156:157], v14, s[8:11], s25 offen
    s_waitcnt lgkmcnt(6)
    v_smfmac_f32_16x16x64_bf16 v[124:127], v[16:19], a[160:167], v8
    ds_read_b64_tr_b16 v[32:33], v190 offset:256
    s_waitcnt lgkmcnt(5)
    v_mov_b64 v[144:145], 0
    v_smfmac_f32_16x16x64_bf16 v[124:127], v[20:23], a[168:175], v8
    ds_read_b64_tr_b16 v[34:35], v190 offset:288
    s_waitcnt lgkmcnt(4)
    v_mov_b64 v[146:147], 0
    v_smfmac_f32_16x16x64_bf16 v[124:127], v[24:27], a[176:183], v8
    ds_read_b64_tr_b16 v[36:37], v190 offset:2304
    s_waitcnt lgkmcnt(3)
    v_mov_b64 v[148:149], 0
    v_smfmac_f32_16x16x64_bf16 v[124:127], v[28:31], a[184:191], v8
    ds_read_b64_tr_b16 v[38:39], v190 offset:2336
    v_mov_b64 v[150:151], 0
    v_smfmac_f32_16x16x64_bf16 v[128:131], v[16:19], a[192:199], v8
    ds_read_b64_tr_b16 v[40:41], v190 offset:4352
    v_mov_b64 v[152:153], 0
    v_smfmac_f32_16x16x64_bf16 v[128:131], v[20:23], a[200:207], v8
    ds_read_b64_tr_b16 v[42:43], v190 offset:4384
    v_mov_b64 v[154:155], 0
    v_smfmac_f32_16x16x64_bf16 v[128:131], v[24:27], a[208:215], v8
    ds_read_b64_tr_b16 v[44:45], v190 offset:6400
    v_mov_b64 v[156:157], 0
    v_smfmac_f32_16x16x64_bf16 v[128:131], v[28:31], a[216:223], v8
    ds_read_b64_tr_b16 v[46:47], v190 offset:6432
    v_mov_b64 v[158:159], 0
    v_smfmac_f32_16x16x64_bf16 v[132:135], v[16:19], a[224:231], v8
    buffer_load_dwordx4 v[48:51], v15, s[8:11], s77 offen offset:0 sc1
    s_add_u32 s74, s62, s68
    s_add_u32 s75, s61, s68
    v_mov_b64 v[160:161], 0
    v_smfmac_f32_16x16x64_bf16 v[132:135], v[20:23], a[232:239], v8
    buffer_load_dwordx4 v[52:55], v15, s[8:11], s77 offen offset:1024 sc1
    s_add_u32 s31, s31, 1
    s_and_b32 s28, s31, 3
    v_mov_b64 v[162:163], 0
    v_smfmac_f32_16x16x64_bf16 v[132:135], v[24:27], a[240:247], v8
    s_lshl_b32 s28, s28, 15
    s_add_u32 s32, s28, s51
    v_smfmac_f32_16x16x64_bf16 v[132:135], v[28:31], a[248:255], v8
    s_add_u32 s33, s32, s36
    s_add_u32 s34, s33, 4096
    v_smfmac_f32_16x16x64_bf16 v[136:139], v[16:19], v[192:199], v8
    s_add_u32 s35, s32, s37
    v_smfmac_f32_16x16x64_bf16 v[136:139], v[20:23], v[200:207], v8
    v_smfmac_f32_16x16x64_bf16 v[136:139], v[24:27], v[208:215], v8
    v_smfmac_f32_16x16x64_bf16 v[136:139], v[28:31], v[216:223], v8
    v_smfmac_f32_16x16x64_bf16 v[140:143], v[16:19], v[224:231], v8
    buffer_load_dwordx4 v[48:51], v15, s[8:11], s77 offen offset:0 sc1
    v_smfmac_f32_16x16x64_bf16 v[140:143], v[20:23], v[232:239], v8
    buffer_load_dwordx4 v[52:55], v15, s[8:11], s77 offen offset:1024 sc1
    v_smfmac_f32_16x16x64_bf16 v[140:143], v[24:27], v[240:247], v8
    v_smfmac_f32_16x16x64_bf16 v[140:143], v[28:31], v[248:255], v8
    s_cmp_eq_u32 s63, 1
    s_cbranch_scc1 TV_RE
TV_RD:
    s_waitcnt lgkmcnt(0)
    s_branch TV_LOOP
TV_LAST:
    buffer_store_dwordx4 v[64:67], v6, s[8:11], s39 offen offset:1024 sc1
    s_waitcnt vmcnt(0)
    s_barrier
    s_cmp_eq_u32 s17, 0
    s_cbranch_scc0 TV_LA
    s_lshl_b32 s28, s18, 8
    s_add_u32 s28, s28, 1048704
    v_mov_b32 v188, 0
    v_mov_b32 v189, 128
    s_mov_b64 exec, 1
    buffer_store_dword v189, v188, s[8:11], s28 offen sc1
    s_mov_b64 exec, -1
TV_LA:
    s_branch T_EXIT
TV_SLOW:
    s_nop 15
    s_waitcnt vmcnt(0)
TV_SL1:
    buffer_load_dwordx4 v[164:167], v1, s[8:11], s48 offen offset:1024 sc1
    buffer_load_dwordx4 v[168:171], v1, s[8:11], s48 offen offset:1280 sc1
    buffer_load_dwordx2 v[172:173], v0, s[8:11], s48 offen offset:1536 sc1
    s_add_u32 s30, s30, 1
    s_cmp_gt_u32 s30, 600000
    s_cbranch_scc1 T_EXIT
    s_waitcnt vmcnt(0)
    v_min3_i32 v12, v164, v165, v166
    v_min3_i32 v12, v12, v167, v168
    v_min3_i32 v12, v12, v169, v170
    v_min3_i32 v12, v12, v171, v172
    v_min_i32 v12, v12, v173
    v_cmp_gt_i32 vcc, 0, v12
    s_nop 0
    s_cbranch_vccnz TV_SL1
    s_barrier
    v_mov_b32 v60, -1
    v_mov_b32 v61, -1
    v_mov_b32 v62, -1
    v_mov_b32 v63, -1
    buffer_store_dwordx4 v[60:63], v6, s[8:11], s48 offen offset:1024
    v_mfma_f32_16x16x32_bf16 v[56:59], v[164:167], v[178:181], 0
    v_mfma_f32_16x16x32_bf16 v[56:59], v[168:171], v[178:181], v[56:59]
    v_mfma_f32_16x16x32_bf16 v[56:59], v[172:175], v[178:181], v[56:59]
    v_mfma_f32_16x16x32_bf16 v[160:163], v[164:167], v[108:111], 0
    v_mfma_f32_16x16x32_bf16 v[160:163], v[168:171], v[112:115], v[160:163]
    v_mfma_f32_16x16x32_bf16 v[160:163], v[172:175], v[116:119], v[160:163]
    v_mfma_f32_16x16x32_bf16 v[144:147], v[164:167], v[68:71], 0
    v_mfma_f32_16x16x32_bf16 v[144:147], v[168:171], v[72:75], v[144:147]
    v_mfma_f32_16x16x32_bf16 v[144:147], v[172:175], v[76:79], v[144:147]
    v_rcp_f32 v60, v56
    v_rcp_f32 v61, v57
    v_rcp_f32 v62, v58
    v_rcp_f32 v63, v59
    s_waitcnt vmcnt(0)
    s_nop 15
    s_branch TV_GO
TV_CK:
    s_bitcmp1_b32 s28, 0
    s_cselect_b32 s29, 1, 0
    s_lshr_b32 s28, s28, 3
    s_lshl_b32 s28, s28, 2
    s_add_u32 s28, s28, 208
    s_cmp_eq_u32 s29, 1
    s_cbranch_scc1 TV_CKT
    v_mov_b32 v188, 0
    buffer_load_dword v189, v188, s[4:7], s28 offen sc1
    s_branch TV_CKR
TV_CKT:
    v_readfirstlane_b32 s29, v189
    s_nop 0
    s_cmp_ge_u32 s29, 1
    s_cbranch_scc1 TV_CKR
    v_mov_b32 v188, 0
TV_CKW:
    buffer_load_dword v189, v188, s[4:7], s28 offen sc1
    s_add_u32 s3, s3, 1
    s_cmp_gt_u32 s3, 2000000
    s_cbranch_scc1 K_END
    s_waitcnt vmcnt(0)
    v_readfirstlane_b32 s29, v189
    s_nop 0
    s_cmp_ge_u32 s29, 1
    s_cbranch_scc1 TV_CKW_OK
    s_sleep 2
    s_branch TV_CKW
TV_CKW_OK:
    s_branch TV_CKR
TV_GAS:
    buffer_load_dwordx4 v[16:19], v182, s[8:11], s33 offen offset:0 sc1
    buffer_load_dwordx4 v[20:23], v182, s[8:11], s33 offen offset:512 sc1
    buffer_load_dwordx4 v[24:27], v182, s[8:11], s34 offen offset:0 sc1
    buffer_load_dwordx4 v[28:31], v182, s[8:11], s34 offen offset:512 sc1
    buffer_load_dwordx4 v[52:55], v182, s[8:11], s35 offen offset:0 sc1
    s_add_u32 s30, s30, 1
    s_cmp_gt_u32 s30, 600000
    s_cbranch_scc1 T_EXIT
    s_branch TV_GA
TV_PTS0:
    buffer_load_dwordx4 v[164:167], v1, s[8:11], s48 offen offset:0 sc1
    buffer_load_dwordx4 v[168:171], v1, s[8:11], s48 offen offset:256 sc1
    buffer_load_dwordx2 v[172:173], v0, s[8:11], s48 offen offset:512 sc1
    s_add_u32 s30, s30, 1
    s_cmp_gt_u32 s30, 600000
    s_cbranch_scc1 T_EXIT
    s_branch TV_PT0
TV_PT1:
    s_waitcnt vmcnt(3)
    v_max3_i32 v12, v164, v165, v166
    v_max3_i32 v13, v167, v168, v169
    v_max3_i32 v11, v170, v171, v172
    v_mfma_f32_16x16x32_bf16 v[56:59], v[164:167], v[178:181], 0
    v_max3_i32 v12, v12, v13, v173
    v_mfma_f32_16x16x32_bf16 v[56:59], v[168:171], v[178:181], v[56:59]
    v_max_i32 v12, v12, v11
    v_mfma_f32_16x16x32_bf16 v[56:59], v[172:175], v[178:181], v[56:59]
    v_cmp_le_i32 vcc, 0, v12
    v_mfma_f32_16x16x32_bf16 v[160:163], v[164:167], v[108:111], 0
    s_nop 0
    s_and_b64 vcc, vcc, s[64:65]
    s_cbranch_vccnz TV_PTS1
    s_branch TV_PTG
TV_PTS1:
    buffer_load_dwordx4 v[164:167], v1, s[8:11], s48 offen offset:0 sc1
    buffer_load_dwordx4 v[168:171], v1, s[8:11], s48 offen offset:256 sc1
    buffer_load_dwordx2 v[172:173], v0, s[8:11], s48 offen offset:512 sc1
    s_add_u32 s30, s30, 1
    s_cmp_gt_u32 s30, 600000
    s_cbranch_scc1 T_EXIT
    s_branch TV_PT1
TV_RES:
    buffer_load_dwordx4 v[48:51], v15, s[8:11], s77 offen offset:0 sc1
    buffer_load_dwordx4 v[52:55], v15, s[8:11], s77 offen offset:1024 sc1
    s_add_u32 s30, s30, 1
    s_cmp_gt_u32 s30, 600000
    s_cbranch_scc1 T_EXIT
    s_branch TV_RE
TV_RE:
    s_waitcnt vmcnt(3)
    v_max_u32 v12, v48, v49
    v_max_u32 v13, v50, v51
    v_mfma_f32_16x16x32_bf16 v[56:59], v[48:51], v[184:187], 0
    s_waitcnt vmcnt(2)
    v_max3_u32 v12, v12, v52, v53
    v_max3_u32 v13, v13, v54, v55
    v_mfma_f32_16x16x32_bf16 v[56:59], v[52:55], v[184:187], v[56:59]
    v_max_u32 v12, v12, v13
    v_cmp_eq_u32 vcc, -1, v12
    s_nop 0
    s_cbranch_vccnz TV_RES
    s_nop 3
    v_permlane32_swap_b32 v56, v58
    v_permlane32_swap_b32 v57, v59
    v_add_f32 v56, v56, v58
    v_add_f32 v57, v57, v59
    v_cvt_pk_bf16_f32 v56, v56, v57
    buffer_store_dword v56, v191, s[8:11], s75 offen
    buffer_store_dword v56, v191, s[8:11], s74 offen sc1
    s_branch TV_RD
SQ_LOOP:
    s_and_b32 s28, s31, 3
    s_lshl_b32 s28, s28, 15
    s_add_u32 s32, s28, s51
    s_add_u32 s33, s32, s36
    s_add_u32 s34, s33, 4096
    s_add_u32 s35, s32, s37
    v_mov_b64 v[100:101], 0
    v_mov_b64 v[102:103], 0
    v_mov_b64 v[104:105], 0
    v_mov_b64 v[106:107], 0
    v_mov_b64 v[108:109], 0
    v_mov_b64 v[110:111], 0
    v_mov_b64 v[112:113], 0
    v_mov_b64 v[114:115], 0
    s_and_b32 s28, s31, 1
    s_mul_i32 s49, s28, 0x80008000
    s_add_u32 s73, s32, s67
    s_add_u32 s72, s73, 261120
    s_add_u32 s74, s31, 3
    s_and_b32 s74, s74, 3
    s_lshl_b32 s74, s74, 19
    s_add_u32 s74, s74, s60
    s_cmp_eq_u32 s31, 0
    s_cbranch_scc1 SQ_G0
    v_mov_b64 v[116:117], v[76:77]
    v_mov_b64 v[118:119], v[78:79]
    v_mov_b64 v[120:121], v[80:81]
    v_mov_b64 v[122:123], v[82:83]
    v_mov_b64 v[124:125], v[84:85]
    v_mov_b64 v[126:127], v[86:87]
    v_mov_b64 v[128:129], v[88:89]
    v_mov_b64 v[130:131], v[90:91]
    s_sleep 8
    buffer_load_dwordx4 v[16:19], v6, s[8:11], s74 offen offset:0 sc1
    buffer_load_dwordx4 v[20:23], v6, s[8:11], s74 offen offset:1024 sc1
    s_sleep 1
    buffer_load_dwordx4 v[16:19], v6, s[8:11], s74 offen offset:0 sc1
    buffer_load_dwordx4 v[20:23], v6, s[8:11], s74 offen offset:1024 sc1
SQ_RE:
    s_waitcnt vmcnt(3)
    v_max_u32 v12, v16, v17
    v_max_u32 v13, v18, v19
    v_mfma_f32_16x16x32_bf16 v[24:27], v[16:19], v[148:151], 0
    s_waitcnt vmcnt(2)
    v_max3_u32 v12, v12, v20, v21
    v_max3_u32 v13, v13, v22, v23
    v_mfma_f32_16x16x32_bf16 v[24:27], v[20:23], v[148:151], v[24:27]
    v_max_u32 v12, v12, v13
    v_cmp_eq_u32 vcc, -1, v12
    s_nop 0
    s_cbranch_vccnz SQ_RES
    s_nop 3
    v_permlane32_swap_b32 v24, v26
    v_permlane32_swap_b32 v25, v27
    v_add_f32 v24, v24, v26
    v_add_f32 v25, v25, v27
    v_cvt_pk_bf16_f32 v24, v24, v25
    buffer_store_dword v24, v191, s[8:11], s73 offen sc1
    s_barrier
    buffer_store_dword v24, v191, s[8:11], s72 offen sc1
    s_sleep 7
SQ_G0:
    buffer_load_dwordx4 v[56:59], v182, s[8:11], s33 offen offset:0 sc1
    buffer_load_dwordx4 v[60:63], v182, s[8:11], s33 offen offset:512 sc1
    buffer_load_dwordx4 v[64:67], v182, s[8:11], s34 offen offset:0 sc1
    buffer_load_dwordx4 v[68:71], v182, s[8:11], s34 offen offset:512 sc1
    buffer_load_dwordx4 v[72:75], v182, s[8:11], s35 offen offset:0 sc1
SQ_GA:
    s_nop 0
    s_waitcnt vmcnt(4)
    v_max_u32 v12, v56, v57
    v_max_u32 v13, v58, v59
    v_mfma_f32_16x16x32_bf16 v[160:163], v[184:187], v[56:59], 0
    s_waitcnt vmcnt(3)
    v_max3_u32 v12, v12, v60, v61
    v_max3_u32 v13, v13, v62, v63
    v_mfma_f32_16x16x32_bf16 v[164:167], v[184:187], v[60:63], 0
    s_waitcnt vmcnt(2)
    v_max3_u32 v12, v12, v64, v65
    v_max3_u32 v13, v13, v66, v67
    v_mfma_f32_16x16x32_bf16 v[168:171], v[184:187], v[64:67], 0
    s_waitcnt vmcnt(1)
    v_max3_u32 v12, v12, v68, v69
    v_max3_u32 v13, v13, v70, v71
    v_mfma_f32_16x16x32_bf16 v[172:175], v[184:187], v[68:71], 0
    v_cvt_pk_bf16_f32 v16, v160, v161
    v_cvt_pk_bf16_f32 v17, v162, v163
    s_waitcnt vmcnt(0)
    v_max3_u32 v12, v12, v72, v73
    v_max3_u32 v13, v13, v74, v75
    v_mfma_f32_16x16x32_bf16 v[176:179], v[184:187], v[72:75], 0
    v_max_u32 v12, v12, v13
    v_cvt_pk_bf16_f32 v18, v164, v165
    v_cmp_eq_u32 vcc, -1, v12
    v_cvt_pk_bf16_f32 v19, v166, v167
    s_cbranch_vccnz SQ_GAS
    ds_write_b128 v2, v[16:19]
    v_cvt_pk_bf16_f32 v32, v168, v169
    v_smfmac_f32_16x16x64_bf16 v[100:103], v[16:19], a[0:7], v8
    v_cvt_pk_bf16_f32 v33, v170, v171
    v_cvt_pk_bf16_f32 v34, v172, v173
    v_smfmac_f32_16x16x64_bf16 v[104:107], v[16:19], a[8:15], v8
    v_cvt_pk_bf16_f32 v35, v174, v175
    v_cvt_pk_bf16_f32 v98, v176, v177
    v_smfmac_f32_16x16x64_bf16 v[108:111], v[16:19], a[16:23], v8
    ds_write_b128 v2, v[32:35] offset:4096
    v_cvt_pk_bf16_f32 v99, v178, v179
    v_smfmac_f32_16x16x64_bf16 v[112:115], v[16:19], a[24:31], v8
    ds_write_b64 v7, v[98:99] offset:8192
    s_waitcnt lgkmcnt(2)
    s_barrier
    ds_read_b128 v[20:23], v3
    v_smfmac_f32_16x16x64_bf16 v[100:103], v[32:35], a[128:135], v8
    ds_read_b128 v[24:27], v4
    s_add_u32 s28, s31, 2
    s_and_b32 s29, s28, 0x42
    s_cbranch_scc0 SQ_CK
SQ_CKR:
    s_add_u32 s38, s38, 524288
    v_smfmac_f32_16x16x64_bf16 v[104:107], v[32:35], a[136:143], v8
    ds_read_b128 v[28:31], v5
    buffer_load_dwordx4 v[76:79], v0, s[8:11], s38 offen offset:0 sc1
    v_smfmac_f32_16x16x64_bf16 v[108:111], v[32:35], a[144:151], v8
    v_smfmac_f32_16x16x64_bf16 v[112:115], v[32:35], a[152:159], v8
    buffer_load_dwordx4 v[80:83], v0, s[8:11], s38 offen offset:1024 sc1
    s_waitcnt lgkmcnt(2)
    v_smfmac_f32_16x16x64_bf16 v[100:103], v[20:23], a[32:39], v8
    s_barrier
    ds_read_b128 v[36:39], v3 offset:4096
    v_smfmac_f32_16x16x64_bf16 v[104:107], v[20:23], a[40:47], v8
    ds_read_b128 v[40:43], v4 offset:4096
    buffer_load_dwordx4 v[84:87], v0, s[8:11], s38 offen offset:2048 sc1
    s_waitcnt lgkmcnt(3)
    v_smfmac_f32_16x16x64_bf16 v[100:103], v[24:27], a[64:71], v8
    ds_read_b128 v[44:47], v5 offset:4096
    v_smfmac_f32_16x16x64_bf16 v[104:107], v[24:27], a[72:79], v8
    ds_read_b128 v[48:51], v6 offset:8192
    buffer_load_dwordx4 v[88:91], v0, s[8:11], s38 offen offset:3072 sc1
    s_waitcnt lgkmcnt(4)
    v_smfmac_f32_16x16x64_bf16 v[100:103], v[28:31], a[96:103], v8
    ds_read_b128 v[52:55], v6 offset:9216
    v_smfmac_f32_16x16x64_bf16 v[104:107], v[28:31], a[104:111], v8
    buffer_store_dwordx4 v[156:159], v6, s[8:11], s39 offen sc1
    s_add_u32 s39, s39, 262144
    s_waitcnt lgkmcnt(4)
    v_smfmac_f32_16x16x64_bf16 v[100:103], v[36:39], a[160:167], v8
    v_smfmac_f32_16x16x64_bf16 v[104:107], v[36:39], a[168:175], v8
    s_waitcnt lgkmcnt(3)
    v_smfmac_f32_16x16x64_bf16 v[100:103], v[40:43], a[192:199], v8
    v_smfmac_f32_16x16x64_bf16 v[104:107], v[40:43], a[200:207], v8
    s_waitcnt lgkmcnt(2)
    v_smfmac_f32_16x16x64_bf16 v[100:103], v[44:47], a[224:231], v8
    v_smfmac_f32_16x16x64_bf16 v[104:107], v[44:47], a[232:239], v8
    s_waitcnt lgkmcnt(1)
    v_smfmac_f32_16x16x64_bf16 v[100:103], v[48:51], v[192:199], v8
    v_smfmac_f32_16x16x64_bf16 v[104:107], v[48:51], v[200:207], v8
    s_waitcnt lgkmcnt(0)
    v_smfmac_f32_16x16x64_bf16 v[100:103], v[52:55], v[224:231], v8
    v_smfmac_f32_16x16x64_bf16 v[104:107], v[52:55], v[232:239], v8
    v_smfmac_f32_16x16x64_bf16 v[108:111], v[20:23], a[48:55], v8
    v_smfmac_f32_16x16x64_bf16 v[112:115], v[20:23], a[56:63], v8
    v_permlane32_swap_b32 v100, v104
    v_permlane32_swap_b32 v101, v105
    v_smfmac_f32_16x16x64_bf16 v[108:111], v[24:27], a[80:87], v8
    v_permlane32_swap_b32 v102, v106
    v_permlane32_swap_b32 v103, v107
    v_smfmac_f32_16x16x64_bf16 v[112:115], v[24:27], a[88:95], v8
    v_add_f32 v100, v100, v104
    v_add_f32 v101, v101, v105
    v_add_f32 v102, v102, v106
    v_smfmac_f32_16x16x64_bf16 v[108:111], v[28:31], a[112:119], v8
    v_add_f32 v103, v103, v107
    v_cvt_pk_bf16_f32 v100, v100, v101
    v_cvt_pk_bf16_f32 v101, v102, v103
    ds_write_b64 v9, v[100:101]
    v_smfmac_f32_16x16x64_bf16 v[112:115], v[28:31], a[120:127], v8
    v_smfmac_f32_16x16x64_bf16 v[108:111], v[36:39], a[176:183], v8
    v_smfmac_f32_16x16x64_bf16 v[112:115], v[36:39], a[184:191], v8
    v_smfmac_f32_16x16x64_bf16 v[108:111], v[40:43], a[208:215], v8
    v_smfmac_f32_16x16x64_bf16 v[112:115], v[40:43], a[216:223], v8
    s_waitcnt lgkmcnt(0)
    s_barrier
    ds_read_b64_tr_b16 v[132:133], v10 offset:0
    v_smfmac_f32_16x16x64_bf16 v[108:111], v[44:47], a[240:247], v8
    ds_read_b64_tr_b16 v[134:135], v10 offset:32
    ds_read_b64_tr_b16 v[136:137], v10 offset:576
    v_smfmac_f32_16x16x64_bf16 v[108:111], v[48:51], v[208:215], v8
    ds_read_b64_tr_b16 v[138:139], v10 offset:608
    v_smfmac_f32_16x16x64_bf16 v[108:111], v[52:55], v[240:247], v8
    ds_read_b64_tr_b16 v[140:141], v10 offset:1152
    ds_read_b64_tr_b16 v[142:143], v10 offset:1184
    v_smfmac_f32_16x16x64_bf16 v[112:115], v[44:47], a[248:255], v8
    ds_read_b64_tr_b16 v[144:145], v10 offset:1728
    ds_read_b64_tr_b16 v[146:147], v10 offset:1760
    v_smfmac_f32_16x16x64_bf16 v[112:115], v[48:51], v[216:223], v8
    v_cvt_pk_bf16_f32 v156, v108, v109
    v_smfmac_f32_16x16x64_bf16 v[112:115], v[52:55], v[248:255], v8
    v_cvt_pk_bf16_f32 v157, v110, v111
    ds_write_b64 v14, v[156:157]
    s_cmp_eq_u32 s31, 63
    s_nop 4
    v_cvt_pk_bf16_f32 v158, v112, v113
    v_cvt_pk_bf16_f32 v159, v114, v115
    ds_write_b64 v14, v[158:159] offset:576
    s_cbranch_scc1 SQ_LAST
    s_cmp_lt_u32 s17, 2
    s_cbranch_scc0 SQ_MM
    s_waitcnt lgkmcnt(8)
    v_mfma_f32_16x16x32_bf16 v[16:19], v[116:119], v[132:135], 0
    s_waitcnt lgkmcnt(6)
    v_mfma_f32_16x16x32_bf16 v[16:19], v[120:123], v[136:139], v[16:19]
    s_waitcnt lgkmcnt(4)
    v_mfma_f32_16x16x32_bf16 v[16:19], v[124:127], v[140:143], v[16:19]
    s_waitcnt lgkmcnt(2)
    v_mfma_f32_16x16x32_bf16 v[16:19], v[128:131], v[144:147], v[16:19]
    s_waitcnt lgkmcnt(0)
    s_barrier
    s_nop 5
    v_mul_f32 v20, s64, v16
    v_mul_f32 v21, s64, v17
    v_mul_f32 v22, s64, v18
    v_mul_f32 v23, s64, v19
    v_exp_f32 v152, v20
    v_exp_f32 v153, v21
    v_exp_f32 v154, v22
    v_exp_f32 v155, v23
    v_cmp_nge_f32 s[40:41], s65, abs(v20)
    v_cmp_nge_f32 s[42:43], s65, abs(v21)
    v_cmp_nge_f32 s[44:45], s65, abs(v22)
    v_cmp_nge_f32 s[46:47], s65, abs(v23)
    v_cvt_pk_bf16_f32 v152, v152, v153
    v_cvt_pk_bf16_f32 v153, v154, v155
    s_or_b64 vcc, s[40:41], s[42:43]
    s_or_b64 vcc, vcc, s[44:45]
    s_or_b64 vcc, vcc, s[46:47]
    v_or_b32 v152, s49, v152
    v_or_b32 v153, s49, v153
    s_cbranch_vccnz SQ_T_BAD
SQ_T_SEND:
    buffer_store_dwordx2 v[152:153], v1, s[8:11], s48 offen sc1
SQ_J:
    v_mov_b32 v12, 28160
    s_waitcnt lgkmcnt(0)
    s_barrier
    ds_read_b32 v13, v12
    s_waitcnt vmcnt(1)
    s_cmp_eq_u32 s17, 3
    s_cbranch_scc0 SQ_FLR
    s_lshl_b32 s28, s18, 8
    s_add_u32 s28, s28, 1048576
    v_mov_b32 v96, 0
    v_mov_b32 v97, s31
    s_mov_b64 exec, 1
    buffer_store_dword v97, v96, s[8:11], s28 offen sc1
    s_mov_b64 exec, -1
SQ_FLR:
    v_mov_b64 v[132:133], -1
    v_mov_b64 v[134:135], -1
    s_add_u32 s72, s31, 3
    s_and_b32 s72, s72, 3
    s_lshl_b32 s72, s72, 15
    s_add_u32 s72, s72, s51
    s_add_u32 s73, s31, 2
    s_and_b32 s73, s73, 3
    s_lshl_b32 s73, s73, 19
    s_add_u32 s28, s72, s67
    buffer_store_dword v132, v191, s[8:11], s28 offen sc1
    s_add_u32 s28, s28, 261120
    buffer_store_dword v132, v191, s[8:11], s28 offen sc1
    s_add_u32 s28, s73, s60
    buffer_store_dwordx4 v[132:135], v6, s[8:11], s28 offen sc1
    buffer_store_dwordx4 v[132:135], v6, s[8:11], s28 offen offset:1024 sc1
    s_cmp_eq_u32 s63, 0
    s_cbranch_scc1 SQ_NA2
    s_add_u32 s28, s72, s68
    buffer_store_dword v132, v191, s[8:11], s28 offen sc1
    s_add_u32 s28, s28, 261120
    buffer_store_dword v132, v191, s[8:11], s28 offen sc1
    s_add_u32 s28, s73, s66
    buffer_store_dwordx4 v[132:135], v6, s[8:11], s28 offen sc1
    buffer_store_dwordx4 v[132:135], v6, s[8:11], s28 offen offset:1024 sc1
SQ_NA2:
    s_add_u32 s31, s31, 1
    s_waitcnt lgkmcnt(0)
    v_cmp_ne_u32 vcc, 0, v13
    s_nop 0
    s_cbranch_vccnz SQ_SLOW
    s_branch SQ_LOOP
SQ_LAST:
    buffer_store_dwordx4 v[156:159], v6, s[8:11], s39 offen sc1
    s_waitcnt vmcnt(0)
    s_barrier
    s_cmp_eq_u32 s17, 0
    s_cbranch_scc0 SQ_LA
    s_lshl_b32 s28, s18, 8
    s_add_u32 s28, s28, 1048580
    v_mov_b32 v96, 0
    v_mov_b32 v97, 128
    s_mov_b64 exec, 1
    buffer_store_dword v97, v96, s[8:11], s28 offen sc1
    s_mov_b64 exec, -1
SQ_LA:
    s_branch T_EXIT
SQ_SLOW:
    v_max_f32 v13, v16, v17
    v_max3_f32 v13, v13, v18, v19
    v_and_b32 v132, 0x70, v2
    v_lshlrev_b32 v132, 2, v132
    v_lshrrev_b32 v133, 8, v2
    v_lshl_add_u32 v133, v133, 2, v132
    ds_write_b32 v133, v13 offset:27648
    s_waitcnt lgkmcnt(0)
    s_barrier
    v_mov_b32 v13, 0
    ds_write_b32 v12, v13
    ds_read_b128 v[136:139], v132 offset:27648
    ds_read_b128 v[140:143], v132 offset:27664
    ds_read_b128 v[144:147], v132 offset:27680
    s_waitcnt lgkmcnt(2)
    v_max3_f32 v13, v136, v137, v138
    s_waitcnt lgkmcnt(1)
    v_max3_f32 v13, v13, v139, v140
    v_max3_f32 v13, v13, v141, v142
    s_waitcnt lgkmcnt(0)
    v_max3_f32 v13, v13, v143, v144
    v_max3_f32 v13, v13, v145, v146
    v_max_f32 v13, v13, v147
    v_sub_f32 v152, v16, v13
    v_sub_f32 v153, v17, v13
    v_sub_f32 v154, v18, v13
    v_sub_f32 v155, v19, v13
    v_mul_f32 v152, s64, v152
    v_mul_f32 v153, s64, v153
    v_mul_f32 v154, s64, v154
    v_mul_f32 v155, s64, v155
    v_exp_f32 v152, v152
    v_exp_f32 v153, v153
    v_exp_f32 v154, v154
    v_exp_f32 v155, v155
    v_cvt_pk_bf16_f32 v152, v152, v153
    v_cvt_pk_bf16_f32 v153, v154, v155
    v_and_b32 v152, 0x7fff7fff, v152
    v_and_b32 v153, 0x7fff7fff, v153
    s_cmp_lt_u32 s17, 2
    s_cbranch_scc0 SQ_SLOWM
    buffer_store_dwordx2 v[152:153], v1, s[8:11], s48 offen offset:1024 sc1
    s_branch SQ_LOOP
SQ_SLOWM:
    buffer_store_dword v152, v1, s[8:11], s48 offen offset:1024 sc1
    s_branch SQ_LOOP
SQ_RES:
    buffer_load_dwordx4 v[16:19], v6, s[8:11], s74 offen offset:0 sc1
    buffer_load_dwordx4 v[20:23], v6, s[8:11], s74 offen offset:1024 sc1
    s_add_u32 s30, s30, 1
    s_cmp_gt_u32 s30, 600000
    s_cbranch_scc1 T_EXIT
    s_branch SQ_RE
SQ_GAS:
    buffer_load_dwordx4 v[56:59], v182, s[8:11], s33 offen offset:0 sc1
    buffer_load_dwordx4 v[60:63], v182, s[8:11], s33 offen offset:512 sc1
    buffer_load_dwordx4 v[64:67], v182, s[8:11], s34 offen offset:0 sc1
    buffer_load_dwordx4 v[68:71], v182, s[8:11], s34 offen offset:512 sc1
    buffer_load_dwordx4 v[72:75], v182, s[8:11], s35 offen offset:0 sc1
    s_add_u32 s30, s30, 1
    s_cmp_gt_u32 s30, 600000
    s_cbranch_scc1 T_EXIT
    s_branch SQ_GA
SQ_CK:
    s_bitcmp1_b32 s28, 0
    s_cselect_b32 s29, 1, 0
    s_lshr_b32 s28, s28, 3
    s_lshl_b32 s28, s28, 2
    s_add_u32 s28, s28, 208
    s_cmp_eq_u32 s29, 1
    s_cbranch_scc1 SQ_CKT
    v_mov_b32 v96, 0
    buffer_load_dword v190, v96, s[4:7], s28 offen sc1
    s_branch SQ_CKR
SQ_CKT:
    v_readfirstlane_b32 s29, v190
    s_nop 0
    s_cmp_ge_u32 s29, 1
    s_cbranch_scc1 SQ_CKR
    v_mov_b32 v96, 0
SQ_CKW:
    buffer_load_dword v190, v96, s[4:7], s28 offen sc1
    s_add_u32 s3, s3, 1
    s_cmp_gt_u32 s3, 2000000
    s_cbranch_scc1 K_END
    s_waitcnt vmcnt(0)
    v_readfirstlane_b32 s29, v190
    s_nop 0
    s_cmp_ge_u32 s29, 1
    s_cbranch_scc1 SQ_CKW_OK
    s_sleep 2
    s_branch SQ_CKW
SQ_CKW_OK:
    s_branch SQ_CKR
SQ_T_BAD:
    s_or_b32 s28, s49, 0x7fc07fc0
    v_mov_b32 v152, s28
    v_mov_b32 v153, s28
    v_mov_b32 v12, 28160
    v_mov_b32 v13, 1
    ds_write_b32 v12, v13
    s_branch SQ_T_SEND
SQ_M_BAD:
    s_or_b32 s28, s49, 0x7fc07fc0
    v_mov_b32 v152, s28
    v_mov_b32 v153, s28
    v_mov_b32 v12, 28160
    v_mov_b32 v13, 1
    ds_write_b32 v12, v13
    s_branch SQ_M_SEND
SQ_MM:
    s_waitcnt lgkmcnt(0)
    s_barrier
    ds_read_b64_tr_b16 v[116:117], v15 offset:0
    ds_read_b64_tr_b16 v[118:119], v15 offset:64
    ds_read_b64_tr_b16 v[120:121], v15 offset:1152
    ds_read_b64_tr_b16 v[122:123], v15 offset:1216
    ds_read_b64_tr_b16 v[124:125], v15 offset:2304
    ds_read_b64_tr_b16 v[126:127], v15 offset:2368
    ds_read_b64_tr_b16 v[128:129], v15 offset:3456
    ds_read_b64_tr_b16 v[130:131], v15 offset:3520
    s_waitcnt lgkmcnt(6)
    v_mfma_f32_16x16x32_bf16 v[16:19], v[116:119], v[132:135], 0
    s_waitcnt lgkmcnt(4)
    v_mfma_f32_16x16x32_bf16 v[16:19], v[120:123], v[136:139], v[16:19]
    s_waitcnt lgkmcnt(2)
    v_mfma_f32_16x16x32_bf16 v[16:19], v[124:127], v[140:143], v[16:19]
    s_waitcnt lgkmcnt(0)
    v_mfma_f32_16x16x32_bf16 v[16:19], v[128:131], v[144:147], v[16:19]
    s_nop 7
    v_permlane32_swap_b32 v16, v18
    v_permlane32_swap_b32 v17, v19
    v_add_f32 v16, v16, v18
    v_add_f32 v17, v17, v19
    v_mul_f32 v20, s64, v16
    v_mul_f32 v21, s64, v17
    v_exp_f32 v152, v20
    v_exp_f32 v153, v21
    v_cmp_nge_f32 s[40:41], s65, abs(v20)
    v_cmp_nge_f32 s[42:43], s65, abs(v21)
    v_cvt_pk_bf16_f32 v152, v152, v153
    s_or_b64 vcc, s[40:41], s[42:43]
    v_or_b32 v152, s49, v152
    s_cbranch_vccnz SQ_M_BAD
SQ_M_SEND:
    buffer_store_dword v152, v1, s[8:11], s48 offen sc1
    v_mov_b32 v18, v16
    v_mov_b32 v19, v17
    s_branch SQ_J
SV_LOOP:
    v_smfmac_f32_16x16x64_bf16 v[144:147], v[32:35], a[160:167], v8
    ds_read_b64_tr_b16 v[16:17], v190 offset:512
    v_cvt_pk_bf16_f32 v68, v124, v125
    v_smfmac_f32_16x16x64_bf16 v[144:147], v[36:39], a[168:175], v8
    ds_read_b64_tr_b16 v[18:19], v190 offset:544
    v_cvt_pk_bf16_f32 v69, v126, v127
    v_smfmac_f32_16x16x64_bf16 v[144:147], v[40:43], a[176:183], v8
    ds_read_b64_tr_b16 v[20:21], v190 offset:2560
    v_mov_b64 v[124:125], 0
    v_smfmac_f32_16x16x64_bf16 v[144:147], v[44:47], a[184:191], v8
    ds_read_b64_tr_b16 v[22:23], v190 offset:2592
    v_mov_b64 v[126:127], 0
    v_smfmac_f32_16x16x64_bf16 v[148:151], v[32:35], a[192:199], v8
    ds_read_b64_tr_b16 v[24:25], v190 offset:4608
    v_cvt_pk_bf16_f32 v78, v128, v129
    v_smfmac_f32_16x16x64_bf16 v[148:151], v[36:39], a[200:207], v8
    ds_read_b64_tr_b16 v[26:27], v190 offset:4640
    v_cvt_pk_bf16_f32 v79, v130, v131
    v_smfmac_f32_16x16x64_bf16 v[148:151], v[40:43], a[208:215], v8
    ds_read_b64_tr_b16 v[28:29], v190 offset:6656
    v_mov_b64 v[128:129], 0
    v_smfmac_f32_16x16x64_bf16 v[148:151], v[44:47], a[216:223], v8
    s_barrier
    s_add_u32 s28, s31, 2
    s_and_b32 s29, s28, 0x42
    s_cbranch_scc0 SV_CK
SV_CKR:
    ds_read_b64_tr_b16 v[30:31], v190 offset:6688
    v_mov_b64 v[130:131], 0
    v_smfmac_f32_16x16x64_bf16 v[152:155], v[32:35], a[224:231], v8
    s_mov_b32 m0, s70
    s_nop 0
    buffer_load_dwordx4 v6, s[8:11], s38 offen sc1 lds
    v_cvt_pk_bf16_f32 v88, v132, v133
    v_smfmac_f32_16x16x64_bf16 v[152:155], v[36:39], a[232:239], v8
    buffer_load_dwordx4 v6, s[8:11], s38 offen offset:1024 sc1 lds
    s_add_u32 s38, s38, 524288
    v_cvt_pk_bf16_f32 v89, v134, v135
    v_smfmac_f32_16x16x64_bf16 v[152:155], v[40:43], a[240:247], v8
    s_xor_b32 s70, s70, 8192
    buffer_store_dwordx4 v[64:67], v6, s[8:11], s39 offen offset:1024 sc1
    v_mov_b64 v[132:133], 0
    v_smfmac_f32_16x16x64_bf16 v[152:155], v[44:47], a[248:255], v8
    s_add_u32 s39, s39, 262144
    s_and_b32 s49, s31, 1
    v_mov_b64 v[134:135], 0
    v_smfmac_f32_16x16x64_bf16 v[156:159], v[32:35], v[192:199], v8
    s_add_u32 s28, s31, 1
    s_and_b32 s28, s28, 3
    v_cvt_pk_bf16_f32 v98, v136, v137
    v_smfmac_f32_16x16x64_bf16 v[156:159], v[36:39], v[200:207], v8
    s_lshl_b32 s28, s28, 15
    s_add_u32 s61, s28, s51
    v_cvt_pk_bf16_f32 v99, v138, v139
    v_smfmac_f32_16x16x64_bf16 v[156:159], v[40:43], v[208:215], v8
    s_add_u32 s62, s28, s69
    s_and_b32 s28, s31, 3
    v_mov_b64 v[136:137], 0
    v_smfmac_f32_16x16x64_bf16 v[156:159], v[44:47], v[216:223], v8
    s_lshl_b32 s28, s28, 19
    s_add_u32 s76, s28, s60
    v_mov_b64 v[138:139], 0
    v_smfmac_f32_16x16x64_bf16 v[160:163], v[32:35], v[224:231], v8
    s_add_u32 s77, s28, s66
    s_add_u32 s22, s28, 20971520
    v_cvt_pk_bf16_f32 v108, v140, v141
    v_smfmac_f32_16x16x64_bf16 v[160:163], v[36:39], v[232:239], v8
    s_add_u32 s23, s28, 21004288
    s_add_u32 s24, s28, 21037056
    v_cvt_pk_bf16_f32 v109, v142, v143
    v_smfmac_f32_16x16x64_bf16 v[160:163], v[40:43], v[240:247], v8
    s_add_u32 s25, s28, 21069824
    s_add_u32 s26, s28, 21102592
    v_mov_b64 v[140:141], 0
    v_smfmac_f32_16x16x64_bf16 v[160:163], v[44:47], v[248:255], v8
    s_waitcnt lgkmcnt(6)
    v_mov_b64 v[142:143], 0
    v_smfmac_f32_16x16x64_bf16 v[124:127], v[16:19], a[160:167], v8
    ds_read_b64_tr_b16 v[32:33], v190 offset:768
    s_waitcnt lgkmcnt(5)
    v_cvt_pk_bf16_f32 v70, v144, v145
    v_smfmac_f32_16x16x64_bf16 v[124:127], v[20:23], a[168:175], v8
    ds_read_b64_tr_b16 v[34:35], v190 offset:800
    s_waitcnt lgkmcnt(4)
    v_cvt_pk_bf16_f32 v71, v146, v147
    v_smfmac_f32_16x16x64_bf16 v[124:127], v[24:27], a[176:183], v8
    ds_read_b64_tr_b16 v[36:37], v190 offset:2816
    s_waitcnt lgkmcnt(3)
    v_mov_b64 v[144:145], 0
    v_smfmac_f32_16x16x64_bf16 v[124:127], v[28:31], a[184:191], v8
    ds_read_b64_tr_b16 v[38:39], v190 offset:2848
    v_mov_b64 v[146:147], 0
    v_smfmac_f32_16x16x64_bf16 v[128:131], v[16:19], a[192:199], v8
    ds_read_b64_tr_b16 v[40:41], v190 offset:4864
    v_cvt_pk_bf16_f32 v80, v148, v149
    v_smfmac_f32_16x16x64_bf16 v[128:131], v[20:23], a[200:207], v8
    ds_read_b64_tr_b16 v[42:43], v190 offset:4896
    v_cvt_pk_bf16_f32 v81, v150, v151
    v_smfmac_f32_16x16x64_bf16 v[128:131], v[24:27], a[208:215], v8
    ds_read_b64_tr_b16 v[44:45], v190 offset:6912
    v_mov_b64 v[148:149], 0
    v_smfmac_f32_16x16x64_bf16 v[128:131], v[28:31], a[216:223], v8
    ds_read_b64_tr_b16 v[46:47], v190 offset:6944
    v_mov_b64 v[150:151], 0
    v_smfmac_f32_16x16x64_bf16 v[132:135], v[16:19], a[224:231], v8
    v_cvt_pk_bf16_f32 v90, v152, v153
    v_smfmac_f32_16x16x64_bf16 v[132:135], v[20:23], a[232:239], v8
    v_cvt_pk_bf16_f32 v91, v154, v155
    v_smfmac_f32_16x16x64_bf16 v[132:135], v[24:27], a[240:247], v8
    v_mov_b64 v[152:153], 0
    v_smfmac_f32_16x16x64_bf16 v[132:135], v[28:31], a[248:255], v8
    v_mov_b64 v[154:155], 0
    v_smfmac_f32_16x16x64_bf16 v[136:139], v[16:19], v[192:199], v8
    v_cvt_pk_bf16_f32 v100, v156, v157
    v_smfmac_f32_16x16x64_bf16 v[136:139], v[20:23], v[200:207], v8
    v_cvt_pk_bf16_f32 v101, v158, v159
    v_smfmac_f32_16x16x64_bf16 v[136:139], v[24:27], v[208:215], v8
    v_mov_b64 v[156:157], 0
    v_smfmac_f32_16x16x64_bf16 v[136:139], v[28:31], v[216:223], v8
    v_mov_b64 v[158:159], 0
    v_smfmac_f32_16x16x64_bf16 v[140:143], v[16:19], v[224:231], v8
    v_cvt_pk_bf16_f32 v110, v160, v161
    v_smfmac_f32_16x16x64_bf16 v[140:143], v[20:23], v[232:239], v8
    v_cvt_pk_bf16_f32 v111, v162, v163
    v_smfmac_f32_16x16x64_bf16 v[140:143], v[24:27], v[240:247], v8
    v_mov_b64 v[160:161], 0
    v_smfmac_f32_16x16x64_bf16 v[140:143], v[28:31], v[248:255], v8
    s_waitcnt lgkmcnt(6)
    v_mov_b64 v[162:163], 0
    v_smfmac_f32_16x16x64_bf16 v[144:147], v[32:35], a[160:167], v8
    s_waitcnt lgkmcnt(4)
    v_cvt_pk_bf16_f32 v72, v124, v125
    v_smfmac_f32_16x16x64_bf16 v[144:147], v[36:39], a[168:175], v8
    s_waitcnt lgkmcnt(2)
    v_cvt_pk_bf16_f32 v73, v126, v127
    v_smfmac_f32_16x16x64_bf16 v[144:147], v[40:43], a[176:183], v8
    s_waitcnt lgkmcnt(0)
    v_cvt_pk_bf16_f32 v82, v128, v129
    v_smfmac_f32_16x16x64_bf16 v[144:147], v[44:47], a[184:191], v8
    v_cvt_pk_bf16_f32 v83, v130, v131
    v_smfmac_f32_16x16x64_bf16 v[148:151], v[32:35], a[192:199], v8
    v_cvt_pk_bf16_f32 v92, v132, v133
    v_smfmac_f32_16x16x64_bf16 v[148:151], v[36:39], a[200:207], v8
    v_cvt_pk_bf16_f32 v93, v134, v135
    v_smfmac_f32_16x16x64_bf16 v[148:151], v[40:43], a[208:215], v8
    v_cvt_pk_bf16_f32 v102, v136, v137
    v_smfmac_f32_16x16x64_bf16 v[148:151], v[44:47], a[216:223], v8
    v_cvt_pk_bf16_f32 v103, v138, v139
    v_smfmac_f32_16x16x64_bf16 v[152:155], v[32:35], a[224:231], v8
    v_cvt_pk_bf16_f32 v112, v140, v141
    v_smfmac_f32_16x16x64_bf16 v[152:155], v[36:39], a[232:239], v8
    v_cvt_pk_bf16_f32 v113, v142, v143
    v_smfmac_f32_16x16x64_bf16 v[152:155], v[40:43], a[240:247], v8
    v_mov_b64 v[56:57], 0
    v_smfmac_f32_16x16x64_bf16 v[152:155], v[44:47], a[248:255], v8
    v_mov_b64 v[58:59], 0
    v_smfmac_f32_16x16x64_bf16 v[156:159], v[32:35], v[192:199], v8
    v_mov_b64 v[60:61], 0
    v_smfmac_f32_16x16x64_bf16 v[156:159], v[36:39], v[200:207], v8
    v_mov_b64 v[62:63], 0
    v_smfmac_f32_16x16x64_bf16 v[156:159], v[40:43], v[208:215], v8
    buffer_load_dwordx4 v[16:19], v182, s[8:11], s33 offen offset:0 sc1
    buffer_load_dwordx4 v[20:23], v182, s[8:11], s33 offen offset:512 sc1
    buffer_load_dwordx4 v[24:27], v182, s[8:11], s34 offen offset:0 sc1
    buffer_load_dwordx4 v[28:31], v182, s[8:11], s34 offen offset:512 sc1
    buffer_load_dwordx4 v[52:55], v182, s[8:11], s35 offen offset:0 sc1
    v_smfmac_f32_16x16x64_bf16 v[156:159], v[44:47], v[216:223], v8
    v_smfmac_f32_16x16x64_bf16 v[160:163], v[32:35], v[224:231], v8
    v_smfmac_f32_16x16x64_bf16 v[160:163], v[36:39], v[232:239], v8
    v_smfmac_f32_16x16x64_bf16 v[160:163], v[40:43], v[240:247], v8
    v_smfmac_f32_16x16x64_bf16 v[160:163], v[44:47], v[248:255], v8
SV_GA:
    s_nop 0
    s_waitcnt vmcnt(4)
    v_max_u32 v12, v16, v17
    v_max_u32 v13, v18, v19
    v_mfma_f32_16x16x32_bf16 v[124:127], v[118:121], v[16:19], 0
    s_waitcnt vmcnt(3)
    v_max3_u32 v12, v12, v20, v21
    v_max3_u32 v13, v13, v22, v23
    v_mfma_f32_16x16x32_bf16 v[128:131], v[118:121], v[20:23], 0
    s_waitcnt vmcnt(2)
    v_max3_u32 v12, v12, v24, v25
    v_max3_u32 v13, v13, v26, v27
    v_mfma_f32_16x16x32_bf16 v[132:135], v[118:121], v[24:27], 0
    s_waitcnt vmcnt(1)
    v_max3_u32 v12, v12, v28, v29
    v_max3_u32 v13, v13, v30, v31
    v_mfma_f32_16x16x32_bf16 v[136:139], v[118:121], v[28:31], 0
    v_cvt_pk_bf16_f32 v48, v124, v125
    v_cvt_pk_bf16_f32 v49, v126, v127
    s_waitcnt vmcnt(0)
    v_max3_u32 v12, v12, v52, v53
    v_max3_u32 v13, v13, v54, v55
    v_mfma_f32_16x16x32_bf16 v[140:143], v[118:121], v[52:55], 0
    v_max_u32 v12, v12, v13
    v_cvt_pk_bf16_f32 v50, v128, v129
    v_cmp_eq_u32 vcc, -1, v12
    v_cvt_pk_bf16_f32 v51, v130, v131
    s_cbranch_vccnz SV_GAS
    ds_write_b128 v2, v[48:51]
    v_cvt_pk_bf16_f32 v52, v132, v133
    v_cvt_pk_bf16_f32 v53, v134, v135
    v_cvt_pk_bf16_f32 v54, v136, v137
    v_cvt_pk_bf16_f32 v55, v138, v139
    v_smfmac_f32_16x16x64_bf16 v[56:59], v[48:51], a[0:7], v8
    ds_write_b128 v2, v[52:55] offset:4096
    v_cvt_pk_bf16_f32 v176, v140, v141
    v_cvt_pk_bf16_f32 v177, v142, v143
    v_smfmac_f32_16x16x64_bf16 v[60:63], v[48:51], a[8:15], v8
    ds_write_b64 v7, v[176:177] offset:8192
    v_smfmac_f32_16x16x64_bf16 v[56:59], v[52:55], a[64:71], v8
    v_mov_b64 v[124:125], 0
    v_smfmac_f32_16x16x64_bf16 v[60:63], v[52:55], a[72:79], v8
    v_mov_b64 v[126:127], 0
    s_waitcnt lgkmcnt(0)
    s_barrier
    ds_read_b128 v[16:19], v3 offset:0
    ds_read_b128 v[20:23], v4 offset:0
    ds_read_b128 v[24:27], v5 offset:0
    ds_read_b128 v[28:31], v3 offset:4096
    s_waitcnt lgkmcnt(3)
    v_smfmac_f32_16x16x64_bf16 v[56:59], v[16:19], a[16:23], v8
    v_mov_b64 v[128:129], 0
    v_smfmac_f32_16x16x64_bf16 v[60:63], v[16:19], a[24:31], v8
    ds_read_b128 v[16:19], v4 offset:4096
    s_waitcnt lgkmcnt(3)
    v_mov_b64 v[130:131], 0
    v_smfmac_f32_16x16x64_bf16 v[56:59], v[20:23], a[32:39], v8
    v_mov_b64 v[132:133], 0
    v_smfmac_f32_16x16x64_bf16 v[60:63], v[20:23], a[40:47], v8
    ds_read_b128 v[20:23], v5 offset:4096
    s_waitcnt lgkmcnt(3)
    v_mov_b64 v[134:135], 0
    v_smfmac_f32_16x16x64_bf16 v[56:59], v[24:27], a[48:55], v8
    v_mov_b64 v[136:137], 0
    v_smfmac_f32_16x16x64_bf16 v[60:63], v[24:27], a[56:63], v8
    ds_read_b128 v[24:27], v6 offset:8192
    s_waitcnt lgkmcnt(3)
    v_mov_b64 v[138:139], 0
    v_smfmac_f32_16x16x64_bf16 v[56:59], v[28:31], a[80:87], v8
    v_mov_b64 v[140:141], 0
    v_smfmac_f32_16x16x64_bf16 v[60:63], v[28:31], a[88:95], v8
    ds_read_b128 v[28:31], v6 offset:9216
    s_waitcnt lgkmcnt(3)
    v_mov_b64 v[142:143], 0
    v_smfmac_f32_16x16x64_bf16 v[56:59], v[16:19], a[96:103], v8
    v_cvt_pk_bf16_f32 v74, v144, v145
    v_smfmac_f32_16x16x64_bf16 v[60:63], v[16:19], a[104:111], v8
    s_waitcnt lgkmcnt(2)
    v_cvt_pk_bf16_f32 v75, v146, v147
    v_smfmac_f32_16x16x64_bf16 v[56:59], v[20:23], a[112:119], v8
    v_cvt_pk_bf16_f32 v84, v148, v149
    v_smfmac_f32_16x16x64_bf16 v[60:63], v[20:23], a[120:127], v8
    s_waitcnt lgkmcnt(1)
    v_cvt_pk_bf16_f32 v85, v150, v151
    v_smfmac_f32_16x16x64_bf16 v[56:59], v[24:27], a[128:135], v8
    v_cvt_pk_bf16_f32 v94, v152, v153
    v_smfmac_f32_16x16x64_bf16 v[60:63], v[24:27], a[136:143], v8
    s_waitcnt lgkmcnt(0)
    v_cvt_pk_bf16_f32 v95, v154, v155
    v_smfmac_f32_16x16x64_bf16 v[56:59], v[28:31], a[144:151], v8
    v_cvt_pk_bf16_f32 v104, v156, v157
    v_smfmac_f32_16x16x64_bf16 v[60:63], v[28:31], a[152:159], v8
    v_cvt_pk_bf16_f32 v105, v158, v159
    v_cvt_pk_bf16_f32 v114, v160, v161
    v_cvt_pk_bf16_f32 v115, v162, v163
    s_cmp_eq_u32 s31, 63
    v_cvt_pk_bf16_f32 v64, v56, v57
    v_cvt_pk_bf16_f32 v65, v58, v59
    s_nop 1
    v_cvt_pk_bf16_f32 v66, v60, v61
    v_cvt_pk_bf16_f32 v67, v62, v63
    s_cbranch_scc1 SV_LAST
    v_permlane32_swap_b32 v56, v60
    v_permlane32_swap_b32 v57, v61
    v_permlane32_swap_b32 v58, v62
    v_permlane32_swap_b32 v59, v63
    v_add_f32 v56, v56, v60
    v_add_f32 v57, v57, v61
    v_add_f32 v58, v58, v62
    v_add_f32 v59, v59, v63
    v_cvt_pk_bf16_f32 v56, v56, v57
    v_cvt_pk_bf16_f32 v57, v58, v59
    ds_write_b64 v9, v[56:57]
    v_xor_b32 v190, 8192, v190
    s_waitcnt lgkmcnt(0)
    s_barrier
    ds_read_b64_tr_b16 v[16:17], v10 offset:0
    ds_read_b64_tr_b16 v[18:19], v10 offset:32
    ds_read_b64_tr_b16 v[20:21], v10 offset:576
    ds_read_b64_tr_b16 v[22:23], v10 offset:608
    ds_read_b64_tr_b16 v[24:25], v10 offset:1152
    ds_read_b64_tr_b16 v[26:27], v10 offset:1184
    ds_read_b64_tr_b16 v[28:29], v10 offset:1728
    ds_read_b64_tr_b16 v[30:31], v10 offset:1760
    s_waitcnt lgkmcnt(6)
    v_smfmac_f32_16x16x64_bf16 v[124:127], v[16:19], a[160:167], v8
    s_waitcnt lgkmcnt(4)
    v_smfmac_f32_16x16x64_bf16 v[124:127], v[20:23], a[168:175], v8
    s_waitcnt lgkmcnt(2)
    v_smfmac_f32_16x16x64_bf16 v[124:127], v[24:27], a[176:183], v8
    s_waitcnt lgkmcnt(0)
    v_smfmac_f32_16x16x64_bf16 v[124:127], v[28:31], a[184:191], v8
    v_smfmac_f32_16x16x64_bf16 v[128:131], v[16:19], a[192:199], v8
    v_smfmac_f32_16x16x64_bf16 v[128:131], v[20:23], a[200:207], v8
    v_cvt_pk_bf16_f32 v76, v124, v125
    v_smfmac_f32_16x16x64_bf16 v[128:131], v[24:27], a[208:215], v8
    v_cvt_pk_bf16_f32 v77, v126, v127
    v_smfmac_f32_16x16x64_bf16 v[128:131], v[28:31], a[216:223], v8
    v_mov_b64 v[124:125], 0
    v_smfmac_f32_16x16x64_bf16 v[132:135], v[16:19], a[224:231], v8
    buffer_load_dwordx4 v[164:167], v1, s[8:11], s48 offen offset:0 sc1
    v_mov_b64 v[126:127], 0
    v_smfmac_f32_16x16x64_bf16 v[132:135], v[20:23], a[232:239], v8
    buffer_load_dwordx4 v[168:171], v1, s[8:11], s48 offen offset:256 sc1
    v_cvt_pk_bf16_f32 v86, v128, v129
    v_smfmac_f32_16x16x64_bf16 v[132:135], v[24:27], a[240:247], v8
    buffer_load_dwordx2 v[172:173], v0, s[8:11], s48 offen offset:512 sc1
    v_cvt_pk_bf16_f32 v87, v130, v131
    v_smfmac_f32_16x16x64_bf16 v[132:135], v[28:31], a[248:255], v8
    v_mov_b64 v[128:129], 0
    v_smfmac_f32_16x16x64_bf16 v[136:139], v[16:19], v[192:199], v8
    v_mov_b64 v[130:131], 0
    v_smfmac_f32_16x16x64_bf16 v[136:139], v[20:23], v[200:207], v8
    v_cvt_pk_bf16_f32 v96, v132, v133
    v_smfmac_f32_16x16x64_bf16 v[136:139], v[24:27], v[208:215], v8
    v_cvt_pk_bf16_f32 v97, v134, v135
    v_smfmac_f32_16x16x64_bf16 v[136:139], v[28:31], v[216:223], v8
    v_mov_b64 v[132:133], 0
    v_smfmac_f32_16x16x64_bf16 v[140:143], v[16:19], v[224:231], v8
    buffer_load_dwordx4 v[164:167], v1, s[8:11], s48 offen offset:0 sc1
    v_mov_b64 v[134:135], 0
    v_smfmac_f32_16x16x64_bf16 v[140:143], v[20:23], v[232:239], v8
    buffer_load_dwordx4 v[168:171], v1, s[8:11], s48 offen offset:256 sc1
    v_cvt_pk_bf16_f32 v106, v136, v137
    v_smfmac_f32_16x16x64_bf16 v[140:143], v[24:27], v[240:247], v8
    buffer_load_dwordx2 v[172:173], v0, s[8:11], s48 offen offset:512 sc1
    v_cvt_pk_bf16_f32 v107, v138, v139
    v_smfmac_f32_16x16x64_bf16 v[140:143], v[28:31], v[248:255], v8
    v_mov_b64 v[136:137], 0
    ds_read_b64_tr_b16 v[16:17], v190 offset:0
    ds_read_b64_tr_b16 v[18:19], v190 offset:32
    ds_read_b64_tr_b16 v[20:21], v190 offset:2048
    ds_read_b64_tr_b16 v[22:23], v190 offset:2080
    ds_read_b64_tr_b16 v[24:25], v190 offset:4096
    ds_read_b64_tr_b16 v[26:27], v190 offset:4128
    ds_read_b64_tr_b16 v[28:29], v190 offset:6144
    ds_read_b64_tr_b16 v[30:31], v190 offset:6176
    v_mov_b64 v[138:139], 0
    v_cvt_pk_bf16_f32 v116, v140, v141
    v_cvt_pk_bf16_f32 v117, v142, v143
    v_mov_b64 v[140:141], 0
    v_mov_b64 v[142:143], 0
    s_nop 1
    s_cmp_eq_u32 s49, 1
    s_cbranch_scc1 SV_PT1
SV_PT0:
    s_waitcnt vmcnt(3)
    v_min3_i32 v12, v164, v165, v166
    v_min3_i32 v13, v167, v168, v169
    v_min3_i32 v11, v170, v171, v172
    v_mfma_f32_16x16x32_bf16 v[56:59], v[164:167], v[178:181], 0
    v_min3_i32 v12, v12, v13, v173
    v_mfma_f32_16x16x32_bf16 v[56:59], v[168:171], v[178:181], v[56:59]
    v_min_i32 v12, v12, v11
    v_mfma_f32_16x16x32_bf16 v[56:59], v[172:175], v[178:181], v[56:59]
    v_cmp_gt_i32 vcc, 0, v12
    v_mfma_f32_16x16x32_bf16 v[160:163], v[164:167], v[108:111], 0
    s_cbranch_vccnz SV_PTS0
SV_PTG:
    v_mfma_f32_16x16x32_bf16 v[160:163], v[168:171], v[112:115], v[160:163]
    v_rcp_f32 v60, v56
    v_mfma_f32_16x16x32_bf16 v[160:163], v[172:175], v[116:119], v[160:163]
    v_rcp_f32 v61, v57
    v_mfma_f32_16x16x32_bf16 v[144:147], v[164:167], v[68:71], 0
    v_rcp_f32 v62, v58
    v_mfma_f32_16x16x32_bf16 v[144:147], v[168:171], v[72:75], v[144:147]
    v_rcp_f32 v63, v59
    v_cmp_u_f32 vcc, v56, v56
    v_mfma_f32_16x16x32_bf16 v[144:147], v[172:175], v[76:79], v[144:147]
    s_cbranch_vccnz SV_SLOW
SV_GO:
    v_mul_f32 v160, v60, v160
    v_mul_f32 v161, v61, v161
    v_mfma_f32_16x16x32_bf16 v[148:151], v[164:167], v[78:81], 0
    v_mul_f32 v162, v62, v162
    v_mul_f32 v163, v63, v163
    v_mfma_f32_16x16x32_bf16 v[148:151], v[168:171], v[82:85], v[148:151]
    v_cvt_pk_bf16_f32 v160, v160, v161
    v_cvt_pk_bf16_f32 v161, v162, v163
    v_mfma_f32_16x16x32_bf16 v[148:151], v[172:175], v[86:89], v[148:151]
    buffer_store_dwordx2 v[160:161], v14, s[8:11], s26 offen sc1
    v_mul_f32 v144, v60, v144
    v_mul_f32 v145, v61, v145
    v_mfma_f32_16x16x32_bf16 v[152:155], v[164:167], v[88:91], 0
    v_mul_f32 v146, v62, v146
    v_mul_f32 v147, v63, v147
    v_mfma_f32_16x16x32_bf16 v[152:155], v[168:171], v[92:95], v[152:155]
    v_cvt_pk_bf16_f32 v144, v144, v145
    v_cvt_pk_bf16_f32 v145, v146, v147
    v_mfma_f32_16x16x32_bf16 v[152:155], v[172:175], v[96:99], v[152:155]
    buffer_store_dwordx2 v[144:145], v14, s[8:11], s22 offen sc1
    v_mul_f32 v148, v60, v148
    v_mul_f32 v149, v61, v149
    v_mfma_f32_16x16x32_bf16 v[156:159], v[164:167], v[98:101], 0
    v_mul_f32 v150, v62, v150
    v_mul_f32 v151, v63, v151
    v_mfma_f32_16x16x32_bf16 v[156:159], v[168:171], v[102:105], v[156:159]
    v_cvt_pk_bf16_f32 v148, v148, v149
    v_cvt_pk_bf16_f32 v149, v150, v151
    v_mfma_f32_16x16x32_bf16 v[156:159], v[172:175], v[106:109], v[156:159]
    buffer_store_dwordx2 v[148:149], v14, s[8:11], s23 offen sc1
    v_pk_mul_f32 v[152:153], v[152:153], v[60:61]
    v_pk_mul_f32 v[154:155], v[154:155], v[62:63]
    v_cvt_pk_bf16_f32 v152, v152, v153
    v_cvt_pk_bf16_f32 v153, v154, v155
    buffer_store_dwordx2 v[152:153], v14, s[8:11], s24 offen sc1
    s_nop 1
    v_pk_mul_f32 v[156:157], v[156:157], v[60:61]
    v_pk_mul_f32 v[158:159], v[158:159], v[62:63]
    v_cvt_pk_bf16_f32 v156, v156, v157
    v_cvt_pk_bf16_f32 v157, v158, v159
    buffer_store_dwordx2 v[156:157], v14, s[8:11], s25 offen sc1
    s_waitcnt lgkmcnt(6)
    v_smfmac_f32_16x16x64_bf16 v[124:127], v[16:19], a[160:167], v8
    ds_read_b64_tr_b16 v[32:33], v190 offset:256
    s_waitcnt lgkmcnt(5)
    v_mov_b64 v[144:145], 0
    v_smfmac_f32_16x16x64_bf16 v[124:127], v[20:23], a[168:175], v8
    ds_read_b64_tr_b16 v[34:35], v190 offset:288
    s_waitcnt lgkmcnt(4)
    v_mov_b64 v[146:147], 0
    v_smfmac_f32_16x16x64_bf16 v[124:127], v[24:27], a[176:183], v8
    ds_read_b64_tr_b16 v[36:37], v190 offset:2304
    s_waitcnt lgkmcnt(3)
    v_mov_b64 v[148:149], 0
    v_smfmac_f32_16x16x64_bf16 v[124:127], v[28:31], a[184:191], v8
    ds_read_b64_tr_b16 v[38:39], v190 offset:2336
    v_mov_b64 v[150:151], 0
    v_smfmac_f32_16x16x64_bf16 v[128:131], v[16:19], a[192:199], v8
    ds_read_b64_tr_b16 v[40:41], v190 offset:4352
    v_mov_b64 v[152:153], 0
    v_smfmac_f32_16x16x64_bf16 v[128:131], v[20:23], a[200:207], v8
    ds_read_b64_tr_b16 v[42:43], v190 offset:4384
    v_mov_b64 v[154:155], 0
    v_smfmac_f32_16x16x64_bf16 v[128:131], v[24:27], a[208:215], v8
    ds_read_b64_tr_b16 v[44:45], v190 offset:6400
    v_mov_b64 v[156:157], 0
    v_smfmac_f32_16x16x64_bf16 v[128:131], v[28:31], a[216:223], v8
    ds_read_b64_tr_b16 v[46:47], v190 offset:6432
    v_mov_b64 v[158:159], 0
    v_smfmac_f32_16x16x64_bf16 v[132:135], v[16:19], a[224:231], v8
    buffer_load_dwordx4 v[48:51], v15, s[8:11], s77 offen offset:0 sc1
    s_add_u32 s74, s62, s68
    s_add_u32 s75, s61, s68
    v_mov_b64 v[160:161], 0
    v_smfmac_f32_16x16x64_bf16 v[132:135], v[20:23], a[232:239], v8
    buffer_load_dwordx4 v[52:55], v15, s[8:11], s77 offen offset:1024 sc1
    s_add_u32 s31, s31, 1
    s_and_b32 s28, s31, 3
    v_mov_b64 v[162:163], 0
    v_smfmac_f32_16x16x64_bf16 v[132:135], v[24:27], a[240:247], v8
    s_lshl_b32 s28, s28, 15
    s_add_u32 s32, s28, s51
    v_smfmac_f32_16x16x64_bf16 v[132:135], v[28:31], a[248:255], v8
    s_add_u32 s33, s32, s36
    s_add_u32 s34, s33, 4096
    v_smfmac_f32_16x16x64_bf16 v[136:139], v[16:19], v[192:199], v8
    s_add_u32 s35, s32, s37
    v_smfmac_f32_16x16x64_bf16 v[136:139], v[20:23], v[200:207], v8
    v_smfmac_f32_16x16x64_bf16 v[136:139], v[24:27], v[208:215], v8
    v_smfmac_f32_16x16x64_bf16 v[136:139], v[28:31], v[216:223], v8
    v_smfmac_f32_16x16x64_bf16 v[140:143], v[16:19], v[224:231], v8
    buffer_load_dwordx4 v[48:51], v15, s[8:11], s77 offen offset:0 sc1
    v_smfmac_f32_16x16x64_bf16 v[140:143], v[20:23], v[232:239], v8
    buffer_load_dwordx4 v[52:55], v15, s[8:11], s77 offen offset:1024 sc1
    v_smfmac_f32_16x16x64_bf16 v[140:143], v[24:27], v[240:247], v8
    v_smfmac_f32_16x16x64_bf16 v[140:143], v[28:31], v[248:255], v8
    s_cmp_eq_u32 s63, 1
    s_cbranch_scc1 SV_RE
SV_RD:
    s_waitcnt lgkmcnt(0)
    s_branch SV_LOOP
SV_LAST:
    buffer_store_dwordx4 v[64:67], v6, s[8:11], s39 offen offset:1024 sc1
    s_waitcnt vmcnt(0)
    s_barrier
    s_cmp_eq_u32 s17, 0
    s_cbranch_scc0 SV_LA
    s_lshl_b32 s28, s18, 8
    s_add_u32 s28, s28, 1048704
    v_mov_b32 v188, 0
    v_mov_b32 v189, 128
    s_mov_b64 exec, 1
    buffer_store_dword v189, v188, s[8:11], s28 offen sc1
    s_mov_b64 exec, -1
SV_LA:
    s_branch T_EXIT
SV_SLOW:
    s_nop 15
    s_waitcnt vmcnt(0)
SV_SL1:
    buffer_load_dwordx4 v[164:167], v1, s[8:11], s48 offen offset:1024 sc1
    buffer_load_dwordx4 v[168:171], v1, s[8:11], s48 offen offset:1280 sc1
    buffer_load_dwordx2 v[172:173], v0, s[8:11], s48 offen offset:1536 sc1
    s_add_u32 s30, s30, 1
    s_cmp_gt_u32 s30, 600000
    s_cbranch_scc1 T_EXIT
    s_waitcnt vmcnt(0)
    v_min3_i32 v12, v164, v165, v166
    v_min3_i32 v12, v12, v167, v168
    v_min3_i32 v12, v12, v169, v170
    v_min3_i32 v12, v12, v171, v172
    v_min_i32 v12, v12, v173
    v_cmp_gt_i32 vcc, 0, v12
    s_nop 0
    s_cbranch_vccnz SV_SL1
    s_barrier
    v_mov_b32 v60, -1
    v_mov_b32 v61, -1
    v_mov_b32 v62, -1
    v_mov_b32 v63, -1
    buffer_store_dwordx4 v[60:63], v6, s[8:11], s48 offen offset:1024 sc1
    v_mfma_f32_16x16x32_bf16 v[56:59], v[164:167], v[178:181], 0
    v_mfma_f32_16x16x32_bf16 v[56:59], v[168:171], v[178:181], v[56:59]
    v_mfma_f32_16x16x32_bf16 v[56:59], v[172:175], v[178:181], v[56:59]
    v_mfma_f32_16x16x32_bf16 v[160:163], v[164:167], v[108:111], 0
    v_mfma_f32_16x16x32_bf16 v[160:163], v[168:171], v[112:115], v[160:163]
    v_mfma_f32_16x16x32_bf16 v[160:163], v[172:175], v[116:119], v[160:163]
    v_mfma_f32_16x16x32_bf16 v[144:147], v[164:167], v[68:71], 0
    v_mfma_f32_16x16x32_bf16 v[144:147], v[168:171], v[72:75], v[144:147]
    v_mfma_f32_16x16x32_bf16 v[144:147], v[172:175], v[76:79], v[144:147]
    v_rcp_f32 v60, v56
    v_rcp_f32 v61, v57
    v_rcp_f32 v62, v58
    v_rcp_f32 v63, v59
    s_waitcnt vmcnt(0)
    s_nop 15
    s_branch SV_GO
SV_CK:
    s_bitcmp1_b32 s28, 0
    s_cselect_b32 s29, 1, 0
    s_lshr_b32 s28, s28, 3
    s_lshl_b32 s28, s28, 2
    s_add_u32 s28, s28, 208
    s_cmp_eq_u32 s29, 1
    s_cbranch_scc1 SV_CKT
    v_mov_b32 v188, 0
    buffer_load_dword v189, v188, s[4:7], s28 offen sc1
    s_branch SV_CKR
SV_CKT:
    v_readfirstlane_b32 s29, v189
    s_nop 0
    s_cmp_ge_u32 s29, 1
    s_cbranch_scc1 SV_CKR
    v_mov_b32 v188, 0
SV_CKW:
    buffer_load_dword v189, v188, s[4:7], s28 offen sc1
    s_add_u32 s3, s3, 1
    s_cmp_gt_u32 s3, 2000000
    s_cbranch_scc1 K_END
    s_waitcnt vmcnt(0)
    v_readfirstlane_b32 s29, v189
    s_nop 0
    s_cmp_ge_u32 s29, 1
    s_cbranch_scc1 SV_CKW_OK
    s_sleep 2
    s_branch SV_CKW
SV_CKW_OK:
    s_branch SV_CKR
SV_GAS:
    buffer_load_dwordx4 v[16:19], v182, s[8:11], s33 offen offset:0 sc1
    buffer_load_dwordx4 v[20:23], v182, s[8:11], s33 offen offset:512 sc1
    buffer_load_dwordx4 v[24:27], v182, s[8:11], s34 offen offset:0 sc1
    buffer_load_dwordx4 v[28:31], v182, s[8:11], s34 offen offset:512 sc1
    buffer_load_dwordx4 v[52:55], v182, s[8:11], s35 offen offset:0 sc1
    s_add_u32 s30, s30, 1
    s_cmp_gt_u32 s30, 600000
    s_cbranch_scc1 T_EXIT
    s_branch SV_GA
SV_PTS0:
    buffer_load_dwordx4 v[164:167], v1, s[8:11], s48 offen offset:0 sc1
    buffer_load_dwordx4 v[168:171], v1, s[8:11], s48 offen offset:256 sc1
    buffer_load_dwordx2 v[172:173], v0, s[8:11], s48 offen offset:512 sc1
    s_add_u32 s30, s30, 1
    s_cmp_gt_u32 s30, 600000
    s_cbranch_scc1 T_EXIT
    s_branch SV_PT0
SV_PT1:
    s_waitcnt vmcnt(3)
    v_max3_i32 v12, v164, v165, v166
    v_max3_i32 v13, v167, v168, v169
    v_max3_i32 v11, v170, v171, v172
    v_mfma_f32_16x16x32_bf16 v[56:59], v[164:167], v[178:181], 0
    v_max3_i32 v12, v12, v13, v173
    v_mfma_f32_16x16x32_bf16 v[56:59], v[168:171], v[178:181], v[56:59]
    v_max_i32 v12, v12, v11
    v_mfma_f32_16x16x32_bf16 v[56:59], v[172:175], v[178:181], v[56:59]
    v_cmp_le_i32 vcc, 0, v12
    v_mfma_f32_16x16x32_bf16 v[160:163], v[164:167], v[108:111], 0
    s_nop 0
    s_and_b64 vcc, vcc, s[64:65]
    s_cbranch_vccnz SV_PTS1
    s_branch SV_PTG
SV_PTS1:
    buffer_load_dwordx4 v[164:167], v1, s[8:11], s48 offen offset:0 sc1
    buffer_load_dwordx4 v[168:171], v1, s[8:11], s48 offen offset:256 sc1
    buffer_load_dwordx2 v[172:173], v0, s[8:11], s48 offen offset:512 sc1
    s_add_u32 s30, s30, 1
    s_cmp_gt_u32 s30, 600000
    s_cbranch_scc1 T_EXIT
    s_branch SV_PT1
SV_RES:
    buffer_load_dwordx4 v[48:51], v15, s[8:11], s77 offen offset:0 sc1
    buffer_load_dwordx4 v[52:55], v15, s[8:11], s77 offen offset:1024 sc1
    s_add_u32 s30, s30, 1
    s_cmp_gt_u32 s30, 600000
    s_cbranch_scc1 T_EXIT
    s_branch SV_RE
SV_RE:
    s_waitcnt vmcnt(3)
    v_max_u32 v12, v48, v49
    v_max_u32 v13, v50, v51
    v_mfma_f32_16x16x32_bf16 v[56:59], v[48:51], v[184:187], 0
    s_waitcnt vmcnt(2)
    v_max3_u32 v12, v12, v52, v53
    v_max3_u32 v13, v13, v54, v55
    v_mfma_f32_16x16x32_bf16 v[56:59], v[52:55], v[184:187], v[56:59]
    v_max_u32 v12, v12, v13
    v_cmp_eq_u32 vcc, -1, v12
    s_nop 0
    s_cbranch_vccnz SV_RES
    s_nop 3
    v_permlane32_swap_b32 v56, v58
    v_permlane32_swap_b32 v57, v59
    v_add_f32 v56, v56, v58
    v_add_f32 v57, v57, v59
    v_cvt_pk_bf16_f32 v56, v56, v57
    buffer_store_dword v56, v191, s[8:11], s75 offen sc1
    buffer_store_dword v56, v191, s[8:11], s74 offen sc1
    s_branch SV_RD
.section .rodata,"a"
.p2align 6
.amdhsa_kernel main_kernel
  .amdhsa_next_free_vgpr 512
  .amdhsa_next_free_sgpr 102
  .amdhsa_accum_offset 256
  .amdhsa_group_segment_fixed_size 0
  .amdhsa_kernarg_size 112
  .amdhsa_user_sgpr_count 2
  .amdhsa_user_sgpr_kernarg_segment_ptr 1
  .amdhsa_system_sgpr_workgroup_id_x 1
.end_amdhsa_kernel
```
